```python
import torch

def _softmax(x, axis=-1):
    return torch.softmax(x, dim=axis)

def _gelu(x):
    return torch.nn.functional.gelu(x, approximate='tanh')

def _silu(x):
    return torch.nn.functional.silu(x)

def _sigmoid(x):
    return torch.sigmoid(x)

def _layernorm(x, axis=-1, eps=1e-05):
    m = x.mean(dim=axis, keepdim=True)
    v = x.var(dim=axis, keepdim=True, unbiased=False)
    return (x - m) / torch.sqrt(v + eps)

def _scatter_add(tgt, idx, src, axis=0):
    return tgt.clone().index_add_(axis, idx, src)

def _segment_sum(src, seg, n):
    out = torch.zeros((n,) + src.shape[1:], dtype=src.dtype)
    return out.index_add_(0, seg, src)

def _pad(x, pw):
    flat = tuple((v for pair in reversed(pw) for v in pair))
    return torch.nn.functional.pad(x, flat)
kernel_name = 'sequential_preLN__memory_aug_recurrent_mem_tr__glu_gated_swiglu__prompt'

def setup_inputs():

    _w = lambda a: (lambda t: t.to(torch.bfloat16) if t.is_floating_point() else t)(torch.as_tensor(a))

    def _A_setup():
        B, S, Dm = (1, 2048, 1024)
        H, Dh = (32, 128)
        M, seg = (8, 32)
        seg = min(seg, S)
        S = S // seg * seg
        return {'x': _w((lambda *s: torch.randn(*s, dtype=torch.bfloat16) * 0.05)(B, S, Dm)), 'mem0': _w((lambda *s: torch.randn(*s, dtype=torch.bfloat16) * 0.2)(B, M, Dm)), 'Wq': _w((lambda *s: torch.randn(*s, dtype=torch.bfloat16) * 1.6)(Dm, H, Dh) * Dm ** (-0.5)), 'Wk': _w((lambda *s: torch.randn(*s, dtype=torch.bfloat16) * 1.6)(Dm, H, Dh) * Dm ** (-0.5)), 'Wv': _w((lambda *s: torch.randn(*s, dtype=torch.bfloat16) * 0.2)(Dm, H, Dh) * Dm ** (-0.5)), 'Wo': _w((lambda *s: torch.randn(*s, dtype=torch.bfloat16) * 0.2)(H, Dh, Dm) * (H * Dh) ** (-0.5)), 'seg_len': seg}
    _A_in = _A_setup()

    def _B_setup():
        B, S, D, F = (1, 2048, 1024, 3584)
        return {'x': _w((lambda *s: torch.randn(*s, dtype=torch.bfloat16) * 0.05)(B, S, D)), 'w1': _w((lambda *s: torch.randn(*s, dtype=torch.bfloat16) * 0.2)(D, F) * (2.0 / D) ** 0.5), 'w3': _w((lambda *s: torch.randn(*s, dtype=torch.bfloat16) * 0.2)(D, F) * (2.0 / D) ** 0.5), 'w2': _w((lambda *s: torch.randn(*s, dtype=torch.bfloat16) * 0.2)(F, D) * (2.0 / F) ** 0.5)}
    _B_in = _B_setup()
    return {'A_x': _A_in['x'], 'A_mem0': _A_in['mem0'], 'A_Wq': _A_in['Wq'], 'A_Wk': _A_in['Wk'], 'A_Wv': _A_in['Wv'], 'A_Wo': _A_in['Wo'], 'A_seg_len': _A_in['seg_len'], 'B_x': _B_in['x'], 'B_w1': _B_in['w1'], 'B_w3': _B_in['w3'], 'B_w2': _B_in['w2']}

def reference(A_x, A_mem0, A_Wq, A_Wk, A_Wv, A_Wo, A_seg_len, B_x, B_w1, B_w3, B_w2):

    def _A_ref(x, mem0, Wq, Wk, Wv, Wo, seg_len):
        B, S, Dm = x.shape
        H, Dh = (Wq.shape[1], Wq.shape[2])
        M = mem0.shape[1]
        scale = Dh ** (-0.5)
        n_seg = S // seg_len
        L = M + seg_len
        idx = torch.arange(L)
        mask = (idx[:, None] < M) | (idx[:, None] >= idx[None, :])
        mem = mem0
        outs = []
        for s in range(n_seg):
            xs = x[:, s * seg_len:(s + 1) * seg_len, :].clone()
            h = torch.concatenate([mem, xs], axis=1)
            q = torch.einsum('btd,dhe->bhte', h, Wq)
            k = torch.einsum('btd,dhe->bhte', h, Wk)
            v = torch.einsum('btd,dhe->bhte', h, Wv)
            scores = torch.einsum('bhqe,bhke->bhqk', q, k) * scale
            scores = torch.where(mask[None, None], scores, -1000000000.0)
            p = _softmax(scores, axis=-1)
            o = torch.einsum('bhqk,bhke->bhqe', p, v)
            o = torch.einsum('bhte,hed->btd', o, Wo)
            mem = o[:, :M, :].clone()
            outs.append(o[:, M:, :])
        return torch.concatenate(outs, axis=1)

    def _B_ref(x, w1, w3, w2):
        gate = torch.einsum('bsd,df->bsf', x, w1)
        up = torch.einsum('bsd,df->bsf', x, w3)
        h = _silu(gate) * up
        out = torch.einsum('bsf,fd->bsd', h, w2)
        return out
    x = A_x
    h = x + _A_ref(_layernorm(x, axis=-1), A_mem0, A_Wq, A_Wk, A_Wv, A_Wo, A_seg_len)
    h2 = h + _B_ref(_layernorm(h, axis=-1), B_w1, B_w3, B_w2)
    return h2
```

```asm
; @launch kernel=mega_kernel grid=(256,1,1) block=(256,1,1) lds=132096
.amdgcn_target "amdgcn-amd-amdhsa--gfx950"
.text
.globl mega_kernel
.p2align 8
.type mega_kernel,@function
mega_kernel:
    s_cmp_ge_u32 s2, 256
    s_cbranch_scc1 ch_exit
    s_load_dwordx2 s[4:5], s[0:1], 104
    s_load_dwordx2 s[6:7], s[0:1], 0
    s_load_dwordx2 s[34:35], s[0:1], 8
    s_load_dwordx2 s[72:73], s[0:1], 96
    s_getreg_b32 s24, hwreg(HW_REG_XCC_ID,0,4)
    s_and_b32 s24, s24, 7
    s_lshl_b32 s24, s24, 2
    s_lshr_b32 s24, 0x73625140, s24
    s_and_b32 s24, s24, 7
    v_lshrrev_b32 v1, 6, v0
    v_and_b32 v0, 63, v0
    v_readfirstlane_b32 s28, v1
    s_and_b32 s21, s24, 3
    s_lshl_b32 s21, s21, 6
    s_lshr_b32 s22, s24, 2
    s_lshl_b32 s22, s22, 2
    s_add_u32 s21, s21, s22
    v_mov_b32 v4, 0x3fc
    s_waitcnt lgkmcnt(0)
    s_mov_b32 s74, 256
    s_mov_b32 s75, 0x20000
    s_cmp_lg_u32 s28, 0
    s_cbranch_scc1 tk_1
    v_mov_b32 v3, 1
    s_mov_b64 exec, 1
    buffer_atomic_add v3, off, s[72:75], s21 sc0
    s_waitcnt vmcnt(0)
    ds_write_b32 v4, v3
    s_mov_b64 exec, -1
tk_1:
    s_waitcnt lgkmcnt(0)
    s_barrier
    ds_read_b32 v3, v4
    s_waitcnt lgkmcnt(0)
    v_readfirstlane_b32 s25, v3
    s_barrier
    s_nop 2
    s_cmp_ge_u32 s25, 32
    s_cbranch_scc1 ch_ovf
ch_role:
    s_cmp_ge_u32 s24, 4
    s_cbranch_scc1 g_entry
    s_lshr_b32 s54, s25, 4
    s_lshl_b32 s26, s24, 1
    s_add_u32 s26, s26, s54
    s_and_b32 s27, s25, 15
    s_lshr_b32 s50, s27, 2
    s_and_b32 s51, s27, 3
    s_lshl_b32 s54, s26, 2
    s_add_u32 s52, s54, s50
    s_add_u32 s53, s54, s28
    v_and_b32 v6, 15, v0
    v_lshrrev_b32 v7, 4, v0
    v_mov_b32 v244, 0x44444444
    v_mov_b32 v245, 0xeeeeeeee
    v_cmp_gt_u32 vcc, 8, v6
    s_nop 1
    v_cndmask_b32 v1, v245, v244, vcc
    v_and_b32 v244, 7, v6
    v_lshlrev_b32 v245, 2, v7
    v_sub_u32 v246, v244, v245
    v_add_u32 v247, 8, v246
    v_mov_b32 v248, 0x3f80
    v_mov_b32 v249, 0x3f800000
    v_cmp_eq_u32 vcc, 0, v246
    s_nop 1
    v_cndmask_b32 v2, 0, v248, vcc
    v_cmp_eq_u32 vcc, 1, v246
    s_nop 1
    v_cndmask_b32 v2, v2, v249, vcc
    v_cmp_eq_u32 vcc, 2, v246
    s_nop 1
    v_cndmask_b32 v3, 0, v248, vcc
    v_cmp_eq_u32 vcc, 3, v246
    s_nop 1
    v_cndmask_b32 v3, v3, v249, vcc
    v_cmp_eq_u32 vcc, 0, v247
    s_nop 1
    v_cndmask_b32 v4, 0, v248, vcc
    v_cmp_eq_u32 vcc, 1, v247
    s_nop 1
    v_cndmask_b32 v4, v4, v249, vcc
    v_cmp_eq_u32 vcc, 2, v247
    s_nop 1
    v_cndmask_b32 v5, 0, v248, vcc
    v_cmp_eq_u32 vcc, 3, v247
    s_nop 1
    v_cndmask_b32 v5, v5, v249, vcc
    v_add_u32 v247, -8, v6
    v_cmp_eq_u32 vcc, 0, v6
    s_nop 1
    v_cndmask_b32 v36, 0, v248, vcc
    v_cmp_eq_u32 vcc, 1, v6
    s_nop 1
    v_cndmask_b32 v36, v36, v249, vcc
    v_cmp_eq_u32 vcc, 2, v6
    s_nop 1
    v_cndmask_b32 v37, 0, v248, vcc
    v_cmp_eq_u32 vcc, 3, v6
    s_nop 1
    v_cndmask_b32 v37, v37, v249, vcc
    v_cmp_eq_u32 vcc, 4, v6
    s_nop 1
    v_cndmask_b32 v38, 0, v248, vcc
    v_cmp_eq_u32 vcc, 5, v6
    s_nop 1
    v_cndmask_b32 v38, v38, v249, vcc
    v_cmp_eq_u32 vcc, 6, v6
    s_nop 1
    v_cndmask_b32 v39, 0, v248, vcc
    v_cmp_eq_u32 vcc, 7, v6
    s_nop 1
    v_cndmask_b32 v39, v39, v249, vcc
    v_cmp_eq_u32 vcc, 0, v247
    s_nop 1
    v_cndmask_b32 v240, 0, v248, vcc
    v_cmp_eq_u32 vcc, 1, v247
    s_nop 1
    v_cndmask_b32 v240, v240, v249, vcc
    v_cmp_eq_u32 vcc, 2, v247
    s_nop 1
    v_cndmask_b32 v241, 0, v248, vcc
    v_cmp_eq_u32 vcc, 3, v247
    s_nop 1
    v_cndmask_b32 v241, v241, v249, vcc
    v_cmp_eq_u32 vcc, 4, v247
    s_nop 1
    v_cndmask_b32 v242, 0, v248, vcc
    v_cmp_eq_u32 vcc, 5, v247
    s_nop 1
    v_cndmask_b32 v242, v242, v249, vcc
    v_cmp_eq_u32 vcc, 6, v247
    s_nop 1
    v_cndmask_b32 v243, 0, v248, vcc
    v_cmp_eq_u32 vcc, 7, v247
    s_nop 1
    v_cndmask_b32 v243, v243, v249, vcc
    v_mov_b32 v8, 0x3f803f80
    v_mov_b32 v16, -1
    v_mov_b32 v9, 0x3f803f80
    v_mov_b32 v17, -1
    v_mov_b32 v10, 0x3f803f80
    v_mov_b32 v18, -1
    v_mov_b32 v11, 0x3f803f80
    v_mov_b32 v19, -1
    v_cmp_lt_u32 vcc, 1, v7
    s_nop 1
    v_cndmask_b32 v12, 0, -1, vcc
    v_and_b32 v15, 4, v6
    v_lshrrev_b32 v244, 3, v6
    v_lshl_add_u32 v15, v244, 1, v15
    v_and_b32 v244, 1, v6
    v_add_u32 v15, v15, v244
    v_lshlrev_b32 v245, 2, v7
    v_sub_u32 v246, v15, v245
    v_add_u32 v247, 8, v246
    v_cmp_eq_u32 vcc, 0, v246
    s_nop 1
    v_cndmask_b32 v68, 0, v248, vcc
    v_cmp_eq_u32 vcc, 1, v246
    s_nop 1
    v_cndmask_b32 v68, v68, v249, vcc
    v_cmp_eq_u32 vcc, 2, v246
    s_nop 1
    v_cndmask_b32 v69, 0, v248, vcc
    v_cmp_eq_u32 vcc, 3, v246
    s_nop 1
    v_cndmask_b32 v69, v69, v249, vcc
    v_cmp_eq_u32 vcc, 0, v247
    s_nop 1
    v_cndmask_b32 v70, 0, v248, vcc
    v_cmp_eq_u32 vcc, 1, v247
    s_nop 1
    v_cndmask_b32 v70, v70, v249, vcc
    v_cmp_eq_u32 vcc, 2, v247
    s_nop 1
    v_cndmask_b32 v71, 0, v248, vcc
    v_cmp_eq_u32 vcc, 3, v247
    s_nop 1
    v_cndmask_b32 v71, v71, v249, vcc
    s_mov_b32 s49, 0x3e0293ee
    v_lshlrev_b32 v250, 4, v0
    s_lshl_b32 s54, s25, 12
    s_add_u32 s54, s54, 0x0
    v_add_u32 v20, s54, v250
    s_lshl_b32 s54, s24, 14
    s_add_u32 s54, s54, 0x40000
    s_lshl_b32 s55, s25, 9
    s_add_u32 s55, s55, s54
    v_lshrrev_b32 v244, 1, v7
    v_lshlrev_b32 v244, 8, v244
    v_lshl_add_u32 v244, v6, 4, v244
    v_and_b32 v245, 1, v7
    v_lshl_add_u32 v244, v245, 3, v244
    v_add_u32 v21, s55, v244
    s_lshl_b32 s55, s28, 12
    s_add_u32 s55, s55, s54
    v_add_u32 v22, s55, v250
    s_lshl_b32 s54, s26, 14
    s_add_u32 s54, s54, 0x50000
    s_lshl_b32 s55, s28, 12
    s_add_u32 s55, s55, s54
    v_add_u32 v24, s55, v250
    s_lshl_b32 s55, s27, 10
    s_add_u32 s55, s55, s54
    v_add_u32 v251, s55, v250
    s_lshl_b32 s54, s26, 13
    s_add_u32 s54, s54, 0x70000
    s_lshl_b32 s55, s28, 11
    s_add_u32 s55, s55, s54
    v_add_u32 v25, s55, v250
    s_lshr_b32 s55, s27, 1
    s_lshl_b32 s55, s55, 10
    s_add_u32 s55, s55, s54
    v_add_u32 v252, s55, v250
    v_lshrrev_b32 v244, 3, v6
    s_and_b32 s54, s51, 1
    s_cmp_eq_u32 s28, 2
    s_cselect_b32 s54, s54, s28
    s_cselect_b64 vcc, -1, 0
    v_cndmask_b32 v245, v251, v252, vcc
    v_cmp_eq_u32 vcc, s54, v244
    v_mov_b32 v246, 0x80000000
    s_nop 0
    v_cndmask_b32 v23, v246, v245, vcc
    s_lshl_b32 s54, s26, 12
    s_add_u32 s54, s54, 0x20000
    s_lshl_b32 s55, s28, 10
    s_add_u32 s55, s55, s54
    v_add_u32 v14, s55, v250
    s_lshl_b32 s55, s50, 10
    s_add_u32 s54, s54, s55
    s_lshl_b32 s55, s51, 2
    s_add_u32 s54, s54, s55
    v_add_u32 v245, s54, v250
    s_cmp_eq_u32 s28, 0
    s_cselect_b64 vcc, -1, 0
    v_cndmask_b32 v23, v23, v251, vcc
    s_cmp_eq_u32 s28, 1
    s_cselect_b64 vcc, -1, 0
    v_cndmask_b32 v23, v23, v245, vcc
    s_lshl_b32 s54, s52, 12
    s_lshl_b32 s55, s51, 10
    s_add_u32 s54, s54, s55
    v_add_u32 v245, s54, v250
    s_cmp_eq_u32 s28, 0
    s_cselect_b64 vcc, -1, 0
    v_cndmask_b32 v13, v246, v245, vcc
    s_lshl_b32 s54, s52, 11
    s_lshl_b32 s55, s51, 9
    s_add_u32 s54, s54, s55
    s_cmp_eq_u32 s28, 2
    s_cselect_b32 s55, 0x400000, 0
    s_add_u32 s54, s54, s55
    v_lshlrev_b32 v244, 3, v7
    v_add_u32 v244, v244, v6
    v_lshlrev_b32 v244, 4, v244
    v_add_u32 v244, s54, v244
    s_sub_u32 s55, s28, 1
    s_cmp_lt_u32 s55, 2
    s_cselect_b32 s55, 8, 0
    v_cmp_gt_u32 vcc, s55, v6
    s_nop 1
    v_cndmask_b32 v28, v246, v244, vcc
    v_lshlrev_b32 v244, 3, v7
    v_add_u32 v244, v244, v15
    v_lshlrev_b32 v244, 4, v244
    v_add_u32 v244, s54, v244
    v_and_b32 v245, 2, v6
    v_cmp_eq_u32 vcc, 0, v245
    s_nop 1
    v_cndmask_b32 v244, v246, v244, vcc
    s_cmp_eq_u32 s28, 1
    s_cselect_b64 vcc, -1, 0
    v_cndmask_b32 v28, v28, v244, vcc
    v_and_b32 v244, 7, v6
    v_lshrrev_b32 v245, 1, v7
    v_lshl_add_u32 v244, v245, 3, v244
    v_lshlrev_b32 v244, 4, v244
    v_lshrrev_b32 v245, 3, v6
    v_lshl_add_u32 v244, v245, 11, v244
    s_lshl_b32 s54, s27, 1
    s_add_u32 s54, s54, s28
    s_lshl_b32 s54, s54, 12
    s_lshl_b32 s55, s26, 8
    s_add_u32 s54, s54, s55
    s_add_u32 s54, s54, 0x0
    v_add_u32 v244, s54, v244
    s_cmp_lt_u32 s28, 2
    s_cselect_b32 s55, 0, 3
    v_and_b32 v245, 1, v7
    v_cmp_eq_u32 vcc, s55, v245
    s_nop 1
    v_cndmask_b32 v26, v246, v244, vcc
    s_lshl_b32 s54, s53, 12
    v_add_u32 v27, s54, v250
    s_lshl_b32 s54, s25, 6
    v_add_u32 v244, s54, v0
    v_lshrrev_b32 v245, 10, v244
    v_lshlrev_b32 v245, 24, v245
    v_bfe_u32 v247, v244, 9, 1
    v_lshl_add_u32 v245, v247, 17, v245
    v_and_b32 v247, 511, v244
    v_lshl_add_u32 v245, v247, 6, v245
    s_lshl_b32 s54, s24, 15
    v_add_u32 v29, s54, v245
    s_lshl_b32 s54, s28, 10
    v_add_u32 v30, s54, v250
    s_min_u32 s54, s28, 2
    s_lshl_b32 s54, s54, 12
    v_mov_b32 v31, v250
    s_lshl_b32 s54, s28, 12
    s_cmp_eq_u32 s28, 3
    s_cselect_b32 s54, 0, s54
    v_add_u32 v35, s54, v31
    s_lshl_b32 s54, s28, 11
    s_add_u32 s54, s54, 0x3000
    v_add_u32 v32, s54, v250
    s_and_b32 s54, s28, 1
    s_lshl_b32 s54, s54, 10
    s_add_u32 s54, s54, 0x3000
    v_add_u32 v33, s54, v250
    s_add_u32 s8, s4, 0x6400000
    s_addc_u32 s9, s5, 0
    s_mov_b32 s10, 0x200000
    s_mov_b32 s11, 0x20000
    s_add_u32 s12, s4, 0x1400000
    s_addc_u32 s13, s5, 0
    s_mov_b32 s14, 0x2000000
    s_mov_b32 s15, 0x20000
    s_add_u32 s16, s4, 0x3400000
    s_addc_u32 s17, s5, 0
    s_mov_b32 s18, 0x800000
    s_mov_b32 s19, 0x20000
    s_mov_b32 s30, 0x0
    s_mov_b32 s31, 0x80000
    s_mov_b32 s32, 0x100000
    s_mov_b32 s33, 0x180000
    v_lshrrev_b32 v244, 2, v0
    v_lshlrev_b32 v244, 13, v244
    v_and_b32 v245, 3, v0
    v_lshl_add_u32 v244, v245, 4, v244
    s_lshl_b32 s54, s52, 8
    s_lshl_b32 s55, s51, 6
    s_add_u32 s54, s54, s55
    s_lshl_b32 s55, s28, 21
    s_add_u32 s54, s54, s55
    v_add_u32 v244, s54, v244
    v_lshrrev_b32 v245, 3, v0
    v_lshlrev_b32 v245, 11, v245
    v_and_b32 v246, 7, v0
    v_lshl_add_u32 v245, v246, 4, v245
    s_lshl_b32 s54, s53, 18
    s_lshl_b32 s55, s27, 7
    s_add_u32 s54, s54, s55
    v_add_u32 v245, s54, v245
    v_lshrrev_b32 v246, 5, v0
    v_lshlrev_b32 v246, 4, v246
    v_bfe_u32 v247, v0, 4, 1
    v_lshl_add_u32 v246, v247, 2, v246
    v_bfe_u32 v247, v0, 2, 1
    v_add_u32 v246, v246, v247
    v_bfe_u32 v247, v0, 3, 1
    v_lshl_add_u32 v246, v247, 3, v246
    v_lshlrev_b32 v246, 6, v246
    v_and_b32 v247, 3, v0
    v_lshl_add_u32 v246, v247, 3, v246
    s_lshl_b32 s56, s28, 15
    v_add_u32 v246, s56, v246
    v_lshrrev_b32 v248, 2, v0
    v_lshlrev_b32 v248, 7, v248
    v_lshl_add_u32 v248, v247, 3, v248
    v_add_u32 v248, s56, v248
    v_add_u32 v248, 0x4000, v248
    s_add_u32 s57, s56, 0x4000
    s_load_dwordx2 s[20:21], s[0:1], 16
    s_waitcnt lgkmcnt(0)
    s_mov_b32 s22, 0x800000
    s_mov_b32 s23, 0x20000
    s_mov_b32 s55, 0
    s_mov_b32 m0, s56
    s_nop 0
    buffer_load_dwordx4 v244, s[20:23], s55 offen lds
    s_add_u32 s55, s55, 0x20000
    s_add_u32 m0, m0, 1024
    s_nop 0
    buffer_load_dwordx4 v244, s[20:23], s55 offen lds
    s_add_u32 s55, s55, 0x20000
    s_add_u32 m0, m0, 1024
    s_nop 0
    buffer_load_dwordx4 v244, s[20:23], s55 offen lds
    s_add_u32 s55, s55, 0x20000
    s_add_u32 m0, m0, 1024
    s_nop 0
    buffer_load_dwordx4 v244, s[20:23], s55 offen lds
    s_add_u32 s55, s55, 0x20000
    s_add_u32 m0, m0, 1024
    s_nop 0
    buffer_load_dwordx4 v244, s[20:23], s55 offen lds
    s_add_u32 s55, s55, 0x20000
    s_add_u32 m0, m0, 1024
    s_nop 0
    buffer_load_dwordx4 v244, s[20:23], s55 offen lds
    s_add_u32 s55, s55, 0x20000
    s_add_u32 m0, m0, 1024
    s_nop 0
    buffer_load_dwordx4 v244, s[20:23], s55 offen lds
    s_add_u32 s55, s55, 0x20000
    s_add_u32 m0, m0, 1024
    s_nop 0
    buffer_load_dwordx4 v244, s[20:23], s55 offen lds
    s_add_u32 s55, s55, 0x20000
    s_add_u32 m0, m0, 1024
    s_nop 0
    buffer_load_dwordx4 v244, s[20:23], s55 offen lds
    s_add_u32 s55, s55, 0x20000
    s_add_u32 m0, m0, 1024
    s_nop 0
    buffer_load_dwordx4 v244, s[20:23], s55 offen lds
    s_add_u32 s55, s55, 0x20000
    s_add_u32 m0, m0, 1024
    s_nop 0
    buffer_load_dwordx4 v244, s[20:23], s55 offen lds
    s_add_u32 s55, s55, 0x20000
    s_add_u32 m0, m0, 1024
    s_nop 0
    buffer_load_dwordx4 v244, s[20:23], s55 offen lds
    s_add_u32 s55, s55, 0x20000
    s_add_u32 m0, m0, 1024
    s_nop 0
    buffer_load_dwordx4 v244, s[20:23], s55 offen lds
    s_add_u32 s55, s55, 0x20000
    s_add_u32 m0, m0, 1024
    s_nop 0
    buffer_load_dwordx4 v244, s[20:23], s55 offen lds
    s_add_u32 s55, s55, 0x20000
    s_add_u32 m0, m0, 1024
    s_nop 0
    buffer_load_dwordx4 v244, s[20:23], s55 offen lds
    s_add_u32 s55, s55, 0x20000
    s_add_u32 m0, m0, 1024
    s_nop 0
    buffer_load_dwordx4 v244, s[20:23], s55 offen lds
    s_load_dwordx2 s[20:21], s[0:1], 24
    s_waitcnt lgkmcnt(0)
    s_mov_b32 s22, 0x800000
    s_mov_b32 s23, 0x20000
    s_mov_b32 s55, 0
    s_mov_b32 m0, s57
    s_nop 0
    buffer_load_dwordx4 v244, s[20:23], s55 offen lds
    s_add_u32 s55, s55, 0x20000
    s_add_u32 m0, m0, 1024
    s_nop 0
    buffer_load_dwordx4 v244, s[20:23], s55 offen lds
    s_add_u32 s55, s55, 0x20000
    s_add_u32 m0, m0, 1024
    s_nop 0
    buffer_load_dwordx4 v244, s[20:23], s55 offen lds
    s_add_u32 s55, s55, 0x20000
    s_add_u32 m0, m0, 1024
    s_nop 0
    buffer_load_dwordx4 v244, s[20:23], s55 offen lds
    s_add_u32 s55, s55, 0x20000
    s_add_u32 m0, m0, 1024
    s_nop 0
    buffer_load_dwordx4 v244, s[20:23], s55 offen lds
    s_add_u32 s55, s55, 0x20000
    s_add_u32 m0, m0, 1024
    s_nop 0
    buffer_load_dwordx4 v244, s[20:23], s55 offen lds
    s_add_u32 s55, s55, 0x20000
    s_add_u32 m0, m0, 1024
    s_nop 0
    buffer_load_dwordx4 v244, s[20:23], s55 offen lds
    s_add_u32 s55, s55, 0x20000
    s_add_u32 m0, m0, 1024
    s_nop 0
    buffer_load_dwordx4 v244, s[20:23], s55 offen lds
    s_add_u32 s55, s55, 0x20000
    s_add_u32 m0, m0, 1024
    s_nop 0
    buffer_load_dwordx4 v244, s[20:23], s55 offen lds
    s_add_u32 s55, s55, 0x20000
    s_add_u32 m0, m0, 1024
    s_nop 0
    buffer_load_dwordx4 v244, s[20:23], s55 offen lds
    s_add_u32 s55, s55, 0x20000
    s_add_u32 m0, m0, 1024
    s_nop 0
    buffer_load_dwordx4 v244, s[20:23], s55 offen lds
    s_add_u32 s55, s55, 0x20000
    s_add_u32 m0, m0, 1024
    s_nop 0
    buffer_load_dwordx4 v244, s[20:23], s55 offen lds
    s_add_u32 s55, s55, 0x20000
    s_add_u32 m0, m0, 1024
    s_nop 0
    buffer_load_dwordx4 v244, s[20:23], s55 offen lds
    s_add_u32 s55, s55, 0x20000
    s_add_u32 m0, m0, 1024
    s_nop 0
    buffer_load_dwordx4 v244, s[20:23], s55 offen lds
    s_add_u32 s55, s55, 0x20000
    s_add_u32 m0, m0, 1024
    s_nop 0
    buffer_load_dwordx4 v244, s[20:23], s55 offen lds
    s_add_u32 s55, s55, 0x20000
    s_add_u32 m0, m0, 1024
    s_nop 0
    buffer_load_dwordx4 v244, s[20:23], s55 offen lds
    s_waitcnt vmcnt(16)
    ds_read_b64_tr_b16 a[0:1], v246 offset:0
    ds_read_b64_tr_b16 a[2:3], v246 offset:128
    ds_read_b64_tr_b16 a[4:5], v246 offset:2048
    ds_read_b64_tr_b16 a[6:7], v246 offset:2176
    s_waitcnt lgkmcnt(0)
    ds_read_b64_tr_b16 a[8:9], v246 offset:4096
    ds_read_b64_tr_b16 a[10:11], v246 offset:4224
    ds_read_b64_tr_b16 a[12:13], v246 offset:6144
    ds_read_b64_tr_b16 a[14:15], v246 offset:6272
    s_waitcnt lgkmcnt(0)
    ds_read_b64_tr_b16 a[16:17], v246 offset:8192
    ds_read_b64_tr_b16 a[18:19], v246 offset:8320
    ds_read_b64_tr_b16 a[20:21], v246 offset:10240
    ds_read_b64_tr_b16 a[22:23], v246 offset:10368
    s_waitcnt lgkmcnt(0)
    ds_read_b64_tr_b16 a[24:25], v246 offset:12288
    ds_read_b64_tr_b16 a[26:27], v246 offset:12416
    ds_read_b64_tr_b16 a[28:29], v246 offset:14336
    ds_read_b64_tr_b16 a[30:31], v246 offset:14464
    s_waitcnt lgkmcnt(0)
    ds_read_b64_tr_b16 a[32:33], v246 offset:32
    ds_read_b64_tr_b16 a[34:35], v246 offset:160
    ds_read_b64_tr_b16 a[36:37], v246 offset:2080
    ds_read_b64_tr_b16 a[38:39], v246 offset:2208
    s_waitcnt lgkmcnt(0)
    ds_read_b64_tr_b16 a[40:41], v246 offset:4128
    ds_read_b64_tr_b16 a[42:43], v246 offset:4256
    ds_read_b64_tr_b16 a[44:45], v246 offset:6176
    ds_read_b64_tr_b16 a[46:47], v246 offset:6304
    s_waitcnt lgkmcnt(0)
    ds_read_b64_tr_b16 a[48:49], v246 offset:8224
    ds_read_b64_tr_b16 a[50:51], v246 offset:8352
    ds_read_b64_tr_b16 a[52:53], v246 offset:10272
    ds_read_b64_tr_b16 a[54:55], v246 offset:10400
    s_waitcnt lgkmcnt(0)
    ds_read_b64_tr_b16 a[56:57], v246 offset:12320
    ds_read_b64_tr_b16 a[58:59], v246 offset:12448
    ds_read_b64_tr_b16 a[60:61], v246 offset:14368
    ds_read_b64_tr_b16 a[62:63], v246 offset:14496
    s_waitcnt lgkmcnt(0)
    s_load_dwordx2 s[20:21], s[0:1], 32
    s_waitcnt lgkmcnt(0)
    s_mov_b32 s22, 0x800000
    s_mov_b32 s23, 0x20000
    s_mov_b32 s55, 0
    s_mov_b32 m0, s56
    s_nop 0
    buffer_load_dwordx4 v244, s[20:23], s55 offen lds
    s_add_u32 s55, s55, 0x20000
    s_add_u32 m0, m0, 1024
    s_nop 0
    buffer_load_dwordx4 v244, s[20:23], s55 offen lds
    s_add_u32 s55, s55, 0x20000
    s_add_u32 m0, m0, 1024
    s_nop 0
    buffer_load_dwordx4 v244, s[20:23], s55 offen lds
    s_add_u32 s55, s55, 0x20000
    s_add_u32 m0, m0, 1024
    s_nop 0
    buffer_load_dwordx4 v244, s[20:23], s55 offen lds
    s_add_u32 s55, s55, 0x20000
    s_add_u32 m0, m0, 1024
    s_nop 0
    buffer_load_dwordx4 v244, s[20:23], s55 offen lds
    s_add_u32 s55, s55, 0x20000
    s_add_u32 m0, m0, 1024
    s_nop 0
    buffer_load_dwordx4 v244, s[20:23], s55 offen lds
    s_add_u32 s55, s55, 0x20000
    s_add_u32 m0, m0, 1024
    s_nop 0
    buffer_load_dwordx4 v244, s[20:23], s55 offen lds
    s_add_u32 s55, s55, 0x20000
    s_add_u32 m0, m0, 1024
    s_nop 0
    buffer_load_dwordx4 v244, s[20:23], s55 offen lds
    s_add_u32 s55, s55, 0x20000
    s_add_u32 m0, m0, 1024
    s_nop 0
    buffer_load_dwordx4 v244, s[20:23], s55 offen lds
    s_add_u32 s55, s55, 0x20000
    s_add_u32 m0, m0, 1024
    s_nop 0
    buffer_load_dwordx4 v244, s[20:23], s55 offen lds
    s_add_u32 s55, s55, 0x20000
    s_add_u32 m0, m0, 1024
    s_nop 0
    buffer_load_dwordx4 v244, s[20:23], s55 offen lds
    s_add_u32 s55, s55, 0x20000
    s_add_u32 m0, m0, 1024
    s_nop 0
    buffer_load_dwordx4 v244, s[20:23], s55 offen lds
    s_add_u32 s55, s55, 0x20000
    s_add_u32 m0, m0, 1024
    s_nop 0
    buffer_load_dwordx4 v244, s[20:23], s55 offen lds
    s_add_u32 s55, s55, 0x20000
    s_add_u32 m0, m0, 1024
    s_nop 0
    buffer_load_dwordx4 v244, s[20:23], s55 offen lds
    s_add_u32 s55, s55, 0x20000
    s_add_u32 m0, m0, 1024
    s_nop 0
    buffer_load_dwordx4 v244, s[20:23], s55 offen lds
    s_add_u32 s55, s55, 0x20000
    s_add_u32 m0, m0, 1024
    s_nop 0
    buffer_load_dwordx4 v244, s[20:23], s55 offen lds
    s_waitcnt vmcnt(16)
    ds_read_b64_tr_b16 a[64:65], v246 offset:16384
    ds_read_b64_tr_b16 a[66:67], v246 offset:16512
    ds_read_b64_tr_b16 a[68:69], v246 offset:18432
    ds_read_b64_tr_b16 a[70:71], v246 offset:18560
    s_waitcnt lgkmcnt(0)
    ds_read_b64_tr_b16 a[72:73], v246 offset:20480
    ds_read_b64_tr_b16 a[74:75], v246 offset:20608
    ds_read_b64_tr_b16 a[76:77], v246 offset:22528
    ds_read_b64_tr_b16 a[78:79], v246 offset:22656
    s_waitcnt lgkmcnt(0)
    ds_read_b64_tr_b16 a[80:81], v246 offset:24576
    ds_read_b64_tr_b16 a[82:83], v246 offset:24704
    ds_read_b64_tr_b16 a[84:85], v246 offset:26624
    ds_read_b64_tr_b16 a[86:87], v246 offset:26752
    s_waitcnt lgkmcnt(0)
    ds_read_b64_tr_b16 a[88:89], v246 offset:28672
    ds_read_b64_tr_b16 a[90:91], v246 offset:28800
    ds_read_b64_tr_b16 a[92:93], v246 offset:30720
    ds_read_b64_tr_b16 a[94:95], v246 offset:30848
    s_waitcnt lgkmcnt(0)
    ds_read_b64_tr_b16 a[96:97], v246 offset:16416
    ds_read_b64_tr_b16 a[98:99], v246 offset:16544
    ds_read_b64_tr_b16 a[100:101], v246 offset:18464
    ds_read_b64_tr_b16 a[102:103], v246 offset:18592
    s_waitcnt lgkmcnt(0)
    ds_read_b64_tr_b16 a[104:105], v246 offset:20512
    ds_read_b64_tr_b16 a[106:107], v246 offset:20640
    ds_read_b64_tr_b16 a[108:109], v246 offset:22560
    ds_read_b64_tr_b16 a[110:111], v246 offset:22688
    s_waitcnt lgkmcnt(0)
    ds_read_b64_tr_b16 a[112:113], v246 offset:24608
    ds_read_b64_tr_b16 a[114:115], v246 offset:24736
    ds_read_b64_tr_b16 a[116:117], v246 offset:26656
    ds_read_b64_tr_b16 a[118:119], v246 offset:26784
    s_waitcnt lgkmcnt(0)
    ds_read_b64_tr_b16 a[120:121], v246 offset:28704
    ds_read_b64_tr_b16 a[122:123], v246 offset:28832
    ds_read_b64_tr_b16 a[124:125], v246 offset:30752
    ds_read_b64_tr_b16 a[126:127], v246 offset:30880
    s_waitcnt lgkmcnt(0)
    s_load_dwordx2 s[20:21], s[0:1], 40
    s_waitcnt lgkmcnt(0)
    s_mov_b32 s22, 0x800000
    s_mov_b32 s23, 0x20000
    s_mov_b32 s55, 0
    s_mov_b32 m0, s57
    s_nop 0
    buffer_load_dwordx4 v245, s[20:23], s55 offen lds
    s_add_u32 s55, s55, 0x4000
    s_add_u32 m0, m0, 1024
    s_nop 0
    buffer_load_dwordx4 v245, s[20:23], s55 offen lds
    s_add_u32 s55, s55, 0x4000
    s_add_u32 m0, m0, 1024
    s_nop 0
    buffer_load_dwordx4 v245, s[20:23], s55 offen lds
    s_add_u32 s55, s55, 0x4000
    s_add_u32 m0, m0, 1024
    s_nop 0
    buffer_load_dwordx4 v245, s[20:23], s55 offen lds
    s_add_u32 s55, s55, 0x4000
    s_add_u32 m0, m0, 1024
    s_nop 0
    buffer_load_dwordx4 v245, s[20:23], s55 offen lds
    s_add_u32 s55, s55, 0x4000
    s_add_u32 m0, m0, 1024
    s_nop 0
    buffer_load_dwordx4 v245, s[20:23], s55 offen lds
    s_add_u32 s55, s55, 0x4000
    s_add_u32 m0, m0, 1024
    s_nop 0
    buffer_load_dwordx4 v245, s[20:23], s55 offen lds
    s_add_u32 s55, s55, 0x4000
    s_add_u32 m0, m0, 1024
    s_nop 0
    buffer_load_dwordx4 v245, s[20:23], s55 offen lds
    s_add_u32 s55, s55, 0x4000
    s_add_u32 m0, m0, 1024
    s_nop 0
    buffer_load_dwordx4 v245, s[20:23], s55 offen lds
    s_add_u32 s55, s55, 0x4000
    s_add_u32 m0, m0, 1024
    s_nop 0
    buffer_load_dwordx4 v245, s[20:23], s55 offen lds
    s_add_u32 s55, s55, 0x4000
    s_add_u32 m0, m0, 1024
    s_nop 0
    buffer_load_dwordx4 v245, s[20:23], s55 offen lds
    s_add_u32 s55, s55, 0x4000
    s_add_u32 m0, m0, 1024
    s_nop 0
    buffer_load_dwordx4 v245, s[20:23], s55 offen lds
    s_add_u32 s55, s55, 0x4000
    s_add_u32 m0, m0, 1024
    s_nop 0
    buffer_load_dwordx4 v245, s[20:23], s55 offen lds
    s_add_u32 s55, s55, 0x4000
    s_add_u32 m0, m0, 1024
    s_nop 0
    buffer_load_dwordx4 v245, s[20:23], s55 offen lds
    s_add_u32 s55, s55, 0x4000
    s_add_u32 m0, m0, 1024
    s_nop 0
    buffer_load_dwordx4 v245, s[20:23], s55 offen lds
    s_add_u32 s55, s55, 0x4000
    s_add_u32 m0, m0, 1024
    s_nop 0
    buffer_load_dwordx4 v245, s[20:23], s55 offen lds
    s_waitcnt vmcnt(16)
    ds_read_b64_tr_b16 a[128:129], v246 offset:0
    ds_read_b64_tr_b16 a[130:131], v246 offset:128
    ds_read_b64_tr_b16 a[132:133], v246 offset:2048
    ds_read_b64_tr_b16 a[134:135], v246 offset:2176
    s_waitcnt lgkmcnt(0)
    ds_read_b64_tr_b16 a[136:137], v246 offset:4096
    ds_read_b64_tr_b16 a[138:139], v246 offset:4224
    ds_read_b64_tr_b16 a[140:141], v246 offset:6144
    ds_read_b64_tr_b16 a[142:143], v246 offset:6272
    s_waitcnt lgkmcnt(0)
    ds_read_b64_tr_b16 a[144:145], v246 offset:8192
    ds_read_b64_tr_b16 a[146:147], v246 offset:8320
    ds_read_b64_tr_b16 a[148:149], v246 offset:10240
    ds_read_b64_tr_b16 a[150:151], v246 offset:10368
    s_waitcnt lgkmcnt(0)
    ds_read_b64_tr_b16 a[152:153], v246 offset:12288
    ds_read_b64_tr_b16 a[154:155], v246 offset:12416
    ds_read_b64_tr_b16 a[156:157], v246 offset:14336
    ds_read_b64_tr_b16 a[158:159], v246 offset:14464
    s_waitcnt lgkmcnt(0)
    ds_read_b64_tr_b16 a[160:161], v246 offset:32
    ds_read_b64_tr_b16 a[162:163], v246 offset:160
    ds_read_b64_tr_b16 a[164:165], v246 offset:2080
    ds_read_b64_tr_b16 a[166:167], v246 offset:2208
    s_waitcnt lgkmcnt(0)
    ds_read_b64_tr_b16 a[168:169], v246 offset:4128
    ds_read_b64_tr_b16 a[170:171], v246 offset:4256
    ds_read_b64_tr_b16 a[172:173], v246 offset:6176
    ds_read_b64_tr_b16 a[174:175], v246 offset:6304
    s_waitcnt lgkmcnt(0)
    ds_read_b64_tr_b16 a[176:177], v246 offset:8224
    ds_read_b64_tr_b16 a[178:179], v246 offset:8352
    ds_read_b64_tr_b16 a[180:181], v246 offset:10272
    ds_read_b64_tr_b16 a[182:183], v246 offset:10400
    s_waitcnt lgkmcnt(0)
    ds_read_b64_tr_b16 a[184:185], v246 offset:12320
    ds_read_b64_tr_b16 a[186:187], v246 offset:12448
    ds_read_b64_tr_b16 a[188:189], v246 offset:14368
    ds_read_b64_tr_b16 a[190:191], v246 offset:14496
    s_waitcnt lgkmcnt(0)
    s_waitcnt vmcnt(0)
    ds_read_b64_tr_b16 a[192:193], v248 offset:0
    ds_read_b64_tr_b16 a[194:195], v248 offset:2048
    ds_read_b64_tr_b16 a[196:197], v248 offset:4096
    ds_read_b64_tr_b16 a[198:199], v248 offset:6144
    ds_read_b64_tr_b16 a[200:201], v248 offset:8192
    ds_read_b64_tr_b16 a[202:203], v248 offset:10240
    ds_read_b64_tr_b16 a[204:205], v248 offset:12288
    ds_read_b64_tr_b16 a[206:207], v248 offset:14336
    s_waitcnt lgkmcnt(0)
    ds_read_b64_tr_b16 a[208:209], v248 offset:32
    ds_read_b64_tr_b16 a[210:211], v248 offset:2080
    ds_read_b64_tr_b16 a[212:213], v248 offset:4128
    ds_read_b64_tr_b16 a[214:215], v248 offset:6176
    ds_read_b64_tr_b16 a[216:217], v248 offset:8224
    ds_read_b64_tr_b16 a[218:219], v248 offset:10272
    ds_read_b64_tr_b16 a[220:221], v248 offset:12320
    ds_read_b64_tr_b16 a[222:223], v248 offset:14368
    s_waitcnt lgkmcnt(0)
    ds_read_b64_tr_b16 a[224:225], v248 offset:64
    ds_read_b64_tr_b16 a[226:227], v248 offset:2112
    ds_read_b64_tr_b16 a[228:229], v248 offset:4160
    ds_read_b64_tr_b16 a[230:231], v248 offset:6208
    ds_read_b64_tr_b16 a[232:233], v248 offset:8256
    ds_read_b64_tr_b16 a[234:235], v248 offset:10304
    ds_read_b64_tr_b16 a[236:237], v248 offset:12352
    ds_read_b64_tr_b16 a[238:239], v248 offset:14400
    s_waitcnt lgkmcnt(0)
    ds_read_b64_tr_b16 a[240:241], v248 offset:96
    ds_read_b64_tr_b16 a[242:243], v248 offset:2144
    ds_read_b64_tr_b16 a[244:245], v248 offset:4192
    ds_read_b64_tr_b16 a[246:247], v248 offset:6240
    ds_read_b64_tr_b16 a[248:249], v248 offset:8288
    ds_read_b64_tr_b16 a[250:251], v248 offset:10336
    ds_read_b64_tr_b16 a[252:253], v248 offset:12384
    ds_read_b64_tr_b16 a[254:255], v248 offset:14432
    s_waitcnt lgkmcnt(0)
    s_barrier
    s_mov_b32 s29, 0
    s_mov_b32 s48, 0x20000
    s_mov_b32 s70, 0
    s_mov_b32 s60, 0
    s_mov_b32 s61, 0
    s_mov_b32 s62, 0
    s_mov_b32 s63, 0
    s_mov_b32 s64, 0
    s_mov_b32 s65, 0
    s_mov_b32 s66, 0
    s_mov_b32 s67, 0
    s_mov_b32 s68, 0
    s_mov_b32 s69, 0
    s_mov_b32 s34, 0
    s_mov_b32 s35, 0
    s_mov_b32 s36, 0
    s_mov_b32 s37, 0
    s_mov_b32 s38, 0
    s_mov_b32 s44, 0x1000000
    s_mov_b32 s45, 0x1020000
    s_mov_b32 s47, 0x3f0000
    v_mov_b32 v236, -1
    v_mov_b32 v237, -1
    v_mov_b32 v238, -1
    v_mov_b32 v239, -1
    s_mov_b32 s54, 0x10000
    buffer_store_dwordx4 v[16:19], v28, s[16:19], s54 offen sc1
    s_add_u32 s20, s4, 0x6600000
    s_addc_u32 s21, s5, 0
    s_mov_b32 s22, 0x28000
    s_mov_b32 s23, 0x20000
    v_and_b32 v244, 3, v0
    v_lshlrev_b32 v244, 6, v244
    v_lshrrev_b32 v245, 2, v0
    v_lshl_add_u32 v244, v245, 2, v244
    v_mov_b32 v245, 144
    v_cmp_eq_u32 vcc, 8, v0
    s_nop 1
    v_cndmask_b32 v244, v244, v245, vcc
    s_mov_b32 s71, 0x8000
cnw_2:
    s_mov_b64 exec, 0x1ff
    buffer_load_dword v245, v244, s[72:75], 0 offen sc1
    s_waitcnt vmcnt(0)
    s_mov_b64 exec, -1
    v_readlane_b32 s60, v245, 0
    v_readlane_b32 s61, v245, 1
    v_readlane_b32 s62, v245, 2
    v_readlane_b32 s63, v245, 3
    v_readlane_b32 s64, v245, 4
    v_readlane_b32 s65, v245, 5
    v_readlane_b32 s66, v245, 6
    v_readlane_b32 s67, v245, 7
    s_add_u32 s68, s60, s61
    s_max_u32 s69, s60, s61
    s_add_u32 s68, s68, s62
    s_max_u32 s69, s69, s62
    s_add_u32 s68, s68, s63
    s_max_u32 s69, s69, s63
    s_add_u32 s68, s68, s64
    s_max_u32 s69, s69, s64
    s_add_u32 s68, s68, s65
    s_max_u32 s69, s69, s65
    s_add_u32 s68, s68, s66
    s_max_u32 s69, s69, s66
    s_add_u32 s68, s68, s67
    s_max_u32 s69, s69, s67
    v_readlane_b32 s54, v245, 8
    s_nop 3
    s_add_u32 s68, s68, s54
    s_cmp_eq_u32 s68, 384
    s_cbranch_scc1 cnd_3
    s_sleep 8
    s_sub_u32 s71, s71, 1
    s_cbranch_scc0 cnw_2
    s_mov_b32 s70, 10
    s_branch ch_err
cnd_3:
    s_mov_b32 s59, s69
    s_mov_b32 s60, 0
    s_mov_b32 s61, 0
    s_mov_b32 s62, 0
    s_mov_b32 s63, 0
    s_mov_b32 s64, 0
    s_mov_b32 s65, 0
    s_mov_b32 s66, 0
    s_mov_b32 s67, 0
    s_mov_b32 s68, 0
    s_mov_b32 s69, 0
    s_cmp_lg_u32 s28, 0
    s_cbranch_scc1 kw_4
    s_add_u32 s39, s29, 0
    s_lshr_b32 s39, s39, 2
    s_lshl_b32 s39, s39, 2
    s_add_u32 s39, s39, 4096
    buffer_load_dword v34, off, s[20:23], s39 sc1
    s_waitcnt vmcnt(0)
kvw_5:
    v_readfirstlane_b32 s54, v34
    s_nop 3
    s_cmp_ge_u32 s54, 64
    s_cbranch_scc1 kvd_6
    s_sleep 4
    buffer_load_dword v34, off, s[20:23], s39 sc1
    s_waitcnt vmcnt(0)
    s_sub_u32 s48, s48, 1
    s_cbranch_scc0 kvw_5
    s_mov_b32 s70, 9
    s_branch ch_err
kvd_6:
kw_4:
    s_barrier
    v_mov_b32 v34, 64
    s_mov_b32 s42, 0
    s_mov_b32 s43, 0x20000
    buffer_load_dwordx4 v[72:75], v27, s[12:15], s44 offen offset:0
    buffer_load_dwordx4 v[88:91], v27, s[12:15], s45 offen offset:0
    buffer_load_dwordx4 v[76:79], v27, s[12:15], s44 offen offset:1024
    buffer_load_dwordx4 v[92:95], v27, s[12:15], s45 offen offset:1024
    buffer_load_dwordx4 v[80:83], v27, s[12:15], s44 offen offset:2048
    buffer_load_dwordx4 v[96:99], v27, s[12:15], s45 offen offset:2048
    buffer_load_dwordx4 v[84:87], v27, s[12:15], s44 offen offset:3072
    buffer_load_dwordx4 v[100:103], v27, s[12:15], s45 offen offset:3072
    buffer_load_dwordx4 v[40:43], v13, s[12:15], s42 offen
    buffer_load_dwordx4 v[44:47], v13, s[12:15], s43 offen
    s_waitcnt vmcnt(0)
    s_cmp_lg_u32 s59, 32
    s_cbranch_scc1 ch_loop_s
ch_loop:
    buffer_store_dwordx4 v[16:19], v26, s[8:11], s31 offen sc1
    s_cmp_eq_u32 s28, 1
    s_cbranch_scc1 r1_7
    buffer_store_dwordx4 v[16:19], v23, s[8:11], s31 offen
    s_branch r2_8
r1_7:
    buffer_store_dword v16, v23, s[8:11], s31 offen
r2_8:
    buffer_store_dwordx4 v[236:239], v28, s[16:19], s47 offen sc1
    s_add_u32 s54, s29, 2
    s_min_u32 s54, s54, 63
    s_lshl_b32 s54, s54, 16
    buffer_store_dwordx4 v[16:19], v28, s[16:19], s54 offen sc1
    s_lshl_b32 s42, s29, 18
    s_add_u32 s44, s42, 0x1040000
    s_add_u32 s46, s42, 0x80000
    s_add_u32 s42, s42, 0x40000
    s_add_u32 s43, s42, 0x20000
    s_add_u32 s45, s44, 0x20000
    s_lshl_b32 s47, s29, 16
    s_waitcnt vmcnt(7)
    v_mfma_f32_16x16x32_bf16 v[160:163], v[72:75], a[192:195], 0
    v_mfma_f32_16x16x32_bf16 v[164:167], v[88:91], a[192:195], 0
    v_mfma_f32_16x16x32_bf16 v[168:171], v[72:75], a[208:211], 0
    v_mfma_f32_16x16x32_bf16 v[172:175], v[88:91], a[208:211], 0
    v_mfma_f32_16x16x32_bf16 v[176:179], v[72:75], a[224:227], 0
    v_mfma_f32_16x16x32_bf16 v[180:183], v[88:91], a[224:227], 0
    v_mfma_f32_16x16x32_bf16 v[184:187], v[72:75], a[240:243], 0
    v_mfma_f32_16x16x32_bf16 v[188:191], v[88:91], a[240:243], 0
    v_mfma_f32_16x16x32_bf16 v[160:163], v[76:79], a[196:199], v[160:163]
    v_mfma_f32_16x16x32_bf16 v[164:167], v[92:95], a[196:199], v[164:167]
    v_mfma_f32_16x16x32_bf16 v[168:171], v[76:79], a[212:215], v[168:171]
    v_mfma_f32_16x16x32_bf16 v[172:175], v[92:95], a[212:215], v[172:175]
    v_mfma_f32_16x16x32_bf16 v[176:179], v[76:79], a[228:231], v[176:179]
    v_mfma_f32_16x16x32_bf16 v[180:183], v[92:95], a[228:231], v[180:183]
    v_mfma_f32_16x16x32_bf16 v[184:187], v[76:79], a[244:247], v[184:187]
    v_mfma_f32_16x16x32_bf16 v[188:191], v[92:95], a[244:247], v[188:191]
    v_mfma_f32_16x16x32_bf16 v[160:163], v[80:83], a[200:203], v[160:163]
    v_mfma_f32_16x16x32_bf16 v[164:167], v[96:99], a[200:203], v[164:167]
    v_mfma_f32_16x16x32_bf16 v[168:171], v[80:83], a[216:219], v[168:171]
    v_mfma_f32_16x16x32_bf16 v[172:175], v[96:99], a[216:219], v[172:175]
    v_mfma_f32_16x16x32_bf16 v[176:179], v[80:83], a[232:235], v[176:179]
    v_mfma_f32_16x16x32_bf16 v[180:183], v[96:99], a[232:235], v[180:183]
    v_mfma_f32_16x16x32_bf16 v[184:187], v[80:83], a[248:251], v[184:187]
    v_mfma_f32_16x16x32_bf16 v[188:191], v[96:99], a[248:251], v[188:191]
    v_mfma_f32_16x16x32_bf16 v[160:163], v[84:87], a[204:207], v[160:163]
    v_mfma_f32_16x16x32_bf16 v[164:167], v[100:103], a[204:207], v[164:167]
    v_mfma_f32_16x16x32_bf16 v[168:171], v[84:87], a[220:223], v[168:171]
    v_mfma_f32_16x16x32_bf16 v[172:175], v[100:103], a[220:223], v[172:175]
    v_mfma_f32_16x16x32_bf16 v[176:179], v[84:87], a[236:239], v[176:179]
    v_mfma_f32_16x16x32_bf16 v[180:183], v[100:103], a[236:239], v[180:183]
    v_mfma_f32_16x16x32_bf16 v[184:187], v[84:87], a[252:255], v[184:187]
    v_mfma_f32_16x16x32_bf16 v[188:191], v[100:103], a[252:255], v[188:191]
    s_nop 0
    v_cvt_pk_bf16_f32 v104, v160, v161
    v_cvt_pk_bf16_f32 v105, v162, v163
    v_cvt_pk_bf16_f32 v106, v164, v165
    v_cvt_pk_bf16_f32 v107, v166, v167
    v_cvt_pk_bf16_f32 v108, v168, v169
    v_cvt_pk_bf16_f32 v109, v170, v171
    v_cvt_pk_bf16_f32 v110, v172, v173
    v_cvt_pk_bf16_f32 v111, v174, v175
    v_cvt_pk_bf16_f32 v112, v176, v177
    v_cvt_pk_bf16_f32 v113, v178, v179
    v_cvt_pk_bf16_f32 v114, v180, v181
    v_cvt_pk_bf16_f32 v115, v182, v183
    v_cvt_pk_bf16_f32 v116, v184, v185
    v_cvt_pk_bf16_f32 v117, v186, v187
    v_cvt_pk_bf16_f32 v118, v188, v189
    v_cvt_pk_bf16_f32 v119, v190, v191
    s_cmp_lg_u32 s28, 2
    s_cbranch_scc1 nt_9
nt_9:
    v_mov_b32 v136, 0
    v_mov_b32 v137, 0
    v_mov_b32 v138, 0
    v_mov_b32 v139, 0
    v_mov_b32 v140, 0
    v_mov_b32 v141, 0
    v_mov_b32 v142, 0
    v_mov_b32 v143, 0
    v_mov_b32 v144, 0
    v_mov_b32 v145, 0
    v_mov_b32 v146, 0
    v_mov_b32 v147, 0
    v_mov_b32 v148, 0
    v_mov_b32 v149, 0
    v_mov_b32 v150, 0
    v_mov_b32 v151, 0
    v_mov_b32 v152, 0
    v_mov_b32 v153, 0
    v_mov_b32 v154, 0
    v_mov_b32 v155, 0
    v_mov_b32 v156, 0
    v_mov_b32 v157, 0
    v_mov_b32 v158, 0
    v_mov_b32 v159, 0
    s_cmp_lg_u32 s28, 3
    s_cbranch_scc1 noA_10
    s_cmp_eq_u32 s29, 0
    s_cbranch_scc1 noA_10
    buffer_load_dwordx4 v[176:179], v20, s[8:11], s33 offen offset:0 sc1
    buffer_load_dwordx4 v[180:183], v20, s[8:11], s33 offen offset:1024 sc1
    buffer_load_dwordx4 v[184:187], v20, s[8:11], s33 offen offset:2048 sc1
    buffer_load_dwordx4 v[188:191], v20, s[8:11], s33 offen offset:3072 sc1
pw_11:
    s_waitcnt vmcnt(0)
    v_mfma_f32_16x16x32_bf16 v[160:163], v[36:39], v[176:179], 0
    v_max3_u32 v244, v176, v177, v178
    v_max3_u32 v245, v179, v180, v181
    v_max3_u32 v246, v182, v183, v184
    v_mfma_f32_16x16x32_bf16 v[160:163], v[36:39], v[180:183], v[160:163]
    v_max3_u32 v247, v185, v186, v187
    v_max3_u32 v248, v188, v189, v190
    v_max3_u32 v244, v244, v245, v246
    v_mfma_f32_16x16x32_bf16 v[160:163], v[240:243], v[184:187], v[160:163]
    v_max3_u32 v247, v247, v248, v191
    v_max_u32 v244, v244, v247
    v_cmp_eq_u32 vcc, -1, v244
    v_mfma_f32_16x16x32_bf16 v[160:163], v[240:243], v[188:191], v[160:163]
    s_cbranch_vccnz rt_12
    s_nop 6
    v_cvt_pk_bf16_f32 v244, v160, v161
    v_cvt_pk_bf16_f32 v245, v162, v163
    v_min_u32 v244, -2, v244
    v_min_u32 v245, -2, v245
    buffer_store_dwordx2 v[244:245], v21, s[8:11], s30 offen
    buffer_store_dwordx2 v[16:17], v21, s[8:11], s32 offen
noA_10:
    s_barrier
    s_sleep 3
    buffer_load_dwordx4 v[120:123], v22, s[8:11], s30 offen offset:0 sc1
    buffer_load_dwordx4 v[124:127], v22, s[8:11], s30 offen offset:1024 sc1
    buffer_load_dwordx4 v[128:131], v22, s[8:11], s30 offen offset:2048 sc1
    buffer_load_dwordx4 v[132:135], v22, s[8:11], s30 offen offset:3072 sc1
pw_13:
    s_waitcnt vmcnt(0)
    v_smfmac_f32_16x16x64_bf16 v[136:139], v[120:123], a[0:7], v1
    v_max3_u32 v244, v120, v121, v122
    v_max3_u32 v245, v123, v124, v125
    v_max3_u32 v246, v126, v127, v128
    v_smfmac_f32_16x16x64_bf16 v[140:143], v[120:123], a[32:39], v1
    v_max3_u32 v247, v129, v130, v131
    v_max3_u32 v248, v132, v133, v134
    v_max3_u32 v244, v244, v245, v246
    v_smfmac_f32_16x16x64_bf16 v[136:139], v[124:127], a[8:15], v1
    v_max3_u32 v247, v247, v248, v135
    v_max_u32 v244, v244, v247
    v_cmp_eq_u32 vcc, -1, v244
    v_smfmac_f32_16x16x64_bf16 v[140:143], v[124:127], a[40:47], v1
    s_cbranch_vccnz rt_14
    v_smfmac_f32_16x16x64_bf16 v[136:139], v[128:131], a[16:23], v1
    v_smfmac_f32_16x16x64_bf16 v[140:143], v[128:131], a[48:55], v1
    v_smfmac_f32_16x16x64_bf16 v[136:139], v[132:135], a[24:31], v1
    v_smfmac_f32_16x16x64_bf16 v[140:143], v[132:135], a[56:63], v1
    v_smfmac_f32_16x16x64_bf16 v[144:147], v[120:123], a[64:71], v1
    v_smfmac_f32_16x16x64_bf16 v[148:151], v[120:123], a[96:103], v1
    v_smfmac_f32_16x16x64_bf16 v[144:147], v[124:127], a[72:79], v1
    v_smfmac_f32_16x16x64_bf16 v[148:151], v[124:127], a[104:111], v1
    s_nop 3
    v_permlane32_swap_b32 v136, v140
    v_smfmac_f32_16x16x64_bf16 v[144:147], v[128:131], a[80:87], v1
    v_permlane32_swap_b32 v137, v141
    v_smfmac_f32_16x16x64_bf16 v[148:151], v[128:131], a[112:119], v1
    v_permlane32_swap_b32 v138, v142
    v_smfmac_f32_16x16x64_bf16 v[144:147], v[132:135], a[88:95], v1
    v_permlane32_swap_b32 v139, v143
    v_smfmac_f32_16x16x64_bf16 v[148:151], v[132:135], a[120:127], v1
    v_pk_add_f32 v[136:137], v[136:137], v[140:141]
    v_smfmac_f32_16x16x64_bf16 v[152:155], v[120:123], a[128:135], v1
    v_pk_add_f32 v[138:139], v[138:139], v[142:143]
    v_smfmac_f32_16x16x64_bf16 v[156:159], v[120:123], a[160:167], v1
    ds_write_b128 v30, v[136:139]
    v_smfmac_f32_16x16x64_bf16 v[152:155], v[124:127], a[136:143], v1
    v_smfmac_f32_16x16x64_bf16 v[156:159], v[124:127], a[168:175], v1
    s_nop 0
    v_permlane32_swap_b32 v144, v148
    v_permlane32_swap_b32 v145, v149
    v_smfmac_f32_16x16x64_bf16 v[152:155], v[128:131], a[144:151], v1
    v_permlane32_swap_b32 v146, v150
    v_smfmac_f32_16x16x64_bf16 v[156:159], v[128:131], a[176:183], v1
    v_permlane32_swap_b32 v147, v151
    v_pk_add_f32 v[144:145], v[144:145], v[148:149]
    v_smfmac_f32_16x16x64_bf16 v[152:155], v[132:135], a[152:159], v1
    v_pk_add_f32 v[146:147], v[146:147], v[150:151]
    v_smfmac_f32_16x16x64_bf16 v[156:159], v[132:135], a[184:191], v1
    ds_write_b128 v30, v[144:147] offset:4096
    s_nop 6
    v_permlane32_swap_b32 v152, v156
    v_permlane32_swap_b32 v153, v157
    v_permlane32_swap_b32 v154, v158
    v_permlane32_swap_b32 v155, v159
    v_pk_add_f32 v[152:153], v[152:153], v[156:157]
    v_pk_add_f32 v[154:155], v[154:155], v[158:159]
    ds_write_b128 v30, v[152:155] offset:8192
    s_waitcnt lgkmcnt(0)
    s_barrier
    s_cmp_eq_u32 s28, 3
    s_cbranch_scc1 be_17
    ds_read_b128 v[160:163], v35 offset:0
    ds_read_b128 v[164:167], v35 offset:1024
    ds_read_b128 v[168:171], v35 offset:2048
    ds_read_b128 v[172:175], v35 offset:3072
    s_cmp_eq_u32 s28, 1
    s_cbranch_scc1 b1_15
    s_cmp_eq_u32 s28, 2
    s_cbranch_scc1 b2_16
    s_waitcnt lgkmcnt(2)
    v_pk_add_f32 v[160:161], v[160:161], v[164:165]
    v_pk_add_f32 v[162:163], v[162:163], v[166:167]
    s_waitcnt lgkmcnt(0)
    v_pk_add_f32 v[168:169], v[168:169], v[172:173]
    v_pk_add_f32 v[170:171], v[170:171], v[174:175]
    v_pk_add_f32 v[160:161], v[160:161], v[168:169]
    v_pk_add_f32 v[162:163], v[162:163], v[170:171]
    v_cvt_pk_bf16_f32 v244, v160, v161
    v_cvt_pk_bf16_f32 v245, v162, v163
    s_nop 1
    v_mfma_f32_16x16x16_bf16 v[164:167], v[244:245], v[2:3], 0
    v_mfma_f32_16x16x16_bf16 v[168:171], v[244:245], v[4:5], 0
    s_nop 6
    v_cvt_pk_bf16_f32 v172, v164, v165
    v_cvt_pk_bf16_f32 v173, v166, v167
    v_cvt_pk_bf16_f32 v174, v168, v169
    v_cvt_pk_bf16_f32 v175, v170, v171
    s_nop 1
    v_mfma_f32_16x16x32_bf16 v[160:163], v[40:43], v[172:175], 0
    v_mfma_f32_16x16x32_bf16 v[164:167], v[44:47], v[172:175], 0
    s_nop 7
    v_mov_b32_dpp v160, v164 quad_perm:[0,1,2,3] row_mask:0xf bank_mask:0xc
    v_mov_b32_dpp v161, v165 quad_perm:[0,1,2,3] row_mask:0xf bank_mask:0xc
    v_mov_b32_dpp v162, v166 quad_perm:[0,1,2,3] row_mask:0xf bank_mask:0xc
    v_mov_b32_dpp v163, v167 quad_perm:[0,1,2,3] row_mask:0xf bank_mask:0xc
    v_min_u32 v160, -2, v160
    v_min_u32 v161, -2, v161
    v_min_u32 v162, -2, v162
    v_min_u32 v163, -2, v163
    buffer_store_dwordx4 v[160:163], v23, s[8:11], s30 offen
    s_branch be_17
b1_15:
    ds_read_b128 v[48:51], v31 offset:0
    ds_read_b128 v[52:55], v31 offset:1024
    ds_read_b128 v[56:59], v31 offset:2048
    ds_read_b128 v[60:63], v31 offset:3072
    s_waitcnt lgkmcnt(6)
    v_pk_add_f32 v[160:161], v[160:161], v[164:165]
    v_pk_add_f32 v[162:163], v[162:163], v[166:167]
    s_waitcnt lgkmcnt(4)
    v_pk_add_f32 v[168:169], v[168:169], v[172:173]
    v_pk_add_f32 v[170:171], v[170:171], v[174:175]
    v_pk_add_f32 v[160:161], v[160:161], v[168:169]
    v_pk_add_f32 v[162:163], v[162:163], v[170:171]
    v_cvt_pk_bf16_f32 v246, v160, v161
    v_cvt_pk_bf16_f32 v247, v162, v163
    s_waitcnt lgkmcnt(2)
    s_nop 0
    v_mfma_f32_16x16x16_bf16 v[164:167], v[246:247], v[68:69], 0
    v_pk_add_f32 v[48:49], v[48:49], v[52:53]
    v_pk_add_f32 v[50:51], v[50:51], v[54:55]
    v_mfma_f32_16x16x16_bf16 v[168:171], v[246:247], v[70:71], 0
    s_waitcnt lgkmcnt(0)
    v_pk_add_f32 v[56:57], v[56:57], v[60:61]
    v_pk_add_f32 v[58:59], v[58:59], v[62:63]
    v_pk_add_f32 v[48:49], v[48:49], v[56:57]
    v_pk_add_f32 v[50:51], v[50:51], v[58:59]
    v_cvt_pk_bf16_f32 v244, v48, v49
    v_cvt_pk_bf16_f32 v245, v50, v51
    s_nop 1
    v_mfma_f32_16x16x16_bf16 v[52:55], v[244:245], v[2:3], 0
    v_mfma_f32_16x16x16_bf16 v[56:59], v[244:245], v[4:5], 0
    v_cvt_pk_bf16_f32 v172, v164, v165
    v_cvt_pk_bf16_f32 v173, v166, v167
    v_cvt_pk_bf16_f32 v174, v168, v169
    v_cvt_pk_bf16_f32 v175, v170, v171
    s_nop 2
    v_cvt_pk_bf16_f32 v60, v52, v53
    v_cvt_pk_bf16_f32 v61, v54, v55
    v_cvt_pk_bf16_f32 v62, v56, v57
    v_cvt_pk_bf16_f32 v63, v58, v59
    s_nop 1
    v_mfma_f32_16x16x32_bf16 v[48:51], v[172:175], v[60:63], 0
    v_min_u32 v236, -2, v172
    v_min_u32 v237, -2, v173
    v_min_u32 v238, -2, v174
    v_min_u32 v239, -2, v175
    s_nop 3
    v_mov_b32_dpp v48, v49 quad_perm:[0,1,2,3] row_mask:0xf bank_mask:0xc
    v_min_u32 v48, -2, v48
    buffer_store_dword v48, v23, s[8:11], s30 offen
    s_branch be_17
b2_16:
    s_waitcnt lgkmcnt(2)
    v_pk_add_f32 v[160:161], v[160:161], v[164:165]
    v_pk_add_f32 v[162:163], v[162:163], v[166:167]
    s_waitcnt lgkmcnt(0)
    v_pk_add_f32 v[168:169], v[168:169], v[172:173]
    v_pk_add_f32 v[170:171], v[170:171], v[174:175]
    v_pk_add_f32 v[160:161], v[160:161], v[168:169]
    v_pk_add_f32 v[162:163], v[162:163], v[170:171]
    v_cvt_pk_bf16_f32 v244, v160, v161
    v_cvt_pk_bf16_f32 v245, v162, v163
    s_nop 1
    v_mfma_f32_16x16x16_bf16 v[164:167], v[244:245], v[2:3], 0
    v_mfma_f32_16x16x16_bf16 v[168:171], v[244:245], v[4:5], 0
    s_nop 6
    v_cvt_pk_bf16_f32 v236, v164, v165
    v_cvt_pk_bf16_f32 v237, v166, v167
    v_cvt_pk_bf16_f32 v238, v168, v169
    v_cvt_pk_bf16_f32 v239, v170, v171
    v_min_u32 v236, -2, v236
    v_min_u32 v237, -2, v237
    v_min_u32 v238, -2, v238
    v_min_u32 v239, -2, v239
    buffer_store_dwordx4 v[236:239], v23, s[8:11], s30 offen
be_17:
    s_barrier
    s_sleep 2
xv_18:
    buffer_load_dwordx4 v[176:179], v25, s[8:11], s30 offen offset:0 sc1
    buffer_load_dwordx4 v[180:183], v25, s[8:11], s30 offen offset:1024 sc1
    buffer_load_dwordx4 v[48:51], v24, s[8:11], s30 offen offset:0 sc1
    buffer_load_dwordx4 v[52:55], v24, s[8:11], s30 offen offset:1024 sc1
    buffer_load_dwordx4 v[56:59], v24, s[8:11], s30 offen offset:2048 sc1
    buffer_load_dwordx4 v[60:63], v24, s[8:11], s30 offen offset:3072 sc1
    buffer_load_dwordx4 v[64:67], v14, s[8:11], s30 offen sc1
    s_waitcnt vmcnt(5)
    v_mfma_f32_16x16x32_bf16 v[204:207], v[176:179], a[196:199], 0
    v_max3_u32 v244, v176, v177, v178
    v_max3_u32 v245, v179, v180, v181
    v_max_u32 v246, v182, v183
    v_mfma_f32_16x16x32_bf16 v[208:211], v[176:179], a[212:215], 0
    v_max3_u32 v244, v244, v245, v246
    v_cmp_eq_u32 vcc, -1, v244
    v_mfma_f32_16x16x32_bf16 v[212:215], v[176:179], a[228:231], 0
    v_mov_b32_dpp v184, v176 row_ror:8 row_mask:0xf bank_mask:0xf
    v_mov_b32_dpp v185, v177 row_ror:8 row_mask:0xf bank_mask:0xf
    v_mfma_f32_16x16x32_bf16 v[216:219], v[176:179], a[244:247], 0
    s_cbranch_vccnz rt_20
    v_mov_b32_dpp v186, v178 row_ror:8 row_mask:0xf bank_mask:0xf
    v_mov_b32_dpp v187, v179 row_ror:8 row_mask:0xf bank_mask:0xf
    v_mfma_f32_16x16x32_bf16 v[204:207], v[180:183], a[204:207], v[204:207]
    v_mov_b32_dpp v188, v180 row_ror:8 row_mask:0xf bank_mask:0xf
    v_mfma_f32_16x16x32_bf16 v[208:211], v[180:183], a[220:223], v[208:211]
    v_mov_b32_dpp v189, v181 row_ror:8 row_mask:0xf bank_mask:0xf
    v_mfma_f32_16x16x32_bf16 v[212:215], v[180:183], a[236:239], v[212:215]
    v_mov_b32_dpp v190, v182 row_ror:8 row_mask:0xf bank_mask:0xf
    v_mfma_f32_16x16x32_bf16 v[216:219], v[180:183], a[252:255], v[216:219]
    v_mov_b32_dpp v191, v183 row_ror:8 row_mask:0xf bank_mask:0xf
pw_21:
    s_waitcnt vmcnt(0)
    v_max3_u32 v244, v48, v49, v50
    v_max3_u32 v245, v51, v52, v53
    v_max3_u32 v246, v54, v55, v56
    v_max3_u32 v247, v57, v58, v59
    v_max3_u32 v248, v60, v61, v62
    v_max3_u32 v249, v63, v64, v65
    v_max_u32 v250, v66, v67
    v_max3_u32 v244, v244, v245, v246
    v_pk_add_f32 v[48:49], v[48:49], v[52:53]
    v_max3_u32 v247, v247, v248, v249
    v_pk_add_f32 v[50:51], v[50:51], v[54:55]
    v_max3_u32 v244, v244, v247, v250
    v_pk_add_f32 v[56:57], v[56:57], v[60:61]
    v_cmp_eq_u32 vcc, -1, v244
    v_pk_add_f32 v[58:59], v[58:59], v[62:63]
    v_pk_add_f32 v[64:65], v[64:65], v[66:67]
    s_cbranch_vccnz rt_22
    buffer_load_dwordx4 v[72:75], v27, s[12:15], s44 offen offset:0
    v_pk_add_f32 v[192:193], v[48:49], v[56:57]
    v_mfma_f32_16x16x32_bf16 v[204:207], v[184:187], a[192:195], v[204:207]
    buffer_load_dwordx4 v[88:91], v27, s[12:15], s45 offen offset:0
    v_pk_add_f32 v[194:195], v[50:51], v[58:59]
    v_add_f32 v196, v64, v65
    v_mfma_f32_16x16x32_bf16 v[208:211], v[184:187], a[208:211], v[208:211]
    buffer_load_dwordx4 v[76:79], v27, s[12:15], s44 offen offset:1024
    v_max3_f32 v244, v192, v193, v194
    v_max3_f32 v244, v244, v195, v196
    buffer_load_dwordx4 v[92:95], v27, s[12:15], s45 offen offset:1024
    v_mfma_f32_16x16x32_bf16 v[212:215], v[184:187], a[224:227], v[212:215]
    v_max_f32_dpp v244, v244, v244 row_ror:8 row_mask:0xf bank_mask:0xf
    v_mov_b32 v245, v244
    buffer_load_dwordx4 v[80:83], v27, s[12:15], s44 offen offset:2048
    v_mfma_f32_16x16x32_bf16 v[216:219], v[184:187], a[240:243], v[216:219]
    v_permlane32_swap_b32 v244, v245
    buffer_load_dwordx4 v[96:99], v27, s[12:15], s45 offen offset:2048
    v_max_f32 v244, v244, v245
    v_mfma_f32_16x16x32_bf16 v[204:207], v[188:191], a[200:203], v[204:207]
    v_mov_b32 v245, v244
    buffer_load_dwordx4 v[84:87], v27, s[12:15], s44 offen offset:3072
    s_nop 0
    v_permlane16_swap_b32 v244, v245
    v_mfma_f32_16x16x32_bf16 v[208:211], v[188:191], a[216:219], v[208:211]
    buffer_load_dwordx4 v[100:103], v27, s[12:15], s45 offen offset:3072
    v_max_f32 v244, v244, v245
    v_mul_f32 v244, s49, v244
    v_mfma_f32_16x16x32_bf16 v[212:215], v[188:191], a[232:235], v[212:215]
    buffer_load_dwordx4 v[40:43], v13, s[12:15], s42 offen
    v_fma_f32 v192, v192, s49, -v244
    v_fma_f32 v193, v193, s49, -v244
    buffer_load_dwordx4 v[44:47], v13, s[12:15], s43 offen
    v_mfma_f32_16x16x32_bf16 v[216:219], v[188:191], a[248:251], v[216:219]
    v_fma_f32 v194, v194, s49, -v244
    v_fma_f32 v195, v195, s49, -v244
    v_fma_f32 v196, v196, s49, -v244
    v_exp_f32 v192, v192
    v_exp_f32 v193, v193
    v_exp_f32 v194, v194
    v_exp_f32 v195, v195
    v_exp_f32 v196, v196
    v_cvt_pk_bf16_f32 v228, v192, v193
    v_cvt_pk_bf16_f32 v229, v194, v195
    v_mov_b32_dpp v246, v196 row_ror:8 row_mask:0xf bank_mask:0xf
    v_mov_b32_dpp v230, v228 row_ror:8 row_mask:0xf bank_mask:0xf
    v_mov_b32_dpp v231, v229 row_ror:8 row_mask:0xf bank_mask:0xf
    v_cvt_pk_bf16_f32 v232, v196, v246
    s_nop 0
    v_mfma_f32_16x16x32_bf16 v[152:155], v[8:11], v[228:231], 0
    v_mov_b32 v233, v232
    v_cvt_pk_bf16_f32 v220, v204, v205
    v_cvt_pk_bf16_f32 v221, v206, v207
    v_mfma_f32_16x16x32_bf16 v[136:139], v[104:107], v[228:231], 0
    v_permlane32_swap_b32 v232, v233
    v_cvt_pk_bf16_f32 v222, v208, v209
    v_cvt_pk_bf16_f32 v223, v210, v211
    v_mfma_f32_16x16x32_bf16 v[140:143], v[108:111], v[228:231], 0
    v_and_b32 v232, v232, v12
    v_and_b32 v233, v233, v12
    v_cvt_pk_bf16_f32 v224, v212, v213
    v_mfma_f32_16x16x32_bf16 v[144:147], v[112:115], v[228:231], 0
    v_cvt_pk_bf16_f32 v225, v214, v215
    v_cvt_pk_bf16_f32 v226, v216, v217
    v_cvt_pk_bf16_f32 v227, v218, v219
    v_mfma_f32_16x16x32_bf16 v[148:151], v[116:119], v[228:231], 0
    v_mfma_f32_16x16x16_bf16 v[152:155], v[8:9], v[232:233], v[152:155]
    v_mfma_f32_16x16x16_bf16 v[136:139], v[220:221], v[232:233], v[136:139]
    v_mfma_f32_16x16x16_bf16 v[140:143], v[222:223], v[232:233], v[140:143]
    v_mfma_f32_16x16x16_bf16 v[144:147], v[224:225], v[232:233], v[144:147]
    s_nop 1
    v_mfma_f32_16x16x16_bf16 v[148:151], v[226:227], v[232:233], v[148:151]
    s_nop 1
    v_rcp_f32 v244, v152
    s_nop 0
    v_pk_mul_f32 v[136:137], v[136:137], v[244:245] op_sel_hi:[1,0]
    v_pk_mul_f32 v[138:139], v[138:139], v[244:245] op_sel_hi:[1,0]
    v_pk_mul_f32 v[144:145], v[144:145], v[244:245] op_sel_hi:[1,0]
    v_pk_mul_f32 v[146:147], v[146:147], v[244:245] op_sel_hi:[1,0]
    v_mul_f32_dpp v136, v140, v244 row_shr:8 row_mask:0xf bank_mask:0xc
    v_mul_f32_dpp v137, v141, v244 row_shr:8 row_mask:0xf bank_mask:0xc
    v_mul_f32_dpp v138, v142, v244 row_shr:8 row_mask:0xf bank_mask:0xc
    v_mul_f32_dpp v139, v143, v244 row_shr:8 row_mask:0xf bank_mask:0xc
    ds_write_b128 v32, v[136:139] offset:0
    v_mul_f32_dpp v144, v148, v244 row_shr:8 row_mask:0xf bank_mask:0xc
    v_mul_f32_dpp v145, v149, v244 row_shr:8 row_mask:0xf bank_mask:0xc
    v_mul_f32_dpp v146, v150, v244 row_shr:8 row_mask:0xf bank_mask:0xc
    v_mul_f32_dpp v147, v151, v244 row_shr:8 row_mask:0xf bank_mask:0xc
    ds_write_b128 v32, v[144:147] offset:1024
    s_waitcnt lgkmcnt(0)
    s_barrier
    s_cmp_ge_u32 s28, 2
    s_cbranch_scc1 c1_23
    ds_read_b128 v[160:163], v33 offset:0
    ds_read_b128 v[164:167], v33 offset:2048
    ds_read_b128 v[168:171], v33 offset:4096
    ds_read_b128 v[172:175], v33 offset:6144
    s_waitcnt lgkmcnt(2)
    v_pk_add_f32 v[160:161], v[160:161], v[164:165]
    v_pk_add_f32 v[162:163], v[162:163], v[166:167]
    s_waitcnt lgkmcnt(0)
    v_pk_add_f32 v[168:169], v[168:169], v[172:173]
    v_pk_add_f32 v[170:171], v[170:171], v[174:175]
    v_pk_add_f32 v[160:161], v[160:161], v[168:169]
    v_pk_add_f32 v[162:163], v[162:163], v[170:171]
    v_cvt_pk_bf16_f32 v164, v160, v161
    v_cvt_pk_bf16_f32 v165, v162, v163
    v_min_u32 v164, -2, v164
    v_min_u32 v165, -2, v165
    v_mov_b32 v166, v164
    v_mov_b32 v167, v165
    s_nop 0
    v_permlane16_swap_b32 v164, v166
    v_permlane16_swap_b32 v165, v167
c1_23:
    buffer_store_dwordx4 v[164:167], v26, s[8:11], s30 offen sc1
    s_add_u32 s29, s29, 1
    buffer_store_dwordx4 v[16:19], v26, s[8:11], s32 offen sc1
    s_cmp_eq_u32 s28, 1
    s_cbranch_scc1 r1_24
    buffer_store_dwordx4 v[16:19], v23, s[8:11], s32 offen
    s_branch r2_25
r1_24:
    buffer_store_dword v16, v23, s[8:11], s32 offen
r2_25:
    buffer_store_dwordx4 v[236:239], v28, s[16:19], s47 offen sc1
    s_add_u32 s54, s29, 2
    s_min_u32 s54, s54, 63
    s_lshl_b32 s54, s54, 16
    buffer_store_dwordx4 v[16:19], v28, s[16:19], s54 offen sc1
    s_lshl_b32 s42, s29, 18
    s_add_u32 s44, s42, 0x1040000
    s_add_u32 s46, s42, 0x80000
    s_add_u32 s42, s42, 0x40000
    s_add_u32 s43, s42, 0x20000
    s_add_u32 s45, s44, 0x20000
    s_lshl_b32 s47, s29, 16
    s_waitcnt vmcnt(7)
    v_mfma_f32_16x16x32_bf16 v[160:163], v[72:75], a[192:195], 0
    v_mfma_f32_16x16x32_bf16 v[164:167], v[88:91], a[192:195], 0
    v_mfma_f32_16x16x32_bf16 v[168:171], v[72:75], a[208:211], 0
    v_mfma_f32_16x16x32_bf16 v[172:175], v[88:91], a[208:211], 0
    v_mfma_f32_16x16x32_bf16 v[176:179], v[72:75], a[224:227], 0
    v_mfma_f32_16x16x32_bf16 v[180:183], v[88:91], a[224:227], 0
    v_mfma_f32_16x16x32_bf16 v[184:187], v[72:75], a[240:243], 0
    v_mfma_f32_16x16x32_bf16 v[188:191], v[88:91], a[240:243], 0
    v_mfma_f32_16x16x32_bf16 v[160:163], v[76:79], a[196:199], v[160:163]
    v_mfma_f32_16x16x32_bf16 v[164:167], v[92:95], a[196:199], v[164:167]
    v_mfma_f32_16x16x32_bf16 v[168:171], v[76:79], a[212:215], v[168:171]
    v_mfma_f32_16x16x32_bf16 v[172:175], v[92:95], a[212:215], v[172:175]
    v_mfma_f32_16x16x32_bf16 v[176:179], v[76:79], a[228:231], v[176:179]
    v_mfma_f32_16x16x32_bf16 v[180:183], v[92:95], a[228:231], v[180:183]
    v_mfma_f32_16x16x32_bf16 v[184:187], v[76:79], a[244:247], v[184:187]
    v_mfma_f32_16x16x32_bf16 v[188:191], v[92:95], a[244:247], v[188:191]
    v_mfma_f32_16x16x32_bf16 v[160:163], v[80:83], a[200:203], v[160:163]
    v_mfma_f32_16x16x32_bf16 v[164:167], v[96:99], a[200:203], v[164:167]
    v_mfma_f32_16x16x32_bf16 v[168:171], v[80:83], a[216:219], v[168:171]
    v_mfma_f32_16x16x32_bf16 v[172:175], v[96:99], a[216:219], v[172:175]
    v_mfma_f32_16x16x32_bf16 v[176:179], v[80:83], a[232:235], v[176:179]
    v_mfma_f32_16x16x32_bf16 v[180:183], v[96:99], a[232:235], v[180:183]
    v_mfma_f32_16x16x32_bf16 v[184:187], v[80:83], a[248:251], v[184:187]
    v_mfma_f32_16x16x32_bf16 v[188:191], v[96:99], a[248:251], v[188:191]
    v_mfma_f32_16x16x32_bf16 v[160:163], v[84:87], a[204:207], v[160:163]
    v_mfma_f32_16x16x32_bf16 v[164:167], v[100:103], a[204:207], v[164:167]
    v_mfma_f32_16x16x32_bf16 v[168:171], v[84:87], a[220:223], v[168:171]
    v_mfma_f32_16x16x32_bf16 v[172:175], v[100:103], a[220:223], v[172:175]
    v_mfma_f32_16x16x32_bf16 v[176:179], v[84:87], a[236:239], v[176:179]
    v_mfma_f32_16x16x32_bf16 v[180:183], v[100:103], a[236:239], v[180:183]
    v_mfma_f32_16x16x32_bf16 v[184:187], v[84:87], a[252:255], v[184:187]
    v_mfma_f32_16x16x32_bf16 v[188:191], v[100:103], a[252:255], v[188:191]
    s_nop 0
    v_cvt_pk_bf16_f32 v104, v160, v161
    v_cvt_pk_bf16_f32 v105, v162, v163
    v_cvt_pk_bf16_f32 v106, v164, v165
    v_cvt_pk_bf16_f32 v107, v166, v167
    v_cvt_pk_bf16_f32 v108, v168, v169
    v_cvt_pk_bf16_f32 v109, v170, v171
    v_cvt_pk_bf16_f32 v110, v172, v173
    v_cvt_pk_bf16_f32 v111, v174, v175
    v_cvt_pk_bf16_f32 v112, v176, v177
    v_cvt_pk_bf16_f32 v113, v178, v179
    v_cvt_pk_bf16_f32 v114, v180, v181
    v_cvt_pk_bf16_f32 v115, v182, v183
    v_cvt_pk_bf16_f32 v116, v184, v185
    v_cvt_pk_bf16_f32 v117, v186, v187
    v_cvt_pk_bf16_f32 v118, v188, v189
    v_cvt_pk_bf16_f32 v119, v190, v191
    s_cmp_lg_u32 s28, 2
    s_cbranch_scc1 nt_26
nt_26:
    v_mov_b32 v136, 0
    v_mov_b32 v137, 0
    v_mov_b32 v138, 0
    v_mov_b32 v139, 0
    v_mov_b32 v140, 0
    v_mov_b32 v141, 0
    v_mov_b32 v142, 0
    v_mov_b32 v143, 0
    v_mov_b32 v144, 0
    v_mov_b32 v145, 0
    v_mov_b32 v146, 0
    v_mov_b32 v147, 0
    v_mov_b32 v148, 0
    v_mov_b32 v149, 0
    v_mov_b32 v150, 0
    v_mov_b32 v151, 0
    v_mov_b32 v152, 0
    v_mov_b32 v153, 0
    v_mov_b32 v154, 0
    v_mov_b32 v155, 0
    v_mov_b32 v156, 0
    v_mov_b32 v157, 0
    v_mov_b32 v158, 0
    v_mov_b32 v159, 0
    s_cmp_lg_u32 s28, 3
    s_cbranch_scc1 noA_27
    buffer_load_dwordx4 v[176:179], v20, s[8:11], s30 offen offset:0 sc1
    buffer_load_dwordx4 v[180:183], v20, s[8:11], s30 offen offset:1024 sc1
    buffer_load_dwordx4 v[184:187], v20, s[8:11], s30 offen offset:2048 sc1
    buffer_load_dwordx4 v[188:191], v20, s[8:11], s30 offen offset:3072 sc1
pw_28:
    s_waitcnt vmcnt(0)
    v_mfma_f32_16x16x32_bf16 v[160:163], v[36:39], v[176:179], 0
    v_max3_u32 v244, v176, v177, v178
    v_max3_u32 v245, v179, v180, v181
    v_max3_u32 v246, v182, v183, v184
    v_mfma_f32_16x16x32_bf16 v[160:163], v[36:39], v[180:183], v[160:163]
    v_max3_u32 v247, v185, v186, v187
    v_max3_u32 v248, v188, v189, v190
    v_max3_u32 v244, v244, v245, v246
    v_mfma_f32_16x16x32_bf16 v[160:163], v[240:243], v[184:187], v[160:163]
    v_max3_u32 v247, v247, v248, v191
    v_max_u32 v244, v244, v247
    v_cmp_eq_u32 vcc, -1, v244
    v_mfma_f32_16x16x32_bf16 v[160:163], v[240:243], v[188:191], v[160:163]
    s_cbranch_vccnz rt_29
    s_nop 6
    v_cvt_pk_bf16_f32 v244, v160, v161
    v_cvt_pk_bf16_f32 v245, v162, v163
    v_min_u32 v244, -2, v244
    v_min_u32 v245, -2, v245
    buffer_store_dwordx2 v[244:245], v21, s[8:11], s31 offen
    buffer_store_dwordx2 v[16:17], v21, s[8:11], s33 offen
noA_27:
    s_barrier
    s_sleep 3
    buffer_load_dwordx4 v[120:123], v22, s[8:11], s31 offen offset:0 sc1
    buffer_load_dwordx4 v[124:127], v22, s[8:11], s31 offen offset:1024 sc1
    buffer_load_dwordx4 v[128:131], v22, s[8:11], s31 offen offset:2048 sc1
    buffer_load_dwordx4 v[132:135], v22, s[8:11], s31 offen offset:3072 sc1
pw_30:
    s_waitcnt vmcnt(0)
    v_smfmac_f32_16x16x64_bf16 v[136:139], v[120:123], a[0:7], v1
    v_max3_u32 v244, v120, v121, v122
    v_max3_u32 v245, v123, v124, v125
    v_max3_u32 v246, v126, v127, v128
    v_smfmac_f32_16x16x64_bf16 v[140:143], v[120:123], a[32:39], v1
    v_max3_u32 v247, v129, v130, v131
    v_max3_u32 v248, v132, v133, v134
    v_max3_u32 v244, v244, v245, v246
    v_smfmac_f32_16x16x64_bf16 v[136:139], v[124:127], a[8:15], v1
    v_max3_u32 v247, v247, v248, v135
    v_max_u32 v244, v244, v247
    v_cmp_eq_u32 vcc, -1, v244
    v_smfmac_f32_16x16x64_bf16 v[140:143], v[124:127], a[40:47], v1
    s_cbranch_vccnz rt_31
    v_smfmac_f32_16x16x64_bf16 v[136:139], v[128:131], a[16:23], v1
    v_smfmac_f32_16x16x64_bf16 v[140:143], v[128:131], a[48:55], v1
    v_smfmac_f32_16x16x64_bf16 v[136:139], v[132:135], a[24:31], v1
    v_smfmac_f32_16x16x64_bf16 v[140:143], v[132:135], a[56:63], v1
    v_smfmac_f32_16x16x64_bf16 v[144:147], v[120:123], a[64:71], v1
    v_smfmac_f32_16x16x64_bf16 v[148:151], v[120:123], a[96:103], v1
    v_smfmac_f32_16x16x64_bf16 v[144:147], v[124:127], a[72:79], v1
    v_smfmac_f32_16x16x64_bf16 v[148:151], v[124:127], a[104:111], v1
    s_nop 3
    v_permlane32_swap_b32 v136, v140
    v_smfmac_f32_16x16x64_bf16 v[144:147], v[128:131], a[80:87], v1
    v_permlane32_swap_b32 v137, v141
    v_smfmac_f32_16x16x64_bf16 v[148:151], v[128:131], a[112:119], v1
    v_permlane32_swap_b32 v138, v142
    v_smfmac_f32_16x16x64_bf16 v[144:147], v[132:135], a[88:95], v1
    v_permlane32_swap_b32 v139, v143
    v_smfmac_f32_16x16x64_bf16 v[148:151], v[132:135], a[120:127], v1
    v_pk_add_f32 v[136:137], v[136:137], v[140:141]
    v_smfmac_f32_16x16x64_bf16 v[152:155], v[120:123], a[128:135], v1
    v_pk_add_f32 v[138:139], v[138:139], v[142:143]
    v_smfmac_f32_16x16x64_bf16 v[156:159], v[120:123], a[160:167], v1
    ds_write_b128 v30, v[136:139]
    v_smfmac_f32_16x16x64_bf16 v[152:155], v[124:127], a[136:143], v1
    v_smfmac_f32_16x16x64_bf16 v[156:159], v[124:127], a[168:175], v1
    s_nop 0
    v_permlane32_swap_b32 v144, v148
    v_permlane32_swap_b32 v145, v149
    v_smfmac_f32_16x16x64_bf16 v[152:155], v[128:131], a[144:151], v1
    v_permlane32_swap_b32 v146, v150
    v_smfmac_f32_16x16x64_bf16 v[156:159], v[128:131], a[176:183], v1
    v_permlane32_swap_b32 v147, v151
    v_pk_add_f32 v[144:145], v[144:145], v[148:149]
    v_smfmac_f32_16x16x64_bf16 v[152:155], v[132:135], a[152:159], v1
    v_pk_add_f32 v[146:147], v[146:147], v[150:151]
    v_smfmac_f32_16x16x64_bf16 v[156:159], v[132:135], a[184:191], v1
    ds_write_b128 v30, v[144:147] offset:4096
    s_nop 6
    v_permlane32_swap_b32 v152, v156
    v_permlane32_swap_b32 v153, v157
    v_permlane32_swap_b32 v154, v158
    v_permlane32_swap_b32 v155, v159
    v_pk_add_f32 v[152:153], v[152:153], v[156:157]
    v_pk_add_f32 v[154:155], v[154:155], v[158:159]
    ds_write_b128 v30, v[152:155] offset:8192
    s_waitcnt lgkmcnt(0)
    s_barrier
    s_cmp_eq_u32 s28, 3
    s_cbranch_scc1 be_34
    ds_read_b128 v[160:163], v35 offset:0
    ds_read_b128 v[164:167], v35 offset:1024
    ds_read_b128 v[168:171], v35 offset:2048
    ds_read_b128 v[172:175], v35 offset:3072
    s_cmp_eq_u32 s28, 1
    s_cbranch_scc1 b1_32
    s_cmp_eq_u32 s28, 2
    s_cbranch_scc1 b2_33
    s_waitcnt lgkmcnt(2)
    v_pk_add_f32 v[160:161], v[160:161], v[164:165]
    v_pk_add_f32 v[162:163], v[162:163], v[166:167]
    s_waitcnt lgkmcnt(0)
    v_pk_add_f32 v[168:169], v[168:169], v[172:173]
    v_pk_add_f32 v[170:171], v[170:171], v[174:175]
    v_pk_add_f32 v[160:161], v[160:161], v[168:169]
    v_pk_add_f32 v[162:163], v[162:163], v[170:171]
    v_cvt_pk_bf16_f32 v244, v160, v161
    v_cvt_pk_bf16_f32 v245, v162, v163
    s_nop 1
    v_mfma_f32_16x16x16_bf16 v[164:167], v[244:245], v[2:3], 0
    v_mfma_f32_16x16x16_bf16 v[168:171], v[244:245], v[4:5], 0
    s_nop 6
    v_cvt_pk_bf16_f32 v172, v164, v165
    v_cvt_pk_bf16_f32 v173, v166, v167
    v_cvt_pk_bf16_f32 v174, v168, v169
    v_cvt_pk_bf16_f32 v175, v170, v171
    s_nop 1
    v_mfma_f32_16x16x32_bf16 v[160:163], v[40:43], v[172:175], 0
    v_mfma_f32_16x16x32_bf16 v[164:167], v[44:47], v[172:175], 0
    s_nop 7
    v_mov_b32_dpp v160, v164 quad_perm:[0,1,2,3] row_mask:0xf bank_mask:0xc
    v_mov_b32_dpp v161, v165 quad_perm:[0,1,2,3] row_mask:0xf bank_mask:0xc
    v_mov_b32_dpp v162, v166 quad_perm:[0,1,2,3] row_mask:0xf bank_mask:0xc
    v_mov_b32_dpp v163, v167 quad_perm:[0,1,2,3] row_mask:0xf bank_mask:0xc
    v_min_u32 v160, -2, v160
    v_min_u32 v161, -2, v161
    v_min_u32 v162, -2, v162
    v_min_u32 v163, -2, v163
    buffer_store_dwordx4 v[160:163], v23, s[8:11], s31 offen
    s_branch be_34
b1_32:
    ds_read_b128 v[48:51], v31 offset:0
    ds_read_b128 v[52:55], v31 offset:1024
    ds_read_b128 v[56:59], v31 offset:2048
    ds_read_b128 v[60:63], v31 offset:3072
    s_waitcnt lgkmcnt(6)
    v_pk_add_f32 v[160:161], v[160:161], v[164:165]
    v_pk_add_f32 v[162:163], v[162:163], v[166:167]
    s_waitcnt lgkmcnt(4)
    v_pk_add_f32 v[168:169], v[168:169], v[172:173]
    v_pk_add_f32 v[170:171], v[170:171], v[174:175]
    v_pk_add_f32 v[160:161], v[160:161], v[168:169]
    v_pk_add_f32 v[162:163], v[162:163], v[170:171]
    v_cvt_pk_bf16_f32 v246, v160, v161
    v_cvt_pk_bf16_f32 v247, v162, v163
    s_waitcnt lgkmcnt(2)
    s_nop 0
    v_mfma_f32_16x16x16_bf16 v[164:167], v[246:247], v[68:69], 0
    v_pk_add_f32 v[48:49], v[48:49], v[52:53]
    v_pk_add_f32 v[50:51], v[50:51], v[54:55]
    v_mfma_f32_16x16x16_bf16 v[168:171], v[246:247], v[70:71], 0
    s_waitcnt lgkmcnt(0)
    v_pk_add_f32 v[56:57], v[56:57], v[60:61]
    v_pk_add_f32 v[58:59], v[58:59], v[62:63]
    v_pk_add_f32 v[48:49], v[48:49], v[56:57]
    v_pk_add_f32 v[50:51], v[50:51], v[58:59]
    v_cvt_pk_bf16_f32 v244, v48, v49
    v_cvt_pk_bf16_f32 v245, v50, v51
    s_nop 1
    v_mfma_f32_16x16x16_bf16 v[52:55], v[244:245], v[2:3], 0
    v_mfma_f32_16x16x16_bf16 v[56:59], v[244:245], v[4:5], 0
    v_cvt_pk_bf16_f32 v172, v164, v165
    v_cvt_pk_bf16_f32 v173, v166, v167
    v_cvt_pk_bf16_f32 v174, v168, v169
    v_cvt_pk_bf16_f32 v175, v170, v171
    s_nop 2
    v_cvt_pk_bf16_f32 v60, v52, v53
    v_cvt_pk_bf16_f32 v61, v54, v55
    v_cvt_pk_bf16_f32 v62, v56, v57
    v_cvt_pk_bf16_f32 v63, v58, v59
    s_nop 1
    v_mfma_f32_16x16x32_bf16 v[48:51], v[172:175], v[60:63], 0
    v_min_u32 v236, -2, v172
    v_min_u32 v237, -2, v173
    v_min_u32 v238, -2, v174
    v_min_u32 v239, -2, v175
    s_nop 3
    v_mov_b32_dpp v48, v49 quad_perm:[0,1,2,3] row_mask:0xf bank_mask:0xc
    v_min_u32 v48, -2, v48
    buffer_store_dword v48, v23, s[8:11], s31 offen
    s_branch be_34
b2_33:
    s_waitcnt lgkmcnt(2)
    v_pk_add_f32 v[160:161], v[160:161], v[164:165]
    v_pk_add_f32 v[162:163], v[162:163], v[166:167]
    s_waitcnt lgkmcnt(0)
    v_pk_add_f32 v[168:169], v[168:169], v[172:173]
    v_pk_add_f32 v[170:171], v[170:171], v[174:175]
    v_pk_add_f32 v[160:161], v[160:161], v[168:169]
    v_pk_add_f32 v[162:163], v[162:163], v[170:171]
    v_cvt_pk_bf16_f32 v244, v160, v161
    v_cvt_pk_bf16_f32 v245, v162, v163
    s_nop 1
    v_mfma_f32_16x16x16_bf16 v[164:167], v[244:245], v[2:3], 0
    v_mfma_f32_16x16x16_bf16 v[168:171], v[244:245], v[4:5], 0
    s_nop 6
    v_cvt_pk_bf16_f32 v236, v164, v165
    v_cvt_pk_bf16_f32 v237, v166, v167
    v_cvt_pk_bf16_f32 v238, v168, v169
    v_cvt_pk_bf16_f32 v239, v170, v171
    v_min_u32 v236, -2, v236
    v_min_u32 v237, -2, v237
    v_min_u32 v238, -2, v238
    v_min_u32 v239, -2, v239
    buffer_store_dwordx4 v[236:239], v23, s[8:11], s31 offen
be_34:
    s_barrier
    s_sleep 2
xv_35:
    buffer_load_dwordx4 v[176:179], v25, s[8:11], s31 offen offset:0 sc1
    buffer_load_dwordx4 v[180:183], v25, s[8:11], s31 offen offset:1024 sc1
    buffer_load_dwordx4 v[48:51], v24, s[8:11], s31 offen offset:0 sc1
    buffer_load_dwordx4 v[52:55], v24, s[8:11], s31 offen offset:1024 sc1
    buffer_load_dwordx4 v[56:59], v24, s[8:11], s31 offen offset:2048 sc1
    buffer_load_dwordx4 v[60:63], v24, s[8:11], s31 offen offset:3072 sc1
    buffer_load_dwordx4 v[64:67], v14, s[8:11], s31 offen sc1
    s_waitcnt vmcnt(5)
    v_mfma_f32_16x16x32_bf16 v[204:207], v[176:179], a[196:199], 0
    v_max3_u32 v244, v176, v177, v178
    v_max3_u32 v245, v179, v180, v181
    v_max_u32 v246, v182, v183
    v_mfma_f32_16x16x32_bf16 v[208:211], v[176:179], a[212:215], 0
    v_max3_u32 v244, v244, v245, v246
    v_cmp_eq_u32 vcc, -1, v244
    v_mfma_f32_16x16x32_bf16 v[212:215], v[176:179], a[228:231], 0
    v_mov_b32_dpp v184, v176 row_ror:8 row_mask:0xf bank_mask:0xf
    v_mov_b32_dpp v185, v177 row_ror:8 row_mask:0xf bank_mask:0xf
    v_mfma_f32_16x16x32_bf16 v[216:219], v[176:179], a[244:247], 0
    s_cbranch_vccnz rt_37
    v_mov_b32_dpp v186, v178 row_ror:8 row_mask:0xf bank_mask:0xf
    v_mov_b32_dpp v187, v179 row_ror:8 row_mask:0xf bank_mask:0xf
    v_mfma_f32_16x16x32_bf16 v[204:207], v[180:183], a[204:207], v[204:207]
    v_mov_b32_dpp v188, v180 row_ror:8 row_mask:0xf bank_mask:0xf
    v_mfma_f32_16x16x32_bf16 v[208:211], v[180:183], a[220:223], v[208:211]
    v_mov_b32_dpp v189, v181 row_ror:8 row_mask:0xf bank_mask:0xf
    v_mfma_f32_16x16x32_bf16 v[212:215], v[180:183], a[236:239], v[212:215]
    v_mov_b32_dpp v190, v182 row_ror:8 row_mask:0xf bank_mask:0xf
    v_mfma_f32_16x16x32_bf16 v[216:219], v[180:183], a[252:255], v[216:219]
    v_mov_b32_dpp v191, v183 row_ror:8 row_mask:0xf bank_mask:0xf
pw_38:
    s_waitcnt vmcnt(0)
    v_max3_u32 v244, v48, v49, v50
    v_max3_u32 v245, v51, v52, v53
    v_max3_u32 v246, v54, v55, v56
    v_max3_u32 v247, v57, v58, v59
    v_max3_u32 v248, v60, v61, v62
    v_max3_u32 v249, v63, v64, v65
    v_max_u32 v250, v66, v67
    v_max3_u32 v244, v244, v245, v246
    v_pk_add_f32 v[48:49], v[48:49], v[52:53]
    v_max3_u32 v247, v247, v248, v249
    v_pk_add_f32 v[50:51], v[50:51], v[54:55]
    v_max3_u32 v244, v244, v247, v250
    v_pk_add_f32 v[56:57], v[56:57], v[60:61]
    v_cmp_eq_u32 vcc, -1, v244
    v_pk_add_f32 v[58:59], v[58:59], v[62:63]
    v_pk_add_f32 v[64:65], v[64:65], v[66:67]
    s_cbranch_vccnz rt_39
    buffer_load_dwordx4 v[72:75], v27, s[12:15], s44 offen offset:0
    v_pk_add_f32 v[192:193], v[48:49], v[56:57]
    v_mfma_f32_16x16x32_bf16 v[204:207], v[184:187], a[192:195], v[204:207]
    buffer_load_dwordx4 v[88:91], v27, s[12:15], s45 offen offset:0
    v_pk_add_f32 v[194:195], v[50:51], v[58:59]
    v_add_f32 v196, v64, v65
    v_mfma_f32_16x16x32_bf16 v[208:211], v[184:187], a[208:211], v[208:211]
    buffer_load_dwordx4 v[76:79], v27, s[12:15], s44 offen offset:1024
    v_max3_f32 v244, v192, v193, v194
    v_max3_f32 v244, v244, v195, v196
    buffer_load_dwordx4 v[92:95], v27, s[12:15], s45 offen offset:1024
    v_mfma_f32_16x16x32_bf16 v[212:215], v[184:187], a[224:227], v[212:215]
    v_max_f32_dpp v244, v244, v244 row_ror:8 row_mask:0xf bank_mask:0xf
    v_mov_b32 v245, v244
    buffer_load_dwordx4 v[80:83], v27, s[12:15], s44 offen offset:2048
    v_mfma_f32_16x16x32_bf16 v[216:219], v[184:187], a[240:243], v[216:219]
    v_permlane32_swap_b32 v244, v245
    buffer_load_dwordx4 v[96:99], v27, s[12:15], s45 offen offset:2048
    v_max_f32 v244, v244, v245
    v_mfma_f32_16x16x32_bf16 v[204:207], v[188:191], a[200:203], v[204:207]
    v_mov_b32 v245, v244
    buffer_load_dwordx4 v[84:87], v27, s[12:15], s44 offen offset:3072
    s_nop 0
    v_permlane16_swap_b32 v244, v245
    v_mfma_f32_16x16x32_bf16 v[208:211], v[188:191], a[216:219], v[208:211]
    buffer_load_dwordx4 v[100:103], v27, s[12:15], s45 offen offset:3072
    v_max_f32 v244, v244, v245
    v_mul_f32 v244, s49, v244
    v_mfma_f32_16x16x32_bf16 v[212:215], v[188:191], a[232:235], v[212:215]
    buffer_load_dwordx4 v[40:43], v13, s[12:15], s42 offen
    v_fma_f32 v192, v192, s49, -v244
    v_fma_f32 v193, v193, s49, -v244
    buffer_load_dwordx4 v[44:47], v13, s[12:15], s43 offen
    v_mfma_f32_16x16x32_bf16 v[216:219], v[188:191], a[248:251], v[216:219]
    v_fma_f32 v194, v194, s49, -v244
    v_fma_f32 v195, v195, s49, -v244
    v_fma_f32 v196, v196, s49, -v244
    v_exp_f32 v192, v192
    v_exp_f32 v193, v193
    v_exp_f32 v194, v194
    v_exp_f32 v195, v195
    v_exp_f32 v196, v196
    v_cvt_pk_bf16_f32 v228, v192, v193
    v_cvt_pk_bf16_f32 v229, v194, v195
    v_mov_b32_dpp v246, v196 row_ror:8 row_mask:0xf bank_mask:0xf
    v_mov_b32_dpp v230, v228 row_ror:8 row_mask:0xf bank_mask:0xf
    v_mov_b32_dpp v231, v229 row_ror:8 row_mask:0xf bank_mask:0xf
    v_cvt_pk_bf16_f32 v232, v196, v246
    s_nop 0
    v_mfma_f32_16x16x32_bf16 v[152:155], v[8:11], v[228:231], 0
    v_mov_b32 v233, v232
    v_cvt_pk_bf16_f32 v220, v204, v205
    v_cvt_pk_bf16_f32 v221, v206, v207
    v_mfma_f32_16x16x32_bf16 v[136:139], v[104:107], v[228:231], 0
    v_permlane32_swap_b32 v232, v233
    v_cvt_pk_bf16_f32 v222, v208, v209
    v_cvt_pk_bf16_f32 v223, v210, v211
    v_mfma_f32_16x16x32_bf16 v[140:143], v[108:111], v[228:231], 0
    v_and_b32 v232, v232, v12
    v_and_b32 v233, v233, v12
    v_cvt_pk_bf16_f32 v224, v212, v213
    v_mfma_f32_16x16x32_bf16 v[144:147], v[112:115], v[228:231], 0
    v_cvt_pk_bf16_f32 v225, v214, v215
    v_cvt_pk_bf16_f32 v226, v216, v217
    v_cvt_pk_bf16_f32 v227, v218, v219
    v_mfma_f32_16x16x32_bf16 v[148:151], v[116:119], v[228:231], 0
    v_mfma_f32_16x16x16_bf16 v[152:155], v[8:9], v[232:233], v[152:155]
    v_mfma_f32_16x16x16_bf16 v[136:139], v[220:221], v[232:233], v[136:139]
    v_mfma_f32_16x16x16_bf16 v[140:143], v[222:223], v[232:233], v[140:143]
    v_mfma_f32_16x16x16_bf16 v[144:147], v[224:225], v[232:233], v[144:147]
    s_nop 1
    v_mfma_f32_16x16x16_bf16 v[148:151], v[226:227], v[232:233], v[148:151]
    s_nop 1
    v_rcp_f32 v244, v152
    s_nop 0
    v_pk_mul_f32 v[136:137], v[136:137], v[244:245] op_sel_hi:[1,0]
    v_pk_mul_f32 v[138:139], v[138:139], v[244:245] op_sel_hi:[1,0]
    v_pk_mul_f32 v[144:145], v[144:145], v[244:245] op_sel_hi:[1,0]
    v_pk_mul_f32 v[146:147], v[146:147], v[244:245] op_sel_hi:[1,0]
    v_mul_f32_dpp v136, v140, v244 row_shr:8 row_mask:0xf bank_mask:0xc
    v_mul_f32_dpp v137, v141, v244 row_shr:8 row_mask:0xf bank_mask:0xc
    v_mul_f32_dpp v138, v142, v244 row_shr:8 row_mask:0xf bank_mask:0xc
    v_mul_f32_dpp v139, v143, v244 row_shr:8 row_mask:0xf bank_mask:0xc
    ds_write_b128 v32, v[136:139] offset:0
    v_mul_f32_dpp v144, v148, v244 row_shr:8 row_mask:0xf bank_mask:0xc
    v_mul_f32_dpp v145, v149, v244 row_shr:8 row_mask:0xf bank_mask:0xc
    v_mul_f32_dpp v146, v150, v244 row_shr:8 row_mask:0xf bank_mask:0xc
    v_mul_f32_dpp v147, v151, v244 row_shr:8 row_mask:0xf bank_mask:0xc
    ds_write_b128 v32, v[144:147] offset:1024
    s_waitcnt lgkmcnt(0)
    s_barrier
    s_cmp_ge_u32 s28, 2
    s_cbranch_scc1 c1_40
    ds_read_b128 v[160:163], v33 offset:0
    ds_read_b128 v[164:167], v33 offset:2048
    ds_read_b128 v[168:171], v33 offset:4096
    ds_read_b128 v[172:175], v33 offset:6144
    s_waitcnt lgkmcnt(2)
    v_pk_add_f32 v[160:161], v[160:161], v[164:165]
    v_pk_add_f32 v[162:163], v[162:163], v[166:167]
    s_waitcnt lgkmcnt(0)
    v_pk_add_f32 v[168:169], v[168:169], v[172:173]
    v_pk_add_f32 v[170:171], v[170:171], v[174:175]
    v_pk_add_f32 v[160:161], v[160:161], v[168:169]
    v_pk_add_f32 v[162:163], v[162:163], v[170:171]
    v_cvt_pk_bf16_f32 v164, v160, v161
    v_cvt_pk_bf16_f32 v165, v162, v163
    v_min_u32 v164, -2, v164
    v_min_u32 v165, -2, v165
    v_mov_b32 v166, v164
    v_mov_b32 v167, v165
    s_nop 0
    v_permlane16_swap_b32 v164, v166
    v_permlane16_swap_b32 v165, v167
c1_40:
    buffer_store_dwordx4 v[164:167], v26, s[8:11], s31 offen sc1
    s_add_u32 s29, s29, 1
    buffer_store_dwordx4 v[16:19], v26, s[8:11], s33 offen sc1
    s_cmp_eq_u32 s28, 1
    s_cbranch_scc1 r1_41
    buffer_store_dwordx4 v[16:19], v23, s[8:11], s33 offen
    s_branch r2_42
r1_41:
    buffer_store_dword v16, v23, s[8:11], s33 offen
r2_42:
    buffer_store_dwordx4 v[236:239], v28, s[16:19], s47 offen sc1
    s_add_u32 s54, s29, 2
    s_min_u32 s54, s54, 63
    s_lshl_b32 s54, s54, 16
    buffer_store_dwordx4 v[16:19], v28, s[16:19], s54 offen sc1
    s_lshl_b32 s42, s29, 18
    s_add_u32 s44, s42, 0x1040000
    s_add_u32 s46, s42, 0x80000
    s_add_u32 s42, s42, 0x40000
    s_add_u32 s43, s42, 0x20000
    s_add_u32 s45, s44, 0x20000
    s_lshl_b32 s47, s29, 16
    s_waitcnt vmcnt(7)
    v_mfma_f32_16x16x32_bf16 v[160:163], v[72:75], a[192:195], 0
    v_mfma_f32_16x16x32_bf16 v[164:167], v[88:91], a[192:195], 0
    v_mfma_f32_16x16x32_bf16 v[168:171], v[72:75], a[208:211], 0
    v_mfma_f32_16x16x32_bf16 v[172:175], v[88:91], a[208:211], 0
    v_mfma_f32_16x16x32_bf16 v[176:179], v[72:75], a[224:227], 0
    v_mfma_f32_16x16x32_bf16 v[180:183], v[88:91], a[224:227], 0
    v_mfma_f32_16x16x32_bf16 v[184:187], v[72:75], a[240:243], 0
    v_mfma_f32_16x16x32_bf16 v[188:191], v[88:91], a[240:243], 0
    v_mfma_f32_16x16x32_bf16 v[160:163], v[76:79], a[196:199], v[160:163]
    v_mfma_f32_16x16x32_bf16 v[164:167], v[92:95], a[196:199], v[164:167]
    v_mfma_f32_16x16x32_bf16 v[168:171], v[76:79], a[212:215], v[168:171]
    v_mfma_f32_16x16x32_bf16 v[172:175], v[92:95], a[212:215], v[172:175]
    v_mfma_f32_16x16x32_bf16 v[176:179], v[76:79], a[228:231], v[176:179]
    v_mfma_f32_16x16x32_bf16 v[180:183], v[92:95], a[228:231], v[180:183]
    v_mfma_f32_16x16x32_bf16 v[184:187], v[76:79], a[244:247], v[184:187]
    v_mfma_f32_16x16x32_bf16 v[188:191], v[92:95], a[244:247], v[188:191]
    v_mfma_f32_16x16x32_bf16 v[160:163], v[80:83], a[200:203], v[160:163]
    v_mfma_f32_16x16x32_bf16 v[164:167], v[96:99], a[200:203], v[164:167]
    v_mfma_f32_16x16x32_bf16 v[168:171], v[80:83], a[216:219], v[168:171]
    v_mfma_f32_16x16x32_bf16 v[172:175], v[96:99], a[216:219], v[172:175]
    v_mfma_f32_16x16x32_bf16 v[176:179], v[80:83], a[232:235], v[176:179]
    v_mfma_f32_16x16x32_bf16 v[180:183], v[96:99], a[232:235], v[180:183]
    v_mfma_f32_16x16x32_bf16 v[184:187], v[80:83], a[248:251], v[184:187]
    v_mfma_f32_16x16x32_bf16 v[188:191], v[96:99], a[248:251], v[188:191]
    v_mfma_f32_16x16x32_bf16 v[160:163], v[84:87], a[204:207], v[160:163]
    v_mfma_f32_16x16x32_bf16 v[164:167], v[100:103], a[204:207], v[164:167]
    v_mfma_f32_16x16x32_bf16 v[168:171], v[84:87], a[220:223], v[168:171]
    v_mfma_f32_16x16x32_bf16 v[172:175], v[100:103], a[220:223], v[172:175]
    v_mfma_f32_16x16x32_bf16 v[176:179], v[84:87], a[236:239], v[176:179]
    v_mfma_f32_16x16x32_bf16 v[180:183], v[100:103], a[236:239], v[180:183]
    v_mfma_f32_16x16x32_bf16 v[184:187], v[84:87], a[252:255], v[184:187]
    v_mfma_f32_16x16x32_bf16 v[188:191], v[100:103], a[252:255], v[188:191]
    s_nop 0
    v_cvt_pk_bf16_f32 v104, v160, v161
    v_cvt_pk_bf16_f32 v105, v162, v163
    v_cvt_pk_bf16_f32 v106, v164, v165
    v_cvt_pk_bf16_f32 v107, v166, v167
    v_cvt_pk_bf16_f32 v108, v168, v169
    v_cvt_pk_bf16_f32 v109, v170, v171
    v_cvt_pk_bf16_f32 v110, v172, v173
    v_cvt_pk_bf16_f32 v111, v174, v175
    v_cvt_pk_bf16_f32 v112, v176, v177
    v_cvt_pk_bf16_f32 v113, v178, v179
    v_cvt_pk_bf16_f32 v114, v180, v181
    v_cvt_pk_bf16_f32 v115, v182, v183
    v_cvt_pk_bf16_f32 v116, v184, v185
    v_cvt_pk_bf16_f32 v117, v186, v187
    v_cvt_pk_bf16_f32 v118, v188, v189
    v_cvt_pk_bf16_f32 v119, v190, v191
    s_cmp_lg_u32 s28, 2
    s_cbranch_scc1 nt_43
nt_43:
    v_mov_b32 v136, 0
    v_mov_b32 v137, 0
    v_mov_b32 v138, 0
    v_mov_b32 v139, 0
    v_mov_b32 v140, 0
    v_mov_b32 v141, 0
    v_mov_b32 v142, 0
    v_mov_b32 v143, 0
    v_mov_b32 v144, 0
    v_mov_b32 v145, 0
    v_mov_b32 v146, 0
    v_mov_b32 v147, 0
    v_mov_b32 v148, 0
    v_mov_b32 v149, 0
    v_mov_b32 v150, 0
    v_mov_b32 v151, 0
    v_mov_b32 v152, 0
    v_mov_b32 v153, 0
    v_mov_b32 v154, 0
    v_mov_b32 v155, 0
    v_mov_b32 v156, 0
    v_mov_b32 v157, 0
    v_mov_b32 v158, 0
    v_mov_b32 v159, 0
    s_cmp_lg_u32 s28, 3
    s_cbranch_scc1 noA_44
    buffer_load_dwordx4 v[176:179], v20, s[8:11], s31 offen offset:0 sc1
    buffer_load_dwordx4 v[180:183], v20, s[8:11], s31 offen offset:1024 sc1
    buffer_load_dwordx4 v[184:187], v20, s[8:11], s31 offen offset:2048 sc1
    buffer_load_dwordx4 v[188:191], v20, s[8:11], s31 offen offset:3072 sc1
pw_45:
    s_waitcnt vmcnt(0)
    v_mfma_f32_16x16x32_bf16 v[160:163], v[36:39], v[176:179], 0
    v_max3_u32 v244, v176, v177, v178
    v_max3_u32 v245, v179, v180, v181
    v_max3_u32 v246, v182, v183, v184
    v_mfma_f32_16x16x32_bf16 v[160:163], v[36:39], v[180:183], v[160:163]
    v_max3_u32 v247, v185, v186, v187
    v_max3_u32 v248, v188, v189, v190
    v_max3_u32 v244, v244, v245, v246
    v_mfma_f32_16x16x32_bf16 v[160:163], v[240:243], v[184:187], v[160:163]
    v_max3_u32 v247, v247, v248, v191
    v_max_u32 v244, v244, v247
    v_cmp_eq_u32 vcc, -1, v244
    v_mfma_f32_16x16x32_bf16 v[160:163], v[240:243], v[188:191], v[160:163]
    s_cbranch_vccnz rt_46
    s_nop 6
    v_cvt_pk_bf16_f32 v244, v160, v161
    v_cvt_pk_bf16_f32 v245, v162, v163
    v_min_u32 v244, -2, v244
    v_min_u32 v245, -2, v245
    buffer_store_dwordx2 v[244:245], v21, s[8:11], s32 offen
    buffer_store_dwordx2 v[16:17], v21, s[8:11], s30 offen
noA_44:
    s_barrier
    s_sleep 3
    buffer_load_dwordx4 v[120:123], v22, s[8:11], s32 offen offset:0 sc1
    buffer_load_dwordx4 v[124:127], v22, s[8:11], s32 offen offset:1024 sc1
    buffer_load_dwordx4 v[128:131], v22, s[8:11], s32 offen offset:2048 sc1
    buffer_load_dwordx4 v[132:135], v22, s[8:11], s32 offen offset:3072 sc1
pw_47:
    s_waitcnt vmcnt(0)
    v_smfmac_f32_16x16x64_bf16 v[136:139], v[120:123], a[0:7], v1
    v_max3_u32 v244, v120, v121, v122
    v_max3_u32 v245, v123, v124, v125
    v_max3_u32 v246, v126, v127, v128
    v_smfmac_f32_16x16x64_bf16 v[140:143], v[120:123], a[32:39], v1
    v_max3_u32 v247, v129, v130, v131
    v_max3_u32 v248, v132, v133, v134
    v_max3_u32 v244, v244, v245, v246
    v_smfmac_f32_16x16x64_bf16 v[136:139], v[124:127], a[8:15], v1
    v_max3_u32 v247, v247, v248, v135
    v_max_u32 v244, v244, v247
    v_cmp_eq_u32 vcc, -1, v244
    v_smfmac_f32_16x16x64_bf16 v[140:143], v[124:127], a[40:47], v1
    s_cbranch_vccnz rt_48
    v_smfmac_f32_16x16x64_bf16 v[136:139], v[128:131], a[16:23], v1
    v_smfmac_f32_16x16x64_bf16 v[140:143], v[128:131], a[48:55], v1
    v_smfmac_f32_16x16x64_bf16 v[136:139], v[132:135], a[24:31], v1
    v_smfmac_f32_16x16x64_bf16 v[140:143], v[132:135], a[56:63], v1
    v_smfmac_f32_16x16x64_bf16 v[144:147], v[120:123], a[64:71], v1
    v_smfmac_f32_16x16x64_bf16 v[148:151], v[120:123], a[96:103], v1
    v_smfmac_f32_16x16x64_bf16 v[144:147], v[124:127], a[72:79], v1
    v_smfmac_f32_16x16x64_bf16 v[148:151], v[124:127], a[104:111], v1
    s_nop 3
    v_permlane32_swap_b32 v136, v140
    v_smfmac_f32_16x16x64_bf16 v[144:147], v[128:131], a[80:87], v1
    v_permlane32_swap_b32 v137, v141
    v_smfmac_f32_16x16x64_bf16 v[148:151], v[128:131], a[112:119], v1
    v_permlane32_swap_b32 v138, v142
    v_smfmac_f32_16x16x64_bf16 v[144:147], v[132:135], a[88:95], v1
    v_permlane32_swap_b32 v139, v143
    v_smfmac_f32_16x16x64_bf16 v[148:151], v[132:135], a[120:127], v1
    v_pk_add_f32 v[136:137], v[136:137], v[140:141]
    v_smfmac_f32_16x16x64_bf16 v[152:155], v[120:123], a[128:135], v1
    v_pk_add_f32 v[138:139], v[138:139], v[142:143]
    v_smfmac_f32_16x16x64_bf16 v[156:159], v[120:123], a[160:167], v1
    ds_write_b128 v30, v[136:139]
    v_smfmac_f32_16x16x64_bf16 v[152:155], v[124:127], a[136:143], v1
    v_smfmac_f32_16x16x64_bf16 v[156:159], v[124:127], a[168:175], v1
    s_nop 0
    v_permlane32_swap_b32 v144, v148
    v_permlane32_swap_b32 v145, v149
    v_smfmac_f32_16x16x64_bf16 v[152:155], v[128:131], a[144:151], v1
    v_permlane32_swap_b32 v146, v150
    v_smfmac_f32_16x16x64_bf16 v[156:159], v[128:131], a[176:183], v1
    v_permlane32_swap_b32 v147, v151
    v_pk_add_f32 v[144:145], v[144:145], v[148:149]
    v_smfmac_f32_16x16x64_bf16 v[152:155], v[132:135], a[152:159], v1
    v_pk_add_f32 v[146:147], v[146:147], v[150:151]
    v_smfmac_f32_16x16x64_bf16 v[156:159], v[132:135], a[184:191], v1
    ds_write_b128 v30, v[144:147] offset:4096
    s_nop 6
    v_permlane32_swap_b32 v152, v156
    v_permlane32_swap_b32 v153, v157
    v_permlane32_swap_b32 v154, v158
    v_permlane32_swap_b32 v155, v159
    v_pk_add_f32 v[152:153], v[152:153], v[156:157]
    v_pk_add_f32 v[154:155], v[154:155], v[158:159]
    ds_write_b128 v30, v[152:155] offset:8192
    s_waitcnt lgkmcnt(0)
    s_barrier
    s_cmp_eq_u32 s28, 3
    s_cbranch_scc1 be_51
    ds_read_b128 v[160:163], v35 offset:0
    ds_read_b128 v[164:167], v35 offset:1024
    ds_read_b128 v[168:171], v35 offset:2048
    ds_read_b128 v[172:175], v35 offset:3072
    s_cmp_eq_u32 s28, 1
    s_cbranch_scc1 b1_49
    s_cmp_eq_u32 s28, 2
    s_cbranch_scc1 b2_50
    s_waitcnt lgkmcnt(2)
    v_pk_add_f32 v[160:161], v[160:161], v[164:165]
    v_pk_add_f32 v[162:163], v[162:163], v[166:167]
    s_waitcnt lgkmcnt(0)
    v_pk_add_f32 v[168:169], v[168:169], v[172:173]
    v_pk_add_f32 v[170:171], v[170:171], v[174:175]
    v_pk_add_f32 v[160:161], v[160:161], v[168:169]
    v_pk_add_f32 v[162:163], v[162:163], v[170:171]
    v_cvt_pk_bf16_f32 v244, v160, v161
    v_cvt_pk_bf16_f32 v245, v162, v163
    s_nop 1
    v_mfma_f32_16x16x16_bf16 v[164:167], v[244:245], v[2:3], 0
    v_mfma_f32_16x16x16_bf16 v[168:171], v[244:245], v[4:5], 0
    s_nop 6
    v_cvt_pk_bf16_f32 v172, v164, v165
    v_cvt_pk_bf16_f32 v173, v166, v167
    v_cvt_pk_bf16_f32 v174, v168, v169
    v_cvt_pk_bf16_f32 v175, v170, v171
    s_nop 1
    v_mfma_f32_16x16x32_bf16 v[160:163], v[40:43], v[172:175], 0
    v_mfma_f32_16x16x32_bf16 v[164:167], v[44:47], v[172:175], 0
    s_nop 7
    v_mov_b32_dpp v160, v164 quad_perm:[0,1,2,3] row_mask:0xf bank_mask:0xc
    v_mov_b32_dpp v161, v165 quad_perm:[0,1,2,3] row_mask:0xf bank_mask:0xc
    v_mov_b32_dpp v162, v166 quad_perm:[0,1,2,3] row_mask:0xf bank_mask:0xc
    v_mov_b32_dpp v163, v167 quad_perm:[0,1,2,3] row_mask:0xf bank_mask:0xc
    v_min_u32 v160, -2, v160
    v_min_u32 v161, -2, v161
    v_min_u32 v162, -2, v162
    v_min_u32 v163, -2, v163
    buffer_store_dwordx4 v[160:163], v23, s[8:11], s32 offen
    s_branch be_51
b1_49:
    ds_read_b128 v[48:51], v31 offset:0
    ds_read_b128 v[52:55], v31 offset:1024
    ds_read_b128 v[56:59], v31 offset:2048
    ds_read_b128 v[60:63], v31 offset:3072
    s_waitcnt lgkmcnt(6)
    v_pk_add_f32 v[160:161], v[160:161], v[164:165]
    v_pk_add_f32 v[162:163], v[162:163], v[166:167]
    s_waitcnt lgkmcnt(4)
    v_pk_add_f32 v[168:169], v[168:169], v[172:173]
    v_pk_add_f32 v[170:171], v[170:171], v[174:175]
    v_pk_add_f32 v[160:161], v[160:161], v[168:169]
    v_pk_add_f32 v[162:163], v[162:163], v[170:171]
    v_cvt_pk_bf16_f32 v246, v160, v161
    v_cvt_pk_bf16_f32 v247, v162, v163
    s_waitcnt lgkmcnt(2)
    s_nop 0
    v_mfma_f32_16x16x16_bf16 v[164:167], v[246:247], v[68:69], 0
    v_pk_add_f32 v[48:49], v[48:49], v[52:53]
    v_pk_add_f32 v[50:51], v[50:51], v[54:55]
    v_mfma_f32_16x16x16_bf16 v[168:171], v[246:247], v[70:71], 0
    s_waitcnt lgkmcnt(0)
    v_pk_add_f32 v[56:57], v[56:57], v[60:61]
    v_pk_add_f32 v[58:59], v[58:59], v[62:63]
    v_pk_add_f32 v[48:49], v[48:49], v[56:57]
    v_pk_add_f32 v[50:51], v[50:51], v[58:59]
    v_cvt_pk_bf16_f32 v244, v48, v49
    v_cvt_pk_bf16_f32 v245, v50, v51
    s_nop 1
    v_mfma_f32_16x16x16_bf16 v[52:55], v[244:245], v[2:3], 0
    v_mfma_f32_16x16x16_bf16 v[56:59], v[244:245], v[4:5], 0
    v_cvt_pk_bf16_f32 v172, v164, v165
    v_cvt_pk_bf16_f32 v173, v166, v167
    v_cvt_pk_bf16_f32 v174, v168, v169
    v_cvt_pk_bf16_f32 v175, v170, v171
    s_nop 2
    v_cvt_pk_bf16_f32 v60, v52, v53
    v_cvt_pk_bf16_f32 v61, v54, v55
    v_cvt_pk_bf16_f32 v62, v56, v57
    v_cvt_pk_bf16_f32 v63, v58, v59
    s_nop 1
    v_mfma_f32_16x16x32_bf16 v[48:51], v[172:175], v[60:63], 0
    v_min_u32 v236, -2, v172
    v_min_u32 v237, -2, v173
    v_min_u32 v238, -2, v174
    v_min_u32 v239, -2, v175
    s_nop 3
    v_mov_b32_dpp v48, v49 quad_perm:[0,1,2,3] row_mask:0xf bank_mask:0xc
    v_min_u32 v48, -2, v48
    buffer_store_dword v48, v23, s[8:11], s32 offen
    s_branch be_51
b2_50:
    s_waitcnt lgkmcnt(2)
    v_pk_add_f32 v[160:161], v[160:161], v[164:165]
    v_pk_add_f32 v[162:163], v[162:163], v[166:167]
    s_waitcnt lgkmcnt(0)
    v_pk_add_f32 v[168:169], v[168:169], v[172:173]
    v_pk_add_f32 v[170:171], v[170:171], v[174:175]
    v_pk_add_f32 v[160:161], v[160:161], v[168:169]
    v_pk_add_f32 v[162:163], v[162:163], v[170:171]
    v_cvt_pk_bf16_f32 v244, v160, v161
    v_cvt_pk_bf16_f32 v245, v162, v163
    s_nop 1
    v_mfma_f32_16x16x16_bf16 v[164:167], v[244:245], v[2:3], 0
    v_mfma_f32_16x16x16_bf16 v[168:171], v[244:245], v[4:5], 0
    s_nop 6
    v_cvt_pk_bf16_f32 v236, v164, v165
    v_cvt_pk_bf16_f32 v237, v166, v167
    v_cvt_pk_bf16_f32 v238, v168, v169
    v_cvt_pk_bf16_f32 v239, v170, v171
    v_min_u32 v236, -2, v236
    v_min_u32 v237, -2, v237
    v_min_u32 v238, -2, v238
    v_min_u32 v239, -2, v239
    buffer_store_dwordx4 v[236:239], v23, s[8:11], s32 offen
be_51:
    s_barrier
    s_sleep 2
xv_52:
    buffer_load_dwordx4 v[176:179], v25, s[8:11], s32 offen offset:0 sc1
    buffer_load_dwordx4 v[180:183], v25, s[8:11], s32 offen offset:1024 sc1
    buffer_load_dwordx4 v[48:51], v24, s[8:11], s32 offen offset:0 sc1
    buffer_load_dwordx4 v[52:55], v24, s[8:11], s32 offen offset:1024 sc1
    buffer_load_dwordx4 v[56:59], v24, s[8:11], s32 offen offset:2048 sc1
    buffer_load_dwordx4 v[60:63], v24, s[8:11], s32 offen offset:3072 sc1
    buffer_load_dwordx4 v[64:67], v14, s[8:11], s32 offen sc1
    s_waitcnt vmcnt(5)
    v_mfma_f32_16x16x32_bf16 v[204:207], v[176:179], a[196:199], 0
    v_max3_u32 v244, v176, v177, v178
    v_max3_u32 v245, v179, v180, v181
    v_max_u32 v246, v182, v183
    v_mfma_f32_16x16x32_bf16 v[208:211], v[176:179], a[212:215], 0
    v_max3_u32 v244, v244, v245, v246
    v_cmp_eq_u32 vcc, -1, v244
    v_mfma_f32_16x16x32_bf16 v[212:215], v[176:179], a[228:231], 0
    v_mov_b32_dpp v184, v176 row_ror:8 row_mask:0xf bank_mask:0xf
    v_mov_b32_dpp v185, v177 row_ror:8 row_mask:0xf bank_mask:0xf
    v_mfma_f32_16x16x32_bf16 v[216:219], v[176:179], a[244:247], 0
    s_cbranch_vccnz rt_54
    v_mov_b32_dpp v186, v178 row_ror:8 row_mask:0xf bank_mask:0xf
    v_mov_b32_dpp v187, v179 row_ror:8 row_mask:0xf bank_mask:0xf
    v_mfma_f32_16x16x32_bf16 v[204:207], v[180:183], a[204:207], v[204:207]
    v_mov_b32_dpp v188, v180 row_ror:8 row_mask:0xf bank_mask:0xf
    v_mfma_f32_16x16x32_bf16 v[208:211], v[180:183], a[220:223], v[208:211]
    v_mov_b32_dpp v189, v181 row_ror:8 row_mask:0xf bank_mask:0xf
    v_mfma_f32_16x16x32_bf16 v[212:215], v[180:183], a[236:239], v[212:215]
    v_mov_b32_dpp v190, v182 row_ror:8 row_mask:0xf bank_mask:0xf
    v_mfma_f32_16x16x32_bf16 v[216:219], v[180:183], a[252:255], v[216:219]
    v_mov_b32_dpp v191, v183 row_ror:8 row_mask:0xf bank_mask:0xf
pw_55:
    s_waitcnt vmcnt(0)
    v_max3_u32 v244, v48, v49, v50
    v_max3_u32 v245, v51, v52, v53
    v_max3_u32 v246, v54, v55, v56
    v_max3_u32 v247, v57, v58, v59
    v_max3_u32 v248, v60, v61, v62
    v_max3_u32 v249, v63, v64, v65
    v_max_u32 v250, v66, v67
    v_max3_u32 v244, v244, v245, v246
    v_pk_add_f32 v[48:49], v[48:49], v[52:53]
    v_max3_u32 v247, v247, v248, v249
    v_pk_add_f32 v[50:51], v[50:51], v[54:55]
    v_max3_u32 v244, v244, v247, v250
    v_pk_add_f32 v[56:57], v[56:57], v[60:61]
    v_cmp_eq_u32 vcc, -1, v244
    v_pk_add_f32 v[58:59], v[58:59], v[62:63]
    v_pk_add_f32 v[64:65], v[64:65], v[66:67]
    s_cbranch_vccnz rt_56
    buffer_load_dwordx4 v[72:75], v27, s[12:15], s44 offen offset:0
    v_pk_add_f32 v[192:193], v[48:49], v[56:57]
    v_mfma_f32_16x16x32_bf16 v[204:207], v[184:187], a[192:195], v[204:207]
    buffer_load_dwordx4 v[88:91], v27, s[12:15], s45 offen offset:0
    v_pk_add_f32 v[194:195], v[50:51], v[58:59]
    v_add_f32 v196, v64, v65
    v_mfma_f32_16x16x32_bf16 v[208:211], v[184:187], a[208:211], v[208:211]
    buffer_load_dwordx4 v[76:79], v27, s[12:15], s44 offen offset:1024
    v_max3_f32 v244, v192, v193, v194
    v_max3_f32 v244, v244, v195, v196
    buffer_load_dwordx4 v[92:95], v27, s[12:15], s45 offen offset:1024
    v_mfma_f32_16x16x32_bf16 v[212:215], v[184:187], a[224:227], v[212:215]
    v_max_f32_dpp v244, v244, v244 row_ror:8 row_mask:0xf bank_mask:0xf
    v_mov_b32 v245, v244
    buffer_load_dwordx4 v[80:83], v27, s[12:15], s44 offen offset:2048
    v_mfma_f32_16x16x32_bf16 v[216:219], v[184:187], a[240:243], v[216:219]
    v_permlane32_swap_b32 v244, v245
    buffer_load_dwordx4 v[96:99], v27, s[12:15], s45 offen offset:2048
    v_max_f32 v244, v244, v245
    v_mfma_f32_16x16x32_bf16 v[204:207], v[188:191], a[200:203], v[204:207]
    v_mov_b32 v245, v244
    buffer_load_dwordx4 v[84:87], v27, s[12:15], s44 offen offset:3072
    s_nop 0
    v_permlane16_swap_b32 v244, v245
    v_mfma_f32_16x16x32_bf16 v[208:211], v[188:191], a[216:219], v[208:211]
    buffer_load_dwordx4 v[100:103], v27, s[12:15], s45 offen offset:3072
    v_max_f32 v244, v244, v245
    v_mul_f32 v244, s49, v244
    v_mfma_f32_16x16x32_bf16 v[212:215], v[188:191], a[232:235], v[212:215]
    buffer_load_dwordx4 v[40:43], v13, s[12:15], s42 offen
    v_fma_f32 v192, v192, s49, -v244
    v_fma_f32 v193, v193, s49, -v244
    buffer_load_dwordx4 v[44:47], v13, s[12:15], s43 offen
    v_mfma_f32_16x16x32_bf16 v[216:219], v[188:191], a[248:251], v[216:219]
    v_fma_f32 v194, v194, s49, -v244
    v_fma_f32 v195, v195, s49, -v244
    v_fma_f32 v196, v196, s49, -v244
    v_exp_f32 v192, v192
    v_exp_f32 v193, v193
    v_exp_f32 v194, v194
    v_exp_f32 v195, v195
    v_exp_f32 v196, v196
    v_cvt_pk_bf16_f32 v228, v192, v193
    v_cvt_pk_bf16_f32 v229, v194, v195
    v_mov_b32_dpp v246, v196 row_ror:8 row_mask:0xf bank_mask:0xf
    v_mov_b32_dpp v230, v228 row_ror:8 row_mask:0xf bank_mask:0xf
    v_mov_b32_dpp v231, v229 row_ror:8 row_mask:0xf bank_mask:0xf
    v_cvt_pk_bf16_f32 v232, v196, v246
    s_nop 0
    v_mfma_f32_16x16x32_bf16 v[152:155], v[8:11], v[228:231], 0
    v_mov_b32 v233, v232
    v_cvt_pk_bf16_f32 v220, v204, v205
    v_cvt_pk_bf16_f32 v221, v206, v207
    v_mfma_f32_16x16x32_bf16 v[136:139], v[104:107], v[228:231], 0
    v_permlane32_swap_b32 v232, v233
    v_cvt_pk_bf16_f32 v222, v208, v209
    v_cvt_pk_bf16_f32 v223, v210, v211
    v_mfma_f32_16x16x32_bf16 v[140:143], v[108:111], v[228:231], 0
    v_and_b32 v232, v232, v12
    v_and_b32 v233, v233, v12
    v_cvt_pk_bf16_f32 v224, v212, v213
    v_mfma_f32_16x16x32_bf16 v[144:147], v[112:115], v[228:231], 0
    v_cvt_pk_bf16_f32 v225, v214, v215
    v_cvt_pk_bf16_f32 v226, v216, v217
    v_cvt_pk_bf16_f32 v227, v218, v219
    v_mfma_f32_16x16x32_bf16 v[148:151], v[116:119], v[228:231], 0
    v_mfma_f32_16x16x16_bf16 v[152:155], v[8:9], v[232:233], v[152:155]
    v_mfma_f32_16x16x16_bf16 v[136:139], v[220:221], v[232:233], v[136:139]
    v_mfma_f32_16x16x16_bf16 v[140:143], v[222:223], v[232:233], v[140:143]
    v_mfma_f32_16x16x16_bf16 v[144:147], v[224:225], v[232:233], v[144:147]
    s_nop 1
    v_mfma_f32_16x16x16_bf16 v[148:151], v[226:227], v[232:233], v[148:151]
    s_nop 1
    v_rcp_f32 v244, v152
    s_nop 0
    v_pk_mul_f32 v[136:137], v[136:137], v[244:245] op_sel_hi:[1,0]
    v_pk_mul_f32 v[138:139], v[138:139], v[244:245] op_sel_hi:[1,0]
    v_pk_mul_f32 v[144:145], v[144:145], v[244:245] op_sel_hi:[1,0]
    v_pk_mul_f32 v[146:147], v[146:147], v[244:245] op_sel_hi:[1,0]
    v_mul_f32_dpp v136, v140, v244 row_shr:8 row_mask:0xf bank_mask:0xc
    v_mul_f32_dpp v137, v141, v244 row_shr:8 row_mask:0xf bank_mask:0xc
    v_mul_f32_dpp v138, v142, v244 row_shr:8 row_mask:0xf bank_mask:0xc
    v_mul_f32_dpp v139, v143, v244 row_shr:8 row_mask:0xf bank_mask:0xc
    ds_write_b128 v32, v[136:139] offset:0
    v_mul_f32_dpp v144, v148, v244 row_shr:8 row_mask:0xf bank_mask:0xc
    v_mul_f32_dpp v145, v149, v244 row_shr:8 row_mask:0xf bank_mask:0xc
    v_mul_f32_dpp v146, v150, v244 row_shr:8 row_mask:0xf bank_mask:0xc
    v_mul_f32_dpp v147, v151, v244 row_shr:8 row_mask:0xf bank_mask:0xc
    ds_write_b128 v32, v[144:147] offset:1024
    s_waitcnt lgkmcnt(0)
    s_barrier
    s_cmp_ge_u32 s28, 2
    s_cbranch_scc1 c1_57
    ds_read_b128 v[160:163], v33 offset:0
    ds_read_b128 v[164:167], v33 offset:2048
    ds_read_b128 v[168:171], v33 offset:4096
    ds_read_b128 v[172:175], v33 offset:6144
    s_waitcnt lgkmcnt(2)
    v_pk_add_f32 v[160:161], v[160:161], v[164:165]
    v_pk_add_f32 v[162:163], v[162:163], v[166:167]
    s_waitcnt lgkmcnt(0)
    v_pk_add_f32 v[168:169], v[168:169], v[172:173]
    v_pk_add_f32 v[170:171], v[170:171], v[174:175]
    v_pk_add_f32 v[160:161], v[160:161], v[168:169]
    v_pk_add_f32 v[162:163], v[162:163], v[170:171]
    v_cvt_pk_bf16_f32 v164, v160, v161
    v_cvt_pk_bf16_f32 v165, v162, v163
    v_min_u32 v164, -2, v164
    v_min_u32 v165, -2, v165
    v_mov_b32 v166, v164
    v_mov_b32 v167, v165
    s_nop 0
    v_permlane16_swap_b32 v164, v166
    v_permlane16_swap_b32 v165, v167
c1_57:
    buffer_store_dwordx4 v[164:167], v26, s[8:11], s32 offen sc1
    s_add_u32 s29, s29, 1
    buffer_store_dwordx4 v[16:19], v26, s[8:11], s30 offen sc1
    s_cmp_eq_u32 s28, 1
    s_cbranch_scc1 r1_58
    buffer_store_dwordx4 v[16:19], v23, s[8:11], s30 offen
    s_branch r2_59
r1_58:
    buffer_store_dword v16, v23, s[8:11], s30 offen
r2_59:
    buffer_store_dwordx4 v[236:239], v28, s[16:19], s47 offen sc1
    s_add_u32 s54, s29, 2
    s_min_u32 s54, s54, 63
    s_lshl_b32 s54, s54, 16
    buffer_store_dwordx4 v[16:19], v28, s[16:19], s54 offen sc1
    s_lshl_b32 s42, s29, 18
    s_add_u32 s44, s42, 0x1040000
    s_add_u32 s46, s42, 0x80000
    s_add_u32 s42, s42, 0x40000
    s_add_u32 s43, s42, 0x20000
    s_add_u32 s45, s44, 0x20000
    s_lshl_b32 s47, s29, 16
    s_waitcnt vmcnt(7)
    s_add_u32 s39, s29, 1
    s_lshr_b32 s39, s39, 2
    s_lshl_b32 s39, s39, 2
    s_add_u32 s39, s39, 4096
    buffer_load_dword v34, off, s[20:23], s39 sc1
    v_mfma_f32_16x16x32_bf16 v[160:163], v[72:75], a[192:195], 0
    v_mfma_f32_16x16x32_bf16 v[164:167], v[88:91], a[192:195], 0
    v_mfma_f32_16x16x32_bf16 v[168:171], v[72:75], a[208:211], 0
    v_mfma_f32_16x16x32_bf16 v[172:175], v[88:91], a[208:211], 0
    v_mfma_f32_16x16x32_bf16 v[176:179], v[72:75], a[224:227], 0
    v_mfma_f32_16x16x32_bf16 v[180:183], v[88:91], a[224:227], 0
    v_mfma_f32_16x16x32_bf16 v[184:187], v[72:75], a[240:243], 0
    v_mfma_f32_16x16x32_bf16 v[188:191], v[88:91], a[240:243], 0
    v_mfma_f32_16x16x32_bf16 v[160:163], v[76:79], a[196:199], v[160:163]
    v_mfma_f32_16x16x32_bf16 v[164:167], v[92:95], a[196:199], v[164:167]
    v_mfma_f32_16x16x32_bf16 v[168:171], v[76:79], a[212:215], v[168:171]
    v_mfma_f32_16x16x32_bf16 v[172:175], v[92:95], a[212:215], v[172:175]
    v_mfma_f32_16x16x32_bf16 v[176:179], v[76:79], a[228:231], v[176:179]
    v_mfma_f32_16x16x32_bf16 v[180:183], v[92:95], a[228:231], v[180:183]
    v_mfma_f32_16x16x32_bf16 v[184:187], v[76:79], a[244:247], v[184:187]
    v_mfma_f32_16x16x32_bf16 v[188:191], v[92:95], a[244:247], v[188:191]
    v_mfma_f32_16x16x32_bf16 v[160:163], v[80:83], a[200:203], v[160:163]
    v_mfma_f32_16x16x32_bf16 v[164:167], v[96:99], a[200:203], v[164:167]
    v_mfma_f32_16x16x32_bf16 v[168:171], v[80:83], a[216:219], v[168:171]
    v_mfma_f32_16x16x32_bf16 v[172:175], v[96:99], a[216:219], v[172:175]
    v_mfma_f32_16x16x32_bf16 v[176:179], v[80:83], a[232:235], v[176:179]
    v_mfma_f32_16x16x32_bf16 v[180:183], v[96:99], a[232:235], v[180:183]
    v_mfma_f32_16x16x32_bf16 v[184:187], v[80:83], a[248:251], v[184:187]
    v_mfma_f32_16x16x32_bf16 v[188:191], v[96:99], a[248:251], v[188:191]
    v_mfma_f32_16x16x32_bf16 v[160:163], v[84:87], a[204:207], v[160:163]
    v_mfma_f32_16x16x32_bf16 v[164:167], v[100:103], a[204:207], v[164:167]
    v_mfma_f32_16x16x32_bf16 v[168:171], v[84:87], a[220:223], v[168:171]
    v_mfma_f32_16x16x32_bf16 v[172:175], v[100:103], a[220:223], v[172:175]
    v_mfma_f32_16x16x32_bf16 v[176:179], v[84:87], a[236:239], v[176:179]
    v_mfma_f32_16x16x32_bf16 v[180:183], v[100:103], a[236:239], v[180:183]
    v_mfma_f32_16x16x32_bf16 v[184:187], v[84:87], a[252:255], v[184:187]
    v_mfma_f32_16x16x32_bf16 v[188:191], v[100:103], a[252:255], v[188:191]
    s_nop 0
    v_cvt_pk_bf16_f32 v104, v160, v161
    v_cvt_pk_bf16_f32 v105, v162, v163
    v_cvt_pk_bf16_f32 v106, v164, v165
    v_cvt_pk_bf16_f32 v107, v166, v167
    v_cvt_pk_bf16_f32 v108, v168, v169
    v_cvt_pk_bf16_f32 v109, v170, v171
    v_cvt_pk_bf16_f32 v110, v172, v173
    v_cvt_pk_bf16_f32 v111, v174, v175
    v_cvt_pk_bf16_f32 v112, v176, v177
    v_cvt_pk_bf16_f32 v113, v178, v179
    v_cvt_pk_bf16_f32 v114, v180, v181
    v_cvt_pk_bf16_f32 v115, v182, v183
    v_cvt_pk_bf16_f32 v116, v184, v185
    v_cvt_pk_bf16_f32 v117, v186, v187
    v_cvt_pk_bf16_f32 v118, v188, v189
    v_cvt_pk_bf16_f32 v119, v190, v191
    s_cmp_lg_u32 s28, 2
    s_cbranch_scc1 nt_60
nt_60:
    v_mov_b32 v136, 0
    v_mov_b32 v137, 0
    v_mov_b32 v138, 0
    v_mov_b32 v139, 0
    v_mov_b32 v140, 0
    v_mov_b32 v141, 0
    v_mov_b32 v142, 0
    v_mov_b32 v143, 0
    v_mov_b32 v144, 0
    v_mov_b32 v145, 0
    v_mov_b32 v146, 0
    v_mov_b32 v147, 0
    v_mov_b32 v148, 0
    v_mov_b32 v149, 0
    v_mov_b32 v150, 0
    v_mov_b32 v151, 0
    v_mov_b32 v152, 0
    v_mov_b32 v153, 0
    v_mov_b32 v154, 0
    v_mov_b32 v155, 0
    v_mov_b32 v156, 0
    v_mov_b32 v157, 0
    v_mov_b32 v158, 0
    v_mov_b32 v159, 0
    s_cmp_lg_u32 s28, 3
    s_cbranch_scc1 noA_61
    buffer_load_dwordx4 v[176:179], v20, s[8:11], s32 offen offset:0 sc1
    buffer_load_dwordx4 v[180:183], v20, s[8:11], s32 offen offset:1024 sc1
    buffer_load_dwordx4 v[184:187], v20, s[8:11], s32 offen offset:2048 sc1
    buffer_load_dwordx4 v[188:191], v20, s[8:11], s32 offen offset:3072 sc1
pw_62:
    s_waitcnt vmcnt(0)
    v_mfma_f32_16x16x32_bf16 v[160:163], v[36:39], v[176:179], 0
    v_max3_u32 v244, v176, v177, v178
    v_max3_u32 v245, v179, v180, v181
    v_max3_u32 v246, v182, v183, v184
    v_mfma_f32_16x16x32_bf16 v[160:163], v[36:39], v[180:183], v[160:163]
    v_max3_u32 v247, v185, v186, v187
    v_max3_u32 v248, v188, v189, v190
    v_max3_u32 v244, v244, v245, v246
    v_mfma_f32_16x16x32_bf16 v[160:163], v[240:243], v[184:187], v[160:163]
    v_max3_u32 v247, v247, v248, v191
    v_max_u32 v244, v244, v247
    v_cmp_eq_u32 vcc, -1, v244
    v_mfma_f32_16x16x32_bf16 v[160:163], v[240:243], v[188:191], v[160:163]
    s_cbranch_vccnz rt_63
    s_nop 6
    v_cvt_pk_bf16_f32 v244, v160, v161
    v_cvt_pk_bf16_f32 v245, v162, v163
    v_min_u32 v244, -2, v244
    v_min_u32 v245, -2, v245
    buffer_store_dwordx2 v[244:245], v21, s[8:11], s33 offen
    buffer_store_dwordx2 v[16:17], v21, s[8:11], s31 offen
noA_61:
    s_barrier
    s_sleep 3
    buffer_load_dwordx4 v[120:123], v22, s[8:11], s33 offen offset:0 sc1
    buffer_load_dwordx4 v[124:127], v22, s[8:11], s33 offen offset:1024 sc1
    buffer_load_dwordx4 v[128:131], v22, s[8:11], s33 offen offset:2048 sc1
    buffer_load_dwordx4 v[132:135], v22, s[8:11], s33 offen offset:3072 sc1
pw_64:
    s_waitcnt vmcnt(0)
    v_smfmac_f32_16x16x64_bf16 v[136:139], v[120:123], a[0:7], v1
    v_max3_u32 v244, v120, v121, v122
    v_max3_u32 v245, v123, v124, v125
    v_max3_u32 v246, v126, v127, v128
    v_smfmac_f32_16x16x64_bf16 v[140:143], v[120:123], a[32:39], v1
    v_max3_u32 v247, v129, v130, v131
    v_max3_u32 v248, v132, v133, v134
    v_max3_u32 v244, v244, v245, v246
    v_smfmac_f32_16x16x64_bf16 v[136:139], v[124:127], a[8:15], v1
    v_max3_u32 v247, v247, v248, v135
    v_max_u32 v244, v244, v247
    v_cmp_eq_u32 vcc, -1, v244
    v_smfmac_f32_16x16x64_bf16 v[140:143], v[124:127], a[40:47], v1
    s_cbranch_vccnz rt_65
    v_smfmac_f32_16x16x64_bf16 v[136:139], v[128:131], a[16:23], v1
    v_smfmac_f32_16x16x64_bf16 v[140:143], v[128:131], a[48:55], v1
    v_smfmac_f32_16x16x64_bf16 v[136:139], v[132:135], a[24:31], v1
    v_smfmac_f32_16x16x64_bf16 v[140:143], v[132:135], a[56:63], v1
    v_smfmac_f32_16x16x64_bf16 v[144:147], v[120:123], a[64:71], v1
    v_smfmac_f32_16x16x64_bf16 v[148:151], v[120:123], a[96:103], v1
    v_smfmac_f32_16x16x64_bf16 v[144:147], v[124:127], a[72:79], v1
    v_smfmac_f32_16x16x64_bf16 v[148:151], v[124:127], a[104:111], v1
    s_nop 3
    v_permlane32_swap_b32 v136, v140
    v_smfmac_f32_16x16x64_bf16 v[144:147], v[128:131], a[80:87], v1
    v_permlane32_swap_b32 v137, v141
    v_smfmac_f32_16x16x64_bf16 v[148:151], v[128:131], a[112:119], v1
    v_permlane32_swap_b32 v138, v142
    v_smfmac_f32_16x16x64_bf16 v[144:147], v[132:135], a[88:95], v1
    v_permlane32_swap_b32 v139, v143
    v_smfmac_f32_16x16x64_bf16 v[148:151], v[132:135], a[120:127], v1
    v_pk_add_f32 v[136:137], v[136:137], v[140:141]
    v_smfmac_f32_16x16x64_bf16 v[152:155], v[120:123], a[128:135], v1
    v_pk_add_f32 v[138:139], v[138:139], v[142:143]
    v_smfmac_f32_16x16x64_bf16 v[156:159], v[120:123], a[160:167], v1
    ds_write_b128 v30, v[136:139]
    v_smfmac_f32_16x16x64_bf16 v[152:155], v[124:127], a[136:143], v1
    v_smfmac_f32_16x16x64_bf16 v[156:159], v[124:127], a[168:175], v1
    s_nop 0
    v_permlane32_swap_b32 v144, v148
    v_permlane32_swap_b32 v145, v149
    v_smfmac_f32_16x16x64_bf16 v[152:155], v[128:131], a[144:151], v1
    v_permlane32_swap_b32 v146, v150
    v_smfmac_f32_16x16x64_bf16 v[156:159], v[128:131], a[176:183], v1
    v_permlane32_swap_b32 v147, v151
    v_pk_add_f32 v[144:145], v[144:145], v[148:149]
    v_smfmac_f32_16x16x64_bf16 v[152:155], v[132:135], a[152:159], v1
    v_pk_add_f32 v[146:147], v[146:147], v[150:151]
    v_smfmac_f32_16x16x64_bf16 v[156:159], v[132:135], a[184:191], v1
    ds_write_b128 v30, v[144:147] offset:4096
    s_nop 6
    v_permlane32_swap_b32 v152, v156
    v_permlane32_swap_b32 v153, v157
    v_permlane32_swap_b32 v154, v158
    v_permlane32_swap_b32 v155, v159
    v_pk_add_f32 v[152:153], v[152:153], v[156:157]
    v_pk_add_f32 v[154:155], v[154:155], v[158:159]
    ds_write_b128 v30, v[152:155] offset:8192
    s_waitcnt lgkmcnt(0)
    s_barrier
    s_cmp_eq_u32 s28, 3
    s_cbranch_scc1 be_68
    ds_read_b128 v[160:163], v35 offset:0
    ds_read_b128 v[164:167], v35 offset:1024
    ds_read_b128 v[168:171], v35 offset:2048
    ds_read_b128 v[172:175], v35 offset:3072
    s_cmp_eq_u32 s28, 1
    s_cbranch_scc1 b1_66
    s_cmp_eq_u32 s28, 2
    s_cbranch_scc1 b2_67
    s_waitcnt lgkmcnt(2)
    v_pk_add_f32 v[160:161], v[160:161], v[164:165]
    v_pk_add_f32 v[162:163], v[162:163], v[166:167]
    s_waitcnt lgkmcnt(0)
    v_pk_add_f32 v[168:169], v[168:169], v[172:173]
    v_pk_add_f32 v[170:171], v[170:171], v[174:175]
    v_pk_add_f32 v[160:161], v[160:161], v[168:169]
    v_pk_add_f32 v[162:163], v[162:163], v[170:171]
    v_cvt_pk_bf16_f32 v244, v160, v161
    v_cvt_pk_bf16_f32 v245, v162, v163
    s_nop 1
    v_mfma_f32_16x16x16_bf16 v[164:167], v[244:245], v[2:3], 0
    v_mfma_f32_16x16x16_bf16 v[168:171], v[244:245], v[4:5], 0
    s_nop 6
    v_cvt_pk_bf16_f32 v172, v164, v165
    v_cvt_pk_bf16_f32 v173, v166, v167
    v_cvt_pk_bf16_f32 v174, v168, v169
    v_cvt_pk_bf16_f32 v175, v170, v171
    s_nop 1
    v_mfma_f32_16x16x32_bf16 v[160:163], v[40:43], v[172:175], 0
    v_mfma_f32_16x16x32_bf16 v[164:167], v[44:47], v[172:175], 0
    s_nop 7
    v_mov_b32_dpp v160, v164 quad_perm:[0,1,2,3] row_mask:0xf bank_mask:0xc
    v_mov_b32_dpp v161, v165 quad_perm:[0,1,2,3] row_mask:0xf bank_mask:0xc
    v_mov_b32_dpp v162, v166 quad_perm:[0,1,2,3] row_mask:0xf bank_mask:0xc
    v_mov_b32_dpp v163, v167 quad_perm:[0,1,2,3] row_mask:0xf bank_mask:0xc
    v_min_u32 v160, -2, v160
    v_min_u32 v161, -2, v161
    v_min_u32 v162, -2, v162
    v_min_u32 v163, -2, v163
    buffer_store_dwordx4 v[160:163], v23, s[8:11], s33 offen
    s_branch be_68
b1_66:
    ds_read_b128 v[48:51], v31 offset:0
    ds_read_b128 v[52:55], v31 offset:1024
    ds_read_b128 v[56:59], v31 offset:2048
    ds_read_b128 v[60:63], v31 offset:3072
    s_waitcnt lgkmcnt(6)
    v_pk_add_f32 v[160:161], v[160:161], v[164:165]
    v_pk_add_f32 v[162:163], v[162:163], v[166:167]
    s_waitcnt lgkmcnt(4)
    v_pk_add_f32 v[168:169], v[168:169], v[172:173]
    v_pk_add_f32 v[170:171], v[170:171], v[174:175]
    v_pk_add_f32 v[160:161], v[160:161], v[168:169]
    v_pk_add_f32 v[162:163], v[162:163], v[170:171]
    v_cvt_pk_bf16_f32 v246, v160, v161
    v_cvt_pk_bf16_f32 v247, v162, v163
    s_waitcnt lgkmcnt(2)
    s_nop 0
    v_mfma_f32_16x16x16_bf16 v[164:167], v[246:247], v[68:69], 0
    v_pk_add_f32 v[48:49], v[48:49], v[52:53]
    v_pk_add_f32 v[50:51], v[50:51], v[54:55]
    v_mfma_f32_16x16x16_bf16 v[168:171], v[246:247], v[70:71], 0
    s_waitcnt lgkmcnt(0)
    v_pk_add_f32 v[56:57], v[56:57], v[60:61]
    v_pk_add_f32 v[58:59], v[58:59], v[62:63]
    v_pk_add_f32 v[48:49], v[48:49], v[56:57]
    v_pk_add_f32 v[50:51], v[50:51], v[58:59]
    v_cvt_pk_bf16_f32 v244, v48, v49
    v_cvt_pk_bf16_f32 v245, v50, v51
    s_nop 1
    v_mfma_f32_16x16x16_bf16 v[52:55], v[244:245], v[2:3], 0
    v_mfma_f32_16x16x16_bf16 v[56:59], v[244:245], v[4:5], 0
    v_cvt_pk_bf16_f32 v172, v164, v165
    v_cvt_pk_bf16_f32 v173, v166, v167
    v_cvt_pk_bf16_f32 v174, v168, v169
    v_cvt_pk_bf16_f32 v175, v170, v171
    s_nop 2
    v_cvt_pk_bf16_f32 v60, v52, v53
    v_cvt_pk_bf16_f32 v61, v54, v55
    v_cvt_pk_bf16_f32 v62, v56, v57
    v_cvt_pk_bf16_f32 v63, v58, v59
    s_nop 1
    v_mfma_f32_16x16x32_bf16 v[48:51], v[172:175], v[60:63], 0
    v_min_u32 v236, -2, v172
    v_min_u32 v237, -2, v173
    v_min_u32 v238, -2, v174
    v_min_u32 v239, -2, v175
    s_nop 3
    v_mov_b32_dpp v48, v49 quad_perm:[0,1,2,3] row_mask:0xf bank_mask:0xc
    v_min_u32 v48, -2, v48
    buffer_store_dword v48, v23, s[8:11], s33 offen
    s_branch be_68
b2_67:
    s_waitcnt lgkmcnt(2)
    v_pk_add_f32 v[160:161], v[160:161], v[164:165]
    v_pk_add_f32 v[162:163], v[162:163], v[166:167]
    s_waitcnt lgkmcnt(0)
    v_pk_add_f32 v[168:169], v[168:169], v[172:173]
    v_pk_add_f32 v[170:171], v[170:171], v[174:175]
    v_pk_add_f32 v[160:161], v[160:161], v[168:169]
    v_pk_add_f32 v[162:163], v[162:163], v[170:171]
    v_cvt_pk_bf16_f32 v244, v160, v161
    v_cvt_pk_bf16_f32 v245, v162, v163
    s_nop 1
    v_mfma_f32_16x16x16_bf16 v[164:167], v[244:245], v[2:3], 0
    v_mfma_f32_16x16x16_bf16 v[168:171], v[244:245], v[4:5], 0
    s_nop 6
    v_cvt_pk_bf16_f32 v236, v164, v165
    v_cvt_pk_bf16_f32 v237, v166, v167
    v_cvt_pk_bf16_f32 v238, v168, v169
    v_cvt_pk_bf16_f32 v239, v170, v171
    v_min_u32 v236, -2, v236
    v_min_u32 v237, -2, v237
    v_min_u32 v238, -2, v238
    v_min_u32 v239, -2, v239
    buffer_store_dwordx4 v[236:239], v23, s[8:11], s33 offen
be_68:
    s_barrier
    s_cmp_eq_u32 s29, 63
    s_cbranch_scc1 ch_fin
    s_sleep 2
xv_69:
    buffer_load_dwordx4 v[176:179], v25, s[8:11], s33 offen offset:0 sc1
    buffer_load_dwordx4 v[180:183], v25, s[8:11], s33 offen offset:1024 sc1
    buffer_load_dwordx4 v[48:51], v24, s[8:11], s33 offen offset:0 sc1
    buffer_load_dwordx4 v[52:55], v24, s[8:11], s33 offen offset:1024 sc1
    buffer_load_dwordx4 v[56:59], v24, s[8:11], s33 offen offset:2048 sc1
    buffer_load_dwordx4 v[60:63], v24, s[8:11], s33 offen offset:3072 sc1
    buffer_load_dwordx4 v[64:67], v14, s[8:11], s33 offen sc1
    s_waitcnt vmcnt(5)
    v_mfma_f32_16x16x32_bf16 v[204:207], v[176:179], a[196:199], 0
    v_max3_u32 v244, v176, v177, v178
    v_max3_u32 v245, v179, v180, v181
    v_max_u32 v246, v182, v183
    v_mfma_f32_16x16x32_bf16 v[208:211], v[176:179], a[212:215], 0
    v_max3_u32 v244, v244, v245, v246
    v_cmp_eq_u32 vcc, -1, v244
    v_mfma_f32_16x16x32_bf16 v[212:215], v[176:179], a[228:231], 0
    v_mov_b32_dpp v184, v176 row_ror:8 row_mask:0xf bank_mask:0xf
    v_mov_b32_dpp v185, v177 row_ror:8 row_mask:0xf bank_mask:0xf
    v_mfma_f32_16x16x32_bf16 v[216:219], v[176:179], a[244:247], 0
    s_cbranch_vccnz rt_71
    v_mov_b32_dpp v186, v178 row_ror:8 row_mask:0xf bank_mask:0xf
    v_mov_b32_dpp v187, v179 row_ror:8 row_mask:0xf bank_mask:0xf
    v_mfma_f32_16x16x32_bf16 v[204:207], v[180:183], a[204:207], v[204:207]
    v_mov_b32_dpp v188, v180 row_ror:8 row_mask:0xf bank_mask:0xf
    v_mfma_f32_16x16x32_bf16 v[208:211], v[180:183], a[220:223], v[208:211]
    v_mov_b32_dpp v189, v181 row_ror:8 row_mask:0xf bank_mask:0xf
    v_mfma_f32_16x16x32_bf16 v[212:215], v[180:183], a[236:239], v[212:215]
    v_mov_b32_dpp v190, v182 row_ror:8 row_mask:0xf bank_mask:0xf
    v_mfma_f32_16x16x32_bf16 v[216:219], v[180:183], a[252:255], v[216:219]
    v_mov_b32_dpp v191, v183 row_ror:8 row_mask:0xf bank_mask:0xf
pw_72:
    s_waitcnt vmcnt(0)
    v_max3_u32 v244, v48, v49, v50
    v_max3_u32 v245, v51, v52, v53
    v_max3_u32 v246, v54, v55, v56
    v_max3_u32 v247, v57, v58, v59
    v_max3_u32 v248, v60, v61, v62
    v_max3_u32 v249, v63, v64, v65
    v_max_u32 v250, v66, v67
    v_max3_u32 v244, v244, v245, v246
    v_pk_add_f32 v[48:49], v[48:49], v[52:53]
    v_max3_u32 v247, v247, v248, v249
    v_pk_add_f32 v[50:51], v[50:51], v[54:55]
    v_max3_u32 v244, v244, v247, v250
    v_pk_add_f32 v[56:57], v[56:57], v[60:61]
    v_cmp_eq_u32 vcc, -1, v244
    v_pk_add_f32 v[58:59], v[58:59], v[62:63]
    v_pk_add_f32 v[64:65], v[64:65], v[66:67]
    s_cbranch_vccnz rt_73
kvw_74:
    v_readfirstlane_b32 s54, v34
    s_nop 3
    s_cmp_ge_u32 s54, 64
    s_cbranch_scc1 kvd_75
    s_sleep 4
    buffer_load_dword v34, off, s[20:23], s39 sc1
    s_waitcnt vmcnt(0)
    s_sub_u32 s48, s48, 1
    s_cbranch_scc0 kvw_74
    s_mov_b32 s70, 9
    s_branch ch_err
kvd_75:
    buffer_load_dwordx4 v[72:75], v27, s[12:15], s44 offen offset:0
    v_pk_add_f32 v[192:193], v[48:49], v[56:57]
    v_mfma_f32_16x16x32_bf16 v[204:207], v[184:187], a[192:195], v[204:207]
    buffer_load_dwordx4 v[88:91], v27, s[12:15], s45 offen offset:0
    v_pk_add_f32 v[194:195], v[50:51], v[58:59]
    v_add_f32 v196, v64, v65
    v_mfma_f32_16x16x32_bf16 v[208:211], v[184:187], a[208:211], v[208:211]
    buffer_load_dwordx4 v[76:79], v27, s[12:15], s44 offen offset:1024
    v_max3_f32 v244, v192, v193, v194
    v_max3_f32 v244, v244, v195, v196
    buffer_load_dwordx4 v[92:95], v27, s[12:15], s45 offen offset:1024
    v_mfma_f32_16x16x32_bf16 v[212:215], v[184:187], a[224:227], v[212:215]
    v_max_f32_dpp v244, v244, v244 row_ror:8 row_mask:0xf bank_mask:0xf
    v_mov_b32 v245, v244
    buffer_load_dwordx4 v[80:83], v27, s[12:15], s44 offen offset:2048
    v_mfma_f32_16x16x32_bf16 v[216:219], v[184:187], a[240:243], v[216:219]
    v_permlane32_swap_b32 v244, v245
    buffer_load_dwordx4 v[96:99], v27, s[12:15], s45 offen offset:2048
    v_max_f32 v244, v244, v245
    v_mfma_f32_16x16x32_bf16 v[204:207], v[188:191], a[200:203], v[204:207]
    v_mov_b32 v245, v244
    buffer_load_dwordx4 v[84:87], v27, s[12:15], s44 offen offset:3072
    s_nop 0
    v_permlane16_swap_b32 v244, v245
    v_mfma_f32_16x16x32_bf16 v[208:211], v[188:191], a[216:219], v[208:211]
    buffer_load_dwordx4 v[100:103], v27, s[12:15], s45 offen offset:3072
    v_max_f32 v244, v244, v245
    v_mul_f32 v244, s49, v244
    v_mfma_f32_16x16x32_bf16 v[212:215], v[188:191], a[232:235], v[212:215]
    buffer_load_dwordx4 v[40:43], v13, s[12:15], s42 offen
    v_fma_f32 v192, v192, s49, -v244
    v_fma_f32 v193, v193, s49, -v244
    buffer_load_dwordx4 v[44:47], v13, s[12:15], s43 offen
    v_mfma_f32_16x16x32_bf16 v[216:219], v[188:191], a[248:251], v[216:219]
    v_fma_f32 v194, v194, s49, -v244
    v_fma_f32 v195, v195, s49, -v244
    v_fma_f32 v196, v196, s49, -v244
    v_exp_f32 v192, v192
    v_exp_f32 v193, v193
    v_exp_f32 v194, v194
    v_exp_f32 v195, v195
    v_exp_f32 v196, v196
    v_cvt_pk_bf16_f32 v228, v192, v193
    v_cvt_pk_bf16_f32 v229, v194, v195
    v_mov_b32_dpp v246, v196 row_ror:8 row_mask:0xf bank_mask:0xf
    v_mov_b32_dpp v230, v228 row_ror:8 row_mask:0xf bank_mask:0xf
    v_mov_b32_dpp v231, v229 row_ror:8 row_mask:0xf bank_mask:0xf
    v_cvt_pk_bf16_f32 v232, v196, v246
    s_nop 0
    v_mfma_f32_16x16x32_bf16 v[152:155], v[8:11], v[228:231], 0
    v_mov_b32 v233, v232
    v_cvt_pk_bf16_f32 v220, v204, v205
    v_cvt_pk_bf16_f32 v221, v206, v207
    v_mfma_f32_16x16x32_bf16 v[136:139], v[104:107], v[228:231], 0
    v_permlane32_swap_b32 v232, v233
    v_cvt_pk_bf16_f32 v222, v208, v209
    v_cvt_pk_bf16_f32 v223, v210, v211
    v_mfma_f32_16x16x32_bf16 v[140:143], v[108:111], v[228:231], 0
    v_and_b32 v232, v232, v12
    v_and_b32 v233, v233, v12
    v_cvt_pk_bf16_f32 v224, v212, v213
    v_mfma_f32_16x16x32_bf16 v[144:147], v[112:115], v[228:231], 0
    v_cvt_pk_bf16_f32 v225, v214, v215
    v_cvt_pk_bf16_f32 v226, v216, v217
    v_cvt_pk_bf16_f32 v227, v218, v219
    v_mfma_f32_16x16x32_bf16 v[148:151], v[116:119], v[228:231], 0
    v_mfma_f32_16x16x16_bf16 v[152:155], v[8:9], v[232:233], v[152:155]
    v_mfma_f32_16x16x16_bf16 v[136:139], v[220:221], v[232:233], v[136:139]
    v_mfma_f32_16x16x16_bf16 v[140:143], v[222:223], v[232:233], v[140:143]
    v_mfma_f32_16x16x16_bf16 v[144:147], v[224:225], v[232:233], v[144:147]
    s_nop 1
    v_mfma_f32_16x16x16_bf16 v[148:151], v[226:227], v[232:233], v[148:151]
    s_nop 1
    v_rcp_f32 v244, v152
    s_nop 0
    v_pk_mul_f32 v[136:137], v[136:137], v[244:245] op_sel_hi:[1,0]
    v_pk_mul_f32 v[138:139], v[138:139], v[244:245] op_sel_hi:[1,0]
    v_pk_mul_f32 v[144:145], v[144:145], v[244:245] op_sel_hi:[1,0]
    v_pk_mul_f32 v[146:147], v[146:147], v[244:245] op_sel_hi:[1,0]
    v_mul_f32_dpp v136, v140, v244 row_shr:8 row_mask:0xf bank_mask:0xc
    v_mul_f32_dpp v137, v141, v244 row_shr:8 row_mask:0xf bank_mask:0xc
    v_mul_f32_dpp v138, v142, v244 row_shr:8 row_mask:0xf bank_mask:0xc
    v_mul_f32_dpp v139, v143, v244 row_shr:8 row_mask:0xf bank_mask:0xc
    ds_write_b128 v32, v[136:139] offset:0
    v_mul_f32_dpp v144, v148, v244 row_shr:8 row_mask:0xf bank_mask:0xc
    v_mul_f32_dpp v145, v149, v244 row_shr:8 row_mask:0xf bank_mask:0xc
    v_mul_f32_dpp v146, v150, v244 row_shr:8 row_mask:0xf bank_mask:0xc
    v_mul_f32_dpp v147, v151, v244 row_shr:8 row_mask:0xf bank_mask:0xc
    ds_write_b128 v32, v[144:147] offset:1024
    s_waitcnt lgkmcnt(0)
    s_barrier
    s_cmp_ge_u32 s28, 2
    s_cbranch_scc1 c1_76
    ds_read_b128 v[160:163], v33 offset:0
    ds_read_b128 v[164:167], v33 offset:2048
    ds_read_b128 v[168:171], v33 offset:4096
    ds_read_b128 v[172:175], v33 offset:6144
    s_waitcnt lgkmcnt(2)
    v_pk_add_f32 v[160:161], v[160:161], v[164:165]
    v_pk_add_f32 v[162:163], v[162:163], v[166:167]
    s_waitcnt lgkmcnt(0)
    v_pk_add_f32 v[168:169], v[168:169], v[172:173]
    v_pk_add_f32 v[170:171], v[170:171], v[174:175]
    v_pk_add_f32 v[160:161], v[160:161], v[168:169]
    v_pk_add_f32 v[162:163], v[162:163], v[170:171]
    v_cvt_pk_bf16_f32 v164, v160, v161
    v_cvt_pk_bf16_f32 v165, v162, v163
    v_min_u32 v164, -2, v164
    v_min_u32 v165, -2, v165
    v_mov_b32 v166, v164
    v_mov_b32 v167, v165
    s_nop 0
    v_permlane16_swap_b32 v164, v166
    v_permlane16_swap_b32 v165, v167
c1_76:
    buffer_store_dwordx4 v[164:167], v26, s[8:11], s33 offen sc1
    s_add_u32 s29, s29, 1
    s_branch ch_loop
rt_12:
    buffer_load_dwordx4 v[176:179], v20, s[8:11], s33 offen offset:0 sc1
    buffer_load_dwordx4 v[180:183], v20, s[8:11], s33 offen offset:1024 sc1
    buffer_load_dwordx4 v[184:187], v20, s[8:11], s33 offen offset:2048 sc1
    buffer_load_dwordx4 v[188:191], v20, s[8:11], s33 offen offset:3072 sc1
    s_sub_u32 s48, s48, 1
    s_cbranch_scc0 pw_11
    s_mov_b32 s70, 1
    s_branch ch_err
rt_14:
    buffer_load_dwordx4 v[120:123], v22, s[8:11], s30 offen offset:0 sc1
    buffer_load_dwordx4 v[124:127], v22, s[8:11], s30 offen offset:1024 sc1
    buffer_load_dwordx4 v[128:131], v22, s[8:11], s30 offen offset:2048 sc1
    buffer_load_dwordx4 v[132:135], v22, s[8:11], s30 offen offset:3072 sc1
    s_nop 7
    s_nop 7
    v_mov_b32 v136, 0
    v_mov_b32 v137, 0
    v_mov_b32 v138, 0
    v_mov_b32 v139, 0
    v_mov_b32 v140, 0
    v_mov_b32 v141, 0
    v_mov_b32 v142, 0
    v_mov_b32 v143, 0
    s_sub_u32 s48, s48, 1
    s_cbranch_scc0 pw_13
    s_mov_b32 s70, 2
    s_branch ch_err
rt_20:
    s_waitcnt vmcnt(0)
    s_sub_u32 s48, s48, 1
    s_cbranch_scc0 xv_18
    s_mov_b32 s70, 4
    s_branch ch_err
rt_22:
    buffer_load_dwordx4 v[48:51], v24, s[8:11], s30 offen offset:0 sc1
    buffer_load_dwordx4 v[52:55], v24, s[8:11], s30 offen offset:1024 sc1
    buffer_load_dwordx4 v[56:59], v24, s[8:11], s30 offen offset:2048 sc1
    buffer_load_dwordx4 v[60:63], v24, s[8:11], s30 offen offset:3072 sc1
    buffer_load_dwordx4 v[64:67], v14, s[8:11], s30 offen sc1
    s_sub_u32 s48, s48, 1
    s_cbranch_scc0 pw_21
    s_mov_b32 s70, 3
    s_branch ch_err
rt_29:
    buffer_load_dwordx4 v[176:179], v20, s[8:11], s30 offen offset:0 sc1
    buffer_load_dwordx4 v[180:183], v20, s[8:11], s30 offen offset:1024 sc1
    buffer_load_dwordx4 v[184:187], v20, s[8:11], s30 offen offset:2048 sc1
    buffer_load_dwordx4 v[188:191], v20, s[8:11], s30 offen offset:3072 sc1
    s_sub_u32 s48, s48, 1
    s_cbranch_scc0 pw_28
    s_mov_b32 s70, 1
    s_branch ch_err
rt_31:
    buffer_load_dwordx4 v[120:123], v22, s[8:11], s31 offen offset:0 sc1
    buffer_load_dwordx4 v[124:127], v22, s[8:11], s31 offen offset:1024 sc1
    buffer_load_dwordx4 v[128:131], v22, s[8:11], s31 offen offset:2048 sc1
    buffer_load_dwordx4 v[132:135], v22, s[8:11], s31 offen offset:3072 sc1
    s_nop 7
    s_nop 7
    v_mov_b32 v136, 0
    v_mov_b32 v137, 0
    v_mov_b32 v138, 0
    v_mov_b32 v139, 0
    v_mov_b32 v140, 0
    v_mov_b32 v141, 0
    v_mov_b32 v142, 0
    v_mov_b32 v143, 0
    s_sub_u32 s48, s48, 1
    s_cbranch_scc0 pw_30
    s_mov_b32 s70, 2
    s_branch ch_err
rt_37:
    s_waitcnt vmcnt(0)
    s_sub_u32 s48, s48, 1
    s_cbranch_scc0 xv_35
    s_mov_b32 s70, 4
    s_branch ch_err
rt_39:
    buffer_load_dwordx4 v[48:51], v24, s[8:11], s31 offen offset:0 sc1
    buffer_load_dwordx4 v[52:55], v24, s[8:11], s31 offen offset:1024 sc1
    buffer_load_dwordx4 v[56:59], v24, s[8:11], s31 offen offset:2048 sc1
    buffer_load_dwordx4 v[60:63], v24, s[8:11], s31 offen offset:3072 sc1
    buffer_load_dwordx4 v[64:67], v14, s[8:11], s31 offen sc1
    s_sub_u32 s48, s48, 1
    s_cbranch_scc0 pw_38
    s_mov_b32 s70, 3
    s_branch ch_err
rt_46:
    buffer_load_dwordx4 v[176:179], v20, s[8:11], s31 offen offset:0 sc1
    buffer_load_dwordx4 v[180:183], v20, s[8:11], s31 offen offset:1024 sc1
    buffer_load_dwordx4 v[184:187], v20, s[8:11], s31 offen offset:2048 sc1
    buffer_load_dwordx4 v[188:191], v20, s[8:11], s31 offen offset:3072 sc1
    s_sub_u32 s48, s48, 1
    s_cbranch_scc0 pw_45
    s_mov_b32 s70, 1
    s_branch ch_err
rt_48:
    buffer_load_dwordx4 v[120:123], v22, s[8:11], s32 offen offset:0 sc1
    buffer_load_dwordx4 v[124:127], v22, s[8:11], s32 offen offset:1024 sc1
    buffer_load_dwordx4 v[128:131], v22, s[8:11], s32 offen offset:2048 sc1
    buffer_load_dwordx4 v[132:135], v22, s[8:11], s32 offen offset:3072 sc1
    s_nop 7
    s_nop 7
    v_mov_b32 v136, 0
    v_mov_b32 v137, 0
    v_mov_b32 v138, 0
    v_mov_b32 v139, 0
    v_mov_b32 v140, 0
    v_mov_b32 v141, 0
    v_mov_b32 v142, 0
    v_mov_b32 v143, 0
    s_sub_u32 s48, s48, 1
    s_cbranch_scc0 pw_47
    s_mov_b32 s70, 2
    s_branch ch_err
rt_54:
    s_waitcnt vmcnt(0)
    s_sub_u32 s48, s48, 1
    s_cbranch_scc0 xv_52
    s_mov_b32 s70, 4
    s_branch ch_err
rt_56:
    buffer_load_dwordx4 v[48:51], v24, s[8:11], s32 offen offset:0 sc1
    buffer_load_dwordx4 v[52:55], v24, s[8:11], s32 offen offset:1024 sc1
    buffer_load_dwordx4 v[56:59], v24, s[8:11], s32 offen offset:2048 sc1
    buffer_load_dwordx4 v[60:63], v24, s[8:11], s32 offen offset:3072 sc1
    buffer_load_dwordx4 v[64:67], v14, s[8:11], s32 offen sc1
    s_sub_u32 s48, s48, 1
    s_cbranch_scc0 pw_55
    s_mov_b32 s70, 3
    s_branch ch_err
rt_63:
    buffer_load_dwordx4 v[176:179], v20, s[8:11], s32 offen offset:0 sc1
    buffer_load_dwordx4 v[180:183], v20, s[8:11], s32 offen offset:1024 sc1
    buffer_load_dwordx4 v[184:187], v20, s[8:11], s32 offen offset:2048 sc1
    buffer_load_dwordx4 v[188:191], v20, s[8:11], s32 offen offset:3072 sc1
    s_sub_u32 s48, s48, 1
    s_cbranch_scc0 pw_62
    s_mov_b32 s70, 1
    s_branch ch_err
rt_65:
    buffer_load_dwordx4 v[120:123], v22, s[8:11], s33 offen offset:0 sc1
    buffer_load_dwordx4 v[124:127], v22, s[8:11], s33 offen offset:1024 sc1
    buffer_load_dwordx4 v[128:131], v22, s[8:11], s33 offen offset:2048 sc1
    buffer_load_dwordx4 v[132:135], v22, s[8:11], s33 offen offset:3072 sc1
    s_nop 7
    s_nop 7
    v_mov_b32 v136, 0
    v_mov_b32 v137, 0
    v_mov_b32 v138, 0
    v_mov_b32 v139, 0
    v_mov_b32 v140, 0
    v_mov_b32 v141, 0
    v_mov_b32 v142, 0
    v_mov_b32 v143, 0
    s_sub_u32 s48, s48, 1
    s_cbranch_scc0 pw_64
    s_mov_b32 s70, 2
    s_branch ch_err
rt_71:
    s_waitcnt vmcnt(0)
    s_sub_u32 s48, s48, 1
    s_cbranch_scc0 xv_69
    s_mov_b32 s70, 4
    s_branch ch_err
rt_73:
    buffer_load_dwordx4 v[48:51], v24, s[8:11], s33 offen offset:0 sc1
    buffer_load_dwordx4 v[52:55], v24, s[8:11], s33 offen offset:1024 sc1
    buffer_load_dwordx4 v[56:59], v24, s[8:11], s33 offen offset:2048 sc1
    buffer_load_dwordx4 v[60:63], v24, s[8:11], s33 offen offset:3072 sc1
    buffer_load_dwordx4 v[64:67], v14, s[8:11], s33 offen sc1
    s_sub_u32 s48, s48, 1
    s_cbranch_scc0 pw_72
    s_mov_b32 s70, 3
    s_branch ch_err
ch_loop_s:
    buffer_store_dwordx4 v[16:19], v26, s[8:11], s31 offen sc1
    s_cmp_eq_u32 s28, 1
    s_cbranch_scc1 r1_77
    buffer_store_dwordx4 v[16:19], v23, s[8:11], s31 offen sc1
    s_branch r2_78
r1_77:
    buffer_store_dword v16, v23, s[8:11], s31 offen sc1
r2_78:
    buffer_store_dwordx4 v[236:239], v28, s[16:19], s47 offen sc1
    s_add_u32 s54, s29, 2
    s_min_u32 s54, s54, 63
    s_lshl_b32 s54, s54, 16
    buffer_store_dwordx4 v[16:19], v28, s[16:19], s54 offen sc1
    s_lshl_b32 s42, s29, 18
    s_add_u32 s44, s42, 0x1040000
    s_add_u32 s46, s42, 0x80000
    s_add_u32 s42, s42, 0x40000
    s_add_u32 s43, s42, 0x20000
    s_add_u32 s45, s44, 0x20000
    s_lshl_b32 s47, s29, 16
    s_waitcnt vmcnt(7)
    v_mfma_f32_16x16x32_bf16 v[160:163], v[72:75], a[192:195], 0
    v_mfma_f32_16x16x32_bf16 v[164:167], v[88:91], a[192:195], 0
    v_mfma_f32_16x16x32_bf16 v[168:171], v[72:75], a[208:211], 0
    v_mfma_f32_16x16x32_bf16 v[172:175], v[88:91], a[208:211], 0
    v_mfma_f32_16x16x32_bf16 v[176:179], v[72:75], a[224:227], 0
    v_mfma_f32_16x16x32_bf16 v[180:183], v[88:91], a[224:227], 0
    v_mfma_f32_16x16x32_bf16 v[184:187], v[72:75], a[240:243], 0
    v_mfma_f32_16x16x32_bf16 v[188:191], v[88:91], a[240:243], 0
    v_mfma_f32_16x16x32_bf16 v[160:163], v[76:79], a[196:199], v[160:163]
    v_mfma_f32_16x16x32_bf16 v[164:167], v[92:95], a[196:199], v[164:167]
    v_mfma_f32_16x16x32_bf16 v[168:171], v[76:79], a[212:215], v[168:171]
    v_mfma_f32_16x16x32_bf16 v[172:175], v[92:95], a[212:215], v[172:175]
    v_mfma_f32_16x16x32_bf16 v[176:179], v[76:79], a[228:231], v[176:179]
    v_mfma_f32_16x16x32_bf16 v[180:183], v[92:95], a[228:231], v[180:183]
    v_mfma_f32_16x16x32_bf16 v[184:187], v[76:79], a[244:247], v[184:187]
    v_mfma_f32_16x16x32_bf16 v[188:191], v[92:95], a[244:247], v[188:191]
    v_mfma_f32_16x16x32_bf16 v[160:163], v[80:83], a[200:203], v[160:163]
    v_mfma_f32_16x16x32_bf16 v[164:167], v[96:99], a[200:203], v[164:167]
    v_mfma_f32_16x16x32_bf16 v[168:171], v[80:83], a[216:219], v[168:171]
    v_mfma_f32_16x16x32_bf16 v[172:175], v[96:99], a[216:219], v[172:175]
    v_mfma_f32_16x16x32_bf16 v[176:179], v[80:83], a[232:235], v[176:179]
    v_mfma_f32_16x16x32_bf16 v[180:183], v[96:99], a[232:235], v[180:183]
    v_mfma_f32_16x16x32_bf16 v[184:187], v[80:83], a[248:251], v[184:187]
    v_mfma_f32_16x16x32_bf16 v[188:191], v[96:99], a[248:251], v[188:191]
    v_mfma_f32_16x16x32_bf16 v[160:163], v[84:87], a[204:207], v[160:163]
    v_mfma_f32_16x16x32_bf16 v[164:167], v[100:103], a[204:207], v[164:167]
    v_mfma_f32_16x16x32_bf16 v[168:171], v[84:87], a[220:223], v[168:171]
    v_mfma_f32_16x16x32_bf16 v[172:175], v[100:103], a[220:223], v[172:175]
    v_mfma_f32_16x16x32_bf16 v[176:179], v[84:87], a[236:239], v[176:179]
    v_mfma_f32_16x16x32_bf16 v[180:183], v[100:103], a[236:239], v[180:183]
    v_mfma_f32_16x16x32_bf16 v[184:187], v[84:87], a[252:255], v[184:187]
    v_mfma_f32_16x16x32_bf16 v[188:191], v[100:103], a[252:255], v[188:191]
    s_nop 0
    v_cvt_pk_bf16_f32 v104, v160, v161
    v_cvt_pk_bf16_f32 v105, v162, v163
    v_cvt_pk_bf16_f32 v106, v164, v165
    v_cvt_pk_bf16_f32 v107, v166, v167
    v_cvt_pk_bf16_f32 v108, v168, v169
    v_cvt_pk_bf16_f32 v109, v170, v171
    v_cvt_pk_bf16_f32 v110, v172, v173
    v_cvt_pk_bf16_f32 v111, v174, v175
    v_cvt_pk_bf16_f32 v112, v176, v177
    v_cvt_pk_bf16_f32 v113, v178, v179
    v_cvt_pk_bf16_f32 v114, v180, v181
    v_cvt_pk_bf16_f32 v115, v182, v183
    v_cvt_pk_bf16_f32 v116, v184, v185
    v_cvt_pk_bf16_f32 v117, v186, v187
    v_cvt_pk_bf16_f32 v118, v188, v189
    v_cvt_pk_bf16_f32 v119, v190, v191
    s_cmp_lg_u32 s28, 2
    s_cbranch_scc1 nt_79
nt_79:
    v_mov_b32 v136, 0
    v_mov_b32 v137, 0
    v_mov_b32 v138, 0
    v_mov_b32 v139, 0
    v_mov_b32 v140, 0
    v_mov_b32 v141, 0
    v_mov_b32 v142, 0
    v_mov_b32 v143, 0
    v_mov_b32 v144, 0
    v_mov_b32 v145, 0
    v_mov_b32 v146, 0
    v_mov_b32 v147, 0
    v_mov_b32 v148, 0
    v_mov_b32 v149, 0
    v_mov_b32 v150, 0
    v_mov_b32 v151, 0
    v_mov_b32 v152, 0
    v_mov_b32 v153, 0
    v_mov_b32 v154, 0
    v_mov_b32 v155, 0
    v_mov_b32 v156, 0
    v_mov_b32 v157, 0
    v_mov_b32 v158, 0
    v_mov_b32 v159, 0
    s_cmp_lg_u32 s28, 3
    s_cbranch_scc1 noA_80
    s_cmp_eq_u32 s29, 0
    s_cbranch_scc1 noA_80
    buffer_load_dwordx4 v[176:179], v20, s[8:11], s33 offen offset:0 sc1
    buffer_load_dwordx4 v[180:183], v20, s[8:11], s33 offen offset:1024 sc1
    buffer_load_dwordx4 v[184:187], v20, s[8:11], s33 offen offset:2048 sc1
    buffer_load_dwordx4 v[188:191], v20, s[8:11], s33 offen offset:3072 sc1
pw_81:
    s_waitcnt vmcnt(0)
    v_mfma_f32_16x16x32_bf16 v[160:163], v[36:39], v[176:179], 0
    v_max3_u32 v244, v176, v177, v178
    v_max3_u32 v245, v179, v180, v181
    v_max3_u32 v246, v182, v183, v184
    v_mfma_f32_16x16x32_bf16 v[160:163], v[36:39], v[180:183], v[160:163]
    v_max3_u32 v247, v185, v186, v187
    v_max3_u32 v248, v188, v189, v190
    v_max3_u32 v244, v244, v245, v246
    v_mfma_f32_16x16x32_bf16 v[160:163], v[240:243], v[184:187], v[160:163]
    v_max3_u32 v247, v247, v248, v191
    v_max_u32 v244, v244, v247
    v_cmp_eq_u32 vcc, -1, v244
    v_mfma_f32_16x16x32_bf16 v[160:163], v[240:243], v[188:191], v[160:163]
    s_cbranch_vccnz rt_82
    s_nop 6
    v_cvt_pk_bf16_f32 v244, v160, v161
    v_cvt_pk_bf16_f32 v245, v162, v163
    v_min_u32 v244, -2, v244
    v_min_u32 v245, -2, v245
    buffer_store_dwordx2 v[244:245], v21, s[8:11], s30 offen sc1
    buffer_store_dwordx2 v[16:17], v21, s[8:11], s32 offen sc1
noA_80:
    s_barrier
    s_sleep 3
    buffer_load_dwordx4 v[120:123], v22, s[8:11], s30 offen offset:0 sc1
    buffer_load_dwordx4 v[124:127], v22, s[8:11], s30 offen offset:1024 sc1
    buffer_load_dwordx4 v[128:131], v22, s[8:11], s30 offen offset:2048 sc1
    buffer_load_dwordx4 v[132:135], v22, s[8:11], s30 offen offset:3072 sc1
pw_83:
    s_waitcnt vmcnt(0)
    v_smfmac_f32_16x16x64_bf16 v[136:139], v[120:123], a[0:7], v1
    v_max3_u32 v244, v120, v121, v122
    v_max3_u32 v245, v123, v124, v125
    v_max3_u32 v246, v126, v127, v128
    v_smfmac_f32_16x16x64_bf16 v[140:143], v[120:123], a[32:39], v1
    v_max3_u32 v247, v129, v130, v131
    v_max3_u32 v248, v132, v133, v134
    v_max3_u32 v244, v244, v245, v246
    v_smfmac_f32_16x16x64_bf16 v[136:139], v[124:127], a[8:15], v1
    v_max3_u32 v247, v247, v248, v135
    v_max_u32 v244, v244, v247
    v_cmp_eq_u32 vcc, -1, v244
    v_smfmac_f32_16x16x64_bf16 v[140:143], v[124:127], a[40:47], v1
    s_cbranch_vccnz rt_84
    v_smfmac_f32_16x16x64_bf16 v[136:139], v[128:131], a[16:23], v1
    v_smfmac_f32_16x16x64_bf16 v[140:143], v[128:131], a[48:55], v1
    v_smfmac_f32_16x16x64_bf16 v[136:139], v[132:135], a[24:31], v1
    v_smfmac_f32_16x16x64_bf16 v[140:143], v[132:135], a[56:63], v1
    v_smfmac_f32_16x16x64_bf16 v[144:147], v[120:123], a[64:71], v1
    v_smfmac_f32_16x16x64_bf16 v[148:151], v[120:123], a[96:103], v1
    v_smfmac_f32_16x16x64_bf16 v[144:147], v[124:127], a[72:79], v1
    v_smfmac_f32_16x16x64_bf16 v[148:151], v[124:127], a[104:111], v1
    s_nop 3
    v_permlane32_swap_b32 v136, v140
    v_smfmac_f32_16x16x64_bf16 v[144:147], v[128:131], a[80:87], v1
    v_permlane32_swap_b32 v137, v141
    v_smfmac_f32_16x16x64_bf16 v[148:151], v[128:131], a[112:119], v1
    v_permlane32_swap_b32 v138, v142
    v_smfmac_f32_16x16x64_bf16 v[144:147], v[132:135], a[88:95], v1
    v_permlane32_swap_b32 v139, v143
    v_smfmac_f32_16x16x64_bf16 v[148:151], v[132:135], a[120:127], v1
    v_pk_add_f32 v[136:137], v[136:137], v[140:141]
    v_smfmac_f32_16x16x64_bf16 v[152:155], v[120:123], a[128:135], v1
    v_pk_add_f32 v[138:139], v[138:139], v[142:143]
    v_smfmac_f32_16x16x64_bf16 v[156:159], v[120:123], a[160:167], v1
    ds_write_b128 v30, v[136:139]
    v_smfmac_f32_16x16x64_bf16 v[152:155], v[124:127], a[136:143], v1
    v_smfmac_f32_16x16x64_bf16 v[156:159], v[124:127], a[168:175], v1
    s_nop 0
    v_permlane32_swap_b32 v144, v148
    v_permlane32_swap_b32 v145, v149
    v_smfmac_f32_16x16x64_bf16 v[152:155], v[128:131], a[144:151], v1
    v_permlane32_swap_b32 v146, v150
    v_smfmac_f32_16x16x64_bf16 v[156:159], v[128:131], a[176:183], v1
    v_permlane32_swap_b32 v147, v151
    v_pk_add_f32 v[144:145], v[144:145], v[148:149]
    v_smfmac_f32_16x16x64_bf16 v[152:155], v[132:135], a[152:159], v1
    v_pk_add_f32 v[146:147], v[146:147], v[150:151]
    v_smfmac_f32_16x16x64_bf16 v[156:159], v[132:135], a[184:191], v1
    ds_write_b128 v30, v[144:147] offset:4096
    s_nop 6
    v_permlane32_swap_b32 v152, v156
    v_permlane32_swap_b32 v153, v157
    v_permlane32_swap_b32 v154, v158
    v_permlane32_swap_b32 v155, v159
    v_pk_add_f32 v[152:153], v[152:153], v[156:157]
    v_pk_add_f32 v[154:155], v[154:155], v[158:159]
    ds_write_b128 v30, v[152:155] offset:8192
    s_waitcnt lgkmcnt(0)
    s_barrier
    s_cmp_eq_u32 s28, 3
    s_cbranch_scc1 be_87
    ds_read_b128 v[160:163], v35 offset:0
    ds_read_b128 v[164:167], v35 offset:1024
    ds_read_b128 v[168:171], v35 offset:2048
    ds_read_b128 v[172:175], v35 offset:3072
    s_cmp_eq_u32 s28, 1
    s_cbranch_scc1 b1_85
    s_cmp_eq_u32 s28, 2
    s_cbranch_scc1 b2_86
    s_waitcnt lgkmcnt(2)
    v_pk_add_f32 v[160:161], v[160:161], v[164:165]
    v_pk_add_f32 v[162:163], v[162:163], v[166:167]
    s_waitcnt lgkmcnt(0)
    v_pk_add_f32 v[168:169], v[168:169], v[172:173]
    v_pk_add_f32 v[170:171], v[170:171], v[174:175]
    v_pk_add_f32 v[160:161], v[160:161], v[168:169]
    v_pk_add_f32 v[162:163], v[162:163], v[170:171]
    v_cvt_pk_bf16_f32 v244, v160, v161
    v_cvt_pk_bf16_f32 v245, v162, v163
    s_nop 1
    v_mfma_f32_16x16x16_bf16 v[164:167], v[244:245], v[2:3], 0
    v_mfma_f32_16x16x16_bf16 v[168:171], v[244:245], v[4:5], 0
    s_nop 6
    v_cvt_pk_bf16_f32 v172, v164, v165
    v_cvt_pk_bf16_f32 v173, v166, v167
    v_cvt_pk_bf16_f32 v174, v168, v169
    v_cvt_pk_bf16_f32 v175, v170, v171
    s_nop 1
    v_mfma_f32_16x16x32_bf16 v[160:163], v[40:43], v[172:175], 0
    v_mfma_f32_16x16x32_bf16 v[164:167], v[44:47], v[172:175], 0
    s_nop 7
    v_mov_b32_dpp v160, v164 quad_perm:[0,1,2,3] row_mask:0xf bank_mask:0xc
    v_mov_b32_dpp v161, v165 quad_perm:[0,1,2,3] row_mask:0xf bank_mask:0xc
    v_mov_b32_dpp v162, v166 quad_perm:[0,1,2,3] row_mask:0xf bank_mask:0xc
    v_mov_b32_dpp v163, v167 quad_perm:[0,1,2,3] row_mask:0xf bank_mask:0xc
    v_min_u32 v160, -2, v160
    v_min_u32 v161, -2, v161
    v_min_u32 v162, -2, v162
    v_min_u32 v163, -2, v163
    buffer_store_dwordx4 v[160:163], v23, s[8:11], s30 offen sc1
    s_branch be_87
b1_85:
    ds_read_b128 v[48:51], v31 offset:0
    ds_read_b128 v[52:55], v31 offset:1024
    ds_read_b128 v[56:59], v31 offset:2048
    ds_read_b128 v[60:63], v31 offset:3072
    s_waitcnt lgkmcnt(6)
    v_pk_add_f32 v[160:161], v[160:161], v[164:165]
    v_pk_add_f32 v[162:163], v[162:163], v[166:167]
    s_waitcnt lgkmcnt(4)
    v_pk_add_f32 v[168:169], v[168:169], v[172:173]
    v_pk_add_f32 v[170:171], v[170:171], v[174:175]
    v_pk_add_f32 v[160:161], v[160:161], v[168:169]
    v_pk_add_f32 v[162:163], v[162:163], v[170:171]
    v_cvt_pk_bf16_f32 v246, v160, v161
    v_cvt_pk_bf16_f32 v247, v162, v163
    s_waitcnt lgkmcnt(2)
    s_nop 0
    v_mfma_f32_16x16x16_bf16 v[164:167], v[246:247], v[68:69], 0
    v_pk_add_f32 v[48:49], v[48:49], v[52:53]
    v_pk_add_f32 v[50:51], v[50:51], v[54:55]
    v_mfma_f32_16x16x16_bf16 v[168:171], v[246:247], v[70:71], 0
    s_waitcnt lgkmcnt(0)
    v_pk_add_f32 v[56:57], v[56:57], v[60:61]
    v_pk_add_f32 v[58:59], v[58:59], v[62:63]
    v_pk_add_f32 v[48:49], v[48:49], v[56:57]
    v_pk_add_f32 v[50:51], v[50:51], v[58:59]
    v_cvt_pk_bf16_f32 v244, v48, v49
    v_cvt_pk_bf16_f32 v245, v50, v51
    s_nop 1
    v_mfma_f32_16x16x16_bf16 v[52:55], v[244:245], v[2:3], 0
    v_mfma_f32_16x16x16_bf16 v[56:59], v[244:245], v[4:5], 0
    v_cvt_pk_bf16_f32 v172, v164, v165
    v_cvt_pk_bf16_f32 v173, v166, v167
    v_cvt_pk_bf16_f32 v174, v168, v169
    v_cvt_pk_bf16_f32 v175, v170, v171
    s_nop 2
    v_cvt_pk_bf16_f32 v60, v52, v53
    v_cvt_pk_bf16_f32 v61, v54, v55
    v_cvt_pk_bf16_f32 v62, v56, v57
    v_cvt_pk_bf16_f32 v63, v58, v59
    s_nop 1
    v_mfma_f32_16x16x32_bf16 v[48:51], v[172:175], v[60:63], 0
    v_min_u32 v236, -2, v172
    v_min_u32 v237, -2, v173
    v_min_u32 v238, -2, v174
    v_min_u32 v239, -2, v175
    s_nop 3
    v_mov_b32_dpp v48, v49 quad_perm:[0,1,2,3] row_mask:0xf bank_mask:0xc
    v_min_u32 v48, -2, v48
    buffer_store_dword v48, v23, s[8:11], s30 offen sc1
    s_branch be_87
b2_86:
    s_waitcnt lgkmcnt(2)
    v_pk_add_f32 v[160:161], v[160:161], v[164:165]
    v_pk_add_f32 v[162:163], v[162:163], v[166:167]
    s_waitcnt lgkmcnt(0)
    v_pk_add_f32 v[168:169], v[168:169], v[172:173]
    v_pk_add_f32 v[170:171], v[170:171], v[174:175]
    v_pk_add_f32 v[160:161], v[160:161], v[168:169]
    v_pk_add_f32 v[162:163], v[162:163], v[170:171]
    v_cvt_pk_bf16_f32 v244, v160, v161
    v_cvt_pk_bf16_f32 v245, v162, v163
    s_nop 1
    v_mfma_f32_16x16x16_bf16 v[164:167], v[244:245], v[2:3], 0
    v_mfma_f32_16x16x16_bf16 v[168:171], v[244:245], v[4:5], 0
    s_nop 6
    v_cvt_pk_bf16_f32 v236, v164, v165
    v_cvt_pk_bf16_f32 v237, v166, v167
    v_cvt_pk_bf16_f32 v238, v168, v169
    v_cvt_pk_bf16_f32 v239, v170, v171
    v_min_u32 v236, -2, v236
    v_min_u32 v237, -2, v237
    v_min_u32 v238, -2, v238
    v_min_u32 v239, -2, v239
    buffer_store_dwordx4 v[236:239], v23, s[8:11], s30 offen sc1
be_87:
    s_barrier
    s_sleep 2
xv_88:
    buffer_load_dwordx4 v[176:179], v25, s[8:11], s30 offen offset:0 sc1
    buffer_load_dwordx4 v[180:183], v25, s[8:11], s30 offen offset:1024 sc1
    buffer_load_dwordx4 v[48:51], v24, s[8:11], s30 offen offset:0 sc1
    buffer_load_dwordx4 v[52:55], v24, s[8:11], s30 offen offset:1024 sc1
    buffer_load_dwordx4 v[56:59], v24, s[8:11], s30 offen offset:2048 sc1
    buffer_load_dwordx4 v[60:63], v24, s[8:11], s30 offen offset:3072 sc1
    buffer_load_dwordx4 v[64:67], v14, s[8:11], s30 offen sc1
    s_waitcnt vmcnt(5)
    v_mfma_f32_16x16x32_bf16 v[204:207], v[176:179], a[196:199], 0
    v_max3_u32 v244, v176, v177, v178
    v_max3_u32 v245, v179, v180, v181
    v_max_u32 v246, v182, v183
    v_mfma_f32_16x16x32_bf16 v[208:211], v[176:179], a[212:215], 0
    v_max3_u32 v244, v244, v245, v246
    v_cmp_eq_u32 vcc, -1, v244
    v_mfma_f32_16x16x32_bf16 v[212:215], v[176:179], a[228:231], 0
    v_mov_b32_dpp v184, v176 row_ror:8 row_mask:0xf bank_mask:0xf
    v_mov_b32_dpp v185, v177 row_ror:8 row_mask:0xf bank_mask:0xf
    v_mfma_f32_16x16x32_bf16 v[216:219], v[176:179], a[244:247], 0
    s_cbranch_vccnz rt_90
    v_mov_b32_dpp v186, v178 row_ror:8 row_mask:0xf bank_mask:0xf
    v_mov_b32_dpp v187, v179 row_ror:8 row_mask:0xf bank_mask:0xf
    v_mfma_f32_16x16x32_bf16 v[204:207], v[180:183], a[204:207], v[204:207]
    v_mov_b32_dpp v188, v180 row_ror:8 row_mask:0xf bank_mask:0xf
    v_mfma_f32_16x16x32_bf16 v[208:211], v[180:183], a[220:223], v[208:211]
    v_mov_b32_dpp v189, v181 row_ror:8 row_mask:0xf bank_mask:0xf
    v_mfma_f32_16x16x32_bf16 v[212:215], v[180:183], a[236:239], v[212:215]
    v_mov_b32_dpp v190, v182 row_ror:8 row_mask:0xf bank_mask:0xf
    v_mfma_f32_16x16x32_bf16 v[216:219], v[180:183], a[252:255], v[216:219]
    v_mov_b32_dpp v191, v183 row_ror:8 row_mask:0xf bank_mask:0xf
pw_91:
    s_waitcnt vmcnt(0)
    v_max3_u32 v244, v48, v49, v50
    v_max3_u32 v245, v51, v52, v53
    v_max3_u32 v246, v54, v55, v56
    v_max3_u32 v247, v57, v58, v59
    v_max3_u32 v248, v60, v61, v62
    v_max3_u32 v249, v63, v64, v65
    v_max_u32 v250, v66, v67
    v_max3_u32 v244, v244, v245, v246
    v_pk_add_f32 v[48:49], v[48:49], v[52:53]
    v_max3_u32 v247, v247, v248, v249
    v_pk_add_f32 v[50:51], v[50:51], v[54:55]
    v_max3_u32 v244, v244, v247, v250
    v_pk_add_f32 v[56:57], v[56:57], v[60:61]
    v_cmp_eq_u32 vcc, -1, v244
    v_pk_add_f32 v[58:59], v[58:59], v[62:63]
    v_pk_add_f32 v[64:65], v[64:65], v[66:67]
    s_cbranch_vccnz rt_92
    buffer_load_dwordx4 v[72:75], v27, s[12:15], s44 offen offset:0
    v_pk_add_f32 v[192:193], v[48:49], v[56:57]
    v_mfma_f32_16x16x32_bf16 v[204:207], v[184:187], a[192:195], v[204:207]
    buffer_load_dwordx4 v[88:91], v27, s[12:15], s45 offen offset:0
    v_pk_add_f32 v[194:195], v[50:51], v[58:59]
    v_add_f32 v196, v64, v65
    v_mfma_f32_16x16x32_bf16 v[208:211], v[184:187], a[208:211], v[208:211]
    buffer_load_dwordx4 v[76:79], v27, s[12:15], s44 offen offset:1024
    v_max3_f32 v244, v192, v193, v194
    v_max3_f32 v244, v244, v195, v196
    buffer_load_dwordx4 v[92:95], v27, s[12:15], s45 offen offset:1024
    v_mfma_f32_16x16x32_bf16 v[212:215], v[184:187], a[224:227], v[212:215]
    v_max_f32_dpp v244, v244, v244 row_ror:8 row_mask:0xf bank_mask:0xf
    v_mov_b32 v245, v244
    buffer_load_dwordx4 v[80:83], v27, s[12:15], s44 offen offset:2048
    v_mfma_f32_16x16x32_bf16 v[216:219], v[184:187], a[240:243], v[216:219]
    v_permlane32_swap_b32 v244, v245
    buffer_load_dwordx4 v[96:99], v27, s[12:15], s45 offen offset:2048
    v_max_f32 v244, v244, v245
    v_mfma_f32_16x16x32_bf16 v[204:207], v[188:191], a[200:203], v[204:207]
    v_mov_b32 v245, v244
    buffer_load_dwordx4 v[84:87], v27, s[12:15], s44 offen offset:3072
    s_nop 0
    v_permlane16_swap_b32 v244, v245
    v_mfma_f32_16x16x32_bf16 v[208:211], v[188:191], a[216:219], v[208:211]
    buffer_load_dwordx4 v[100:103], v27, s[12:15], s45 offen offset:3072
    v_max_f32 v244, v244, v245
    v_mul_f32 v244, s49, v244
    v_mfma_f32_16x16x32_bf16 v[212:215], v[188:191], a[232:235], v[212:215]
    buffer_load_dwordx4 v[40:43], v13, s[12:15], s42 offen
    v_fma_f32 v192, v192, s49, -v244
    v_fma_f32 v193, v193, s49, -v244
    buffer_load_dwordx4 v[44:47], v13, s[12:15], s43 offen
    v_mfma_f32_16x16x32_bf16 v[216:219], v[188:191], a[248:251], v[216:219]
    v_fma_f32 v194, v194, s49, -v244
    v_fma_f32 v195, v195, s49, -v244
    v_fma_f32 v196, v196, s49, -v244
    v_exp_f32 v192, v192
    v_exp_f32 v193, v193
    v_exp_f32 v194, v194
    v_exp_f32 v195, v195
    v_exp_f32 v196, v196
    v_cvt_pk_bf16_f32 v228, v192, v193
    v_cvt_pk_bf16_f32 v229, v194, v195
    v_mov_b32_dpp v246, v196 row_ror:8 row_mask:0xf bank_mask:0xf
    v_mov_b32_dpp v230, v228 row_ror:8 row_mask:0xf bank_mask:0xf
    v_mov_b32_dpp v231, v229 row_ror:8 row_mask:0xf bank_mask:0xf
    v_cvt_pk_bf16_f32 v232, v196, v246
    s_nop 0
    v_mfma_f32_16x16x32_bf16 v[152:155], v[8:11], v[228:231], 0
    v_mov_b32 v233, v232
    v_cvt_pk_bf16_f32 v220, v204, v205
    v_cvt_pk_bf16_f32 v221, v206, v207
    v_mfma_f32_16x16x32_bf16 v[136:139], v[104:107], v[228:231], 0
    v_permlane32_swap_b32 v232, v233
    v_cvt_pk_bf16_f32 v222, v208, v209
    v_cvt_pk_bf16_f32 v223, v210, v211
    v_mfma_f32_16x16x32_bf16 v[140:143], v[108:111], v[228:231], 0
    v_and_b32 v232, v232, v12
    v_and_b32 v233, v233, v12
    v_cvt_pk_bf16_f32 v224, v212, v213
    v_mfma_f32_16x16x32_bf16 v[144:147], v[112:115], v[228:231], 0
    v_cvt_pk_bf16_f32 v225, v214, v215
    v_cvt_pk_bf16_f32 v226, v216, v217
    v_cvt_pk_bf16_f32 v227, v218, v219
    v_mfma_f32_16x16x32_bf16 v[148:151], v[116:119], v[228:231], 0
    v_mfma_f32_16x16x16_bf16 v[152:155], v[8:9], v[232:233], v[152:155]
    v_mfma_f32_16x16x16_bf16 v[136:139], v[220:221], v[232:233], v[136:139]
    v_mfma_f32_16x16x16_bf16 v[140:143], v[222:223], v[232:233], v[140:143]
    v_mfma_f32_16x16x16_bf16 v[144:147], v[224:225], v[232:233], v[144:147]
    s_nop 1
    v_mfma_f32_16x16x16_bf16 v[148:151], v[226:227], v[232:233], v[148:151]
    s_nop 1
    v_rcp_f32 v244, v152
    s_nop 0
    v_pk_mul_f32 v[136:137], v[136:137], v[244:245] op_sel_hi:[1,0]
    v_pk_mul_f32 v[138:139], v[138:139], v[244:245] op_sel_hi:[1,0]
    v_pk_mul_f32 v[144:145], v[144:145], v[244:245] op_sel_hi:[1,0]
    v_pk_mul_f32 v[146:147], v[146:147], v[244:245] op_sel_hi:[1,0]
    v_mul_f32_dpp v136, v140, v244 row_shr:8 row_mask:0xf bank_mask:0xc
    v_mul_f32_dpp v137, v141, v244 row_shr:8 row_mask:0xf bank_mask:0xc
    v_mul_f32_dpp v138, v142, v244 row_shr:8 row_mask:0xf bank_mask:0xc
    v_mul_f32_dpp v139, v143, v244 row_shr:8 row_mask:0xf bank_mask:0xc
    ds_write_b128 v32, v[136:139] offset:0
    v_mul_f32_dpp v144, v148, v244 row_shr:8 row_mask:0xf bank_mask:0xc
    v_mul_f32_dpp v145, v149, v244 row_shr:8 row_mask:0xf bank_mask:0xc
    v_mul_f32_dpp v146, v150, v244 row_shr:8 row_mask:0xf bank_mask:0xc
    v_mul_f32_dpp v147, v151, v244 row_shr:8 row_mask:0xf bank_mask:0xc
    ds_write_b128 v32, v[144:147] offset:1024
    s_waitcnt lgkmcnt(0)
    s_barrier
    s_cmp_ge_u32 s28, 2
    s_cbranch_scc1 c1_93
    ds_read_b128 v[160:163], v33 offset:0
    ds_read_b128 v[164:167], v33 offset:2048
    ds_read_b128 v[168:171], v33 offset:4096
    ds_read_b128 v[172:175], v33 offset:6144
    s_waitcnt lgkmcnt(2)
    v_pk_add_f32 v[160:161], v[160:161], v[164:165]
    v_pk_add_f32 v[162:163], v[162:163], v[166:167]
    s_waitcnt lgkmcnt(0)
    v_pk_add_f32 v[168:169], v[168:169], v[172:173]
    v_pk_add_f32 v[170:171], v[170:171], v[174:175]
    v_pk_add_f32 v[160:161], v[160:161], v[168:169]
    v_pk_add_f32 v[162:163], v[162:163], v[170:171]
    v_cvt_pk_bf16_f32 v164, v160, v161
    v_cvt_pk_bf16_f32 v165, v162, v163
    v_min_u32 v164, -2, v164
    v_min_u32 v165, -2, v165
    v_mov_b32 v166, v164
    v_mov_b32 v167, v165
    s_nop 0
    v_permlane16_swap_b32 v164, v166
    v_permlane16_swap_b32 v165, v167
c1_93:
    buffer_store_dwordx4 v[164:167], v26, s[8:11], s30 offen sc1
    s_add_u32 s29, s29, 1
    buffer_store_dwordx4 v[16:19], v26, s[8:11], s32 offen sc1
    s_cmp_eq_u32 s28, 1
    s_cbranch_scc1 r1_94
    buffer_store_dwordx4 v[16:19], v23, s[8:11], s32 offen sc1
    s_branch r2_95
r1_94:
    buffer_store_dword v16, v23, s[8:11], s32 offen sc1
r2_95:
    buffer_store_dwordx4 v[236:239], v28, s[16:19], s47 offen sc1
    s_add_u32 s54, s29, 2
    s_min_u32 s54, s54, 63
    s_lshl_b32 s54, s54, 16
    buffer_store_dwordx4 v[16:19], v28, s[16:19], s54 offen sc1
    s_lshl_b32 s42, s29, 18
    s_add_u32 s44, s42, 0x1040000
    s_add_u32 s46, s42, 0x80000
    s_add_u32 s42, s42, 0x40000
    s_add_u32 s43, s42, 0x20000
    s_add_u32 s45, s44, 0x20000
    s_lshl_b32 s47, s29, 16
    s_waitcnt vmcnt(7)
    v_mfma_f32_16x16x32_bf16 v[160:163], v[72:75], a[192:195], 0
    v_mfma_f32_16x16x32_bf16 v[164:167], v[88:91], a[192:195], 0
    v_mfma_f32_16x16x32_bf16 v[168:171], v[72:75], a[208:211], 0
    v_mfma_f32_16x16x32_bf16 v[172:175], v[88:91], a[208:211], 0
    v_mfma_f32_16x16x32_bf16 v[176:179], v[72:75], a[224:227], 0
    v_mfma_f32_16x16x32_bf16 v[180:183], v[88:91], a[224:227], 0
    v_mfma_f32_16x16x32_bf16 v[184:187], v[72:75], a[240:243], 0
    v_mfma_f32_16x16x32_bf16 v[188:191], v[88:91], a[240:243], 0
    v_mfma_f32_16x16x32_bf16 v[160:163], v[76:79], a[196:199], v[160:163]
    v_mfma_f32_16x16x32_bf16 v[164:167], v[92:95], a[196:199], v[164:167]
    v_mfma_f32_16x16x32_bf16 v[168:171], v[76:79], a[212:215], v[168:171]
    v_mfma_f32_16x16x32_bf16 v[172:175], v[92:95], a[212:215], v[172:175]
    v_mfma_f32_16x16x32_bf16 v[176:179], v[76:79], a[228:231], v[176:179]
    v_mfma_f32_16x16x32_bf16 v[180:183], v[92:95], a[228:231], v[180:183]
    v_mfma_f32_16x16x32_bf16 v[184:187], v[76:79], a[244:247], v[184:187]
    v_mfma_f32_16x16x32_bf16 v[188:191], v[92:95], a[244:247], v[188:191]
    v_mfma_f32_16x16x32_bf16 v[160:163], v[80:83], a[200:203], v[160:163]
    v_mfma_f32_16x16x32_bf16 v[164:167], v[96:99], a[200:203], v[164:167]
    v_mfma_f32_16x16x32_bf16 v[168:171], v[80:83], a[216:219], v[168:171]
    v_mfma_f32_16x16x32_bf16 v[172:175], v[96:99], a[216:219], v[172:175]
    v_mfma_f32_16x16x32_bf16 v[176:179], v[80:83], a[232:235], v[176:179]
    v_mfma_f32_16x16x32_bf16 v[180:183], v[96:99], a[232:235], v[180:183]
    v_mfma_f32_16x16x32_bf16 v[184:187], v[80:83], a[248:251], v[184:187]
    v_mfma_f32_16x16x32_bf16 v[188:191], v[96:99], a[248:251], v[188:191]
    v_mfma_f32_16x16x32_bf16 v[160:163], v[84:87], a[204:207], v[160:163]
    v_mfma_f32_16x16x32_bf16 v[164:167], v[100:103], a[204:207], v[164:167]
    v_mfma_f32_16x16x32_bf16 v[168:171], v[84:87], a[220:223], v[168:171]
    v_mfma_f32_16x16x32_bf16 v[172:175], v[100:103], a[220:223], v[172:175]
    v_mfma_f32_16x16x32_bf16 v[176:179], v[84:87], a[236:239], v[176:179]
    v_mfma_f32_16x16x32_bf16 v[180:183], v[100:103], a[236:239], v[180:183]
    v_mfma_f32_16x16x32_bf16 v[184:187], v[84:87], a[252:255], v[184:187]
    v_mfma_f32_16x16x32_bf16 v[188:191], v[100:103], a[252:255], v[188:191]
    s_nop 0
    v_cvt_pk_bf16_f32 v104, v160, v161
    v_cvt_pk_bf16_f32 v105, v162, v163
    v_cvt_pk_bf16_f32 v106, v164, v165
    v_cvt_pk_bf16_f32 v107, v166, v167
    v_cvt_pk_bf16_f32 v108, v168, v169
    v_cvt_pk_bf16_f32 v109, v170, v171
    v_cvt_pk_bf16_f32 v110, v172, v173
    v_cvt_pk_bf16_f32 v111, v174, v175
    v_cvt_pk_bf16_f32 v112, v176, v177
    v_cvt_pk_bf16_f32 v113, v178, v179
    v_cvt_pk_bf16_f32 v114, v180, v181
    v_cvt_pk_bf16_f32 v115, v182, v183
    v_cvt_pk_bf16_f32 v116, v184, v185
    v_cvt_pk_bf16_f32 v117, v186, v187
    v_cvt_pk_bf16_f32 v118, v188, v189
    v_cvt_pk_bf16_f32 v119, v190, v191
    s_cmp_lg_u32 s28, 2
    s_cbranch_scc1 nt_96
nt_96:
    v_mov_b32 v136, 0
    v_mov_b32 v137, 0
    v_mov_b32 v138, 0
    v_mov_b32 v139, 0
    v_mov_b32 v140, 0
    v_mov_b32 v141, 0
    v_mov_b32 v142, 0
    v_mov_b32 v143, 0
    v_mov_b32 v144, 0
    v_mov_b32 v145, 0
    v_mov_b32 v146, 0
    v_mov_b32 v147, 0
    v_mov_b32 v148, 0
    v_mov_b32 v149, 0
    v_mov_b32 v150, 0
    v_mov_b32 v151, 0
    v_mov_b32 v152, 0
    v_mov_b32 v153, 0
    v_mov_b32 v154, 0
    v_mov_b32 v155, 0
    v_mov_b32 v156, 0
    v_mov_b32 v157, 0
    v_mov_b32 v158, 0
    v_mov_b32 v159, 0
    s_cmp_lg_u32 s28, 3
    s_cbranch_scc1 noA_97
    buffer_load_dwordx4 v[176:179], v20, s[8:11], s30 offen offset:0 sc1
    buffer_load_dwordx4 v[180:183], v20, s[8:11], s30 offen offset:1024 sc1
    buffer_load_dwordx4 v[184:187], v20, s[8:11], s30 offen offset:2048 sc1
    buffer_load_dwordx4 v[188:191], v20, s[8:11], s30 offen offset:3072 sc1
pw_98:
    s_waitcnt vmcnt(0)
    v_mfma_f32_16x16x32_bf16 v[160:163], v[36:39], v[176:179], 0
    v_max3_u32 v244, v176, v177, v178
    v_max3_u32 v245, v179, v180, v181
    v_max3_u32 v246, v182, v183, v184
    v_mfma_f32_16x16x32_bf16 v[160:163], v[36:39], v[180:183], v[160:163]
    v_max3_u32 v247, v185, v186, v187
    v_max3_u32 v248, v188, v189, v190
    v_max3_u32 v244, v244, v245, v246
    v_mfma_f32_16x16x32_bf16 v[160:163], v[240:243], v[184:187], v[160:163]
    v_max3_u32 v247, v247, v248, v191
    v_max_u32 v244, v244, v247
    v_cmp_eq_u32 vcc, -1, v244
    v_mfma_f32_16x16x32_bf16 v[160:163], v[240:243], v[188:191], v[160:163]
    s_cbranch_vccnz rt_99
    s_nop 6
    v_cvt_pk_bf16_f32 v244, v160, v161
    v_cvt_pk_bf16_f32 v245, v162, v163
    v_min_u32 v244, -2, v244
    v_min_u32 v245, -2, v245
    buffer_store_dwordx2 v[244:245], v21, s[8:11], s31 offen sc1
    buffer_store_dwordx2 v[16:17], v21, s[8:11], s33 offen sc1
noA_97:
    s_barrier
    s_sleep 3
    buffer_load_dwordx4 v[120:123], v22, s[8:11], s31 offen offset:0 sc1
    buffer_load_dwordx4 v[124:127], v22, s[8:11], s31 offen offset:1024 sc1
    buffer_load_dwordx4 v[128:131], v22, s[8:11], s31 offen offset:2048 sc1
    buffer_load_dwordx4 v[132:135], v22, s[8:11], s31 offen offset:3072 sc1
pw_100:
    s_waitcnt vmcnt(0)
    v_smfmac_f32_16x16x64_bf16 v[136:139], v[120:123], a[0:7], v1
    v_max3_u32 v244, v120, v121, v122
    v_max3_u32 v245, v123, v124, v125
    v_max3_u32 v246, v126, v127, v128
    v_smfmac_f32_16x16x64_bf16 v[140:143], v[120:123], a[32:39], v1
    v_max3_u32 v247, v129, v130, v131
    v_max3_u32 v248, v132, v133, v134
    v_max3_u32 v244, v244, v245, v246
    v_smfmac_f32_16x16x64_bf16 v[136:139], v[124:127], a[8:15], v1
    v_max3_u32 v247, v247, v248, v135
    v_max_u32 v244, v244, v247
    v_cmp_eq_u32 vcc, -1, v244
    v_smfmac_f32_16x16x64_bf16 v[140:143], v[124:127], a[40:47], v1
    s_cbranch_vccnz rt_101
    v_smfmac_f32_16x16x64_bf16 v[136:139], v[128:131], a[16:23], v1
    v_smfmac_f32_16x16x64_bf16 v[140:143], v[128:131], a[48:55], v1
    v_smfmac_f32_16x16x64_bf16 v[136:139], v[132:135], a[24:31], v1
    v_smfmac_f32_16x16x64_bf16 v[140:143], v[132:135], a[56:63], v1
    v_smfmac_f32_16x16x64_bf16 v[144:147], v[120:123], a[64:71], v1
    v_smfmac_f32_16x16x64_bf16 v[148:151], v[120:123], a[96:103], v1
    v_smfmac_f32_16x16x64_bf16 v[144:147], v[124:127], a[72:79], v1
    v_smfmac_f32_16x16x64_bf16 v[148:151], v[124:127], a[104:111], v1
    s_nop 3
    v_permlane32_swap_b32 v136, v140
    v_smfmac_f32_16x16x64_bf16 v[144:147], v[128:131], a[80:87], v1
    v_permlane32_swap_b32 v137, v141
    v_smfmac_f32_16x16x64_bf16 v[148:151], v[128:131], a[112:119], v1
    v_permlane32_swap_b32 v138, v142
    v_smfmac_f32_16x16x64_bf16 v[144:147], v[132:135], a[88:95], v1
    v_permlane32_swap_b32 v139, v143
    v_smfmac_f32_16x16x64_bf16 v[148:151], v[132:135], a[120:127], v1
    v_pk_add_f32 v[136:137], v[136:137], v[140:141]
    v_smfmac_f32_16x16x64_bf16 v[152:155], v[120:123], a[128:135], v1
    v_pk_add_f32 v[138:139], v[138:139], v[142:143]
    v_smfmac_f32_16x16x64_bf16 v[156:159], v[120:123], a[160:167], v1
    ds_write_b128 v30, v[136:139]
    v_smfmac_f32_16x16x64_bf16 v[152:155], v[124:127], a[136:143], v1
    v_smfmac_f32_16x16x64_bf16 v[156:159], v[124:127], a[168:175], v1
    s_nop 0
    v_permlane32_swap_b32 v144, v148
    v_permlane32_swap_b32 v145, v149
    v_smfmac_f32_16x16x64_bf16 v[152:155], v[128:131], a[144:151], v1
    v_permlane32_swap_b32 v146, v150
    v_smfmac_f32_16x16x64_bf16 v[156:159], v[128:131], a[176:183], v1
    v_permlane32_swap_b32 v147, v151
    v_pk_add_f32 v[144:145], v[144:145], v[148:149]
    v_smfmac_f32_16x16x64_bf16 v[152:155], v[132:135], a[152:159], v1
    v_pk_add_f32 v[146:147], v[146:147], v[150:151]
    v_smfmac_f32_16x16x64_bf16 v[156:159], v[132:135], a[184:191], v1
    ds_write_b128 v30, v[144:147] offset:4096
    s_nop 6
    v_permlane32_swap_b32 v152, v156
    v_permlane32_swap_b32 v153, v157
    v_permlane32_swap_b32 v154, v158
    v_permlane32_swap_b32 v155, v159
    v_pk_add_f32 v[152:153], v[152:153], v[156:157]
    v_pk_add_f32 v[154:155], v[154:155], v[158:159]
    ds_write_b128 v30, v[152:155] offset:8192
    s_waitcnt lgkmcnt(0)
    s_barrier
    s_cmp_eq_u32 s28, 3
    s_cbranch_scc1 be_104
    ds_read_b128 v[160:163], v35 offset:0
    ds_read_b128 v[164:167], v35 offset:1024
    ds_read_b128 v[168:171], v35 offset:2048
    ds_read_b128 v[172:175], v35 offset:3072
    s_cmp_eq_u32 s28, 1
    s_cbranch_scc1 b1_102
    s_cmp_eq_u32 s28, 2
    s_cbranch_scc1 b2_103
    s_waitcnt lgkmcnt(2)
    v_pk_add_f32 v[160:161], v[160:161], v[164:165]
    v_pk_add_f32 v[162:163], v[162:163], v[166:167]
    s_waitcnt lgkmcnt(0)
    v_pk_add_f32 v[168:169], v[168:169], v[172:173]
    v_pk_add_f32 v[170:171], v[170:171], v[174:175]
    v_pk_add_f32 v[160:161], v[160:161], v[168:169]
    v_pk_add_f32 v[162:163], v[162:163], v[170:171]
    v_cvt_pk_bf16_f32 v244, v160, v161
    v_cvt_pk_bf16_f32 v245, v162, v163
    s_nop 1
    v_mfma_f32_16x16x16_bf16 v[164:167], v[244:245], v[2:3], 0
    v_mfma_f32_16x16x16_bf16 v[168:171], v[244:245], v[4:5], 0
    s_nop 6
    v_cvt_pk_bf16_f32 v172, v164, v165
    v_cvt_pk_bf16_f32 v173, v166, v167
    v_cvt_pk_bf16_f32 v174, v168, v169
    v_cvt_pk_bf16_f32 v175, v170, v171
    s_nop 1
    v_mfma_f32_16x16x32_bf16 v[160:163], v[40:43], v[172:175], 0
    v_mfma_f32_16x16x32_bf16 v[164:167], v[44:47], v[172:175], 0
    s_nop 7
    v_mov_b32_dpp v160, v164 quad_perm:[0,1,2,3] row_mask:0xf bank_mask:0xc
    v_mov_b32_dpp v161, v165 quad_perm:[0,1,2,3] row_mask:0xf bank_mask:0xc
    v_mov_b32_dpp v162, v166 quad_perm:[0,1,2,3] row_mask:0xf bank_mask:0xc
    v_mov_b32_dpp v163, v167 quad_perm:[0,1,2,3] row_mask:0xf bank_mask:0xc
    v_min_u32 v160, -2, v160
    v_min_u32 v161, -2, v161
    v_min_u32 v162, -2, v162
    v_min_u32 v163, -2, v163
    buffer_store_dwordx4 v[160:163], v23, s[8:11], s31 offen sc1
    s_branch be_104
b1_102:
    ds_read_b128 v[48:51], v31 offset:0
    ds_read_b128 v[52:55], v31 offset:1024
    ds_read_b128 v[56:59], v31 offset:2048
    ds_read_b128 v[60:63], v31 offset:3072
    s_waitcnt lgkmcnt(6)
    v_pk_add_f32 v[160:161], v[160:161], v[164:165]
    v_pk_add_f32 v[162:163], v[162:163], v[166:167]
    s_waitcnt lgkmcnt(4)
    v_pk_add_f32 v[168:169], v[168:169], v[172:173]
    v_pk_add_f32 v[170:171], v[170:171], v[174:175]
    v_pk_add_f32 v[160:161], v[160:161], v[168:169]
    v_pk_add_f32 v[162:163], v[162:163], v[170:171]
    v_cvt_pk_bf16_f32 v246, v160, v161
    v_cvt_pk_bf16_f32 v247, v162, v163
    s_waitcnt lgkmcnt(2)
    s_nop 0
    v_mfma_f32_16x16x16_bf16 v[164:167], v[246:247], v[68:69], 0
    v_pk_add_f32 v[48:49], v[48:49], v[52:53]
    v_pk_add_f32 v[50:51], v[50:51], v[54:55]
    v_mfma_f32_16x16x16_bf16 v[168:171], v[246:247], v[70:71], 0
    s_waitcnt lgkmcnt(0)
    v_pk_add_f32 v[56:57], v[56:57], v[60:61]
    v_pk_add_f32 v[58:59], v[58:59], v[62:63]
    v_pk_add_f32 v[48:49], v[48:49], v[56:57]
    v_pk_add_f32 v[50:51], v[50:51], v[58:59]
    v_cvt_pk_bf16_f32 v244, v48, v49
    v_cvt_pk_bf16_f32 v245, v50, v51
    s_nop 1
    v_mfma_f32_16x16x16_bf16 v[52:55], v[244:245], v[2:3], 0
    v_mfma_f32_16x16x16_bf16 v[56:59], v[244:245], v[4:5], 0
    v_cvt_pk_bf16_f32 v172, v164, v165
    v_cvt_pk_bf16_f32 v173, v166, v167
    v_cvt_pk_bf16_f32 v174, v168, v169
    v_cvt_pk_bf16_f32 v175, v170, v171
    s_nop 2
    v_cvt_pk_bf16_f32 v60, v52, v53
    v_cvt_pk_bf16_f32 v61, v54, v55
    v_cvt_pk_bf16_f32 v62, v56, v57
    v_cvt_pk_bf16_f32 v63, v58, v59
    s_nop 1
    v_mfma_f32_16x16x32_bf16 v[48:51], v[172:175], v[60:63], 0
    v_min_u32 v236, -2, v172
    v_min_u32 v237, -2, v173
    v_min_u32 v238, -2, v174
    v_min_u32 v239, -2, v175
    s_nop 3
    v_mov_b32_dpp v48, v49 quad_perm:[0,1,2,3] row_mask:0xf bank_mask:0xc
    v_min_u32 v48, -2, v48
    buffer_store_dword v48, v23, s[8:11], s31 offen sc1
    s_branch be_104
b2_103:
    s_waitcnt lgkmcnt(2)
    v_pk_add_f32 v[160:161], v[160:161], v[164:165]
    v_pk_add_f32 v[162:163], v[162:163], v[166:167]
    s_waitcnt lgkmcnt(0)
    v_pk_add_f32 v[168:169], v[168:169], v[172:173]
    v_pk_add_f32 v[170:171], v[170:171], v[174:175]
    v_pk_add_f32 v[160:161], v[160:161], v[168:169]
    v_pk_add_f32 v[162:163], v[162:163], v[170:171]
    v_cvt_pk_bf16_f32 v244, v160, v161
    v_cvt_pk_bf16_f32 v245, v162, v163
    s_nop 1
    v_mfma_f32_16x16x16_bf16 v[164:167], v[244:245], v[2:3], 0
    v_mfma_f32_16x16x16_bf16 v[168:171], v[244:245], v[4:5], 0
    s_nop 6
    v_cvt_pk_bf16_f32 v236, v164, v165
    v_cvt_pk_bf16_f32 v237, v166, v167
    v_cvt_pk_bf16_f32 v238, v168, v169
    v_cvt_pk_bf16_f32 v239, v170, v171
    v_min_u32 v236, -2, v236
    v_min_u32 v237, -2, v237
    v_min_u32 v238, -2, v238
    v_min_u32 v239, -2, v239
    buffer_store_dwordx4 v[236:239], v23, s[8:11], s31 offen sc1
be_104:
    s_barrier
    s_sleep 2
xv_105:
    buffer_load_dwordx4 v[176:179], v25, s[8:11], s31 offen offset:0 sc1
    buffer_load_dwordx4 v[180:183], v25, s[8:11], s31 offen offset:1024 sc1
    buffer_load_dwordx4 v[48:51], v24, s[8:11], s31 offen offset:0 sc1
    buffer_load_dwordx4 v[52:55], v24, s[8:11], s31 offen offset:1024 sc1
    buffer_load_dwordx4 v[56:59], v24, s[8:11], s31 offen offset:2048 sc1
    buffer_load_dwordx4 v[60:63], v24, s[8:11], s31 offen offset:3072 sc1
    buffer_load_dwordx4 v[64:67], v14, s[8:11], s31 offen sc1
    s_waitcnt vmcnt(5)
    v_mfma_f32_16x16x32_bf16 v[204:207], v[176:179], a[196:199], 0
    v_max3_u32 v244, v176, v177, v178
    v_max3_u32 v245, v179, v180, v181
    v_max_u32 v246, v182, v183
    v_mfma_f32_16x16x32_bf16 v[208:211], v[176:179], a[212:215], 0
    v_max3_u32 v244, v244, v245, v246
    v_cmp_eq_u32 vcc, -1, v244
    v_mfma_f32_16x16x32_bf16 v[212:215], v[176:179], a[228:231], 0
    v_mov_b32_dpp v184, v176 row_ror:8 row_mask:0xf bank_mask:0xf
    v_mov_b32_dpp v185, v177 row_ror:8 row_mask:0xf bank_mask:0xf
    v_mfma_f32_16x16x32_bf16 v[216:219], v[176:179], a[244:247], 0
    s_cbranch_vccnz rt_107
    v_mov_b32_dpp v186, v178 row_ror:8 row_mask:0xf bank_mask:0xf
    v_mov_b32_dpp v187, v179 row_ror:8 row_mask:0xf bank_mask:0xf
    v_mfma_f32_16x16x32_bf16 v[204:207], v[180:183], a[204:207], v[204:207]
    v_mov_b32_dpp v188, v180 row_ror:8 row_mask:0xf bank_mask:0xf
    v_mfma_f32_16x16x32_bf16 v[208:211], v[180:183], a[220:223], v[208:211]
    v_mov_b32_dpp v189, v181 row_ror:8 row_mask:0xf bank_mask:0xf
    v_mfma_f32_16x16x32_bf16 v[212:215], v[180:183], a[236:239], v[212:215]
    v_mov_b32_dpp v190, v182 row_ror:8 row_mask:0xf bank_mask:0xf
    v_mfma_f32_16x16x32_bf16 v[216:219], v[180:183], a[252:255], v[216:219]
    v_mov_b32_dpp v191, v183 row_ror:8 row_mask:0xf bank_mask:0xf
pw_108:
    s_waitcnt vmcnt(0)
    v_max3_u32 v244, v48, v49, v50
    v_max3_u32 v245, v51, v52, v53
    v_max3_u32 v246, v54, v55, v56
    v_max3_u32 v247, v57, v58, v59
    v_max3_u32 v248, v60, v61, v62
    v_max3_u32 v249, v63, v64, v65
    v_max_u32 v250, v66, v67
    v_max3_u32 v244, v244, v245, v246
    v_pk_add_f32 v[48:49], v[48:49], v[52:53]
    v_max3_u32 v247, v247, v248, v249
    v_pk_add_f32 v[50:51], v[50:51], v[54:55]
    v_max3_u32 v244, v244, v247, v250
    v_pk_add_f32 v[56:57], v[56:57], v[60:61]
    v_cmp_eq_u32 vcc, -1, v244
    v_pk_add_f32 v[58:59], v[58:59], v[62:63]
    v_pk_add_f32 v[64:65], v[64:65], v[66:67]
    s_cbranch_vccnz rt_109
    buffer_load_dwordx4 v[72:75], v27, s[12:15], s44 offen offset:0
    v_pk_add_f32 v[192:193], v[48:49], v[56:57]
    v_mfma_f32_16x16x32_bf16 v[204:207], v[184:187], a[192:195], v[204:207]
    buffer_load_dwordx4 v[88:91], v27, s[12:15], s45 offen offset:0
    v_pk_add_f32 v[194:195], v[50:51], v[58:59]
    v_add_f32 v196, v64, v65
    v_mfma_f32_16x16x32_bf16 v[208:211], v[184:187], a[208:211], v[208:211]
    buffer_load_dwordx4 v[76:79], v27, s[12:15], s44 offen offset:1024
    v_max3_f32 v244, v192, v193, v194
    v_max3_f32 v244, v244, v195, v196
    buffer_load_dwordx4 v[92:95], v27, s[12:15], s45 offen offset:1024
    v_mfma_f32_16x16x32_bf16 v[212:215], v[184:187], a[224:227], v[212:215]
    v_max_f32_dpp v244, v244, v244 row_ror:8 row_mask:0xf bank_mask:0xf
    v_mov_b32 v245, v244
    buffer_load_dwordx4 v[80:83], v27, s[12:15], s44 offen offset:2048
    v_mfma_f32_16x16x32_bf16 v[216:219], v[184:187], a[240:243], v[216:219]
    v_permlane32_swap_b32 v244, v245
    buffer_load_dwordx4 v[96:99], v27, s[12:15], s45 offen offset:2048
    v_max_f32 v244, v244, v245
    v_mfma_f32_16x16x32_bf16 v[204:207], v[188:191], a[200:203], v[204:207]
    v_mov_b32 v245, v244
    buffer_load_dwordx4 v[84:87], v27, s[12:15], s44 offen offset:3072
    s_nop 0
    v_permlane16_swap_b32 v244, v245
    v_mfma_f32_16x16x32_bf16 v[208:211], v[188:191], a[216:219], v[208:211]
    buffer_load_dwordx4 v[100:103], v27, s[12:15], s45 offen offset:3072
    v_max_f32 v244, v244, v245
    v_mul_f32 v244, s49, v244
    v_mfma_f32_16x16x32_bf16 v[212:215], v[188:191], a[232:235], v[212:215]
    buffer_load_dwordx4 v[40:43], v13, s[12:15], s42 offen
    v_fma_f32 v192, v192, s49, -v244
    v_fma_f32 v193, v193, s49, -v244
    buffer_load_dwordx4 v[44:47], v13, s[12:15], s43 offen
    v_mfma_f32_16x16x32_bf16 v[216:219], v[188:191], a[248:251], v[216:219]
    v_fma_f32 v194, v194, s49, -v244
    v_fma_f32 v195, v195, s49, -v244
    v_fma_f32 v196, v196, s49, -v244
    v_exp_f32 v192, v192
    v_exp_f32 v193, v193
    v_exp_f32 v194, v194
    v_exp_f32 v195, v195
    v_exp_f32 v196, v196
    v_cvt_pk_bf16_f32 v228, v192, v193
    v_cvt_pk_bf16_f32 v229, v194, v195
    v_mov_b32_dpp v246, v196 row_ror:8 row_mask:0xf bank_mask:0xf
    v_mov_b32_dpp v230, v228 row_ror:8 row_mask:0xf bank_mask:0xf
    v_mov_b32_dpp v231, v229 row_ror:8 row_mask:0xf bank_mask:0xf
    v_cvt_pk_bf16_f32 v232, v196, v246
    s_nop 0
    v_mfma_f32_16x16x32_bf16 v[152:155], v[8:11], v[228:231], 0
    v_mov_b32 v233, v232
    v_cvt_pk_bf16_f32 v220, v204, v205
    v_cvt_pk_bf16_f32 v221, v206, v207
    v_mfma_f32_16x16x32_bf16 v[136:139], v[104:107], v[228:231], 0
    v_permlane32_swap_b32 v232, v233
    v_cvt_pk_bf16_f32 v222, v208, v209
    v_cvt_pk_bf16_f32 v223, v210, v211
    v_mfma_f32_16x16x32_bf16 v[140:143], v[108:111], v[228:231], 0
    v_and_b32 v232, v232, v12
    v_and_b32 v233, v233, v12
    v_cvt_pk_bf16_f32 v224, v212, v213
    v_mfma_f32_16x16x32_bf16 v[144:147], v[112:115], v[228:231], 0
    v_cvt_pk_bf16_f32 v225, v214, v215
    v_cvt_pk_bf16_f32 v226, v216, v217
    v_cvt_pk_bf16_f32 v227, v218, v219
    v_mfma_f32_16x16x32_bf16 v[148:151], v[116:119], v[228:231], 0
    v_mfma_f32_16x16x16_bf16 v[152:155], v[8:9], v[232:233], v[152:155]
    v_mfma_f32_16x16x16_bf16 v[136:139], v[220:221], v[232:233], v[136:139]
    v_mfma_f32_16x16x16_bf16 v[140:143], v[222:223], v[232:233], v[140:143]
    v_mfma_f32_16x16x16_bf16 v[144:147], v[224:225], v[232:233], v[144:147]
    s_nop 1
    v_mfma_f32_16x16x16_bf16 v[148:151], v[226:227], v[232:233], v[148:151]
    s_nop 1
    v_rcp_f32 v244, v152
    s_nop 0
    v_pk_mul_f32 v[136:137], v[136:137], v[244:245] op_sel_hi:[1,0]
    v_pk_mul_f32 v[138:139], v[138:139], v[244:245] op_sel_hi:[1,0]
    v_pk_mul_f32 v[144:145], v[144:145], v[244:245] op_sel_hi:[1,0]
    v_pk_mul_f32 v[146:147], v[146:147], v[244:245] op_sel_hi:[1,0]
    v_mul_f32_dpp v136, v140, v244 row_shr:8 row_mask:0xf bank_mask:0xc
    v_mul_f32_dpp v137, v141, v244 row_shr:8 row_mask:0xf bank_mask:0xc
    v_mul_f32_dpp v138, v142, v244 row_shr:8 row_mask:0xf bank_mask:0xc
    v_mul_f32_dpp v139, v143, v244 row_shr:8 row_mask:0xf bank_mask:0xc
    ds_write_b128 v32, v[136:139] offset:0
    v_mul_f32_dpp v144, v148, v244 row_shr:8 row_mask:0xf bank_mask:0xc
    v_mul_f32_dpp v145, v149, v244 row_shr:8 row_mask:0xf bank_mask:0xc
    v_mul_f32_dpp v146, v150, v244 row_shr:8 row_mask:0xf bank_mask:0xc
    v_mul_f32_dpp v147, v151, v244 row_shr:8 row_mask:0xf bank_mask:0xc
    ds_write_b128 v32, v[144:147] offset:1024
    s_waitcnt lgkmcnt(0)
    s_barrier
    s_cmp_ge_u32 s28, 2
    s_cbranch_scc1 c1_110
    ds_read_b128 v[160:163], v33 offset:0
    ds_read_b128 v[164:167], v33 offset:2048
    ds_read_b128 v[168:171], v33 offset:4096
    ds_read_b128 v[172:175], v33 offset:6144
    s_waitcnt lgkmcnt(2)
    v_pk_add_f32 v[160:161], v[160:161], v[164:165]
    v_pk_add_f32 v[162:163], v[162:163], v[166:167]
    s_waitcnt lgkmcnt(0)
    v_pk_add_f32 v[168:169], v[168:169], v[172:173]
    v_pk_add_f32 v[170:171], v[170:171], v[174:175]
    v_pk_add_f32 v[160:161], v[160:161], v[168:169]
    v_pk_add_f32 v[162:163], v[162:163], v[170:171]
    v_cvt_pk_bf16_f32 v164, v160, v161
    v_cvt_pk_bf16_f32 v165, v162, v163
    v_min_u32 v164, -2, v164
    v_min_u32 v165, -2, v165
    v_mov_b32 v166, v164
    v_mov_b32 v167, v165
    s_nop 0
    v_permlane16_swap_b32 v164, v166
    v_permlane16_swap_b32 v165, v167
c1_110:
    buffer_store_dwordx4 v[164:167], v26, s[8:11], s31 offen sc1
    s_add_u32 s29, s29, 1
    buffer_store_dwordx4 v[16:19], v26, s[8:11], s33 offen sc1
    s_cmp_eq_u32 s28, 1
    s_cbranch_scc1 r1_111
    buffer_store_dwordx4 v[16:19], v23, s[8:11], s33 offen sc1
    s_branch r2_112
r1_111:
    buffer_store_dword v16, v23, s[8:11], s33 offen sc1
r2_112:
    buffer_store_dwordx4 v[236:239], v28, s[16:19], s47 offen sc1
    s_add_u32 s54, s29, 2
    s_min_u32 s54, s54, 63
    s_lshl_b32 s54, s54, 16
    buffer_store_dwordx4 v[16:19], v28, s[16:19], s54 offen sc1
    s_lshl_b32 s42, s29, 18
    s_add_u32 s44, s42, 0x1040000
    s_add_u32 s46, s42, 0x80000
    s_add_u32 s42, s42, 0x40000
    s_add_u32 s43, s42, 0x20000
    s_add_u32 s45, s44, 0x20000
    s_lshl_b32 s47, s29, 16
    s_waitcnt vmcnt(7)
    v_mfma_f32_16x16x32_bf16 v[160:163], v[72:75], a[192:195], 0
    v_mfma_f32_16x16x32_bf16 v[164:167], v[88:91], a[192:195], 0
    v_mfma_f32_16x16x32_bf16 v[168:171], v[72:75], a[208:211], 0
    v_mfma_f32_16x16x32_bf16 v[172:175], v[88:91], a[208:211], 0
    v_mfma_f32_16x16x32_bf16 v[176:179], v[72:75], a[224:227], 0
    v_mfma_f32_16x16x32_bf16 v[180:183], v[88:91], a[224:227], 0
    v_mfma_f32_16x16x32_bf16 v[184:187], v[72:75], a[240:243], 0
    v_mfma_f32_16x16x32_bf16 v[188:191], v[88:91], a[240:243], 0
    v_mfma_f32_16x16x32_bf16 v[160:163], v[76:79], a[196:199], v[160:163]
    v_mfma_f32_16x16x32_bf16 v[164:167], v[92:95], a[196:199], v[164:167]
    v_mfma_f32_16x16x32_bf16 v[168:171], v[76:79], a[212:215], v[168:171]
    v_mfma_f32_16x16x32_bf16 v[172:175], v[92:95], a[212:215], v[172:175]
    v_mfma_f32_16x16x32_bf16 v[176:179], v[76:79], a[228:231], v[176:179]
    v_mfma_f32_16x16x32_bf16 v[180:183], v[92:95], a[228:231], v[180:183]
    v_mfma_f32_16x16x32_bf16 v[184:187], v[76:79], a[244:247], v[184:187]
    v_mfma_f32_16x16x32_bf16 v[188:191], v[92:95], a[244:247], v[188:191]
    v_mfma_f32_16x16x32_bf16 v[160:163], v[80:83], a[200:203], v[160:163]
    v_mfma_f32_16x16x32_bf16 v[164:167], v[96:99], a[200:203], v[164:167]
    v_mfma_f32_16x16x32_bf16 v[168:171], v[80:83], a[216:219], v[168:171]
    v_mfma_f32_16x16x32_bf16 v[172:175], v[96:99], a[216:219], v[172:175]
    v_mfma_f32_16x16x32_bf16 v[176:179], v[80:83], a[232:235], v[176:179]
    v_mfma_f32_16x16x32_bf16 v[180:183], v[96:99], a[232:235], v[180:183]
    v_mfma_f32_16x16x32_bf16 v[184:187], v[80:83], a[248:251], v[184:187]
    v_mfma_f32_16x16x32_bf16 v[188:191], v[96:99], a[248:251], v[188:191]
    v_mfma_f32_16x16x32_bf16 v[160:163], v[84:87], a[204:207], v[160:163]
    v_mfma_f32_16x16x32_bf16 v[164:167], v[100:103], a[204:207], v[164:167]
    v_mfma_f32_16x16x32_bf16 v[168:171], v[84:87], a[220:223], v[168:171]
    v_mfma_f32_16x16x32_bf16 v[172:175], v[100:103], a[220:223], v[172:175]
    v_mfma_f32_16x16x32_bf16 v[176:179], v[84:87], a[236:239], v[176:179]
    v_mfma_f32_16x16x32_bf16 v[180:183], v[100:103], a[236:239], v[180:183]
    v_mfma_f32_16x16x32_bf16 v[184:187], v[84:87], a[252:255], v[184:187]
    v_mfma_f32_16x16x32_bf16 v[188:191], v[100:103], a[252:255], v[188:191]
    s_nop 0
    v_cvt_pk_bf16_f32 v104, v160, v161
    v_cvt_pk_bf16_f32 v105, v162, v163
    v_cvt_pk_bf16_f32 v106, v164, v165
    v_cvt_pk_bf16_f32 v107, v166, v167
    v_cvt_pk_bf16_f32 v108, v168, v169
    v_cvt_pk_bf16_f32 v109, v170, v171
    v_cvt_pk_bf16_f32 v110, v172, v173
    v_cvt_pk_bf16_f32 v111, v174, v175
    v_cvt_pk_bf16_f32 v112, v176, v177
    v_cvt_pk_bf16_f32 v113, v178, v179
    v_cvt_pk_bf16_f32 v114, v180, v181
    v_cvt_pk_bf16_f32 v115, v182, v183
    v_cvt_pk_bf16_f32 v116, v184, v185
    v_cvt_pk_bf16_f32 v117, v186, v187
    v_cvt_pk_bf16_f32 v118, v188, v189
    v_cvt_pk_bf16_f32 v119, v190, v191
    s_cmp_lg_u32 s28, 2
    s_cbranch_scc1 nt_113
nt_113:
    v_mov_b32 v136, 0
    v_mov_b32 v137, 0
    v_mov_b32 v138, 0
    v_mov_b32 v139, 0
    v_mov_b32 v140, 0
    v_mov_b32 v141, 0
    v_mov_b32 v142, 0
    v_mov_b32 v143, 0
    v_mov_b32 v144, 0
    v_mov_b32 v145, 0
    v_mov_b32 v146, 0
    v_mov_b32 v147, 0
    v_mov_b32 v148, 0
    v_mov_b32 v149, 0
    v_mov_b32 v150, 0
    v_mov_b32 v151, 0
    v_mov_b32 v152, 0
    v_mov_b32 v153, 0
    v_mov_b32 v154, 0
    v_mov_b32 v155, 0
    v_mov_b32 v156, 0
    v_mov_b32 v157, 0
    v_mov_b32 v158, 0
    v_mov_b32 v159, 0
    s_cmp_lg_u32 s28, 3
    s_cbranch_scc1 noA_114
    buffer_load_dwordx4 v[176:179], v20, s[8:11], s31 offen offset:0 sc1
    buffer_load_dwordx4 v[180:183], v20, s[8:11], s31 offen offset:1024 sc1
    buffer_load_dwordx4 v[184:187], v20, s[8:11], s31 offen offset:2048 sc1
    buffer_load_dwordx4 v[188:191], v20, s[8:11], s31 offen offset:3072 sc1
pw_115:
    s_waitcnt vmcnt(0)
    v_mfma_f32_16x16x32_bf16 v[160:163], v[36:39], v[176:179], 0
    v_max3_u32 v244, v176, v177, v178
    v_max3_u32 v245, v179, v180, v181
    v_max3_u32 v246, v182, v183, v184
    v_mfma_f32_16x16x32_bf16 v[160:163], v[36:39], v[180:183], v[160:163]
    v_max3_u32 v247, v185, v186, v187
    v_max3_u32 v248, v188, v189, v190
    v_max3_u32 v244, v244, v245, v246
    v_mfma_f32_16x16x32_bf16 v[160:163], v[240:243], v[184:187], v[160:163]
    v_max3_u32 v247, v247, v248, v191
    v_max_u32 v244, v244, v247
    v_cmp_eq_u32 vcc, -1, v244
    v_mfma_f32_16x16x32_bf16 v[160:163], v[240:243], v[188:191], v[160:163]
    s_cbranch_vccnz rt_116
    s_nop 6
    v_cvt_pk_bf16_f32 v244, v160, v161
    v_cvt_pk_bf16_f32 v245, v162, v163
    v_min_u32 v244, -2, v244
    v_min_u32 v245, -2, v245
    buffer_store_dwordx2 v[244:245], v21, s[8:11], s32 offen sc1
    buffer_store_dwordx2 v[16:17], v21, s[8:11], s30 offen sc1
noA_114:
    s_barrier
    s_sleep 3
    buffer_load_dwordx4 v[120:123], v22, s[8:11], s32 offen offset:0 sc1
    buffer_load_dwordx4 v[124:127], v22, s[8:11], s32 offen offset:1024 sc1
    buffer_load_dwordx4 v[128:131], v22, s[8:11], s32 offen offset:2048 sc1
    buffer_load_dwordx4 v[132:135], v22, s[8:11], s32 offen offset:3072 sc1
pw_117:
    s_waitcnt vmcnt(0)
    v_smfmac_f32_16x16x64_bf16 v[136:139], v[120:123], a[0:7], v1
    v_max3_u32 v244, v120, v121, v122
    v_max3_u32 v245, v123, v124, v125
    v_max3_u32 v246, v126, v127, v128
    v_smfmac_f32_16x16x64_bf16 v[140:143], v[120:123], a[32:39], v1
    v_max3_u32 v247, v129, v130, v131
    v_max3_u32 v248, v132, v133, v134
    v_max3_u32 v244, v244, v245, v246
    v_smfmac_f32_16x16x64_bf16 v[136:139], v[124:127], a[8:15], v1
    v_max3_u32 v247, v247, v248, v135
    v_max_u32 v244, v244, v247
    v_cmp_eq_u32 vcc, -1, v244
    v_smfmac_f32_16x16x64_bf16 v[140:143], v[124:127], a[40:47], v1
    s_cbranch_vccnz rt_118
    v_smfmac_f32_16x16x64_bf16 v[136:139], v[128:131], a[16:23], v1
    v_smfmac_f32_16x16x64_bf16 v[140:143], v[128:131], a[48:55], v1
    v_smfmac_f32_16x16x64_bf16 v[136:139], v[132:135], a[24:31], v1
    v_smfmac_f32_16x16x64_bf16 v[140:143], v[132:135], a[56:63], v1
    v_smfmac_f32_16x16x64_bf16 v[144:147], v[120:123], a[64:71], v1
    v_smfmac_f32_16x16x64_bf16 v[148:151], v[120:123], a[96:103], v1
    v_smfmac_f32_16x16x64_bf16 v[144:147], v[124:127], a[72:79], v1
    v_smfmac_f32_16x16x64_bf16 v[148:151], v[124:127], a[104:111], v1
    s_nop 3
    v_permlane32_swap_b32 v136, v140
    v_smfmac_f32_16x16x64_bf16 v[144:147], v[128:131], a[80:87], v1
    v_permlane32_swap_b32 v137, v141
    v_smfmac_f32_16x16x64_bf16 v[148:151], v[128:131], a[112:119], v1
    v_permlane32_swap_b32 v138, v142
    v_smfmac_f32_16x16x64_bf16 v[144:147], v[132:135], a[88:95], v1
    v_permlane32_swap_b32 v139, v143
    v_smfmac_f32_16x16x64_bf16 v[148:151], v[132:135], a[120:127], v1
    v_pk_add_f32 v[136:137], v[136:137], v[140:141]
    v_smfmac_f32_16x16x64_bf16 v[152:155], v[120:123], a[128:135], v1
    v_pk_add_f32 v[138:139], v[138:139], v[142:143]
    v_smfmac_f32_16x16x64_bf16 v[156:159], v[120:123], a[160:167], v1
    ds_write_b128 v30, v[136:139]
    v_smfmac_f32_16x16x64_bf16 v[152:155], v[124:127], a[136:143], v1
    v_smfmac_f32_16x16x64_bf16 v[156:159], v[124:127], a[168:175], v1
    s_nop 0
    v_permlane32_swap_b32 v144, v148
    v_permlane32_swap_b32 v145, v149
    v_smfmac_f32_16x16x64_bf16 v[152:155], v[128:131], a[144:151], v1
    v_permlane32_swap_b32 v146, v150
    v_smfmac_f32_16x16x64_bf16 v[156:159], v[128:131], a[176:183], v1
    v_permlane32_swap_b32 v147, v151
    v_pk_add_f32 v[144:145], v[144:145], v[148:149]
    v_smfmac_f32_16x16x64_bf16 v[152:155], v[132:135], a[152:159], v1
    v_pk_add_f32 v[146:147], v[146:147], v[150:151]
    v_smfmac_f32_16x16x64_bf16 v[156:159], v[132:135], a[184:191], v1
    ds_write_b128 v30, v[144:147] offset:4096
    s_nop 6
    v_permlane32_swap_b32 v152, v156
    v_permlane32_swap_b32 v153, v157
    v_permlane32_swap_b32 v154, v158
    v_permlane32_swap_b32 v155, v159
    v_pk_add_f32 v[152:153], v[152:153], v[156:157]
    v_pk_add_f32 v[154:155], v[154:155], v[158:159]
    ds_write_b128 v30, v[152:155] offset:8192
    s_waitcnt lgkmcnt(0)
    s_barrier
    s_cmp_eq_u32 s28, 3
    s_cbranch_scc1 be_121
    ds_read_b128 v[160:163], v35 offset:0
    ds_read_b128 v[164:167], v35 offset:1024
    ds_read_b128 v[168:171], v35 offset:2048
    ds_read_b128 v[172:175], v35 offset:3072
    s_cmp_eq_u32 s28, 1
    s_cbranch_scc1 b1_119
    s_cmp_eq_u32 s28, 2
    s_cbranch_scc1 b2_120
    s_waitcnt lgkmcnt(2)
    v_pk_add_f32 v[160:161], v[160:161], v[164:165]
    v_pk_add_f32 v[162:163], v[162:163], v[166:167]
    s_waitcnt lgkmcnt(0)
    v_pk_add_f32 v[168:169], v[168:169], v[172:173]
    v_pk_add_f32 v[170:171], v[170:171], v[174:175]
    v_pk_add_f32 v[160:161], v[160:161], v[168:169]
    v_pk_add_f32 v[162:163], v[162:163], v[170:171]
    v_cvt_pk_bf16_f32 v244, v160, v161
    v_cvt_pk_bf16_f32 v245, v162, v163
    s_nop 1
    v_mfma_f32_16x16x16_bf16 v[164:167], v[244:245], v[2:3], 0
    v_mfma_f32_16x16x16_bf16 v[168:171], v[244:245], v[4:5], 0
    s_nop 6
    v_cvt_pk_bf16_f32 v172, v164, v165
    v_cvt_pk_bf16_f32 v173, v166, v167
    v_cvt_pk_bf16_f32 v174, v168, v169
    v_cvt_pk_bf16_f32 v175, v170, v171
    s_nop 1
    v_mfma_f32_16x16x32_bf16 v[160:163], v[40:43], v[172:175], 0
    v_mfma_f32_16x16x32_bf16 v[164:167], v[44:47], v[172:175], 0
    s_nop 7
    v_mov_b32_dpp v160, v164 quad_perm:[0,1,2,3] row_mask:0xf bank_mask:0xc
    v_mov_b32_dpp v161, v165 quad_perm:[0,1,2,3] row_mask:0xf bank_mask:0xc
    v_mov_b32_dpp v162, v166 quad_perm:[0,1,2,3] row_mask:0xf bank_mask:0xc
    v_mov_b32_dpp v163, v167 quad_perm:[0,1,2,3] row_mask:0xf bank_mask:0xc
    v_min_u32 v160, -2, v160
    v_min_u32 v161, -2, v161
    v_min_u32 v162, -2, v162
    v_min_u32 v163, -2, v163
    buffer_store_dwordx4 v[160:163], v23, s[8:11], s32 offen sc1
    s_branch be_121
b1_119:
    ds_read_b128 v[48:51], v31 offset:0
    ds_read_b128 v[52:55], v31 offset:1024
    ds_read_b128 v[56:59], v31 offset:2048
    ds_read_b128 v[60:63], v31 offset:3072
    s_waitcnt lgkmcnt(6)
    v_pk_add_f32 v[160:161], v[160:161], v[164:165]
    v_pk_add_f32 v[162:163], v[162:163], v[166:167]
    s_waitcnt lgkmcnt(4)
    v_pk_add_f32 v[168:169], v[168:169], v[172:173]
    v_pk_add_f32 v[170:171], v[170:171], v[174:175]
    v_pk_add_f32 v[160:161], v[160:161], v[168:169]
    v_pk_add_f32 v[162:163], v[162:163], v[170:171]
    v_cvt_pk_bf16_f32 v246, v160, v161
    v_cvt_pk_bf16_f32 v247, v162, v163
    s_waitcnt lgkmcnt(2)
    s_nop 0
    v_mfma_f32_16x16x16_bf16 v[164:167], v[246:247], v[68:69], 0
    v_pk_add_f32 v[48:49], v[48:49], v[52:53]
    v_pk_add_f32 v[50:51], v[50:51], v[54:55]
    v_mfma_f32_16x16x16_bf16 v[168:171], v[246:247], v[70:71], 0
    s_waitcnt lgkmcnt(0)
    v_pk_add_f32 v[56:57], v[56:57], v[60:61]
    v_pk_add_f32 v[58:59], v[58:59], v[62:63]
    v_pk_add_f32 v[48:49], v[48:49], v[56:57]
    v_pk_add_f32 v[50:51], v[50:51], v[58:59]
    v_cvt_pk_bf16_f32 v244, v48, v49
    v_cvt_pk_bf16_f32 v245, v50, v51
    s_nop 1
    v_mfma_f32_16x16x16_bf16 v[52:55], v[244:245], v[2:3], 0
    v_mfma_f32_16x16x16_bf16 v[56:59], v[244:245], v[4:5], 0
    v_cvt_pk_bf16_f32 v172, v164, v165
    v_cvt_pk_bf16_f32 v173, v166, v167
    v_cvt_pk_bf16_f32 v174, v168, v169
    v_cvt_pk_bf16_f32 v175, v170, v171
    s_nop 2
    v_cvt_pk_bf16_f32 v60, v52, v53
    v_cvt_pk_bf16_f32 v61, v54, v55
    v_cvt_pk_bf16_f32 v62, v56, v57
    v_cvt_pk_bf16_f32 v63, v58, v59
    s_nop 1
    v_mfma_f32_16x16x32_bf16 v[48:51], v[172:175], v[60:63], 0
    v_min_u32 v236, -2, v172
    v_min_u32 v237, -2, v173
    v_min_u32 v238, -2, v174
    v_min_u32 v239, -2, v175
    s_nop 3
    v_mov_b32_dpp v48, v49 quad_perm:[0,1,2,3] row_mask:0xf bank_mask:0xc
    v_min_u32 v48, -2, v48
    buffer_store_dword v48, v23, s[8:11], s32 offen sc1
    s_branch be_121
b2_120:
    s_waitcnt lgkmcnt(2)
    v_pk_add_f32 v[160:161], v[160:161], v[164:165]
    v_pk_add_f32 v[162:163], v[162:163], v[166:167]
    s_waitcnt lgkmcnt(0)
    v_pk_add_f32 v[168:169], v[168:169], v[172:173]
    v_pk_add_f32 v[170:171], v[170:171], v[174:175]
    v_pk_add_f32 v[160:161], v[160:161], v[168:169]
    v_pk_add_f32 v[162:163], v[162:163], v[170:171]
    v_cvt_pk_bf16_f32 v244, v160, v161
    v_cvt_pk_bf16_f32 v245, v162, v163
    s_nop 1
    v_mfma_f32_16x16x16_bf16 v[164:167], v[244:245], v[2:3], 0
    v_mfma_f32_16x16x16_bf16 v[168:171], v[244:245], v[4:5], 0
    s_nop 6
    v_cvt_pk_bf16_f32 v236, v164, v165
    v_cvt_pk_bf16_f32 v237, v166, v167
    v_cvt_pk_bf16_f32 v238, v168, v169
    v_cvt_pk_bf16_f32 v239, v170, v171
    v_min_u32 v236, -2, v236
    v_min_u32 v237, -2, v237
    v_min_u32 v238, -2, v238
    v_min_u32 v239, -2, v239
    buffer_store_dwordx4 v[236:239], v23, s[8:11], s32 offen sc1
be_121:
    s_barrier
    s_sleep 2
xv_122:
    buffer_load_dwordx4 v[176:179], v25, s[8:11], s32 offen offset:0 sc1
    buffer_load_dwordx4 v[180:183], v25, s[8:11], s32 offen offset:1024 sc1
    buffer_load_dwordx4 v[48:51], v24, s[8:11], s32 offen offset:0 sc1
    buffer_load_dwordx4 v[52:55], v24, s[8:11], s32 offen offset:1024 sc1
    buffer_load_dwordx4 v[56:59], v24, s[8:11], s32 offen offset:2048 sc1
    buffer_load_dwordx4 v[60:63], v24, s[8:11], s32 offen offset:3072 sc1
    buffer_load_dwordx4 v[64:67], v14, s[8:11], s32 offen sc1
    s_waitcnt vmcnt(5)
    v_mfma_f32_16x16x32_bf16 v[204:207], v[176:179], a[196:199], 0
    v_max3_u32 v244, v176, v177, v178
    v_max3_u32 v245, v179, v180, v181
    v_max_u32 v246, v182, v183
    v_mfma_f32_16x16x32_bf16 v[208:211], v[176:179], a[212:215], 0
    v_max3_u32 v244, v244, v245, v246
    v_cmp_eq_u32 vcc, -1, v244
    v_mfma_f32_16x16x32_bf16 v[212:215], v[176:179], a[228:231], 0
    v_mov_b32_dpp v184, v176 row_ror:8 row_mask:0xf bank_mask:0xf
    v_mov_b32_dpp v185, v177 row_ror:8 row_mask:0xf bank_mask:0xf
    v_mfma_f32_16x16x32_bf16 v[216:219], v[176:179], a[244:247], 0
    s_cbranch_vccnz rt_124
    v_mov_b32_dpp v186, v178 row_ror:8 row_mask:0xf bank_mask:0xf
    v_mov_b32_dpp v187, v179 row_ror:8 row_mask:0xf bank_mask:0xf
    v_mfma_f32_16x16x32_bf16 v[204:207], v[180:183], a[204:207], v[204:207]
    v_mov_b32_dpp v188, v180 row_ror:8 row_mask:0xf bank_mask:0xf
    v_mfma_f32_16x16x32_bf16 v[208:211], v[180:183], a[220:223], v[208:211]
    v_mov_b32_dpp v189, v181 row_ror:8 row_mask:0xf bank_mask:0xf
    v_mfma_f32_16x16x32_bf16 v[212:215], v[180:183], a[236:239], v[212:215]
    v_mov_b32_dpp v190, v182 row_ror:8 row_mask:0xf bank_mask:0xf
    v_mfma_f32_16x16x32_bf16 v[216:219], v[180:183], a[252:255], v[216:219]
    v_mov_b32_dpp v191, v183 row_ror:8 row_mask:0xf bank_mask:0xf
pw_125:
    s_waitcnt vmcnt(0)
    v_max3_u32 v244, v48, v49, v50
    v_max3_u32 v245, v51, v52, v53
    v_max3_u32 v246, v54, v55, v56
    v_max3_u32 v247, v57, v58, v59
    v_max3_u32 v248, v60, v61, v62
    v_max3_u32 v249, v63, v64, v65
    v_max_u32 v250, v66, v67
    v_max3_u32 v244, v244, v245, v246
    v_pk_add_f32 v[48:49], v[48:49], v[52:53]
    v_max3_u32 v247, v247, v248, v249
    v_pk_add_f32 v[50:51], v[50:51], v[54:55]
    v_max3_u32 v244, v244, v247, v250
    v_pk_add_f32 v[56:57], v[56:57], v[60:61]
    v_cmp_eq_u32 vcc, -1, v244
    v_pk_add_f32 v[58:59], v[58:59], v[62:63]
    v_pk_add_f32 v[64:65], v[64:65], v[66:67]
    s_cbranch_vccnz rt_126
    buffer_load_dwordx4 v[72:75], v27, s[12:15], s44 offen offset:0
    v_pk_add_f32 v[192:193], v[48:49], v[56:57]
    v_mfma_f32_16x16x32_bf16 v[204:207], v[184:187], a[192:195], v[204:207]
    buffer_load_dwordx4 v[88:91], v27, s[12:15], s45 offen offset:0
    v_pk_add_f32 v[194:195], v[50:51], v[58:59]
    v_add_f32 v196, v64, v65
    v_mfma_f32_16x16x32_bf16 v[208:211], v[184:187], a[208:211], v[208:211]
    buffer_load_dwordx4 v[76:79], v27, s[12:15], s44 offen offset:1024
    v_max3_f32 v244, v192, v193, v194
    v_max3_f32 v244, v244, v195, v196
    buffer_load_dwordx4 v[92:95], v27, s[12:15], s45 offen offset:1024
    v_mfma_f32_16x16x32_bf16 v[212:215], v[184:187], a[224:227], v[212:215]
    v_max_f32_dpp v244, v244, v244 row_ror:8 row_mask:0xf bank_mask:0xf
    v_mov_b32 v245, v244
    buffer_load_dwordx4 v[80:83], v27, s[12:15], s44 offen offset:2048
    v_mfma_f32_16x16x32_bf16 v[216:219], v[184:187], a[240:243], v[216:219]
    v_permlane32_swap_b32 v244, v245
    buffer_load_dwordx4 v[96:99], v27, s[12:15], s45 offen offset:2048
    v_max_f32 v244, v244, v245
    v_mfma_f32_16x16x32_bf16 v[204:207], v[188:191], a[200:203], v[204:207]
    v_mov_b32 v245, v244
    buffer_load_dwordx4 v[84:87], v27, s[12:15], s44 offen offset:3072
    s_nop 0
    v_permlane16_swap_b32 v244, v245
    v_mfma_f32_16x16x32_bf16 v[208:211], v[188:191], a[216:219], v[208:211]
    buffer_load_dwordx4 v[100:103], v27, s[12:15], s45 offen offset:3072
    v_max_f32 v244, v244, v245
    v_mul_f32 v244, s49, v244
    v_mfma_f32_16x16x32_bf16 v[212:215], v[188:191], a[232:235], v[212:215]
    buffer_load_dwordx4 v[40:43], v13, s[12:15], s42 offen
    v_fma_f32 v192, v192, s49, -v244
    v_fma_f32 v193, v193, s49, -v244
    buffer_load_dwordx4 v[44:47], v13, s[12:15], s43 offen
    v_mfma_f32_16x16x32_bf16 v[216:219], v[188:191], a[248:251], v[216:219]
    v_fma_f32 v194, v194, s49, -v244
    v_fma_f32 v195, v195, s49, -v244
    v_fma_f32 v196, v196, s49, -v244
    v_exp_f32 v192, v192
    v_exp_f32 v193, v193
    v_exp_f32 v194, v194
    v_exp_f32 v195, v195
    v_exp_f32 v196, v196
    v_cvt_pk_bf16_f32 v228, v192, v193
    v_cvt_pk_bf16_f32 v229, v194, v195
    v_mov_b32_dpp v246, v196 row_ror:8 row_mask:0xf bank_mask:0xf
    v_mov_b32_dpp v230, v228 row_ror:8 row_mask:0xf bank_mask:0xf
    v_mov_b32_dpp v231, v229 row_ror:8 row_mask:0xf bank_mask:0xf
    v_cvt_pk_bf16_f32 v232, v196, v246
    s_nop 0
    v_mfma_f32_16x16x32_bf16 v[152:155], v[8:11], v[228:231], 0
    v_mov_b32 v233, v232
    v_cvt_pk_bf16_f32 v220, v204, v205
    v_cvt_pk_bf16_f32 v221, v206, v207
    v_mfma_f32_16x16x32_bf16 v[136:139], v[104:107], v[228:231], 0
    v_permlane32_swap_b32 v232, v233
    v_cvt_pk_bf16_f32 v222, v208, v209
    v_cvt_pk_bf16_f32 v223, v210, v211
    v_mfma_f32_16x16x32_bf16 v[140:143], v[108:111], v[228:231], 0
    v_and_b32 v232, v232, v12
    v_and_b32 v233, v233, v12
    v_cvt_pk_bf16_f32 v224, v212, v213
    v_mfma_f32_16x16x32_bf16 v[144:147], v[112:115], v[228:231], 0
    v_cvt_pk_bf16_f32 v225, v214, v215
    v_cvt_pk_bf16_f32 v226, v216, v217
    v_cvt_pk_bf16_f32 v227, v218, v219
    v_mfma_f32_16x16x32_bf16 v[148:151], v[116:119], v[228:231], 0
    v_mfma_f32_16x16x16_bf16 v[152:155], v[8:9], v[232:233], v[152:155]
    v_mfma_f32_16x16x16_bf16 v[136:139], v[220:221], v[232:233], v[136:139]
    v_mfma_f32_16x16x16_bf16 v[140:143], v[222:223], v[232:233], v[140:143]
    v_mfma_f32_16x16x16_bf16 v[144:147], v[224:225], v[232:233], v[144:147]
    s_nop 1
    v_mfma_f32_16x16x16_bf16 v[148:151], v[226:227], v[232:233], v[148:151]
    s_nop 1
    v_rcp_f32 v244, v152
    s_nop 0
    v_pk_mul_f32 v[136:137], v[136:137], v[244:245] op_sel_hi:[1,0]
    v_pk_mul_f32 v[138:139], v[138:139], v[244:245] op_sel_hi:[1,0]
    v_pk_mul_f32 v[144:145], v[144:145], v[244:245] op_sel_hi:[1,0]
    v_pk_mul_f32 v[146:147], v[146:147], v[244:245] op_sel_hi:[1,0]
    v_mul_f32_dpp v136, v140, v244 row_shr:8 row_mask:0xf bank_mask:0xc
    v_mul_f32_dpp v137, v141, v244 row_shr:8 row_mask:0xf bank_mask:0xc
    v_mul_f32_dpp v138, v142, v244 row_shr:8 row_mask:0xf bank_mask:0xc
    v_mul_f32_dpp v139, v143, v244 row_shr:8 row_mask:0xf bank_mask:0xc
    ds_write_b128 v32, v[136:139] offset:0
    v_mul_f32_dpp v144, v148, v244 row_shr:8 row_mask:0xf bank_mask:0xc
    v_mul_f32_dpp v145, v149, v244 row_shr:8 row_mask:0xf bank_mask:0xc
    v_mul_f32_dpp v146, v150, v244 row_shr:8 row_mask:0xf bank_mask:0xc
    v_mul_f32_dpp v147, v151, v244 row_shr:8 row_mask:0xf bank_mask:0xc
    ds_write_b128 v32, v[144:147] offset:1024
    s_waitcnt lgkmcnt(0)
    s_barrier
    s_cmp_ge_u32 s28, 2
    s_cbranch_scc1 c1_127
    ds_read_b128 v[160:163], v33 offset:0
    ds_read_b128 v[164:167], v33 offset:2048
    ds_read_b128 v[168:171], v33 offset:4096
    ds_read_b128 v[172:175], v33 offset:6144
    s_waitcnt lgkmcnt(2)
    v_pk_add_f32 v[160:161], v[160:161], v[164:165]
    v_pk_add_f32 v[162:163], v[162:163], v[166:167]
    s_waitcnt lgkmcnt(0)
    v_pk_add_f32 v[168:169], v[168:169], v[172:173]
    v_pk_add_f32 v[170:171], v[170:171], v[174:175]
    v_pk_add_f32 v[160:161], v[160:161], v[168:169]
    v_pk_add_f32 v[162:163], v[162:163], v[170:171]
    v_cvt_pk_bf16_f32 v164, v160, v161
    v_cvt_pk_bf16_f32 v165, v162, v163
    v_min_u32 v164, -2, v164
    v_min_u32 v165, -2, v165
    v_mov_b32 v166, v164
    v_mov_b32 v167, v165
    s_nop 0
    v_permlane16_swap_b32 v164, v166
    v_permlane16_swap_b32 v165, v167
c1_127:
    buffer_store_dwordx4 v[164:167], v26, s[8:11], s32 offen sc1
    s_add_u32 s29, s29, 1
    buffer_store_dwordx4 v[16:19], v26, s[8:11], s30 offen sc1
    s_cmp_eq_u32 s28, 1
    s_cbranch_scc1 r1_128
    buffer_store_dwordx4 v[16:19], v23, s[8:11], s30 offen sc1
    s_branch r2_129
r1_128:
    buffer_store_dword v16, v23, s[8:11], s30 offen sc1
r2_129:
    buffer_store_dwordx4 v[236:239], v28, s[16:19], s47 offen sc1
    s_add_u32 s54, s29, 2
    s_min_u32 s54, s54, 63
    s_lshl_b32 s54, s54, 16
    buffer_store_dwordx4 v[16:19], v28, s[16:19], s54 offen sc1
    s_lshl_b32 s42, s29, 18
    s_add_u32 s44, s42, 0x1040000
    s_add_u32 s46, s42, 0x80000
    s_add_u32 s42, s42, 0x40000
    s_add_u32 s43, s42, 0x20000
    s_add_u32 s45, s44, 0x20000
    s_lshl_b32 s47, s29, 16
    s_waitcnt vmcnt(7)
    s_add_u32 s39, s29, 1
    s_lshr_b32 s39, s39, 2
    s_lshl_b32 s39, s39, 2
    s_add_u32 s39, s39, 4096
    buffer_load_dword v34, off, s[20:23], s39 sc1
    v_mfma_f32_16x16x32_bf16 v[160:163], v[72:75], a[192:195], 0
    v_mfma_f32_16x16x32_bf16 v[164:167], v[88:91], a[192:195], 0
    v_mfma_f32_16x16x32_bf16 v[168:171], v[72:75], a[208:211], 0
    v_mfma_f32_16x16x32_bf16 v[172:175], v[88:91], a[208:211], 0
    v_mfma_f32_16x16x32_bf16 v[176:179], v[72:75], a[224:227], 0
    v_mfma_f32_16x16x32_bf16 v[180:183], v[88:91], a[224:227], 0
    v_mfma_f32_16x16x32_bf16 v[184:187], v[72:75], a[240:243], 0
    v_mfma_f32_16x16x32_bf16 v[188:191], v[88:91], a[240:243], 0
    v_mfma_f32_16x16x32_bf16 v[160:163], v[76:79], a[196:199], v[160:163]
    v_mfma_f32_16x16x32_bf16 v[164:167], v[92:95], a[196:199], v[164:167]
    v_mfma_f32_16x16x32_bf16 v[168:171], v[76:79], a[212:215], v[168:171]
    v_mfma_f32_16x16x32_bf16 v[172:175], v[92:95], a[212:215], v[172:175]
    v_mfma_f32_16x16x32_bf16 v[176:179], v[76:79], a[228:231], v[176:179]
    v_mfma_f32_16x16x32_bf16 v[180:183], v[92:95], a[228:231], v[180:183]
    v_mfma_f32_16x16x32_bf16 v[184:187], v[76:79], a[244:247], v[184:187]
    v_mfma_f32_16x16x32_bf16 v[188:191], v[92:95], a[244:247], v[188:191]
    v_mfma_f32_16x16x32_bf16 v[160:163], v[80:83], a[200:203], v[160:163]
    v_mfma_f32_16x16x32_bf16 v[164:167], v[96:99], a[200:203], v[164:167]
    v_mfma_f32_16x16x32_bf16 v[168:171], v[80:83], a[216:219], v[168:171]
    v_mfma_f32_16x16x32_bf16 v[172:175], v[96:99], a[216:219], v[172:175]
    v_mfma_f32_16x16x32_bf16 v[176:179], v[80:83], a[232:235], v[176:179]
    v_mfma_f32_16x16x32_bf16 v[180:183], v[96:99], a[232:235], v[180:183]
    v_mfma_f32_16x16x32_bf16 v[184:187], v[80:83], a[248:251], v[184:187]
    v_mfma_f32_16x16x32_bf16 v[188:191], v[96:99], a[248:251], v[188:191]
    v_mfma_f32_16x16x32_bf16 v[160:163], v[84:87], a[204:207], v[160:163]
    v_mfma_f32_16x16x32_bf16 v[164:167], v[100:103], a[204:207], v[164:167]
    v_mfma_f32_16x16x32_bf16 v[168:171], v[84:87], a[220:223], v[168:171]
    v_mfma_f32_16x16x32_bf16 v[172:175], v[100:103], a[220:223], v[172:175]
    v_mfma_f32_16x16x32_bf16 v[176:179], v[84:87], a[236:239], v[176:179]
    v_mfma_f32_16x16x32_bf16 v[180:183], v[100:103], a[236:239], v[180:183]
    v_mfma_f32_16x16x32_bf16 v[184:187], v[84:87], a[252:255], v[184:187]
    v_mfma_f32_16x16x32_bf16 v[188:191], v[100:103], a[252:255], v[188:191]
    s_nop 0
    v_cvt_pk_bf16_f32 v104, v160, v161
    v_cvt_pk_bf16_f32 v105, v162, v163
    v_cvt_pk_bf16_f32 v106, v164, v165
    v_cvt_pk_bf16_f32 v107, v166, v167
    v_cvt_pk_bf16_f32 v108, v168, v169
    v_cvt_pk_bf16_f32 v109, v170, v171
    v_cvt_pk_bf16_f32 v110, v172, v173
    v_cvt_pk_bf16_f32 v111, v174, v175
    v_cvt_pk_bf16_f32 v112, v176, v177
    v_cvt_pk_bf16_f32 v113, v178, v179
    v_cvt_pk_bf16_f32 v114, v180, v181
    v_cvt_pk_bf16_f32 v115, v182, v183
    v_cvt_pk_bf16_f32 v116, v184, v185
    v_cvt_pk_bf16_f32 v117, v186, v187
    v_cvt_pk_bf16_f32 v118, v188, v189
    v_cvt_pk_bf16_f32 v119, v190, v191
    s_cmp_lg_u32 s28, 2
    s_cbranch_scc1 nt_130
nt_130:
    v_mov_b32 v136, 0
    v_mov_b32 v137, 0
    v_mov_b32 v138, 0
    v_mov_b32 v139, 0
    v_mov_b32 v140, 0
    v_mov_b32 v141, 0
    v_mov_b32 v142, 0
    v_mov_b32 v143, 0
    v_mov_b32 v144, 0
    v_mov_b32 v145, 0
    v_mov_b32 v146, 0
    v_mov_b32 v147, 0
    v_mov_b32 v148, 0
    v_mov_b32 v149, 0
    v_mov_b32 v150, 0
    v_mov_b32 v151, 0
    v_mov_b32 v152, 0
    v_mov_b32 v153, 0
    v_mov_b32 v154, 0
    v_mov_b32 v155, 0
    v_mov_b32 v156, 0
    v_mov_b32 v157, 0
    v_mov_b32 v158, 0
    v_mov_b32 v159, 0
    s_cmp_lg_u32 s28, 3
    s_cbranch_scc1 noA_131
    buffer_load_dwordx4 v[176:179], v20, s[8:11], s32 offen offset:0 sc1
    buffer_load_dwordx4 v[180:183], v20, s[8:11], s32 offen offset:1024 sc1
    buffer_load_dwordx4 v[184:187], v20, s[8:11], s32 offen offset:2048 sc1
    buffer_load_dwordx4 v[188:191], v20, s[8:11], s32 offen offset:3072 sc1
pw_132:
    s_waitcnt vmcnt(0)
    v_mfma_f32_16x16x32_bf16 v[160:163], v[36:39], v[176:179], 0
    v_max3_u32 v244, v176, v177, v178
    v_max3_u32 v245, v179, v180, v181
    v_max3_u32 v246, v182, v183, v184
    v_mfma_f32_16x16x32_bf16 v[160:163], v[36:39], v[180:183], v[160:163]
    v_max3_u32 v247, v185, v186, v187
    v_max3_u32 v248, v188, v189, v190
    v_max3_u32 v244, v244, v245, v246
    v_mfma_f32_16x16x32_bf16 v[160:163], v[240:243], v[184:187], v[160:163]
    v_max3_u32 v247, v247, v248, v191
    v_max_u32 v244, v244, v247
    v_cmp_eq_u32 vcc, -1, v244
    v_mfma_f32_16x16x32_bf16 v[160:163], v[240:243], v[188:191], v[160:163]
    s_cbranch_vccnz rt_133
    s_nop 6
    v_cvt_pk_bf16_f32 v244, v160, v161
    v_cvt_pk_bf16_f32 v245, v162, v163
    v_min_u32 v244, -2, v244
    v_min_u32 v245, -2, v245
    buffer_store_dwordx2 v[244:245], v21, s[8:11], s33 offen sc1
    buffer_store_dwordx2 v[16:17], v21, s[8:11], s31 offen sc1
noA_131:
    s_barrier
    s_sleep 3
    buffer_load_dwordx4 v[120:123], v22, s[8:11], s33 offen offset:0 sc1
    buffer_load_dwordx4 v[124:127], v22, s[8:11], s33 offen offset:1024 sc1
    buffer_load_dwordx4 v[128:131], v22, s[8:11], s33 offen offset:2048 sc1
    buffer_load_dwordx4 v[132:135], v22, s[8:11], s33 offen offset:3072 sc1
pw_134:
    s_waitcnt vmcnt(0)
    v_smfmac_f32_16x16x64_bf16 v[136:139], v[120:123], a[0:7], v1
    v_max3_u32 v244, v120, v121, v122
    v_max3_u32 v245, v123, v124, v125
    v_max3_u32 v246, v126, v127, v128
    v_smfmac_f32_16x16x64_bf16 v[140:143], v[120:123], a[32:39], v1
    v_max3_u32 v247, v129, v130, v131
    v_max3_u32 v248, v132, v133, v134
    v_max3_u32 v244, v244, v245, v246
    v_smfmac_f32_16x16x64_bf16 v[136:139], v[124:127], a[8:15], v1
    v_max3_u32 v247, v247, v248, v135
    v_max_u32 v244, v244, v247
    v_cmp_eq_u32 vcc, -1, v244
    v_smfmac_f32_16x16x64_bf16 v[140:143], v[124:127], a[40:47], v1
    s_cbranch_vccnz rt_135
    v_smfmac_f32_16x16x64_bf16 v[136:139], v[128:131], a[16:23], v1
    v_smfmac_f32_16x16x64_bf16 v[140:143], v[128:131], a[48:55], v1
    v_smfmac_f32_16x16x64_bf16 v[136:139], v[132:135], a[24:31], v1
    v_smfmac_f32_16x16x64_bf16 v[140:143], v[132:135], a[56:63], v1
    v_smfmac_f32_16x16x64_bf16 v[144:147], v[120:123], a[64:71], v1
    v_smfmac_f32_16x16x64_bf16 v[148:151], v[120:123], a[96:103], v1
    v_smfmac_f32_16x16x64_bf16 v[144:147], v[124:127], a[72:79], v1
    v_smfmac_f32_16x16x64_bf16 v[148:151], v[124:127], a[104:111], v1
    s_nop 3
    v_permlane32_swap_b32 v136, v140
    v_smfmac_f32_16x16x64_bf16 v[144:147], v[128:131], a[80:87], v1
    v_permlane32_swap_b32 v137, v141
    v_smfmac_f32_16x16x64_bf16 v[148:151], v[128:131], a[112:119], v1
    v_permlane32_swap_b32 v138, v142
    v_smfmac_f32_16x16x64_bf16 v[144:147], v[132:135], a[88:95], v1
    v_permlane32_swap_b32 v139, v143
    v_smfmac_f32_16x16x64_bf16 v[148:151], v[132:135], a[120:127], v1
    v_pk_add_f32 v[136:137], v[136:137], v[140:141]
    v_smfmac_f32_16x16x64_bf16 v[152:155], v[120:123], a[128:135], v1
    v_pk_add_f32 v[138:139], v[138:139], v[142:143]
    v_smfmac_f32_16x16x64_bf16 v[156:159], v[120:123], a[160:167], v1
    ds_write_b128 v30, v[136:139]
    v_smfmac_f32_16x16x64_bf16 v[152:155], v[124:127], a[136:143], v1
    v_smfmac_f32_16x16x64_bf16 v[156:159], v[124:127], a[168:175], v1
    s_nop 0
    v_permlane32_swap_b32 v144, v148
    v_permlane32_swap_b32 v145, v149
    v_smfmac_f32_16x16x64_bf16 v[152:155], v[128:131], a[144:151], v1
    v_permlane32_swap_b32 v146, v150
    v_smfmac_f32_16x16x64_bf16 v[156:159], v[128:131], a[176:183], v1
    v_permlane32_swap_b32 v147, v151
    v_pk_add_f32 v[144:145], v[144:145], v[148:149]
    v_smfmac_f32_16x16x64_bf16 v[152:155], v[132:135], a[152:159], v1
    v_pk_add_f32 v[146:147], v[146:147], v[150:151]
    v_smfmac_f32_16x16x64_bf16 v[156:159], v[132:135], a[184:191], v1
    ds_write_b128 v30, v[144:147] offset:4096
    s_nop 6
    v_permlane32_swap_b32 v152, v156
    v_permlane32_swap_b32 v153, v157
    v_permlane32_swap_b32 v154, v158
    v_permlane32_swap_b32 v155, v159
    v_pk_add_f32 v[152:153], v[152:153], v[156:157]
    v_pk_add_f32 v[154:155], v[154:155], v[158:159]
    ds_write_b128 v30, v[152:155] offset:8192
    s_waitcnt lgkmcnt(0)
    s_barrier
    s_cmp_eq_u32 s28, 3
    s_cbranch_scc1 be_138
    ds_read_b128 v[160:163], v35 offset:0
    ds_read_b128 v[164:167], v35 offset:1024
    ds_read_b128 v[168:171], v35 offset:2048
    ds_read_b128 v[172:175], v35 offset:3072
    s_cmp_eq_u32 s28, 1
    s_cbranch_scc1 b1_136
    s_cmp_eq_u32 s28, 2
    s_cbranch_scc1 b2_137
    s_waitcnt lgkmcnt(2)
    v_pk_add_f32 v[160:161], v[160:161], v[164:165]
    v_pk_add_f32 v[162:163], v[162:163], v[166:167]
    s_waitcnt lgkmcnt(0)
    v_pk_add_f32 v[168:169], v[168:169], v[172:173]
    v_pk_add_f32 v[170:171], v[170:171], v[174:175]
    v_pk_add_f32 v[160:161], v[160:161], v[168:169]
    v_pk_add_f32 v[162:163], v[162:163], v[170:171]
    v_cvt_pk_bf16_f32 v244, v160, v161
    v_cvt_pk_bf16_f32 v245, v162, v163
    s_nop 1
    v_mfma_f32_16x16x16_bf16 v[164:167], v[244:245], v[2:3], 0
    v_mfma_f32_16x16x16_bf16 v[168:171], v[244:245], v[4:5], 0
    s_nop 6
    v_cvt_pk_bf16_f32 v172, v164, v165
    v_cvt_pk_bf16_f32 v173, v166, v167
    v_cvt_pk_bf16_f32 v174, v168, v169
    v_cvt_pk_bf16_f32 v175, v170, v171
    s_nop 1
    v_mfma_f32_16x16x32_bf16 v[160:163], v[40:43], v[172:175], 0
    v_mfma_f32_16x16x32_bf16 v[164:167], v[44:47], v[172:175], 0
    s_nop 7
    v_mov_b32_dpp v160, v164 quad_perm:[0,1,2,3] row_mask:0xf bank_mask:0xc
    v_mov_b32_dpp v161, v165 quad_perm:[0,1,2,3] row_mask:0xf bank_mask:0xc
    v_mov_b32_dpp v162, v166 quad_perm:[0,1,2,3] row_mask:0xf bank_mask:0xc
    v_mov_b32_dpp v163, v167 quad_perm:[0,1,2,3] row_mask:0xf bank_mask:0xc
    v_min_u32 v160, -2, v160
    v_min_u32 v161, -2, v161
    v_min_u32 v162, -2, v162
    v_min_u32 v163, -2, v163
    buffer_store_dwordx4 v[160:163], v23, s[8:11], s33 offen sc1
    s_branch be_138
b1_136:
    ds_read_b128 v[48:51], v31 offset:0
    ds_read_b128 v[52:55], v31 offset:1024
    ds_read_b128 v[56:59], v31 offset:2048
    ds_read_b128 v[60:63], v31 offset:3072
    s_waitcnt lgkmcnt(6)
    v_pk_add_f32 v[160:161], v[160:161], v[164:165]
    v_pk_add_f32 v[162:163], v[162:163], v[166:167]
    s_waitcnt lgkmcnt(4)
    v_pk_add_f32 v[168:169], v[168:169], v[172:173]
    v_pk_add_f32 v[170:171], v[170:171], v[174:175]
    v_pk_add_f32 v[160:161], v[160:161], v[168:169]
    v_pk_add_f32 v[162:163], v[162:163], v[170:171]
    v_cvt_pk_bf16_f32 v246, v160, v161
    v_cvt_pk_bf16_f32 v247, v162, v163
    s_waitcnt lgkmcnt(2)
    s_nop 0
    v_mfma_f32_16x16x16_bf16 v[164:167], v[246:247], v[68:69], 0
    v_pk_add_f32 v[48:49], v[48:49], v[52:53]
    v_pk_add_f32 v[50:51], v[50:51], v[54:55]
    v_mfma_f32_16x16x16_bf16 v[168:171], v[246:247], v[70:71], 0
    s_waitcnt lgkmcnt(0)
    v_pk_add_f32 v[56:57], v[56:57], v[60:61]
    v_pk_add_f32 v[58:59], v[58:59], v[62:63]
    v_pk_add_f32 v[48:49], v[48:49], v[56:57]
    v_pk_add_f32 v[50:51], v[50:51], v[58:59]
    v_cvt_pk_bf16_f32 v244, v48, v49
    v_cvt_pk_bf16_f32 v245, v50, v51
    s_nop 1
    v_mfma_f32_16x16x16_bf16 v[52:55], v[244:245], v[2:3], 0
    v_mfma_f32_16x16x16_bf16 v[56:59], v[244:245], v[4:5], 0
    v_cvt_pk_bf16_f32 v172, v164, v165
    v_cvt_pk_bf16_f32 v173, v166, v167
    v_cvt_pk_bf16_f32 v174, v168, v169
    v_cvt_pk_bf16_f32 v175, v170, v171
    s_nop 2
    v_cvt_pk_bf16_f32 v60, v52, v53
    v_cvt_pk_bf16_f32 v61, v54, v55
    v_cvt_pk_bf16_f32 v62, v56, v57
    v_cvt_pk_bf16_f32 v63, v58, v59
    s_nop 1
    v_mfma_f32_16x16x32_bf16 v[48:51], v[172:175], v[60:63], 0
    v_min_u32 v236, -2, v172
    v_min_u32 v237, -2, v173
    v_min_u32 v238, -2, v174
    v_min_u32 v239, -2, v175
    s_nop 3
    v_mov_b32_dpp v48, v49 quad_perm:[0,1,2,3] row_mask:0xf bank_mask:0xc
    v_min_u32 v48, -2, v48
    buffer_store_dword v48, v23, s[8:11], s33 offen sc1
    s_branch be_138
b2_137:
    s_waitcnt lgkmcnt(2)
    v_pk_add_f32 v[160:161], v[160:161], v[164:165]
    v_pk_add_f32 v[162:163], v[162:163], v[166:167]
    s_waitcnt lgkmcnt(0)
    v_pk_add_f32 v[168:169], v[168:169], v[172:173]
    v_pk_add_f32 v[170:171], v[170:171], v[174:175]
    v_pk_add_f32 v[160:161], v[160:161], v[168:169]
    v_pk_add_f32 v[162:163], v[162:163], v[170:171]
    v_cvt_pk_bf16_f32 v244, v160, v161
    v_cvt_pk_bf16_f32 v245, v162, v163
    s_nop 1
    v_mfma_f32_16x16x16_bf16 v[164:167], v[244:245], v[2:3], 0
    v_mfma_f32_16x16x16_bf16 v[168:171], v[244:245], v[4:5], 0
    s_nop 6
    v_cvt_pk_bf16_f32 v236, v164, v165
    v_cvt_pk_bf16_f32 v237, v166, v167
    v_cvt_pk_bf16_f32 v238, v168, v169
    v_cvt_pk_bf16_f32 v239, v170, v171
    v_min_u32 v236, -2, v236
    v_min_u32 v237, -2, v237
    v_min_u32 v238, -2, v238
    v_min_u32 v239, -2, v239
    buffer_store_dwordx4 v[236:239], v23, s[8:11], s33 offen sc1
be_138:
    s_barrier
    s_cmp_eq_u32 s29, 63
    s_cbranch_scc1 ch_fin
    s_sleep 2
xv_139:
    buffer_load_dwordx4 v[176:179], v25, s[8:11], s33 offen offset:0 sc1
    buffer_load_dwordx4 v[180:183], v25, s[8:11], s33 offen offset:1024 sc1
    buffer_load_dwordx4 v[48:51], v24, s[8:11], s33 offen offset:0 sc1
    buffer_load_dwordx4 v[52:55], v24, s[8:11], s33 offen offset:1024 sc1
    buffer_load_dwordx4 v[56:59], v24, s[8:11], s33 offen offset:2048 sc1
    buffer_load_dwordx4 v[60:63], v24, s[8:11], s33 offen offset:3072 sc1
    buffer_load_dwordx4 v[64:67], v14, s[8:11], s33 offen sc1
    s_waitcnt vmcnt(5)
    v_mfma_f32_16x16x32_bf16 v[204:207], v[176:179], a[196:199], 0
    v_max3_u32 v244, v176, v177, v178
    v_max3_u32 v245, v179, v180, v181
    v_max_u32 v246, v182, v183
    v_mfma_f32_16x16x32_bf16 v[208:211], v[176:179], a[212:215], 0
    v_max3_u32 v244, v244, v245, v246
    v_cmp_eq_u32 vcc, -1, v244
    v_mfma_f32_16x16x32_bf16 v[212:215], v[176:179], a[228:231], 0
    v_mov_b32_dpp v184, v176 row_ror:8 row_mask:0xf bank_mask:0xf
    v_mov_b32_dpp v185, v177 row_ror:8 row_mask:0xf bank_mask:0xf
    v_mfma_f32_16x16x32_bf16 v[216:219], v[176:179], a[244:247], 0
    s_cbranch_vccnz rt_141
    v_mov_b32_dpp v186, v178 row_ror:8 row_mask:0xf bank_mask:0xf
    v_mov_b32_dpp v187, v179 row_ror:8 row_mask:0xf bank_mask:0xf
    v_mfma_f32_16x16x32_bf16 v[204:207], v[180:183], a[204:207], v[204:207]
    v_mov_b32_dpp v188, v180 row_ror:8 row_mask:0xf bank_mask:0xf
    v_mfma_f32_16x16x32_bf16 v[208:211], v[180:183], a[220:223], v[208:211]
    v_mov_b32_dpp v189, v181 row_ror:8 row_mask:0xf bank_mask:0xf
    v_mfma_f32_16x16x32_bf16 v[212:215], v[180:183], a[236:239], v[212:215]
    v_mov_b32_dpp v190, v182 row_ror:8 row_mask:0xf bank_mask:0xf
    v_mfma_f32_16x16x32_bf16 v[216:219], v[180:183], a[252:255], v[216:219]
    v_mov_b32_dpp v191, v183 row_ror:8 row_mask:0xf bank_mask:0xf
pw_142:
    s_waitcnt vmcnt(0)
    v_max3_u32 v244, v48, v49, v50
    v_max3_u32 v245, v51, v52, v53
    v_max3_u32 v246, v54, v55, v56
    v_max3_u32 v247, v57, v58, v59
    v_max3_u32 v248, v60, v61, v62
    v_max3_u32 v249, v63, v64, v65
    v_max_u32 v250, v66, v67
    v_max3_u32 v244, v244, v245, v246
    v_pk_add_f32 v[48:49], v[48:49], v[52:53]
    v_max3_u32 v247, v247, v248, v249
    v_pk_add_f32 v[50:51], v[50:51], v[54:55]
    v_max3_u32 v244, v244, v247, v250
    v_pk_add_f32 v[56:57], v[56:57], v[60:61]
    v_cmp_eq_u32 vcc, -1, v244
    v_pk_add_f32 v[58:59], v[58:59], v[62:63]
    v_pk_add_f32 v[64:65], v[64:65], v[66:67]
    s_cbranch_vccnz rt_143
kvw_144:
    v_readfirstlane_b32 s54, v34
    s_nop 3
    s_cmp_ge_u32 s54, 64
    s_cbranch_scc1 kvd_145
    s_sleep 4
    buffer_load_dword v34, off, s[20:23], s39 sc1
    s_waitcnt vmcnt(0)
    s_sub_u32 s48, s48, 1
    s_cbranch_scc0 kvw_144
    s_mov_b32 s70, 9
    s_branch ch_err
kvd_145:
    buffer_load_dwordx4 v[72:75], v27, s[12:15], s44 offen offset:0
    v_pk_add_f32 v[192:193], v[48:49], v[56:57]
    v_mfma_f32_16x16x32_bf16 v[204:207], v[184:187], a[192:195], v[204:207]
    buffer_load_dwordx4 v[88:91], v27, s[12:15], s45 offen offset:0
    v_pk_add_f32 v[194:195], v[50:51], v[58:59]
    v_add_f32 v196, v64, v65
    v_mfma_f32_16x16x32_bf16 v[208:211], v[184:187], a[208:211], v[208:211]
    buffer_load_dwordx4 v[76:79], v27, s[12:15], s44 offen offset:1024
    v_max3_f32 v244, v192, v193, v194
    v_max3_f32 v244, v244, v195, v196
    buffer_load_dwordx4 v[92:95], v27, s[12:15], s45 offen offset:1024
    v_mfma_f32_16x16x32_bf16 v[212:215], v[184:187], a[224:227], v[212:215]
    v_max_f32_dpp v244, v244, v244 row_ror:8 row_mask:0xf bank_mask:0xf
    v_mov_b32 v245, v244
    buffer_load_dwordx4 v[80:83], v27, s[12:15], s44 offen offset:2048
    v_mfma_f32_16x16x32_bf16 v[216:219], v[184:187], a[240:243], v[216:219]
    v_permlane32_swap_b32 v244, v245
    buffer_load_dwordx4 v[96:99], v27, s[12:15], s45 offen offset:2048
    v_max_f32 v244, v244, v245
    v_mfma_f32_16x16x32_bf16 v[204:207], v[188:191], a[200:203], v[204:207]
    v_mov_b32 v245, v244
    buffer_load_dwordx4 v[84:87], v27, s[12:15], s44 offen offset:3072
    s_nop 0
    v_permlane16_swap_b32 v244, v245
    v_mfma_f32_16x16x32_bf16 v[208:211], v[188:191], a[216:219], v[208:211]
    buffer_load_dwordx4 v[100:103], v27, s[12:15], s45 offen offset:3072
    v_max_f32 v244, v244, v245
    v_mul_f32 v244, s49, v244
    v_mfma_f32_16x16x32_bf16 v[212:215], v[188:191], a[232:235], v[212:215]
    buffer_load_dwordx4 v[40:43], v13, s[12:15], s42 offen
    v_fma_f32 v192, v192, s49, -v244
    v_fma_f32 v193, v193, s49, -v244
    buffer_load_dwordx4 v[44:47], v13, s[12:15], s43 offen
    v_mfma_f32_16x16x32_bf16 v[216:219], v[188:191], a[248:251], v[216:219]
    v_fma_f32 v194, v194, s49, -v244
    v_fma_f32 v195, v195, s49, -v244
    v_fma_f32 v196, v196, s49, -v244
    v_exp_f32 v192, v192
    v_exp_f32 v193, v193
    v_exp_f32 v194, v194
    v_exp_f32 v195, v195
    v_exp_f32 v196, v196
    v_cvt_pk_bf16_f32 v228, v192, v193
    v_cvt_pk_bf16_f32 v229, v194, v195
    v_mov_b32_dpp v246, v196 row_ror:8 row_mask:0xf bank_mask:0xf
    v_mov_b32_dpp v230, v228 row_ror:8 row_mask:0xf bank_mask:0xf
    v_mov_b32_dpp v231, v229 row_ror:8 row_mask:0xf bank_mask:0xf
    v_cvt_pk_bf16_f32 v232, v196, v246
    s_nop 0
    v_mfma_f32_16x16x32_bf16 v[152:155], v[8:11], v[228:231], 0
    v_mov_b32 v233, v232
    v_cvt_pk_bf16_f32 v220, v204, v205
    v_cvt_pk_bf16_f32 v221, v206, v207
    v_mfma_f32_16x16x32_bf16 v[136:139], v[104:107], v[228:231], 0
    v_permlane32_swap_b32 v232, v233
    v_cvt_pk_bf16_f32 v222, v208, v209
    v_cvt_pk_bf16_f32 v223, v210, v211
    v_mfma_f32_16x16x32_bf16 v[140:143], v[108:111], v[228:231], 0
    v_and_b32 v232, v232, v12
    v_and_b32 v233, v233, v12
    v_cvt_pk_bf16_f32 v224, v212, v213
    v_mfma_f32_16x16x32_bf16 v[144:147], v[112:115], v[228:231], 0
    v_cvt_pk_bf16_f32 v225, v214, v215
    v_cvt_pk_bf16_f32 v226, v216, v217
    v_cvt_pk_bf16_f32 v227, v218, v219
    v_mfma_f32_16x16x32_bf16 v[148:151], v[116:119], v[228:231], 0
    v_mfma_f32_16x16x16_bf16 v[152:155], v[8:9], v[232:233], v[152:155]
    v_mfma_f32_16x16x16_bf16 v[136:139], v[220:221], v[232:233], v[136:139]
    v_mfma_f32_16x16x16_bf16 v[140:143], v[222:223], v[232:233], v[140:143]
    v_mfma_f32_16x16x16_bf16 v[144:147], v[224:225], v[232:233], v[144:147]
    s_nop 1
    v_mfma_f32_16x16x16_bf16 v[148:151], v[226:227], v[232:233], v[148:151]
    s_nop 1
    v_rcp_f32 v244, v152
    s_nop 0
    v_pk_mul_f32 v[136:137], v[136:137], v[244:245] op_sel_hi:[1,0]
    v_pk_mul_f32 v[138:139], v[138:139], v[244:245] op_sel_hi:[1,0]
    v_pk_mul_f32 v[144:145], v[144:145], v[244:245] op_sel_hi:[1,0]
    v_pk_mul_f32 v[146:147], v[146:147], v[244:245] op_sel_hi:[1,0]
    v_mul_f32_dpp v136, v140, v244 row_shr:8 row_mask:0xf bank_mask:0xc
    v_mul_f32_dpp v137, v141, v244 row_shr:8 row_mask:0xf bank_mask:0xc
    v_mul_f32_dpp v138, v142, v244 row_shr:8 row_mask:0xf bank_mask:0xc
    v_mul_f32_dpp v139, v143, v244 row_shr:8 row_mask:0xf bank_mask:0xc
    ds_write_b128 v32, v[136:139] offset:0
    v_mul_f32_dpp v144, v148, v244 row_shr:8 row_mask:0xf bank_mask:0xc
    v_mul_f32_dpp v145, v149, v244 row_shr:8 row_mask:0xf bank_mask:0xc
    v_mul_f32_dpp v146, v150, v244 row_shr:8 row_mask:0xf bank_mask:0xc
    v_mul_f32_dpp v147, v151, v244 row_shr:8 row_mask:0xf bank_mask:0xc
    ds_write_b128 v32, v[144:147] offset:1024
    s_waitcnt lgkmcnt(0)
    s_barrier
    s_cmp_ge_u32 s28, 2
    s_cbranch_scc1 c1_146
    ds_read_b128 v[160:163], v33 offset:0
    ds_read_b128 v[164:167], v33 offset:2048
    ds_read_b128 v[168:171], v33 offset:4096
    ds_read_b128 v[172:175], v33 offset:6144
    s_waitcnt lgkmcnt(2)
    v_pk_add_f32 v[160:161], v[160:161], v[164:165]
    v_pk_add_f32 v[162:163], v[162:163], v[166:167]
    s_waitcnt lgkmcnt(0)
    v_pk_add_f32 v[168:169], v[168:169], v[172:173]
    v_pk_add_f32 v[170:171], v[170:171], v[174:175]
    v_pk_add_f32 v[160:161], v[160:161], v[168:169]
    v_pk_add_f32 v[162:163], v[162:163], v[170:171]
    v_cvt_pk_bf16_f32 v164, v160, v161
    v_cvt_pk_bf16_f32 v165, v162, v163
    v_min_u32 v164, -2, v164
    v_min_u32 v165, -2, v165
    v_mov_b32 v166, v164
    v_mov_b32 v167, v165
    s_nop 0
    v_permlane16_swap_b32 v164, v166
    v_permlane16_swap_b32 v165, v167
c1_146:
    buffer_store_dwordx4 v[164:167], v26, s[8:11], s33 offen sc1
    s_add_u32 s29, s29, 1
    s_branch ch_loop_s
rt_82:
    buffer_load_dwordx4 v[176:179], v20, s[8:11], s33 offen offset:0 sc1
    buffer_load_dwordx4 v[180:183], v20, s[8:11], s33 offen offset:1024 sc1
    buffer_load_dwordx4 v[184:187], v20, s[8:11], s33 offen offset:2048 sc1
    buffer_load_dwordx4 v[188:191], v20, s[8:11], s33 offen offset:3072 sc1
    s_sub_u32 s48, s48, 1
    s_cbranch_scc0 pw_81
    s_mov_b32 s70, 1
    s_branch ch_err
rt_84:
    buffer_load_dwordx4 v[120:123], v22, s[8:11], s30 offen offset:0 sc1
    buffer_load_dwordx4 v[124:127], v22, s[8:11], s30 offen offset:1024 sc1
    buffer_load_dwordx4 v[128:131], v22, s[8:11], s30 offen offset:2048 sc1
    buffer_load_dwordx4 v[132:135], v22, s[8:11], s30 offen offset:3072 sc1
    s_nop 7
    s_nop 7
    v_mov_b32 v136, 0
    v_mov_b32 v137, 0
    v_mov_b32 v138, 0
    v_mov_b32 v139, 0
    v_mov_b32 v140, 0
    v_mov_b32 v141, 0
    v_mov_b32 v142, 0
    v_mov_b32 v143, 0
    s_sub_u32 s48, s48, 1
    s_cbranch_scc0 pw_83
    s_mov_b32 s70, 2
    s_branch ch_err
rt_90:
    s_waitcnt vmcnt(0)
    s_sub_u32 s48, s48, 1
    s_cbranch_scc0 xv_88
    s_mov_b32 s70, 4
    s_branch ch_err
rt_92:
    buffer_load_dwordx4 v[48:51], v24, s[8:11], s30 offen offset:0 sc1
    buffer_load_dwordx4 v[52:55], v24, s[8:11], s30 offen offset:1024 sc1
    buffer_load_dwordx4 v[56:59], v24, s[8:11], s30 offen offset:2048 sc1
    buffer_load_dwordx4 v[60:63], v24, s[8:11], s30 offen offset:3072 sc1
    buffer_load_dwordx4 v[64:67], v14, s[8:11], s30 offen sc1
    s_sub_u32 s48, s48, 1
    s_cbranch_scc0 pw_91
    s_mov_b32 s70, 3
    s_branch ch_err
rt_99:
    buffer_load_dwordx4 v[176:179], v20, s[8:11], s30 offen offset:0 sc1
    buffer_load_dwordx4 v[180:183], v20, s[8:11], s30 offen offset:1024 sc1
    buffer_load_dwordx4 v[184:187], v20, s[8:11], s30 offen offset:2048 sc1
    buffer_load_dwordx4 v[188:191], v20, s[8:11], s30 offen offset:3072 sc1
    s_sub_u32 s48, s48, 1
    s_cbranch_scc0 pw_98
    s_mov_b32 s70, 1
    s_branch ch_err
rt_101:
    buffer_load_dwordx4 v[120:123], v22, s[8:11], s31 offen offset:0 sc1
    buffer_load_dwordx4 v[124:127], v22, s[8:11], s31 offen offset:1024 sc1
    buffer_load_dwordx4 v[128:131], v22, s[8:11], s31 offen offset:2048 sc1
    buffer_load_dwordx4 v[132:135], v22, s[8:11], s31 offen offset:3072 sc1
    s_nop 7
    s_nop 7
    v_mov_b32 v136, 0
    v_mov_b32 v137, 0
    v_mov_b32 v138, 0
    v_mov_b32 v139, 0
    v_mov_b32 v140, 0
    v_mov_b32 v141, 0
    v_mov_b32 v142, 0
    v_mov_b32 v143, 0
    s_sub_u32 s48, s48, 1
    s_cbranch_scc0 pw_100
    s_mov_b32 s70, 2
    s_branch ch_err
rt_107:
    s_waitcnt vmcnt(0)
    s_sub_u32 s48, s48, 1
    s_cbranch_scc0 xv_105
    s_mov_b32 s70, 4
    s_branch ch_err
rt_109:
    buffer_load_dwordx4 v[48:51], v24, s[8:11], s31 offen offset:0 sc1
    buffer_load_dwordx4 v[52:55], v24, s[8:11], s31 offen offset:1024 sc1
    buffer_load_dwordx4 v[56:59], v24, s[8:11], s31 offen offset:2048 sc1
    buffer_load_dwordx4 v[60:63], v24, s[8:11], s31 offen offset:3072 sc1
    buffer_load_dwordx4 v[64:67], v14, s[8:11], s31 offen sc1
    s_sub_u32 s48, s48, 1
    s_cbranch_scc0 pw_108
    s_mov_b32 s70, 3
    s_branch ch_err
rt_116:
    buffer_load_dwordx4 v[176:179], v20, s[8:11], s31 offen offset:0 sc1
    buffer_load_dwordx4 v[180:183], v20, s[8:11], s31 offen offset:1024 sc1
    buffer_load_dwordx4 v[184:187], v20, s[8:11], s31 offen offset:2048 sc1
    buffer_load_dwordx4 v[188:191], v20, s[8:11], s31 offen offset:3072 sc1
    s_sub_u32 s48, s48, 1
    s_cbranch_scc0 pw_115
    s_mov_b32 s70, 1
    s_branch ch_err
rt_118:
    buffer_load_dwordx4 v[120:123], v22, s[8:11], s32 offen offset:0 sc1
    buffer_load_dwordx4 v[124:127], v22, s[8:11], s32 offen offset:1024 sc1
    buffer_load_dwordx4 v[128:131], v22, s[8:11], s32 offen offset:2048 sc1
    buffer_load_dwordx4 v[132:135], v22, s[8:11], s32 offen offset:3072 sc1
    s_nop 7
    s_nop 7
    v_mov_b32 v136, 0
    v_mov_b32 v137, 0
    v_mov_b32 v138, 0
    v_mov_b32 v139, 0
    v_mov_b32 v140, 0
    v_mov_b32 v141, 0
    v_mov_b32 v142, 0
    v_mov_b32 v143, 0
    s_sub_u32 s48, s48, 1
    s_cbranch_scc0 pw_117
    s_mov_b32 s70, 2
    s_branch ch_err
rt_124:
    s_waitcnt vmcnt(0)
    s_sub_u32 s48, s48, 1
    s_cbranch_scc0 xv_122
    s_mov_b32 s70, 4
    s_branch ch_err
rt_126:
    buffer_load_dwordx4 v[48:51], v24, s[8:11], s32 offen offset:0 sc1
    buffer_load_dwordx4 v[52:55], v24, s[8:11], s32 offen offset:1024 sc1
    buffer_load_dwordx4 v[56:59], v24, s[8:11], s32 offen offset:2048 sc1
    buffer_load_dwordx4 v[60:63], v24, s[8:11], s32 offen offset:3072 sc1
    buffer_load_dwordx4 v[64:67], v14, s[8:11], s32 offen sc1
    s_sub_u32 s48, s48, 1
    s_cbranch_scc0 pw_125
    s_mov_b32 s70, 3
    s_branch ch_err
rt_133:
    buffer_load_dwordx4 v[176:179], v20, s[8:11], s32 offen offset:0 sc1
    buffer_load_dwordx4 v[180:183], v20, s[8:11], s32 offen offset:1024 sc1
    buffer_load_dwordx4 v[184:187], v20, s[8:11], s32 offen offset:2048 sc1
    buffer_load_dwordx4 v[188:191], v20, s[8:11], s32 offen offset:3072 sc1
    s_sub_u32 s48, s48, 1
    s_cbranch_scc0 pw_132
    s_mov_b32 s70, 1
    s_branch ch_err
rt_135:
    buffer_load_dwordx4 v[120:123], v22, s[8:11], s33 offen offset:0 sc1
    buffer_load_dwordx4 v[124:127], v22, s[8:11], s33 offen offset:1024 sc1
    buffer_load_dwordx4 v[128:131], v22, s[8:11], s33 offen offset:2048 sc1
    buffer_load_dwordx4 v[132:135], v22, s[8:11], s33 offen offset:3072 sc1
    s_nop 7
    s_nop 7
    v_mov_b32 v136, 0
    v_mov_b32 v137, 0
    v_mov_b32 v138, 0
    v_mov_b32 v139, 0
    v_mov_b32 v140, 0
    v_mov_b32 v141, 0
    v_mov_b32 v142, 0
    v_mov_b32 v143, 0
    s_sub_u32 s48, s48, 1
    s_cbranch_scc0 pw_134
    s_mov_b32 s70, 2
    s_branch ch_err
rt_141:
    s_waitcnt vmcnt(0)
    s_sub_u32 s48, s48, 1
    s_cbranch_scc0 xv_139
    s_mov_b32 s70, 4
    s_branch ch_err
rt_143:
    buffer_load_dwordx4 v[48:51], v24, s[8:11], s33 offen offset:0 sc1
    buffer_load_dwordx4 v[52:55], v24, s[8:11], s33 offen offset:1024 sc1
    buffer_load_dwordx4 v[56:59], v24, s[8:11], s33 offen offset:2048 sc1
    buffer_load_dwordx4 v[60:63], v24, s[8:11], s33 offen offset:3072 sc1
    buffer_load_dwordx4 v[64:67], v14, s[8:11], s33 offen sc1
    s_sub_u32 s48, s48, 1
    s_cbranch_scc0 pw_142
    s_mov_b32 s70, 3
    s_branch ch_err
ch_fin:
    buffer_store_dwordx4 v[236:239], v28, s[16:19], s47 offen sc1
ch_end:
    s_waitcnt vmcnt(0)
    s_endpgm
ch_err:
    v_mov_b32 v3, s70
    s_add_u32 s20, s4, 0x6600000
    s_addc_u32 s21, s5, 0
    s_mov_b32 s22, 0x28000
    s_mov_b32 s23, 0x20000
    buffer_store_dword v3, off, s[20:23], 0 offset:1536
    s_waitcnt vmcnt(0) lgkmcnt(0)
ch_exit:
    s_endpgm
ch_ovf:
    v_and_b32 v244, 3, v0
    v_lshlrev_b32 v244, 6, v244
    v_lshrrev_b32 v245, 2, v0
    v_lshl_add_u32 v244, v245, 2, v244
    v_mov_b32 v245, 144
    v_cmp_eq_u32 vcc, 8, v0
    s_nop 1
    v_cndmask_b32 v244, v244, v245, vcc
    s_mov_b32 s71, 0x8000
cnw_147:
    s_mov_b64 exec, 0x1ff
    buffer_load_dword v245, v244, s[72:75], 0 offen sc1
    s_waitcnt vmcnt(0)
    s_mov_b64 exec, -1
    v_readlane_b32 s60, v245, 0
    v_readlane_b32 s61, v245, 1
    v_readlane_b32 s62, v245, 2
    v_readlane_b32 s63, v245, 3
    v_readlane_b32 s64, v245, 4
    v_readlane_b32 s65, v245, 5
    v_readlane_b32 s66, v245, 6
    v_readlane_b32 s67, v245, 7
    s_add_u32 s68, s60, s61
    s_max_u32 s69, s60, s61
    s_add_u32 s68, s68, s62
    s_max_u32 s69, s69, s62
    s_add_u32 s68, s68, s63
    s_max_u32 s69, s69, s63
    s_add_u32 s68, s68, s64
    s_max_u32 s69, s69, s64
    s_add_u32 s68, s68, s65
    s_max_u32 s69, s69, s65
    s_add_u32 s68, s68, s66
    s_max_u32 s69, s69, s66
    s_add_u32 s68, s68, s67
    s_max_u32 s69, s69, s67
    s_cmp_eq_u32 s68, 256
    s_cbranch_scc1 cnd_148
    s_sleep 8
    s_sub_u32 s71, s71, 1
    s_cbranch_scc0 cnw_147
    s_mov_b32 s70, 10
    s_branch ch_err
cnd_148:
    v_mov_b32 v246, 0
    s_cmp_lg_u32 s28, 0
    s_cbranch_scc1 ov_149
    v_mov_b32 v247, 1
    s_mov_b64 exec, 1
    buffer_atomic_add v247, off, s[72:75], 0 offset:208 sc0
    s_waitcnt vmcnt(0)
    ds_write_b32 v246, v247
    s_mov_b64 exec, -1
ov_149:
    s_waitcnt lgkmcnt(0)
    s_barrier
    ds_read_b32 v247, v246
    s_waitcnt lgkmcnt(0)
    v_readfirstlane_b32 s54, v247
    s_barrier
    s_min_u32 s55, s60, 32
    s_sub_u32 s55, 32, s55
    s_mov_b32 s24, 0
    s_add_u32 s25, s60, s54
    s_cmp_lt_u32 s54, s55
    s_cbranch_scc1 ch_role
    s_sub_u32 s54, s54, s55
    s_min_u32 s55, s61, 32
    s_sub_u32 s55, 32, s55
    s_mov_b32 s24, 1
    s_add_u32 s25, s61, s54
    s_cmp_lt_u32 s54, s55
    s_cbranch_scc1 ch_role
    s_sub_u32 s54, s54, s55
    s_min_u32 s55, s62, 32
    s_sub_u32 s55, 32, s55
    s_mov_b32 s24, 2
    s_add_u32 s25, s62, s54
    s_cmp_lt_u32 s54, s55
    s_cbranch_scc1 ch_role
    s_sub_u32 s54, s54, s55
    s_min_u32 s55, s63, 32
    s_sub_u32 s55, 32, s55
    s_mov_b32 s24, 3
    s_add_u32 s25, s63, s54
    s_cmp_lt_u32 s54, s55
    s_cbranch_scc1 ch_role
    s_sub_u32 s54, s54, s55
    s_min_u32 s55, s64, 32
    s_sub_u32 s55, 32, s55
    s_mov_b32 s24, 4
    s_add_u32 s25, s64, s54
    s_cmp_lt_u32 s54, s55
    s_cbranch_scc1 ch_role
    s_sub_u32 s54, s54, s55
    s_min_u32 s55, s65, 32
    s_sub_u32 s55, 32, s55
    s_mov_b32 s24, 5
    s_add_u32 s25, s65, s54
    s_cmp_lt_u32 s54, s55
    s_cbranch_scc1 ch_role
    s_sub_u32 s54, s54, s55
    s_min_u32 s55, s66, 32
    s_sub_u32 s55, 32, s55
    s_mov_b32 s24, 6
    s_add_u32 s25, s66, s54
    s_cmp_lt_u32 s54, s55
    s_cbranch_scc1 ch_role
    s_sub_u32 s54, s54, s55
    s_min_u32 s55, s67, 32
    s_sub_u32 s55, 32, s55
    s_mov_b32 s24, 7
    s_add_u32 s25, s67, s54
    s_cmp_lt_u32 s54, s55
    s_cbranch_scc1 ch_role
    s_sub_u32 s54, s54, s55
    s_mov_b32 s70, 11
    s_branch ch_err
g_entry:
    s_and_b32 s91, s24, 3
    s_mov_b32 s90, s28
    s_mov_b32 s92, s25
    s_lshl_b32 s83, s24, 5
    s_add_u32 s83, s83, s25
    s_mov_b32 s87, 0
    s_add_u32 s96, s4, 0x6600000
    s_addc_u32 s97, s5, 0
    s_mov_b32 s98, 0x28000
    s_mov_b32 s99, 0x20000
    s_load_dwordx2 s[6:7], s[0:1], 0
    s_load_dwordx2 s[34:35], s[0:1], 8
    s_lshl_b32 s26, s92, 2
    s_add_u32 s26, s26, s91
    s_mov_b32 s20, s90
    v_mbcnt_lo_u32_b32 v1, -1, 0
    v_mbcnt_hi_u32_b32 v1, -1, v1
    v_and_b32 v2, 15, v1
    v_lshrrev_b32 v3, 4, v1
    s_lshl_b32 s21, s20, 6
    v_add_u32 v114, s21, v1
    s_waitcnt lgkmcnt(0)
    s_mov_b32 s8, s6
    s_mov_b32 s9, s7
    s_mov_b32 s10, 0x400000
    s_mov_b32 s11, 0x20000
    s_mov_b32 s12, s4
    s_mov_b32 s13, s5
    s_mov_b32 s14, 0x400000
    s_mov_b32 s15, 0x20000
    s_lshl_b32 s21, s26, 15
    s_lshl_b32 s22, s20, 9
    s_add_u32 s21, s21, s22
    v_lshlrev_b32 v4, 11, v2
    v_lshl_add_u32 v4, v3, 4, v4
    v_add_u32 v4, s21, v4
    buffer_load_dwordx4 v[16:19], v4, s[8:11], 0 offen offset:0
    buffer_load_dwordx4 v[20:23], v4, s[8:11], 0 offen offset:64
    buffer_load_dwordx4 v[24:27], v4, s[8:11], 0 offen offset:128
    buffer_load_dwordx4 v[28:31], v4, s[8:11], 0 offen offset:192
    buffer_load_dwordx4 v[32:35], v4, s[8:11], 0 offen offset:256
    buffer_load_dwordx4 v[36:39], v4, s[8:11], 0 offen offset:320
    buffer_load_dwordx4 v[40:43], v4, s[8:11], 0 offen offset:384
    buffer_load_dwordx4 v[44:47], v4, s[8:11], 0 offen offset:448
    s_mov_b32 s36, s34
    s_mov_b32 s37, s35
    s_mov_b32 s38, 0x4000
    s_mov_b32 s39, 0x20000
    s_lshl_b32 s21, s26, 2
    s_add_u32 s21, s21, s20
    s_and_b32 s21, s21, 15
    s_lshl_b32 s21, s21, 7
    v_and_b32 v6, 7, v1
    v_lshlrev_b32 v6, 11, v6
    v_lshrrev_b32 v7, 3, v1
    v_lshl_add_u32 v6, v7, 4, v6
    v_add_u32 v6, s21, v6
    buffer_load_dwordx4 v[120:123], v6, s[36:39], 0 offen
    s_add_u32 s16, s4, 0x6400000
    s_addc_u32 s17, s5, 0
    s_mov_b32 s18, 0x200000
    s_mov_b32 s19, 0x20000
    s_lshl_b32 s21, s26, 12
    v_lshlrev_b32 v115, 4, v114
    v_add_u32 v124, s21, v115
    v_mov_b32 v8, -1
    v_mov_b32 v12, 0
    v_mov_b32 v9, -1
    v_mov_b32 v13, 0
    v_mov_b32 v10, -1
    v_mov_b32 v14, 0
    v_mov_b32 v11, -1
    v_mov_b32 v15, 0
    s_mov_b32 s21, 0x80000
    buffer_store_dwordx4 v[8:11], v124, s[16:19], s21 offen sc1
    s_mov_b32 s21, 0x100000
    buffer_store_dwordx4 v[8:11], v124, s[16:19], s21 offen sc1
    s_mov_b32 s21, 0x180000
    buffer_store_dwordx4 v[8:11], v124, s[16:19], s21 offen sc1
    s_add_u32 s36, s4, 0x3400000
    s_addc_u32 s37, s5, 0
    s_mov_b32 s38, 0x800000
    s_mov_b32 s39, 0x20000
    s_lshr_b32 s21, s26, 6
    s_lshl_b32 s21, s21, 22
    s_and_b32 s22, s26, 63
    s_lshl_b32 s22, s22, 10
    s_add_u32 s21, s21, s22
    v_lshlrev_b32 v126, 2, v114
    buffer_store_dword v8, v126, s[36:39], s21 offen sc1
    s_add_u32 s36, s4, 0x6600000
    s_addc_u32 s37, s5, 0
    s_mov_b32 s38, 0x28000
    s_mov_b32 s39, 0x20000
    s_lshl_b32 s21, s26, 12
    v_add_u32 v125, s21, v115
    buffer_store_dwordx4 v[12:15], v125, s[36:39], 0 offen sc1
    s_waitcnt vmcnt(6)
    v_permlane16_swap_b32 v16, v18
    v_permlane16_swap_b32 v17, v19
    s_nop 0
    v_permlane32_swap_b32 v16, v18
    v_permlane32_swap_b32 v17, v19
    v_permlane16_swap_b32 v20, v22
    v_permlane16_swap_b32 v21, v23
    s_nop 0
    v_permlane32_swap_b32 v20, v22
    v_permlane32_swap_b32 v21, v23
    v_permlane16_swap_b32 v24, v26
    v_permlane16_swap_b32 v25, v27
    s_nop 0
    v_permlane32_swap_b32 v24, v26
    v_permlane32_swap_b32 v25, v27
    v_permlane16_swap_b32 v28, v30
    v_permlane16_swap_b32 v29, v31
    s_nop 0
    v_permlane32_swap_b32 v28, v30
    v_permlane32_swap_b32 v29, v31
    v_permlane16_swap_b32 v32, v34
    v_permlane16_swap_b32 v33, v35
    s_nop 0
    v_permlane32_swap_b32 v32, v34
    v_permlane32_swap_b32 v33, v35
    v_permlane16_swap_b32 v36, v38
    v_permlane16_swap_b32 v37, v39
    s_nop 0
    v_permlane32_swap_b32 v36, v38
    v_permlane32_swap_b32 v37, v39
    v_permlane16_swap_b32 v40, v42
    v_permlane16_swap_b32 v41, v43
    s_nop 0
    v_permlane32_swap_b32 v40, v42
    v_permlane32_swap_b32 v41, v43
    v_permlane16_swap_b32 v44, v46
    v_permlane16_swap_b32 v45, v47
    s_nop 0
    v_permlane32_swap_b32 v44, v46
    v_permlane32_swap_b32 v45, v47
    s_mov_b32 s23, 0xffff0000
    v_lshlrev_b32 v48, 16, v16
    v_and_b32 v49, s23, v16
    v_lshlrev_b32 v50, 16, v17
    v_and_b32 v51, s23, v17
    v_lshlrev_b32 v52, 16, v18
    v_and_b32 v53, s23, v18
    v_lshlrev_b32 v54, 16, v19
    v_and_b32 v55, s23, v19
    v_lshlrev_b32 v56, 16, v20
    v_and_b32 v57, s23, v20
    v_lshlrev_b32 v58, 16, v21
    v_and_b32 v59, s23, v21
    v_lshlrev_b32 v60, 16, v22
    v_and_b32 v61, s23, v22
    v_lshlrev_b32 v62, 16, v23
    v_and_b32 v63, s23, v23
    v_lshlrev_b32 v64, 16, v24
    v_and_b32 v65, s23, v24
    v_lshlrev_b32 v66, 16, v25
    v_and_b32 v67, s23, v25
    v_lshlrev_b32 v68, 16, v26
    v_and_b32 v69, s23, v26
    v_lshlrev_b32 v70, 16, v27
    v_and_b32 v71, s23, v27
    v_lshlrev_b32 v72, 16, v28
    v_and_b32 v73, s23, v28
    v_lshlrev_b32 v74, 16, v29
    v_and_b32 v75, s23, v29
    v_lshlrev_b32 v76, 16, v30
    v_and_b32 v77, s23, v30
    v_lshlrev_b32 v78, 16, v31
    v_and_b32 v79, s23, v31
    v_lshlrev_b32 v80, 16, v32
    v_and_b32 v81, s23, v32
    v_lshlrev_b32 v82, 16, v33
    v_and_b32 v83, s23, v33
    v_lshlrev_b32 v84, 16, v34
    v_and_b32 v85, s23, v34
    v_lshlrev_b32 v86, 16, v35
    v_and_b32 v87, s23, v35
    v_lshlrev_b32 v88, 16, v36
    v_and_b32 v89, s23, v36
    v_lshlrev_b32 v90, 16, v37
    v_and_b32 v91, s23, v37
    v_lshlrev_b32 v92, 16, v38
    v_and_b32 v93, s23, v38
    v_lshlrev_b32 v94, 16, v39
    v_and_b32 v95, s23, v39
    v_lshlrev_b32 v96, 16, v40
    v_and_b32 v97, s23, v40
    v_lshlrev_b32 v98, 16, v41
    v_and_b32 v99, s23, v41
    v_lshlrev_b32 v100, 16, v42
    v_and_b32 v101, s23, v42
    v_lshlrev_b32 v102, 16, v43
    v_and_b32 v103, s23, v43
    v_lshlrev_b32 v104, 16, v44
    v_and_b32 v105, s23, v44
    v_lshlrev_b32 v106, 16, v45
    v_and_b32 v107, s23, v45
    v_lshlrev_b32 v108, 16, v46
    v_and_b32 v109, s23, v46
    v_lshlrev_b32 v110, 16, v47
    v_and_b32 v111, s23, v47
    s_lshl_b32 s22, s20, 2
    v_lshlrev_b32 v5, 4, v2
    v_add_u32 v6, s22, v5
    v_mov_b32 v8, v48
    v_mov_b32 v9, v49
    v_mov_b32 v10, v50
    v_mov_b32 v11, v51
    v_add_f32 v8, v8, v52
    v_add_f32 v9, v9, v53
    v_add_f32 v10, v10, v54
    v_add_f32 v11, v11, v55
    v_add_f32 v8, v8, v56
    v_add_f32 v9, v9, v57
    v_add_f32 v10, v10, v58
    v_add_f32 v11, v11, v59
    v_add_f32 v8, v8, v60
    v_add_f32 v9, v9, v61
    v_add_f32 v10, v10, v62
    v_add_f32 v11, v11, v63
    v_add_f32 v8, v8, v64
    v_add_f32 v9, v9, v65
    v_add_f32 v10, v10, v66
    v_add_f32 v11, v11, v67
    v_add_f32 v8, v8, v68
    v_add_f32 v9, v9, v69
    v_add_f32 v10, v10, v70
    v_add_f32 v11, v11, v71
    v_add_f32 v8, v8, v72
    v_add_f32 v9, v9, v73
    v_add_f32 v10, v10, v74
    v_add_f32 v11, v11, v75
    v_add_f32 v8, v8, v76
    v_add_f32 v9, v9, v77
    v_add_f32 v10, v10, v78
    v_add_f32 v11, v11, v79
    v_add_f32 v8, v8, v80
    v_add_f32 v9, v9, v81
    v_add_f32 v10, v10, v82
    v_add_f32 v11, v11, v83
    v_add_f32 v8, v8, v84
    v_add_f32 v9, v9, v85
    v_add_f32 v10, v10, v86
    v_add_f32 v11, v11, v87
    v_add_f32 v8, v8, v88
    v_add_f32 v9, v9, v89
    v_add_f32 v10, v10, v90
    v_add_f32 v11, v11, v91
    v_add_f32 v8, v8, v92
    v_add_f32 v9, v9, v93
    v_add_f32 v10, v10, v94
    v_add_f32 v11, v11, v95
    v_add_f32 v8, v8, v96
    v_add_f32 v9, v9, v97
    v_add_f32 v10, v10, v98
    v_add_f32 v11, v11, v99
    v_add_f32 v8, v8, v100
    v_add_f32 v9, v9, v101
    v_add_f32 v10, v10, v102
    v_add_f32 v11, v11, v103
    v_add_f32 v8, v8, v104
    v_add_f32 v9, v9, v105
    v_add_f32 v10, v10, v106
    v_add_f32 v11, v11, v107
    v_add_f32 v8, v8, v108
    v_add_f32 v9, v9, v109
    v_add_f32 v10, v10, v110
    v_add_f32 v11, v11, v111
    v_add_f32 v8, v8, v9
    v_add_f32 v10, v10, v11
    v_add_f32 v8, v8, v10
    v_mov_b32 v9, v8
    s_nop 1
    v_permlane32_swap_b32 v8, v9
    v_add_f32 v8, v8, v9
    v_mov_b32 v9, v8
    s_nop 1
    v_permlane16_swap_b32 v8, v9
    v_add_f32 v8, v8, v9
    ds_write_b32 v6, v8 offset:0
    s_waitcnt lgkmcnt(0)
    s_barrier
    ds_read_b128 v[8:11], v5 offset:0
    s_waitcnt lgkmcnt(0)
    v_add_f32 v8, v8, v9
    v_add_f32 v10, v10, v11
    v_add_f32 v8, v8, v10
    v_mul_f32 v8, 0x3a800000, v8
    v_sub_f32 v48, v48, v8
    v_sub_f32 v49, v49, v8
    v_sub_f32 v50, v50, v8
    v_sub_f32 v51, v51, v8
    v_sub_f32 v52, v52, v8
    v_sub_f32 v53, v53, v8
    v_sub_f32 v54, v54, v8
    v_sub_f32 v55, v55, v8
    v_sub_f32 v56, v56, v8
    v_sub_f32 v57, v57, v8
    v_sub_f32 v58, v58, v8
    v_sub_f32 v59, v59, v8
    v_sub_f32 v60, v60, v8
    v_sub_f32 v61, v61, v8
    v_sub_f32 v62, v62, v8
    v_sub_f32 v63, v63, v8
    v_sub_f32 v64, v64, v8
    v_sub_f32 v65, v65, v8
    v_sub_f32 v66, v66, v8
    v_sub_f32 v67, v67, v8
    v_sub_f32 v68, v68, v8
    v_sub_f32 v69, v69, v8
    v_sub_f32 v70, v70, v8
    v_sub_f32 v71, v71, v8
    v_sub_f32 v72, v72, v8
    v_sub_f32 v73, v73, v8
    v_sub_f32 v74, v74, v8
    v_sub_f32 v75, v75, v8
    v_sub_f32 v76, v76, v8
    v_sub_f32 v77, v77, v8
    v_sub_f32 v78, v78, v8
    v_sub_f32 v79, v79, v8
    v_sub_f32 v80, v80, v8
    v_sub_f32 v81, v81, v8
    v_sub_f32 v82, v82, v8
    v_sub_f32 v83, v83, v8
    v_sub_f32 v84, v84, v8
    v_sub_f32 v85, v85, v8
    v_sub_f32 v86, v86, v8
    v_sub_f32 v87, v87, v8
    v_sub_f32 v88, v88, v8
    v_sub_f32 v89, v89, v8
    v_sub_f32 v90, v90, v8
    v_sub_f32 v91, v91, v8
    v_sub_f32 v92, v92, v8
    v_sub_f32 v93, v93, v8
    v_sub_f32 v94, v94, v8
    v_sub_f32 v95, v95, v8
    v_sub_f32 v96, v96, v8
    v_sub_f32 v97, v97, v8
    v_sub_f32 v98, v98, v8
    v_sub_f32 v99, v99, v8
    v_sub_f32 v100, v100, v8
    v_sub_f32 v101, v101, v8
    v_sub_f32 v102, v102, v8
    v_sub_f32 v103, v103, v8
    v_sub_f32 v104, v104, v8
    v_sub_f32 v105, v105, v8
    v_sub_f32 v106, v106, v8
    v_sub_f32 v107, v107, v8
    v_sub_f32 v108, v108, v8
    v_sub_f32 v109, v109, v8
    v_sub_f32 v110, v110, v8
    v_sub_f32 v111, v111, v8
    v_mul_f32 v8, v48, v48
    v_mul_f32 v9, v49, v49
    v_mul_f32 v10, v50, v50
    v_mul_f32 v11, v51, v51
    v_fma_f32 v8, v52, v52, v8
    v_fma_f32 v9, v53, v53, v9
    v_fma_f32 v10, v54, v54, v10
    v_fma_f32 v11, v55, v55, v11
    v_fma_f32 v8, v56, v56, v8
    v_fma_f32 v9, v57, v57, v9
    v_fma_f32 v10, v58, v58, v10
    v_fma_f32 v11, v59, v59, v11
    v_fma_f32 v8, v60, v60, v8
    v_fma_f32 v9, v61, v61, v9
    v_fma_f32 v10, v62, v62, v10
    v_fma_f32 v11, v63, v63, v11
    v_fma_f32 v8, v64, v64, v8
    v_fma_f32 v9, v65, v65, v9
    v_fma_f32 v10, v66, v66, v10
    v_fma_f32 v11, v67, v67, v11
    v_fma_f32 v8, v68, v68, v8
    v_fma_f32 v9, v69, v69, v9
    v_fma_f32 v10, v70, v70, v10
    v_fma_f32 v11, v71, v71, v11
    v_fma_f32 v8, v72, v72, v8
    v_fma_f32 v9, v73, v73, v9
    v_fma_f32 v10, v74, v74, v10
    v_fma_f32 v11, v75, v75, v11
    v_fma_f32 v8, v76, v76, v8
    v_fma_f32 v9, v77, v77, v9
    v_fma_f32 v10, v78, v78, v10
    v_fma_f32 v11, v79, v79, v11
    v_fma_f32 v8, v80, v80, v8
    v_fma_f32 v9, v81, v81, v9
    v_fma_f32 v10, v82, v82, v10
    v_fma_f32 v11, v83, v83, v11
    v_fma_f32 v8, v84, v84, v8
    v_fma_f32 v9, v85, v85, v9
    v_fma_f32 v10, v86, v86, v10
    v_fma_f32 v11, v87, v87, v11
    v_fma_f32 v8, v88, v88, v8
    v_fma_f32 v9, v89, v89, v9
    v_fma_f32 v10, v90, v90, v10
    v_fma_f32 v11, v91, v91, v11
    v_fma_f32 v8, v92, v92, v8
    v_fma_f32 v9, v93, v93, v9
    v_fma_f32 v10, v94, v94, v10
    v_fma_f32 v11, v95, v95, v11
    v_fma_f32 v8, v96, v96, v8
    v_fma_f32 v9, v97, v97, v9
    v_fma_f32 v10, v98, v98, v10
    v_fma_f32 v11, v99, v99, v11
    v_fma_f32 v8, v100, v100, v8
    v_fma_f32 v9, v101, v101, v9
    v_fma_f32 v10, v102, v102, v10
    v_fma_f32 v11, v103, v103, v11
    v_fma_f32 v8, v104, v104, v8
    v_fma_f32 v9, v105, v105, v9
    v_fma_f32 v10, v106, v106, v10
    v_fma_f32 v11, v107, v107, v11
    v_fma_f32 v8, v108, v108, v8
    v_fma_f32 v9, v109, v109, v9
    v_fma_f32 v10, v110, v110, v10
    v_fma_f32 v11, v111, v111, v11
    v_add_f32 v8, v8, v9
    v_add_f32 v10, v10, v11
    v_add_f32 v8, v8, v10
    v_mov_b32 v9, v8
    s_nop 1
    v_permlane32_swap_b32 v8, v9
    v_add_f32 v8, v8, v9
    v_mov_b32 v9, v8
    s_nop 1
    v_permlane16_swap_b32 v8, v9
    v_add_f32 v8, v8, v9
    ds_write_b32 v6, v8 offset:256
    s_waitcnt lgkmcnt(0)
    s_barrier
    ds_read_b128 v[8:11], v5 offset:256
    s_waitcnt lgkmcnt(0)
    v_add_f32 v8, v8, v9
    v_add_f32 v10, v10, v11
    v_add_f32 v8, v8, v10
    v_mul_f32 v8, 0x3a800000, v8
    v_add_f32 v8, 0x3727c5ac, v8
    v_rsq_f32 v8, v8
    s_nop 0
    v_mul_f32 v48, v48, v8
    v_mul_f32 v49, v49, v8
    v_mul_f32 v50, v50, v8
    v_mul_f32 v51, v51, v8
    v_mul_f32 v52, v52, v8
    v_mul_f32 v53, v53, v8
    v_mul_f32 v54, v54, v8
    v_mul_f32 v55, v55, v8
    v_mul_f32 v56, v56, v8
    v_mul_f32 v57, v57, v8
    v_mul_f32 v58, v58, v8
    v_mul_f32 v59, v59, v8
    v_mul_f32 v60, v60, v8
    v_mul_f32 v61, v61, v8
    v_mul_f32 v62, v62, v8
    v_mul_f32 v63, v63, v8
    v_mul_f32 v64, v64, v8
    v_mul_f32 v65, v65, v8
    v_mul_f32 v66, v66, v8
    v_mul_f32 v67, v67, v8
    v_mul_f32 v68, v68, v8
    v_mul_f32 v69, v69, v8
    v_mul_f32 v70, v70, v8
    v_mul_f32 v71, v71, v8
    v_mul_f32 v72, v72, v8
    v_mul_f32 v73, v73, v8
    v_mul_f32 v74, v74, v8
    v_mul_f32 v75, v75, v8
    v_mul_f32 v76, v76, v8
    v_mul_f32 v77, v77, v8
    v_mul_f32 v78, v78, v8
    v_mul_f32 v79, v79, v8
    v_mul_f32 v80, v80, v8
    v_mul_f32 v81, v81, v8
    v_mul_f32 v82, v82, v8
    v_mul_f32 v83, v83, v8
    v_mul_f32 v84, v84, v8
    v_mul_f32 v85, v85, v8
    v_mul_f32 v86, v86, v8
    v_mul_f32 v87, v87, v8
    v_mul_f32 v88, v88, v8
    v_mul_f32 v89, v89, v8
    v_mul_f32 v90, v90, v8
    v_mul_f32 v91, v91, v8
    v_mul_f32 v92, v92, v8
    v_mul_f32 v93, v93, v8
    v_mul_f32 v94, v94, v8
    v_mul_f32 v95, v95, v8
    v_mul_f32 v96, v96, v8
    v_mul_f32 v97, v97, v8
    v_mul_f32 v98, v98, v8
    v_mul_f32 v99, v99, v8
    v_mul_f32 v100, v100, v8
    v_mul_f32 v101, v101, v8
    v_mul_f32 v102, v102, v8
    v_mul_f32 v103, v103, v8
    v_mul_f32 v104, v104, v8
    v_mul_f32 v105, v105, v8
    v_mul_f32 v106, v106, v8
    v_mul_f32 v107, v107, v8
    v_mul_f32 v108, v108, v8
    v_mul_f32 v109, v109, v8
    v_mul_f32 v110, v110, v8
    v_mul_f32 v111, v111, v8
    v_cvt_pk_bf16_f32 v16, v48, v49
    v_cvt_pk_bf16_f32 v17, v50, v51
    v_cvt_pk_bf16_f32 v18, v52, v53
    v_cvt_pk_bf16_f32 v19, v54, v55
    v_cvt_pk_bf16_f32 v20, v56, v57
    v_cvt_pk_bf16_f32 v21, v58, v59
    v_cvt_pk_bf16_f32 v22, v60, v61
    v_cvt_pk_bf16_f32 v23, v62, v63
    v_cvt_pk_bf16_f32 v24, v64, v65
    v_cvt_pk_bf16_f32 v25, v66, v67
    v_cvt_pk_bf16_f32 v26, v68, v69
    v_cvt_pk_bf16_f32 v27, v70, v71
    v_cvt_pk_bf16_f32 v28, v72, v73
    v_cvt_pk_bf16_f32 v29, v74, v75
    v_cvt_pk_bf16_f32 v30, v76, v77
    v_cvt_pk_bf16_f32 v31, v78, v79
    v_cvt_pk_bf16_f32 v32, v80, v81
    v_cvt_pk_bf16_f32 v33, v82, v83
    v_cvt_pk_bf16_f32 v34, v84, v85
    v_cvt_pk_bf16_f32 v35, v86, v87
    v_cvt_pk_bf16_f32 v36, v88, v89
    v_cvt_pk_bf16_f32 v37, v90, v91
    v_cvt_pk_bf16_f32 v38, v92, v93
    v_cvt_pk_bf16_f32 v39, v94, v95
    v_cvt_pk_bf16_f32 v40, v96, v97
    v_cvt_pk_bf16_f32 v41, v98, v99
    v_cvt_pk_bf16_f32 v42, v100, v101
    v_cvt_pk_bf16_f32 v43, v102, v103
    v_cvt_pk_bf16_f32 v44, v104, v105
    v_cvt_pk_bf16_f32 v45, v106, v107
    v_cvt_pk_bf16_f32 v46, v108, v109
    v_cvt_pk_bf16_f32 v47, v110, v111
    s_lshl_b32 s21, s26, 15
    s_lshl_b32 s22, s20, 13
    s_add_u32 s21, s21, s22
    v_lshlrev_b32 v4, 4, v1
    v_add_u32 v4, s21, v4
    s_mov_b32 s22, 0
    buffer_store_dwordx4 v[16:19], v4, s[12:15], s22 offen sc1
    s_mov_b32 s22, 1024
    buffer_store_dwordx4 v[20:23], v4, s[12:15], s22 offen sc1
    s_mov_b32 s22, 2048
    buffer_store_dwordx4 v[24:27], v4, s[12:15], s22 offen sc1
    s_mov_b32 s22, 3072
    buffer_store_dwordx4 v[28:31], v4, s[12:15], s22 offen sc1
    s_mov_b32 s22, 4096
    buffer_store_dwordx4 v[32:35], v4, s[12:15], s22 offen sc1
    s_mov_b32 s22, 5120
    buffer_store_dwordx4 v[36:39], v4, s[12:15], s22 offen sc1
    s_mov_b32 s22, 6144
    buffer_store_dwordx4 v[40:43], v4, s[12:15], s22 offen sc1
    s_mov_b32 s22, 7168
    buffer_store_dwordx4 v[44:47], v4, s[12:15], s22 offen sc1
    s_waitcnt vmcnt(13)
    s_lshr_b32 s21, s26, 4
    s_cmp_lg_u32 s21, 4
    v_mov_b32 v8, -1
    v_mov_b32 v9, -1
    v_mov_b32 v10, -1
    v_mov_b32 v11, -1
    s_cbranch_scc1 nomem_150
    v_min_u32 v8, -2, v120
    v_min_u32 v9, -2, v121
    v_min_u32 v10, -2, v122
    v_min_u32 v11, -2, v123
nomem_150:
    buffer_store_dwordx4 v[8:11], v124, s[16:19], 0 offen sc1
    s_waitcnt vmcnt(0)
    s_barrier
    s_cmp_lg_u32 s20, 0
    s_cbranch_scc1 lns_151
    v_mov_b32 v112, 1
    s_mov_b64 exec, 1
    s_cmp_ge_u32 s26, 16
    s_cbranch_scc1 lns_152
    s_lshr_b32 s21, s26, 3
    s_lshl_b32 s21, s21, 2
    buffer_atomic_add v112, off, s[72:75], s21 offset:80
lns_152:
    buffer_atomic_add v112, off, s[72:75], 0 offset:144
    s_mov_b64 exec, -1
lns_151:
    s_lshr_b32 s88, s92, 4
    s_lshl_b32 s46, s91, 4
    s_and_b32 s47, s92, 15
    s_add_u32 s46, s46, s47
    s_lshr_b32 s48, s46, 5
    s_and_b32 s46, s46, 31
    s_lshl_b32 s49, s48, 3
    s_add_u32 s50, s0, s49
    s_addc_u32 s51, s1, 0
    s_load_dwordx2 s[6:7], s[50:51], 24
    s_mov_b32 s24, s90
    s_and_b32 s25, s90, 1
    s_lshr_b32 s26, s90, 1
    v_mbcnt_lo_u32_b32 v1, -1, 0
    v_mbcnt_hi_u32_b32 v1, -1, v1
    s_waitcnt lgkmcnt(0)
    s_mov_b32 s8, s6
    s_mov_b32 s9, s7
    s_mov_b32 s10, 0x800000
    s_mov_b32 s11, 0x20000
    s_mov_b32 s12, s4
    s_mov_b32 s13, s5
    s_mov_b32 s14, 0x400000
    s_mov_b32 s15, 0x20000
    s_lshl_b32 s49, s48, 24
    s_add_u32 s50, s4, s49
    s_addc_u32 s51, s5, 0
    s_add_u32 s16, s50, 0x1400000
    s_addc_u32 s17, s51, 0
    s_mov_b32 s18, 0x1000000
    s_mov_b32 s19, 0x20000
    s_lshl_b32 s28, s88, 3
    s_mov_b32 s29, 0
    s_lshl_b32 s27, s46, 8
    s_lshl_b32 s49, s46, 7
    s_lshl_b32 s50, s25, 6
    s_add_u32 s39, s49, s50
    v_lshrrev_b32 v28, 2, v1
    v_and_b32 v29, 7, v28
    s_lshl_b32 s35, s25, 2
    v_xor_b32 v29, s35, v29
    v_lshlrev_b32 v28, 8, v28
    v_and_b32 v30, 3, v1
    v_lshl_add_u32 v28, v30, 3, v28
    s_mov_b32 s35, 0
    v_add_u32 v28, s35, v28
    v_xor_b32 v30, 0, v29
    v_lshl_add_u32 v2, v30, 5, v28
    v_add_u32 v10, 65536, v2
    v_xor_b32 v30, 1, v29
    v_lshl_add_u32 v3, v30, 5, v28
    v_add_u32 v11, 65536, v3
    v_xor_b32 v30, 2, v29
    v_lshl_add_u32 v4, v30, 5, v28
    v_add_u32 v12, 65536, v4
    v_xor_b32 v30, 3, v29
    v_lshl_add_u32 v5, v30, 5, v28
    v_add_u32 v13, 65536, v5
    s_mul_i32 s35, s26, 8192
    s_add_u32 s35, s35, 16384
    v_lshlrev_b32 v28, 4, v1
    v_add_u32 v18, s35, v28
    v_add_u32 v19, 65536, v18
    s_mul_i32 s35, s24, 2
    s_add_u32 s35, s35, s28
    s_mul_i32 s35, s35, 32
    s_add_u32 s35, s35, s29
    s_lshl_b32 s35, s35, 10
    v_add_u32 v24, s35, v28
    s_mul_i32 s35, s24, 2
    s_add_u32 s35, s35, s28
    s_mul_i32 s35, s35, 32
    s_add_u32 s35, s35, s29
    s_lshl_b32 s35, s35, 10
    v_add_u32 v25, s35, v28
    s_mul_i32 s35, s24, 2
    s_add_u32 s35, s35, 1
    s_add_u32 s35, s35, s28
    s_mul_i32 s35, s35, 32
    s_add_u32 s35, s35, s29
    s_add_i32 s35, s35, -2
    s_lshl_b32 s35, s35, 10
    v_add_u32 v26, s35, v28
    s_mul_i32 s35, s24, 2
    s_add_u32 s35, s35, 1
    s_add_u32 s35, s35, s28
    s_mul_i32 s35, s35, 32
    s_add_u32 s35, s35, s29
    s_add_i32 s35, s35, -2
    s_lshl_b32 s35, s35, 10
    v_add_u32 v27, s35, v28
    s_lshl_b32 s35, s24, 2
    s_and_b32 s35, s35, 15
    s_lshl_b32 s36, s29, 3
    s_add_u32 s35, s35, s36
    s_mul_i32 s35, s35, 32768
    s_add_u32 s35, s35, s27
    v_lshrrev_b32 v28, 4, v1
    s_mov_b32 s36, 8192
    v_mul_lo_u32 v29, v28, s36
    v_add_u32 v29, s35, v29
    v_and_b32 v30, 15, v1
    v_lshlrev_b32 v31, 1, v28
    v_xor_b32 v31, v31, v30
    v_lshl_add_u32 v20, v31, 4, v29
    v_lshlrev_b32 v31, 1, v28
    v_add_u32 v31, 8, v31
    v_xor_b32 v31, v31, v30
    v_lshl_add_u32 v21, v31, 4, v29
    v_add_u32 v21, 31744, v21
    v_lshlrev_b32 v31, 1, v28
    v_xor_b32 v31, v31, v30
    v_lshl_add_u32 v22, v31, 4, v29
    v_add_u32 v22, 63488, v22
    v_lshlrev_b32 v31, 1, v28
    v_add_u32 v31, 8, v31
    v_xor_b32 v31, v31, v30
    v_lshl_add_u32 v23, v31, 4, v29
    v_add_u32 v23, 95232, v23
    s_lshl_b32 s32, s24, 12
    s_mul_i32 s33, s24, 4096
    s_add_u32 s33, s33, 16384
    s_mov_b32 s30, 0
    s_mov_b32 s31, 0
    s_lshl_b32 s69, s88, 2
    s_cmp_lg_u32 s90, 0
    s_cbranch_scc1 dw_155
    s_mov_b32 s71, 0x8000
dw_153:
    buffer_load_dword v28, off, s[72:75], s69 offset:80 sc1
    s_waitcnt vmcnt(0)
dw_154:
    v_readfirstlane_b32 s70, v28
    s_nop 3
    s_cmp_ge_u32 s70, 8
    s_cbranch_scc1 dw_155
    s_sleep 2
    s_sub_u32 s71, s71, 1
    s_cbranch_scc0 dw_153
dw_155:
    s_barrier
    s_add_u32 m0, s32, 0
    s_nop 0
    buffer_load_dwordx4 v20, s[8:11], s30 offen offset:0 lds
    buffer_load_dwordx4 v21, s[8:11], s30 offen offset:1024 lds
    buffer_load_dwordx4 v22, s[8:11], s30 offen offset:2048 lds
    buffer_load_dwordx4 v23, s[8:11], s30 offen offset:3072 lds
    s_add_u32 m0, s33, 0
    s_nop 0
    buffer_load_dwordx4 v24, s[12:15], s31 offen offset:0 lds
    buffer_load_dwordx4 v25, s[12:15], s31 offen offset:1024 lds
    buffer_load_dwordx4 v26, s[12:15], s31 offen offset:2048 lds
    buffer_load_dwordx4 v27, s[12:15], s31 offen offset:3072 lds
    s_add_u32 s30, s30, 524288
    s_add_u32 s31, s31, 2048
    s_add_u32 m0, s32, 32768
    s_nop 0
    buffer_load_dwordx4 v20, s[8:11], s30 offen offset:0 lds
    buffer_load_dwordx4 v21, s[8:11], s30 offen offset:1024 lds
    buffer_load_dwordx4 v22, s[8:11], s30 offen offset:2048 lds
    buffer_load_dwordx4 v23, s[8:11], s30 offen offset:3072 lds
    s_add_u32 m0, s33, 32768
    s_nop 0
    buffer_load_dwordx4 v24, s[12:15], s31 offen offset:0 lds
    buffer_load_dwordx4 v25, s[12:15], s31 offen offset:1024 lds
    buffer_load_dwordx4 v26, s[12:15], s31 offen offset:2048 lds
    buffer_load_dwordx4 v27, s[12:15], s31 offen offset:3072 lds
    s_add_u32 s30, s30, 524288
    s_add_u32 s31, s31, 2048
    s_add_u32 m0, s32, 65536
    s_nop 0
    buffer_load_dwordx4 v20, s[8:11], s30 offen offset:0 lds
    buffer_load_dwordx4 v21, s[8:11], s30 offen offset:1024 lds
    buffer_load_dwordx4 v22, s[8:11], s30 offen offset:2048 lds
    buffer_load_dwordx4 v23, s[8:11], s30 offen offset:3072 lds
    s_add_u32 m0, s33, 65536
    s_nop 0
    buffer_load_dwordx4 v24, s[12:15], s31 offen offset:0 lds
    buffer_load_dwordx4 v25, s[12:15], s31 offen offset:1024 lds
    buffer_load_dwordx4 v26, s[12:15], s31 offen offset:2048 lds
    buffer_load_dwordx4 v27, s[12:15], s31 offen offset:3072 lds
    s_add_u32 s30, s30, 524288
    s_add_u32 s31, s31, 2048
    s_add_u32 m0, s32, 98304
    s_nop 0
    buffer_load_dwordx4 v20, s[8:11], s30 offen offset:0 lds
    buffer_load_dwordx4 v21, s[8:11], s30 offen offset:1024 lds
    buffer_load_dwordx4 v22, s[8:11], s30 offen offset:2048 lds
    buffer_load_dwordx4 v23, s[8:11], s30 offen offset:3072 lds
    s_add_u32 m0, s33, 98304
    s_nop 0
    buffer_load_dwordx4 v24, s[12:15], s31 offen offset:0 lds
    buffer_load_dwordx4 v25, s[12:15], s31 offen offset:1024 lds
    buffer_load_dwordx4 v26, s[12:15], s31 offen offset:2048 lds
    buffer_load_dwordx4 v27, s[12:15], s31 offen offset:3072 lds
    s_add_u32 s30, s30, 524288
    s_add_u32 s31, s31, 2048
    v_mov_b32 v32, 0
    v_mov_b32 v33, 0
    v_mov_b32 v34, 0
    v_mov_b32 v35, 0
    v_mov_b32 v36, 0
    v_mov_b32 v37, 0
    v_mov_b32 v38, 0
    v_mov_b32 v39, 0
    v_mov_b32 v40, 0
    v_mov_b32 v41, 0
    v_mov_b32 v42, 0
    v_mov_b32 v43, 0
    v_mov_b32 v44, 0
    v_mov_b32 v45, 0
    v_mov_b32 v46, 0
    v_mov_b32 v47, 0
    v_mov_b32 v48, 0
    v_mov_b32 v49, 0
    v_mov_b32 v50, 0
    v_mov_b32 v51, 0
    v_mov_b32 v52, 0
    v_mov_b32 v53, 0
    v_mov_b32 v54, 0
    v_mov_b32 v55, 0
    v_mov_b32 v56, 0
    v_mov_b32 v57, 0
    v_mov_b32 v58, 0
    v_mov_b32 v59, 0
    v_mov_b32 v60, 0
    v_mov_b32 v61, 0
    v_mov_b32 v62, 0
    v_mov_b32 v63, 0
    v_mov_b32 v64, 0
    v_mov_b32 v65, 0
    v_mov_b32 v66, 0
    v_mov_b32 v67, 0
    v_mov_b32 v68, 0
    v_mov_b32 v69, 0
    v_mov_b32 v70, 0
    v_mov_b32 v71, 0
    v_mov_b32 v72, 0
    v_mov_b32 v73, 0
    v_mov_b32 v74, 0
    v_mov_b32 v75, 0
    v_mov_b32 v76, 0
    v_mov_b32 v77, 0
    v_mov_b32 v78, 0
    v_mov_b32 v79, 0
    v_mov_b32 v80, 0
    v_mov_b32 v81, 0
    v_mov_b32 v82, 0
    v_mov_b32 v83, 0
    v_mov_b32 v84, 0
    v_mov_b32 v85, 0
    v_mov_b32 v86, 0
    v_mov_b32 v87, 0
    v_mov_b32 v88, 0
    v_mov_b32 v89, 0
    v_mov_b32 v90, 0
    v_mov_b32 v91, 0
    v_mov_b32 v92, 0
    v_mov_b32 v93, 0
    v_mov_b32 v94, 0
    v_mov_b32 v95, 0
    s_waitcnt vmcnt(24)
    s_barrier
    ds_read_b128 a[48:51], v18 offset:0
    ds_read_b128 a[52:55], v18 offset:2048
    ds_read_b128 a[56:59], v18 offset:4096
    ds_read_b128 a[60:63], v18 offset:6144
    ds_read_b64_tr_b16 a[32:33], v2 offset:0
    ds_read_b64_tr_b16 a[34:35], v2 offset:4096
    ds_read_b64_tr_b16 a[36:37], v3 offset:0
    ds_read_b64_tr_b16 a[38:39], v3 offset:4096
    ds_read_b64_tr_b16 a[40:41], v4 offset:0
    ds_read_b64_tr_b16 a[42:43], v4 offset:4096
    ds_read_b64_tr_b16 a[44:45], v5 offset:0
    ds_read_b64_tr_b16 a[46:47], v5 offset:4096
    s_mov_b32 s34, 3
k0_loop_156:
    s_waitcnt lgkmcnt(0)
    v_mfma_f32_16x16x32_bf16 v[32:35], a[32:35], a[48:51], v[32:35]
    ds_read_b128 a[80:83], v18 offset:1024
    ds_read_b128 a[84:87], v18 offset:3072
    v_mfma_f32_16x16x32_bf16 v[36:39], a[32:35], a[52:55], v[36:39]
    ds_read_b128 a[88:91], v18 offset:5120
    v_mfma_f32_16x16x32_bf16 v[40:43], a[32:35], a[56:59], v[40:43]
    ds_read_b128 a[92:95], v18 offset:7168
    v_mfma_f32_16x16x32_bf16 v[44:47], a[32:35], a[60:63], v[44:47]
    ds_read_b64_tr_b16 a[64:65], v2 offset:8192
    v_mfma_f32_16x16x32_bf16 v[48:51], a[36:39], a[48:51], v[48:51]
    ds_read_b64_tr_b16 a[66:67], v2 offset:12288
    v_mfma_f32_16x16x32_bf16 v[52:55], a[36:39], a[52:55], v[52:55]
    ds_read_b64_tr_b16 a[68:69], v3 offset:8192
    ds_read_b64_tr_b16 a[70:71], v3 offset:12288
    v_mfma_f32_16x16x32_bf16 v[56:59], a[36:39], a[56:59], v[56:59]
    ds_read_b64_tr_b16 a[72:73], v4 offset:8192
    v_mfma_f32_16x16x32_bf16 v[60:63], a[36:39], a[60:63], v[60:63]
    ds_read_b64_tr_b16 a[74:75], v4 offset:12288
    v_mfma_f32_16x16x32_bf16 v[64:67], a[40:43], a[48:51], v[64:67]
    ds_read_b64_tr_b16 a[76:77], v5 offset:8192
    v_mfma_f32_16x16x32_bf16 v[68:71], a[40:43], a[52:55], v[68:71]
    ds_read_b64_tr_b16 a[78:79], v5 offset:12288
    v_mfma_f32_16x16x32_bf16 v[72:75], a[40:43], a[56:59], v[72:75]
    v_mfma_f32_16x16x32_bf16 v[76:79], a[40:43], a[60:63], v[76:79]
    v_mfma_f32_16x16x32_bf16 v[80:83], a[44:47], a[48:51], v[80:83]
    v_mfma_f32_16x16x32_bf16 v[84:87], a[44:47], a[52:55], v[84:87]
    v_mfma_f32_16x16x32_bf16 v[88:91], a[44:47], a[56:59], v[88:91]
    v_mfma_f32_16x16x32_bf16 v[92:95], a[44:47], a[60:63], v[92:95]
    s_waitcnt vmcnt(16) lgkmcnt(0)
    s_barrier
    v_mfma_f32_16x16x32_bf16 v[32:35], a[64:67], a[80:83], v[32:35]
    ds_read_b128 a[48:51], v18 offset:32768
    ds_read_b128 a[52:55], v18 offset:34816
    s_add_u32 m0, s32, 0
    v_mfma_f32_16x16x32_bf16 v[36:39], a[64:67], a[84:87], v[36:39]
    ds_read_b128 a[56:59], v18 offset:36864
    buffer_load_dwordx4 v20, s[8:11], s30 offen offset:0 lds
    v_mfma_f32_16x16x32_bf16 v[40:43], a[64:67], a[88:91], v[40:43]
    ds_read_b128 a[60:63], v18 offset:38912
    buffer_load_dwordx4 v21, s[8:11], s30 offen offset:1024 lds
    v_mfma_f32_16x16x32_bf16 v[44:47], a[64:67], a[92:95], v[44:47]
    ds_read_b64_tr_b16 a[32:33], v2 offset:32768
    v_mfma_f32_16x16x32_bf16 v[48:51], a[68:71], a[80:83], v[48:51]
    ds_read_b64_tr_b16 a[34:35], v2 offset:36864
    buffer_load_dwordx4 v22, s[8:11], s30 offen offset:2048 lds
    v_mfma_f32_16x16x32_bf16 v[52:55], a[68:71], a[84:87], v[52:55]
    ds_read_b64_tr_b16 a[36:37], v3 offset:32768
    ds_read_b64_tr_b16 a[38:39], v3 offset:36864
    buffer_load_dwordx4 v23, s[8:11], s30 offen offset:3072 lds
    v_mfma_f32_16x16x32_bf16 v[56:59], a[68:71], a[88:91], v[56:59]
    ds_read_b64_tr_b16 a[40:41], v4 offset:32768
    s_add_u32 m0, s33, 0
    v_mfma_f32_16x16x32_bf16 v[60:63], a[68:71], a[92:95], v[60:63]
    ds_read_b64_tr_b16 a[42:43], v4 offset:36864
    v_mfma_f32_16x16x32_bf16 v[64:67], a[72:75], a[80:83], v[64:67]
    ds_read_b64_tr_b16 a[44:45], v5 offset:32768
    buffer_load_dwordx4 v24, s[12:15], s31 offen offset:0 lds
    v_mfma_f32_16x16x32_bf16 v[68:71], a[72:75], a[84:87], v[68:71]
    ds_read_b64_tr_b16 a[46:47], v5 offset:36864
    buffer_load_dwordx4 v25, s[12:15], s31 offen offset:1024 lds
    v_mfma_f32_16x16x32_bf16 v[72:75], a[72:75], a[88:91], v[72:75]
    buffer_load_dwordx4 v26, s[12:15], s31 offen offset:2048 lds
    v_mfma_f32_16x16x32_bf16 v[76:79], a[72:75], a[92:95], v[76:79]
    v_mfma_f32_16x16x32_bf16 v[80:83], a[76:79], a[80:83], v[80:83]
    buffer_load_dwordx4 v27, s[12:15], s31 offen offset:3072 lds
    v_mfma_f32_16x16x32_bf16 v[84:87], a[76:79], a[84:87], v[84:87]
    s_add_u32 s30, s30, 524288
    v_mfma_f32_16x16x32_bf16 v[88:91], a[76:79], a[88:91], v[88:91]
    s_add_u32 s31, s31, 2048
    v_mfma_f32_16x16x32_bf16 v[92:95], a[76:79], a[92:95], v[92:95]
    s_waitcnt lgkmcnt(0)
    v_mfma_f32_16x16x32_bf16 v[32:35], a[32:35], a[48:51], v[32:35]
    ds_read_b128 a[80:83], v18 offset:33792
    ds_read_b128 a[84:87], v18 offset:35840
    v_mfma_f32_16x16x32_bf16 v[36:39], a[32:35], a[52:55], v[36:39]
    ds_read_b128 a[88:91], v18 offset:37888
    v_mfma_f32_16x16x32_bf16 v[40:43], a[32:35], a[56:59], v[40:43]
    ds_read_b128 a[92:95], v18 offset:39936
    v_mfma_f32_16x16x32_bf16 v[44:47], a[32:35], a[60:63], v[44:47]
    ds_read_b64_tr_b16 a[64:65], v2 offset:40960
    v_mfma_f32_16x16x32_bf16 v[48:51], a[36:39], a[48:51], v[48:51]
    ds_read_b64_tr_b16 a[66:67], v2 offset:45056
    v_mfma_f32_16x16x32_bf16 v[52:55], a[36:39], a[52:55], v[52:55]
    ds_read_b64_tr_b16 a[68:69], v3 offset:40960
    ds_read_b64_tr_b16 a[70:71], v3 offset:45056
    v_mfma_f32_16x16x32_bf16 v[56:59], a[36:39], a[56:59], v[56:59]
    ds_read_b64_tr_b16 a[72:73], v4 offset:40960
    v_mfma_f32_16x16x32_bf16 v[60:63], a[36:39], a[60:63], v[60:63]
    ds_read_b64_tr_b16 a[74:75], v4 offset:45056
    v_mfma_f32_16x16x32_bf16 v[64:67], a[40:43], a[48:51], v[64:67]
    ds_read_b64_tr_b16 a[76:77], v5 offset:40960
    v_mfma_f32_16x16x32_bf16 v[68:71], a[40:43], a[52:55], v[68:71]
    ds_read_b64_tr_b16 a[78:79], v5 offset:45056
    v_mfma_f32_16x16x32_bf16 v[72:75], a[40:43], a[56:59], v[72:75]
    v_mfma_f32_16x16x32_bf16 v[76:79], a[40:43], a[60:63], v[76:79]
    v_mfma_f32_16x16x32_bf16 v[80:83], a[44:47], a[48:51], v[80:83]
    v_mfma_f32_16x16x32_bf16 v[84:87], a[44:47], a[52:55], v[84:87]
    v_mfma_f32_16x16x32_bf16 v[88:91], a[44:47], a[56:59], v[88:91]
    v_mfma_f32_16x16x32_bf16 v[92:95], a[44:47], a[60:63], v[92:95]
    s_waitcnt vmcnt(16) lgkmcnt(0)
    s_barrier
    v_mfma_f32_16x16x32_bf16 v[32:35], a[64:67], a[80:83], v[32:35]
    ds_read_b128 a[48:51], v19 offset:0
    ds_read_b128 a[52:55], v19 offset:2048
    s_add_u32 m0, s32, 32768
    v_mfma_f32_16x16x32_bf16 v[36:39], a[64:67], a[84:87], v[36:39]
    ds_read_b128 a[56:59], v19 offset:4096
    buffer_load_dwordx4 v20, s[8:11], s30 offen offset:0 lds
    v_mfma_f32_16x16x32_bf16 v[40:43], a[64:67], a[88:91], v[40:43]
    ds_read_b128 a[60:63], v19 offset:6144
    buffer_load_dwordx4 v21, s[8:11], s30 offen offset:1024 lds
    v_mfma_f32_16x16x32_bf16 v[44:47], a[64:67], a[92:95], v[44:47]
    ds_read_b64_tr_b16 a[32:33], v10 offset:0
    v_mfma_f32_16x16x32_bf16 v[48:51], a[68:71], a[80:83], v[48:51]
    ds_read_b64_tr_b16 a[34:35], v10 offset:4096
    buffer_load_dwordx4 v22, s[8:11], s30 offen offset:2048 lds
    v_mfma_f32_16x16x32_bf16 v[52:55], a[68:71], a[84:87], v[52:55]
    ds_read_b64_tr_b16 a[36:37], v11 offset:0
    ds_read_b64_tr_b16 a[38:39], v11 offset:4096
    buffer_load_dwordx4 v23, s[8:11], s30 offen offset:3072 lds
    v_mfma_f32_16x16x32_bf16 v[56:59], a[68:71], a[88:91], v[56:59]
    ds_read_b64_tr_b16 a[40:41], v12 offset:0
    s_add_u32 m0, s33, 32768
    v_mfma_f32_16x16x32_bf16 v[60:63], a[68:71], a[92:95], v[60:63]
    ds_read_b64_tr_b16 a[42:43], v12 offset:4096
    v_mfma_f32_16x16x32_bf16 v[64:67], a[72:75], a[80:83], v[64:67]
    ds_read_b64_tr_b16 a[44:45], v13 offset:0
    buffer_load_dwordx4 v24, s[12:15], s31 offen offset:0 lds
    v_mfma_f32_16x16x32_bf16 v[68:71], a[72:75], a[84:87], v[68:71]
    ds_read_b64_tr_b16 a[46:47], v13 offset:4096
    buffer_load_dwordx4 v25, s[12:15], s31 offen offset:1024 lds
    v_mfma_f32_16x16x32_bf16 v[72:75], a[72:75], a[88:91], v[72:75]
    buffer_load_dwordx4 v26, s[12:15], s31 offen offset:2048 lds
    v_mfma_f32_16x16x32_bf16 v[76:79], a[72:75], a[92:95], v[76:79]
    v_mfma_f32_16x16x32_bf16 v[80:83], a[76:79], a[80:83], v[80:83]
    buffer_load_dwordx4 v27, s[12:15], s31 offen offset:3072 lds
    v_mfma_f32_16x16x32_bf16 v[84:87], a[76:79], a[84:87], v[84:87]
    s_add_u32 s30, s30, 524288
    v_mfma_f32_16x16x32_bf16 v[88:91], a[76:79], a[88:91], v[88:91]
    s_add_u32 s31, s31, 2048
    v_mfma_f32_16x16x32_bf16 v[92:95], a[76:79], a[92:95], v[92:95]
    s_waitcnt lgkmcnt(0)
    v_mfma_f32_16x16x32_bf16 v[32:35], a[32:35], a[48:51], v[32:35]
    ds_read_b128 a[80:83], v19 offset:1024
    ds_read_b128 a[84:87], v19 offset:3072
    v_mfma_f32_16x16x32_bf16 v[36:39], a[32:35], a[52:55], v[36:39]
    ds_read_b128 a[88:91], v19 offset:5120
    v_mfma_f32_16x16x32_bf16 v[40:43], a[32:35], a[56:59], v[40:43]
    ds_read_b128 a[92:95], v19 offset:7168
    v_mfma_f32_16x16x32_bf16 v[44:47], a[32:35], a[60:63], v[44:47]
    ds_read_b64_tr_b16 a[64:65], v10 offset:8192
    v_mfma_f32_16x16x32_bf16 v[48:51], a[36:39], a[48:51], v[48:51]
    ds_read_b64_tr_b16 a[66:67], v10 offset:12288
    v_mfma_f32_16x16x32_bf16 v[52:55], a[36:39], a[52:55], v[52:55]
    ds_read_b64_tr_b16 a[68:69], v11 offset:8192
    ds_read_b64_tr_b16 a[70:71], v11 offset:12288
    v_mfma_f32_16x16x32_bf16 v[56:59], a[36:39], a[56:59], v[56:59]
    ds_read_b64_tr_b16 a[72:73], v12 offset:8192
    v_mfma_f32_16x16x32_bf16 v[60:63], a[36:39], a[60:63], v[60:63]
    ds_read_b64_tr_b16 a[74:75], v12 offset:12288
    v_mfma_f32_16x16x32_bf16 v[64:67], a[40:43], a[48:51], v[64:67]
    ds_read_b64_tr_b16 a[76:77], v13 offset:8192
    v_mfma_f32_16x16x32_bf16 v[68:71], a[40:43], a[52:55], v[68:71]
    ds_read_b64_tr_b16 a[78:79], v13 offset:12288
    v_mfma_f32_16x16x32_bf16 v[72:75], a[40:43], a[56:59], v[72:75]
    v_mfma_f32_16x16x32_bf16 v[76:79], a[40:43], a[60:63], v[76:79]
    v_mfma_f32_16x16x32_bf16 v[80:83], a[44:47], a[48:51], v[80:83]
    v_mfma_f32_16x16x32_bf16 v[84:87], a[44:47], a[52:55], v[84:87]
    v_mfma_f32_16x16x32_bf16 v[88:91], a[44:47], a[56:59], v[88:91]
    v_mfma_f32_16x16x32_bf16 v[92:95], a[44:47], a[60:63], v[92:95]
    s_waitcnt vmcnt(16) lgkmcnt(0)
    s_barrier
    v_mfma_f32_16x16x32_bf16 v[32:35], a[64:67], a[80:83], v[32:35]
    ds_read_b128 a[48:51], v19 offset:32768
    ds_read_b128 a[52:55], v19 offset:34816
    s_add_u32 m0, s32, 65536
    v_mfma_f32_16x16x32_bf16 v[36:39], a[64:67], a[84:87], v[36:39]
    ds_read_b128 a[56:59], v19 offset:36864
    buffer_load_dwordx4 v20, s[8:11], s30 offen offset:0 lds
    v_mfma_f32_16x16x32_bf16 v[40:43], a[64:67], a[88:91], v[40:43]
    ds_read_b128 a[60:63], v19 offset:38912
    buffer_load_dwordx4 v21, s[8:11], s30 offen offset:1024 lds
    v_mfma_f32_16x16x32_bf16 v[44:47], a[64:67], a[92:95], v[44:47]
    ds_read_b64_tr_b16 a[32:33], v10 offset:32768
    v_mfma_f32_16x16x32_bf16 v[48:51], a[68:71], a[80:83], v[48:51]
    ds_read_b64_tr_b16 a[34:35], v10 offset:36864
    buffer_load_dwordx4 v22, s[8:11], s30 offen offset:2048 lds
    v_mfma_f32_16x16x32_bf16 v[52:55], a[68:71], a[84:87], v[52:55]
    ds_read_b64_tr_b16 a[36:37], v11 offset:32768
    ds_read_b64_tr_b16 a[38:39], v11 offset:36864
    buffer_load_dwordx4 v23, s[8:11], s30 offen offset:3072 lds
    v_mfma_f32_16x16x32_bf16 v[56:59], a[68:71], a[88:91], v[56:59]
    ds_read_b64_tr_b16 a[40:41], v12 offset:32768
    s_add_u32 m0, s33, 65536
    v_mfma_f32_16x16x32_bf16 v[60:63], a[68:71], a[92:95], v[60:63]
    ds_read_b64_tr_b16 a[42:43], v12 offset:36864
    v_mfma_f32_16x16x32_bf16 v[64:67], a[72:75], a[80:83], v[64:67]
    ds_read_b64_tr_b16 a[44:45], v13 offset:32768
    buffer_load_dwordx4 v24, s[12:15], s31 offen offset:0 lds
    v_mfma_f32_16x16x32_bf16 v[68:71], a[72:75], a[84:87], v[68:71]
    ds_read_b64_tr_b16 a[46:47], v13 offset:36864
    buffer_load_dwordx4 v25, s[12:15], s31 offen offset:1024 lds
    v_mfma_f32_16x16x32_bf16 v[72:75], a[72:75], a[88:91], v[72:75]
    buffer_load_dwordx4 v26, s[12:15], s31 offen offset:2048 lds
    v_mfma_f32_16x16x32_bf16 v[76:79], a[72:75], a[92:95], v[76:79]
    v_mfma_f32_16x16x32_bf16 v[80:83], a[76:79], a[80:83], v[80:83]
    buffer_load_dwordx4 v27, s[12:15], s31 offen offset:3072 lds
    v_mfma_f32_16x16x32_bf16 v[84:87], a[76:79], a[84:87], v[84:87]
    s_add_u32 s30, s30, 524288
    v_mfma_f32_16x16x32_bf16 v[88:91], a[76:79], a[88:91], v[88:91]
    s_add_u32 s31, s31, 2048
    v_mfma_f32_16x16x32_bf16 v[92:95], a[76:79], a[92:95], v[92:95]
    s_waitcnt lgkmcnt(0)
    v_mfma_f32_16x16x32_bf16 v[32:35], a[32:35], a[48:51], v[32:35]
    ds_read_b128 a[80:83], v19 offset:33792
    ds_read_b128 a[84:87], v19 offset:35840
    v_mfma_f32_16x16x32_bf16 v[36:39], a[32:35], a[52:55], v[36:39]
    ds_read_b128 a[88:91], v19 offset:37888
    v_mfma_f32_16x16x32_bf16 v[40:43], a[32:35], a[56:59], v[40:43]
    ds_read_b128 a[92:95], v19 offset:39936
    v_mfma_f32_16x16x32_bf16 v[44:47], a[32:35], a[60:63], v[44:47]
    ds_read_b64_tr_b16 a[64:65], v10 offset:40960
    v_mfma_f32_16x16x32_bf16 v[48:51], a[36:39], a[48:51], v[48:51]
    ds_read_b64_tr_b16 a[66:67], v10 offset:45056
    v_mfma_f32_16x16x32_bf16 v[52:55], a[36:39], a[52:55], v[52:55]
    ds_read_b64_tr_b16 a[68:69], v11 offset:40960
    ds_read_b64_tr_b16 a[70:71], v11 offset:45056
    v_mfma_f32_16x16x32_bf16 v[56:59], a[36:39], a[56:59], v[56:59]
    ds_read_b64_tr_b16 a[72:73], v12 offset:40960
    v_mfma_f32_16x16x32_bf16 v[60:63], a[36:39], a[60:63], v[60:63]
    ds_read_b64_tr_b16 a[74:75], v12 offset:45056
    v_mfma_f32_16x16x32_bf16 v[64:67], a[40:43], a[48:51], v[64:67]
    ds_read_b64_tr_b16 a[76:77], v13 offset:40960
    v_mfma_f32_16x16x32_bf16 v[68:71], a[40:43], a[52:55], v[68:71]
    ds_read_b64_tr_b16 a[78:79], v13 offset:45056
    v_mfma_f32_16x16x32_bf16 v[72:75], a[40:43], a[56:59], v[72:75]
    v_mfma_f32_16x16x32_bf16 v[76:79], a[40:43], a[60:63], v[76:79]
    v_mfma_f32_16x16x32_bf16 v[80:83], a[44:47], a[48:51], v[80:83]
    v_mfma_f32_16x16x32_bf16 v[84:87], a[44:47], a[52:55], v[84:87]
    v_mfma_f32_16x16x32_bf16 v[88:91], a[44:47], a[56:59], v[88:91]
    v_mfma_f32_16x16x32_bf16 v[92:95], a[44:47], a[60:63], v[92:95]
    s_waitcnt vmcnt(16) lgkmcnt(0)
    s_barrier
    v_mfma_f32_16x16x32_bf16 v[32:35], a[64:67], a[80:83], v[32:35]
    ds_read_b128 a[48:51], v18 offset:0
    ds_read_b128 a[52:55], v18 offset:2048
    s_add_u32 m0, s32, 98304
    v_mfma_f32_16x16x32_bf16 v[36:39], a[64:67], a[84:87], v[36:39]
    ds_read_b128 a[56:59], v18 offset:4096
    buffer_load_dwordx4 v20, s[8:11], s30 offen offset:0 lds
    v_mfma_f32_16x16x32_bf16 v[40:43], a[64:67], a[88:91], v[40:43]
    ds_read_b128 a[60:63], v18 offset:6144
    buffer_load_dwordx4 v21, s[8:11], s30 offen offset:1024 lds
    v_mfma_f32_16x16x32_bf16 v[44:47], a[64:67], a[92:95], v[44:47]
    ds_read_b64_tr_b16 a[32:33], v2 offset:0
    v_mfma_f32_16x16x32_bf16 v[48:51], a[68:71], a[80:83], v[48:51]
    ds_read_b64_tr_b16 a[34:35], v2 offset:4096
    buffer_load_dwordx4 v22, s[8:11], s30 offen offset:2048 lds
    v_mfma_f32_16x16x32_bf16 v[52:55], a[68:71], a[84:87], v[52:55]
    ds_read_b64_tr_b16 a[36:37], v3 offset:0
    ds_read_b64_tr_b16 a[38:39], v3 offset:4096
    buffer_load_dwordx4 v23, s[8:11], s30 offen offset:3072 lds
    v_mfma_f32_16x16x32_bf16 v[56:59], a[68:71], a[88:91], v[56:59]
    ds_read_b64_tr_b16 a[40:41], v4 offset:0
    s_add_u32 m0, s33, 98304
    v_mfma_f32_16x16x32_bf16 v[60:63], a[68:71], a[92:95], v[60:63]
    ds_read_b64_tr_b16 a[42:43], v4 offset:4096
    v_mfma_f32_16x16x32_bf16 v[64:67], a[72:75], a[80:83], v[64:67]
    ds_read_b64_tr_b16 a[44:45], v5 offset:0
    buffer_load_dwordx4 v24, s[12:15], s31 offen offset:0 lds
    v_mfma_f32_16x16x32_bf16 v[68:71], a[72:75], a[84:87], v[68:71]
    ds_read_b64_tr_b16 a[46:47], v5 offset:4096
    buffer_load_dwordx4 v25, s[12:15], s31 offen offset:1024 lds
    v_mfma_f32_16x16x32_bf16 v[72:75], a[72:75], a[88:91], v[72:75]
    buffer_load_dwordx4 v26, s[12:15], s31 offen offset:2048 lds
    v_mfma_f32_16x16x32_bf16 v[76:79], a[72:75], a[92:95], v[76:79]
    v_mfma_f32_16x16x32_bf16 v[80:83], a[76:79], a[80:83], v[80:83]
    buffer_load_dwordx4 v27, s[12:15], s31 offen offset:3072 lds
    v_mfma_f32_16x16x32_bf16 v[84:87], a[76:79], a[84:87], v[84:87]
    s_add_u32 s30, s30, 524288
    v_mfma_f32_16x16x32_bf16 v[88:91], a[76:79], a[88:91], v[88:91]
    s_add_u32 s31, s31, 2048
    v_mfma_f32_16x16x32_bf16 v[92:95], a[76:79], a[92:95], v[92:95]
    s_sub_u32 s34, s34, 1
    s_cmp_lg_u32 s34, 0
    s_cbranch_scc1 k0_loop_156
    s_waitcnt lgkmcnt(0)
    v_mfma_f32_16x16x32_bf16 v[32:35], a[32:35], a[48:51], v[32:35]
    ds_read_b128 a[80:83], v18 offset:1024
    ds_read_b128 a[84:87], v18 offset:3072
    v_mfma_f32_16x16x32_bf16 v[36:39], a[32:35], a[52:55], v[36:39]
    ds_read_b128 a[88:91], v18 offset:5120
    v_mfma_f32_16x16x32_bf16 v[40:43], a[32:35], a[56:59], v[40:43]
    ds_read_b128 a[92:95], v18 offset:7168
    v_mfma_f32_16x16x32_bf16 v[44:47], a[32:35], a[60:63], v[44:47]
    ds_read_b64_tr_b16 a[64:65], v2 offset:8192
    v_mfma_f32_16x16x32_bf16 v[48:51], a[36:39], a[48:51], v[48:51]
    ds_read_b64_tr_b16 a[66:67], v2 offset:12288
    v_mfma_f32_16x16x32_bf16 v[52:55], a[36:39], a[52:55], v[52:55]
    ds_read_b64_tr_b16 a[68:69], v3 offset:8192
    ds_read_b64_tr_b16 a[70:71], v3 offset:12288
    v_mfma_f32_16x16x32_bf16 v[56:59], a[36:39], a[56:59], v[56:59]
    ds_read_b64_tr_b16 a[72:73], v4 offset:8192
    v_mfma_f32_16x16x32_bf16 v[60:63], a[36:39], a[60:63], v[60:63]
    ds_read_b64_tr_b16 a[74:75], v4 offset:12288
    v_mfma_f32_16x16x32_bf16 v[64:67], a[40:43], a[48:51], v[64:67]
    ds_read_b64_tr_b16 a[76:77], v5 offset:8192
    v_mfma_f32_16x16x32_bf16 v[68:71], a[40:43], a[52:55], v[68:71]
    ds_read_b64_tr_b16 a[78:79], v5 offset:12288
    v_mfma_f32_16x16x32_bf16 v[72:75], a[40:43], a[56:59], v[72:75]
    v_mfma_f32_16x16x32_bf16 v[76:79], a[40:43], a[60:63], v[76:79]
    v_mfma_f32_16x16x32_bf16 v[80:83], a[44:47], a[48:51], v[80:83]
    v_mfma_f32_16x16x32_bf16 v[84:87], a[44:47], a[52:55], v[84:87]
    v_mfma_f32_16x16x32_bf16 v[88:91], a[44:47], a[56:59], v[88:91]
    v_mfma_f32_16x16x32_bf16 v[92:95], a[44:47], a[60:63], v[92:95]
    s_waitcnt vmcnt(16) lgkmcnt(0)
    s_barrier
    v_mfma_f32_16x16x32_bf16 v[32:35], a[64:67], a[80:83], v[32:35]
    ds_read_b128 a[48:51], v18 offset:32768
    ds_read_b128 a[52:55], v18 offset:34816
    v_mfma_f32_16x16x32_bf16 v[36:39], a[64:67], a[84:87], v[36:39]
    ds_read_b128 a[56:59], v18 offset:36864
    v_mfma_f32_16x16x32_bf16 v[40:43], a[64:67], a[88:91], v[40:43]
    ds_read_b128 a[60:63], v18 offset:38912
    v_mfma_f32_16x16x32_bf16 v[44:47], a[64:67], a[92:95], v[44:47]
    ds_read_b64_tr_b16 a[32:33], v2 offset:32768
    v_mfma_f32_16x16x32_bf16 v[48:51], a[68:71], a[80:83], v[48:51]
    ds_read_b64_tr_b16 a[34:35], v2 offset:36864
    v_mfma_f32_16x16x32_bf16 v[52:55], a[68:71], a[84:87], v[52:55]
    ds_read_b64_tr_b16 a[36:37], v3 offset:32768
    ds_read_b64_tr_b16 a[38:39], v3 offset:36864
    v_mfma_f32_16x16x32_bf16 v[56:59], a[68:71], a[88:91], v[56:59]
    ds_read_b64_tr_b16 a[40:41], v4 offset:32768
    v_mfma_f32_16x16x32_bf16 v[60:63], a[68:71], a[92:95], v[60:63]
    ds_read_b64_tr_b16 a[42:43], v4 offset:36864
    v_mfma_f32_16x16x32_bf16 v[64:67], a[72:75], a[80:83], v[64:67]
    ds_read_b64_tr_b16 a[44:45], v5 offset:32768
    v_mfma_f32_16x16x32_bf16 v[68:71], a[72:75], a[84:87], v[68:71]
    ds_read_b64_tr_b16 a[46:47], v5 offset:36864
    v_mfma_f32_16x16x32_bf16 v[72:75], a[72:75], a[88:91], v[72:75]
    v_mfma_f32_16x16x32_bf16 v[76:79], a[72:75], a[92:95], v[76:79]
    v_mfma_f32_16x16x32_bf16 v[80:83], a[76:79], a[80:83], v[80:83]
    v_mfma_f32_16x16x32_bf16 v[84:87], a[76:79], a[84:87], v[84:87]
    v_mfma_f32_16x16x32_bf16 v[88:91], a[76:79], a[88:91], v[88:91]
    v_mfma_f32_16x16x32_bf16 v[92:95], a[76:79], a[92:95], v[92:95]
    s_waitcnt lgkmcnt(0)
    v_mfma_f32_16x16x32_bf16 v[32:35], a[32:35], a[48:51], v[32:35]
    ds_read_b128 a[80:83], v18 offset:33792
    ds_read_b128 a[84:87], v18 offset:35840
    v_mfma_f32_16x16x32_bf16 v[36:39], a[32:35], a[52:55], v[36:39]
    ds_read_b128 a[88:91], v18 offset:37888
    v_mfma_f32_16x16x32_bf16 v[40:43], a[32:35], a[56:59], v[40:43]
    ds_read_b128 a[92:95], v18 offset:39936
    v_mfma_f32_16x16x32_bf16 v[44:47], a[32:35], a[60:63], v[44:47]
    ds_read_b64_tr_b16 a[64:65], v2 offset:40960
    v_mfma_f32_16x16x32_bf16 v[48:51], a[36:39], a[48:51], v[48:51]
    ds_read_b64_tr_b16 a[66:67], v2 offset:45056
    v_mfma_f32_16x16x32_bf16 v[52:55], a[36:39], a[52:55], v[52:55]
    ds_read_b64_tr_b16 a[68:69], v3 offset:40960
    ds_read_b64_tr_b16 a[70:71], v3 offset:45056
    v_mfma_f32_16x16x32_bf16 v[56:59], a[36:39], a[56:59], v[56:59]
    ds_read_b64_tr_b16 a[72:73], v4 offset:40960
    v_mfma_f32_16x16x32_bf16 v[60:63], a[36:39], a[60:63], v[60:63]
    ds_read_b64_tr_b16 a[74:75], v4 offset:45056
    v_mfma_f32_16x16x32_bf16 v[64:67], a[40:43], a[48:51], v[64:67]
    ds_read_b64_tr_b16 a[76:77], v5 offset:40960
    v_mfma_f32_16x16x32_bf16 v[68:71], a[40:43], a[52:55], v[68:71]
    ds_read_b64_tr_b16 a[78:79], v5 offset:45056
    v_mfma_f32_16x16x32_bf16 v[72:75], a[40:43], a[56:59], v[72:75]
    v_mfma_f32_16x16x32_bf16 v[76:79], a[40:43], a[60:63], v[76:79]
    v_mfma_f32_16x16x32_bf16 v[80:83], a[44:47], a[48:51], v[80:83]
    v_mfma_f32_16x16x32_bf16 v[84:87], a[44:47], a[52:55], v[84:87]
    v_mfma_f32_16x16x32_bf16 v[88:91], a[44:47], a[56:59], v[88:91]
    v_mfma_f32_16x16x32_bf16 v[92:95], a[44:47], a[60:63], v[92:95]
    s_waitcnt vmcnt(8) lgkmcnt(0)
    s_barrier
    v_mfma_f32_16x16x32_bf16 v[32:35], a[64:67], a[80:83], v[32:35]
    ds_read_b128 a[48:51], v19 offset:0
    ds_read_b128 a[52:55], v19 offset:2048
    v_mfma_f32_16x16x32_bf16 v[36:39], a[64:67], a[84:87], v[36:39]
    ds_read_b128 a[56:59], v19 offset:4096
    v_mfma_f32_16x16x32_bf16 v[40:43], a[64:67], a[88:91], v[40:43]
    ds_read_b128 a[60:63], v19 offset:6144
    v_mfma_f32_16x16x32_bf16 v[44:47], a[64:67], a[92:95], v[44:47]
    ds_read_b64_tr_b16 a[32:33], v10 offset:0
    v_mfma_f32_16x16x32_bf16 v[48:51], a[68:71], a[80:83], v[48:51]
    ds_read_b64_tr_b16 a[34:35], v10 offset:4096
    v_mfma_f32_16x16x32_bf16 v[52:55], a[68:71], a[84:87], v[52:55]
    ds_read_b64_tr_b16 a[36:37], v11 offset:0
    ds_read_b64_tr_b16 a[38:39], v11 offset:4096
    v_mfma_f32_16x16x32_bf16 v[56:59], a[68:71], a[88:91], v[56:59]
    ds_read_b64_tr_b16 a[40:41], v12 offset:0
    v_mfma_f32_16x16x32_bf16 v[60:63], a[68:71], a[92:95], v[60:63]
    ds_read_b64_tr_b16 a[42:43], v12 offset:4096
    v_mfma_f32_16x16x32_bf16 v[64:67], a[72:75], a[80:83], v[64:67]
    ds_read_b64_tr_b16 a[44:45], v13 offset:0
    v_mfma_f32_16x16x32_bf16 v[68:71], a[72:75], a[84:87], v[68:71]
    ds_read_b64_tr_b16 a[46:47], v13 offset:4096
    v_mfma_f32_16x16x32_bf16 v[72:75], a[72:75], a[88:91], v[72:75]
    v_mfma_f32_16x16x32_bf16 v[76:79], a[72:75], a[92:95], v[76:79]
    v_mfma_f32_16x16x32_bf16 v[80:83], a[76:79], a[80:83], v[80:83]
    v_mfma_f32_16x16x32_bf16 v[84:87], a[76:79], a[84:87], v[84:87]
    v_mfma_f32_16x16x32_bf16 v[88:91], a[76:79], a[88:91], v[88:91]
    v_mfma_f32_16x16x32_bf16 v[92:95], a[76:79], a[92:95], v[92:95]
    s_waitcnt lgkmcnt(0)
    v_mfma_f32_16x16x32_bf16 v[32:35], a[32:35], a[48:51], v[32:35]
    ds_read_b128 a[80:83], v19 offset:1024
    ds_read_b128 a[84:87], v19 offset:3072
    v_mfma_f32_16x16x32_bf16 v[36:39], a[32:35], a[52:55], v[36:39]
    ds_read_b128 a[88:91], v19 offset:5120
    v_mfma_f32_16x16x32_bf16 v[40:43], a[32:35], a[56:59], v[40:43]
    ds_read_b128 a[92:95], v19 offset:7168
    v_mfma_f32_16x16x32_bf16 v[44:47], a[32:35], a[60:63], v[44:47]
    ds_read_b64_tr_b16 a[64:65], v10 offset:8192
    v_mfma_f32_16x16x32_bf16 v[48:51], a[36:39], a[48:51], v[48:51]
    ds_read_b64_tr_b16 a[66:67], v10 offset:12288
    v_mfma_f32_16x16x32_bf16 v[52:55], a[36:39], a[52:55], v[52:55]
    ds_read_b64_tr_b16 a[68:69], v11 offset:8192
    ds_read_b64_tr_b16 a[70:71], v11 offset:12288
    v_mfma_f32_16x16x32_bf16 v[56:59], a[36:39], a[56:59], v[56:59]
    ds_read_b64_tr_b16 a[72:73], v12 offset:8192
    v_mfma_f32_16x16x32_bf16 v[60:63], a[36:39], a[60:63], v[60:63]
    ds_read_b64_tr_b16 a[74:75], v12 offset:12288
    v_mfma_f32_16x16x32_bf16 v[64:67], a[40:43], a[48:51], v[64:67]
    ds_read_b64_tr_b16 a[76:77], v13 offset:8192
    v_mfma_f32_16x16x32_bf16 v[68:71], a[40:43], a[52:55], v[68:71]
    ds_read_b64_tr_b16 a[78:79], v13 offset:12288
    v_mfma_f32_16x16x32_bf16 v[72:75], a[40:43], a[56:59], v[72:75]
    v_mfma_f32_16x16x32_bf16 v[76:79], a[40:43], a[60:63], v[76:79]
    v_mfma_f32_16x16x32_bf16 v[80:83], a[44:47], a[48:51], v[80:83]
    v_mfma_f32_16x16x32_bf16 v[84:87], a[44:47], a[52:55], v[84:87]
    v_mfma_f32_16x16x32_bf16 v[88:91], a[44:47], a[56:59], v[88:91]
    v_mfma_f32_16x16x32_bf16 v[92:95], a[44:47], a[60:63], v[92:95]
    s_waitcnt vmcnt(0) lgkmcnt(0)
    s_barrier
    v_mfma_f32_16x16x32_bf16 v[32:35], a[64:67], a[80:83], v[32:35]
    ds_read_b128 a[48:51], v19 offset:32768
    ds_read_b128 a[52:55], v19 offset:34816
    v_mfma_f32_16x16x32_bf16 v[36:39], a[64:67], a[84:87], v[36:39]
    ds_read_b128 a[56:59], v19 offset:36864
    v_mfma_f32_16x16x32_bf16 v[40:43], a[64:67], a[88:91], v[40:43]
    ds_read_b128 a[60:63], v19 offset:38912
    v_mfma_f32_16x16x32_bf16 v[44:47], a[64:67], a[92:95], v[44:47]
    ds_read_b64_tr_b16 a[32:33], v10 offset:32768
    v_mfma_f32_16x16x32_bf16 v[48:51], a[68:71], a[80:83], v[48:51]
    ds_read_b64_tr_b16 a[34:35], v10 offset:36864
    v_mfma_f32_16x16x32_bf16 v[52:55], a[68:71], a[84:87], v[52:55]
    ds_read_b64_tr_b16 a[36:37], v11 offset:32768
    ds_read_b64_tr_b16 a[38:39], v11 offset:36864
    v_mfma_f32_16x16x32_bf16 v[56:59], a[68:71], a[88:91], v[56:59]
    ds_read_b64_tr_b16 a[40:41], v12 offset:32768
    v_mfma_f32_16x16x32_bf16 v[60:63], a[68:71], a[92:95], v[60:63]
    ds_read_b64_tr_b16 a[42:43], v12 offset:36864
    v_mfma_f32_16x16x32_bf16 v[64:67], a[72:75], a[80:83], v[64:67]
    ds_read_b64_tr_b16 a[44:45], v13 offset:32768
    v_mfma_f32_16x16x32_bf16 v[68:71], a[72:75], a[84:87], v[68:71]
    ds_read_b64_tr_b16 a[46:47], v13 offset:36864
    v_mfma_f32_16x16x32_bf16 v[72:75], a[72:75], a[88:91], v[72:75]
    v_mfma_f32_16x16x32_bf16 v[76:79], a[72:75], a[92:95], v[76:79]
    v_mfma_f32_16x16x32_bf16 v[80:83], a[76:79], a[80:83], v[80:83]
    v_mfma_f32_16x16x32_bf16 v[84:87], a[76:79], a[84:87], v[84:87]
    v_mfma_f32_16x16x32_bf16 v[88:91], a[76:79], a[88:91], v[88:91]
    v_mfma_f32_16x16x32_bf16 v[92:95], a[76:79], a[92:95], v[92:95]
    s_waitcnt lgkmcnt(0)
    v_mfma_f32_16x16x32_bf16 v[32:35], a[32:35], a[48:51], v[32:35]
    ds_read_b128 a[80:83], v19 offset:33792
    ds_read_b128 a[84:87], v19 offset:35840
    v_mfma_f32_16x16x32_bf16 v[36:39], a[32:35], a[52:55], v[36:39]
    ds_read_b128 a[88:91], v19 offset:37888
    v_mfma_f32_16x16x32_bf16 v[40:43], a[32:35], a[56:59], v[40:43]
    ds_read_b128 a[92:95], v19 offset:39936
    v_mfma_f32_16x16x32_bf16 v[44:47], a[32:35], a[60:63], v[44:47]
    ds_read_b64_tr_b16 a[64:65], v10 offset:40960
    v_mfma_f32_16x16x32_bf16 v[48:51], a[36:39], a[48:51], v[48:51]
    ds_read_b64_tr_b16 a[66:67], v10 offset:45056
    v_mfma_f32_16x16x32_bf16 v[52:55], a[36:39], a[52:55], v[52:55]
    ds_read_b64_tr_b16 a[68:69], v11 offset:40960
    ds_read_b64_tr_b16 a[70:71], v11 offset:45056
    v_mfma_f32_16x16x32_bf16 v[56:59], a[36:39], a[56:59], v[56:59]
    ds_read_b64_tr_b16 a[72:73], v12 offset:40960
    v_mfma_f32_16x16x32_bf16 v[60:63], a[36:39], a[60:63], v[60:63]
    ds_read_b64_tr_b16 a[74:75], v12 offset:45056
    v_mfma_f32_16x16x32_bf16 v[64:67], a[40:43], a[48:51], v[64:67]
    ds_read_b64_tr_b16 a[76:77], v13 offset:40960
    v_mfma_f32_16x16x32_bf16 v[68:71], a[40:43], a[52:55], v[68:71]
    ds_read_b64_tr_b16 a[78:79], v13 offset:45056
    v_mfma_f32_16x16x32_bf16 v[72:75], a[40:43], a[56:59], v[72:75]
    v_mfma_f32_16x16x32_bf16 v[76:79], a[40:43], a[60:63], v[76:79]
    v_mfma_f32_16x16x32_bf16 v[80:83], a[44:47], a[48:51], v[80:83]
    v_mfma_f32_16x16x32_bf16 v[84:87], a[44:47], a[52:55], v[84:87]
    v_mfma_f32_16x16x32_bf16 v[88:91], a[44:47], a[56:59], v[88:91]
    v_mfma_f32_16x16x32_bf16 v[92:95], a[44:47], a[60:63], v[92:95]
    s_waitcnt lgkmcnt(0)
    v_mfma_f32_16x16x32_bf16 v[32:35], a[64:67], a[80:83], v[32:35]
    v_mfma_f32_16x16x32_bf16 v[36:39], a[64:67], a[84:87], v[36:39]
    v_mfma_f32_16x16x32_bf16 v[40:43], a[64:67], a[88:91], v[40:43]
    v_mfma_f32_16x16x32_bf16 v[44:47], a[64:67], a[92:95], v[44:47]
    v_mfma_f32_16x16x32_bf16 v[48:51], a[68:71], a[80:83], v[48:51]
    v_mfma_f32_16x16x32_bf16 v[52:55], a[68:71], a[84:87], v[52:55]
    v_mfma_f32_16x16x32_bf16 v[56:59], a[68:71], a[88:91], v[56:59]
    v_mfma_f32_16x16x32_bf16 v[60:63], a[68:71], a[92:95], v[60:63]
    v_mfma_f32_16x16x32_bf16 v[64:67], a[72:75], a[80:83], v[64:67]
    v_mfma_f32_16x16x32_bf16 v[68:71], a[72:75], a[84:87], v[68:71]
    v_mfma_f32_16x16x32_bf16 v[72:75], a[72:75], a[88:91], v[72:75]
    v_mfma_f32_16x16x32_bf16 v[76:79], a[72:75], a[92:95], v[76:79]
    v_mfma_f32_16x16x32_bf16 v[80:83], a[76:79], a[80:83], v[80:83]
    v_mfma_f32_16x16x32_bf16 v[84:87], a[76:79], a[84:87], v[84:87]
    v_mfma_f32_16x16x32_bf16 v[88:91], a[76:79], a[88:91], v[88:91]
    v_mfma_f32_16x16x32_bf16 v[92:95], a[76:79], a[92:95], v[92:95]
    s_cmp_lg_u32 s90, 0
    s_cbranch_scc1 al_157
    buffer_load_dword v30, off, s[72:75], 0 offset:144 sc1
al_157:
    s_mul_i32 s35, s26, 4
    s_add_u32 s35, s35, s28
    s_mul_i32 s35, s35, 128
    s_lshr_b32 s36, s39, 5
    s_add_u32 s35, s35, s36
    s_lshl_b32 s35, s35, 10
    v_lshlrev_b32 v2, 4, v1
    v_add_u32 v2, s35, v2
    s_mov_b32 s37, 0
    v_cvt_pk_bf16_f32 v4, v32, v33
    v_cvt_pk_bf16_f32 v5, v34, v35
    v_cvt_pk_bf16_f32 v6, v48, v49
    v_cvt_pk_bf16_f32 v7, v50, v51
    buffer_store_dwordx4 v[4:7], v2, s[16:19], s37 offen offset:0 sc1
    v_cvt_pk_bf16_f32 v8, v64, v65
    v_cvt_pk_bf16_f32 v9, v66, v67
    v_cvt_pk_bf16_f32 v10, v80, v81
    v_cvt_pk_bf16_f32 v11, v82, v83
    buffer_store_dwordx4 v[8:11], v2, s[16:19], s37 offen offset:1024 sc1
    s_mov_b32 s37, 131072
    v_cvt_pk_bf16_f32 v12, v36, v37
    v_cvt_pk_bf16_f32 v13, v38, v39
    v_cvt_pk_bf16_f32 v14, v52, v53
    v_cvt_pk_bf16_f32 v15, v54, v55
    buffer_store_dwordx4 v[12:15], v2, s[16:19], s37 offen offset:0 sc1
    v_cvt_pk_bf16_f32 v16, v68, v69
    v_cvt_pk_bf16_f32 v17, v70, v71
    v_cvt_pk_bf16_f32 v18, v84, v85
    v_cvt_pk_bf16_f32 v19, v86, v87
    buffer_store_dwordx4 v[16:19], v2, s[16:19], s37 offen offset:1024 sc1
    s_mov_b32 s37, 262144
    v_cvt_pk_bf16_f32 v20, v40, v41
    v_cvt_pk_bf16_f32 v21, v42, v43
    v_cvt_pk_bf16_f32 v22, v56, v57
    v_cvt_pk_bf16_f32 v23, v58, v59
    buffer_store_dwordx4 v[20:23], v2, s[16:19], s37 offen offset:0 sc1
    v_cvt_pk_bf16_f32 v24, v72, v73
    v_cvt_pk_bf16_f32 v25, v74, v75
    v_cvt_pk_bf16_f32 v26, v88, v89
    v_cvt_pk_bf16_f32 v27, v90, v91
    buffer_store_dwordx4 v[24:27], v2, s[16:19], s37 offen offset:1024 sc1
    s_mov_b32 s37, 393216
    v_cvt_pk_bf16_f32 v4, v44, v45
    v_cvt_pk_bf16_f32 v5, v46, v47
    v_cvt_pk_bf16_f32 v6, v60, v61
    v_cvt_pk_bf16_f32 v7, v62, v63
    buffer_store_dwordx4 v[4:7], v2, s[16:19], s37 offen offset:0 sc1
    v_cvt_pk_bf16_f32 v8, v76, v77
    v_cvt_pk_bf16_f32 v9, v78, v79
    v_cvt_pk_bf16_f32 v10, v92, v93
    v_cvt_pk_bf16_f32 v11, v94, v95
    buffer_store_dwordx4 v[8:11], v2, s[16:19], s37 offen offset:1024 sc1
    s_waitcnt vmcnt(0) lgkmcnt(0)
    s_cmp_lg_u32 s90, 0
    s_cbranch_scc1 dw_160
    s_mov_b32 s71, 0x8000
    s_branch dw_159
dw_158:
    buffer_load_dword v30, off, s[72:75], 0 offset:144 sc1
    s_waitcnt vmcnt(0)
dw_159:
    v_readfirstlane_b32 s70, v30
    s_nop 3
    s_cmp_ge_u32 s70, 128
    s_cbranch_scc1 dw_160
    s_sleep 2
    s_sub_u32 s71, s71, 1
    s_cbranch_scc0 dw_158
dw_160:
    s_barrier
    s_cmp_lg_u32 s90, 0
    s_cbranch_scc1 w0_161
    s_lshl_b32 s95, s88, 2
    s_add_u32 s95, s95, 4096
    v_mov_b32 v2, 1
    s_mov_b64 exec, 1
    buffer_atomic_add v2, off, s[96:99], s95
    s_mov_b64 exec, -1
w0_161:
    s_mov_b32 s93, 0
    s_cmp_ge_u32 s92, 8
    s_cbranch_scc1 g_round
    s_cmp_lg_u32 s93, 0
    s_cbranch_scc1 rnd_163
    s_cmp_lt_u32 s92, 0
    s_cbranch_scc1 g_roles
    s_sub_u32 s45, s92, 0
    s_mov_b32 s47, 1
    s_mov_b32 s48, 1
    s_mov_b32 s49, 0
    s_cmp_ge_u32 s45, 8
    s_cselect_b32 s47, 0, s47
    s_cselect_b32 s48, 0, s48
    s_cselect_b32 s49, 8, s49
    s_cmp_ge_u32 s45, 12
    s_cselect_b32 s47, 1, s47
    s_cselect_b32 s48, 0, s48
    s_cselect_b32 s49, 12, s49
    s_cmp_ge_u32 s45, 16
    s_cselect_b32 s47, 2, s47
    s_cselect_b32 s48, 1, s48
    s_cselect_b32 s49, 16, s49
    s_cmp_ge_u32 s45, 24
    s_cselect_b32 s47, 2, s47
    s_cselect_b32 s48, 0, s48
    s_cselect_b32 s49, 24, s49
    s_cmp_ge_u32 s45, 28
    s_cselect_b32 s47, 3, s47
    s_cselect_b32 s48, 0, s48
    s_cselect_b32 s49, 28, s49
    s_cmp_ge_u32 s45, 32
    s_cbranch_scc1 g_roles
    s_branch g_tile_162
rnd_163:
    s_cmp_lg_u32 s93, 1
    s_cbranch_scc1 rnd_164
    s_cmp_lt_u32 s92, 2
    s_cbranch_scc1 g_roles
    s_sub_u32 s45, s92, 2
    s_mov_b32 s47, 3
    s_mov_b32 s48, 1
    s_mov_b32 s49, 0
    s_cmp_ge_u32 s45, 8
    s_cselect_b32 s47, 4, s47
    s_cselect_b32 s48, 1, s48
    s_cselect_b32 s49, 8, s49
    s_cmp_ge_u32 s45, 16
    s_cselect_b32 s47, 4, s47
    s_cselect_b32 s48, 0, s48
    s_cselect_b32 s49, 16, s49
    s_cmp_ge_u32 s45, 20
    s_cselect_b32 s47, 5, s47
    s_cselect_b32 s48, 0, s48
    s_cselect_b32 s49, 20, s49
    s_cmp_ge_u32 s45, 24
    s_cselect_b32 s47, 5, s47
    s_cselect_b32 s48, 1, s48
    s_cselect_b32 s49, 24, s49
    s_cmp_ge_u32 s45, 30
    s_cbranch_scc1 g_roles
    s_branch g_tile_162
rnd_164:
    s_cmp_lg_u32 s93, 2
    s_cbranch_scc1 rnd_165
    s_cmp_lt_u32 s92, 10
    s_cbranch_scc1 g_roles
    s_sub_u32 s45, s92, 10
    s_mov_b32 s47, 5
    s_mov_b32 s48, 1
    s_mov_b32 s49, -6
    s_cmp_ge_u32 s45, 2
    s_cselect_b32 s47, 6, s47
    s_cselect_b32 s48, 1, s48
    s_cselect_b32 s49, 2, s49
    s_cmp_ge_u32 s45, 10
    s_cselect_b32 s47, 7, s47
    s_cselect_b32 s48, 1, s48
    s_cselect_b32 s49, 10, s49
    s_cmp_ge_u32 s45, 18
    s_cselect_b32 s47, 6, s47
    s_cselect_b32 s48, 0, s48
    s_cselect_b32 s49, 18, s49
    s_cmp_ge_u32 s45, 22
    s_cbranch_scc1 g_roles
    s_branch g_tile_162
rnd_165:
    s_branch g_roles
g_tile_162:
    s_sub_i32 s46, s45, s49
    s_add_u32 s50, s48, 2
    s_lshl_b32 s50, s91, s50
    s_add_u32 s46, s46, s50
    s_lshr_b32 s50, s46, 4
    s_add_u32 s48, s48, s50
    s_and_b32 s46, s46, 15
    s_mov_b32 s67, 0
    s_mov_b32 s71, 2
    s_mov_b32 s68, s46
    s_mov_b32 s69, s47
    s_mov_b32 s70, s48
    s_mov_b32 s72, 0
g_half:
    s_mov_b32 s24, s90
    s_and_b32 s25, s90, 1
    s_lshr_b32 s26, s90, 1
    v_mbcnt_lo_u32_b32 v1, -1, 0
    v_mbcnt_hi_u32_b32 v1, -1, v1
    s_lshl_b32 s49, s70, 3
    s_add_u32 s50, s0, s49
    s_addc_u32 s51, s1, 0
    s_load_dwordx2 s[6:7], s[50:51], 16
    s_lshl_b32 s88, s69, 1
    s_add_u32 s88, s88, s67
    s_mov_b32 s46, s68
    s_mov_b32 s47, s69
    s_waitcnt lgkmcnt(0)
    s_mov_b32 s8, s6
    s_mov_b32 s9, s7
    s_mov_b32 s10, 0x800000
    s_mov_b32 s11, 0x20000
    s_mov_b32 s12, s4
    s_mov_b32 s13, s5
    s_mov_b32 s14, 0x400000
    s_mov_b32 s15, 0x20000
    s_lshl_b32 s49, s70, 24
    s_add_u32 s50, s4, s49
    s_addc_u32 s51, s5, 0
    s_add_u32 s16, s50, 0x400000
    s_addc_u32 s17, s51, 0
    s_mov_b32 s18, 0x1000000
    s_mov_b32 s19, 0x20000
    s_mul_i32 s28, s47, 16
    s_mov_b32 s29, 0
    s_lshl_b32 s49, s46, 8
    s_lshr_b32 s50, s24, 1
    s_lshl_b32 s50, s50, 7
    s_add_u32 s50, s50, s49
    s_lshl_b32 s27, s50, 1
    s_lshl_b32 s50, s25, 7
    s_add_u32 s39, s50, s49
    s_lshl_b32 s49, s67, 3
    s_add_u32 s28, s28, s49
    s_cmp_eq_u32 s70, 0
    s_cselect_b32 s79, 64, 0
    s_cselect_b32 s66, 1, 2
    s_add_u32 s79, s79, 4096
    v_lshrrev_b32 v28, 2, v1
    v_and_b32 v29, 7, v28
    v_lshlrev_b32 v28, 8, v28
    v_and_b32 v30, 3, v1
    v_lshl_add_u32 v28, v30, 3, v28
    s_mul_i32 s35, s25, 8192
    s_add_u32 s35, s35, 0
    v_add_u32 v28, s35, v28
    v_xor_b32 v30, 0, v29
    v_lshl_add_u32 v2, v30, 5, v28
    v_add_u32 v10, 49152, v2
    v_xor_b32 v30, 1, v29
    v_lshl_add_u32 v3, v30, 5, v28
    v_add_u32 v11, 49152, v3
    v_xor_b32 v30, 2, v29
    v_lshl_add_u32 v4, v30, 5, v28
    v_add_u32 v12, 49152, v4
    v_xor_b32 v30, 3, v29
    v_lshl_add_u32 v5, v30, 5, v28
    v_add_u32 v13, 49152, v5
    v_xor_b32 v30, 4, v29
    v_lshl_add_u32 v6, v30, 5, v28
    v_add_u32 v14, 49152, v6
    v_xor_b32 v30, 5, v29
    v_lshl_add_u32 v7, v30, 5, v28
    v_add_u32 v15, 49152, v7
    v_xor_b32 v30, 6, v29
    v_lshl_add_u32 v8, v30, 5, v28
    v_add_u32 v16, 49152, v8
    v_xor_b32 v30, 7, v29
    v_lshl_add_u32 v9, v30, 5, v28
    v_add_u32 v17, 49152, v9
    s_mul_i32 s35, s26, 4096
    s_add_u32 s35, s35, 16384
    v_lshlrev_b32 v28, 4, v1
    v_add_u32 v18, s35, v28
    v_add_u32 v19, 49152, v18
    s_mul_i32 s35, s24, 2
    s_add_u32 s35, s35, 0
    s_add_u32 s35, s35, s28
    s_mul_i32 s35, s35, 32
    s_add_u32 s35, s35, s29
    s_lshl_b32 s35, s35, 10
    v_add_u32 v24, s35, v28
    s_mul_i32 s35, s24, 2
    s_add_u32 s35, s35, 1
    s_add_u32 s35, s35, s28
    s_mul_i32 s35, s35, 32
    s_add_u32 s35, s35, s29
    s_add_i32 s35, s35, -1
    s_lshl_b32 s35, s35, 10
    v_add_u32 v25, s35, v28
    s_lshl_b32 s35, s24, 2
    s_and_b32 s35, s35, 7
    s_lshl_b32 s36, s29, 3
    s_add_u32 s35, s35, s36
    s_mul_i32 s35, s35, 32768
    s_add_u32 s35, s35, s27
    v_lshrrev_b32 v28, 4, v1
    s_mov_b32 s36, 8192
    v_mul_lo_u32 v29, v28, s36
    v_add_u32 v29, s35, v29
    v_and_b32 v30, 15, v1
    v_lshlrev_b32 v31, 1, v28
    v_xor_b32 v31, v31, v30
    v_lshl_add_u32 v20, v31, 4, v29
    v_lshlrev_b32 v31, 1, v28
    v_add_u32 v31, 8, v31
    v_xor_b32 v31, v31, v30
    v_lshl_add_u32 v21, v31, 4, v29
    v_add_u32 v21, 31744, v21
    v_lshlrev_b32 v31, 1, v28
    v_xor_b32 v31, v31, v30
    v_lshl_add_u32 v22, v31, 4, v29
    v_add_u32 v22, 63488, v22
    v_lshlrev_b32 v31, 1, v28
    v_add_u32 v31, 8, v31
    v_xor_b32 v31, v31, v30
    v_lshl_add_u32 v23, v31, 4, v29
    v_add_u32 v23, 95232, v23
    s_lshl_b32 s32, s24, 12
    s_mul_i32 s33, s24, 2048
    s_add_u32 s33, s33, 16384
    s_mov_b32 s30, 0
    s_mov_b32 s31, 0
    s_add_u32 m0, s32, 0
    s_nop 0
    buffer_load_dwordx4 v20, s[8:11], s30 offen offset:0 lds
    buffer_load_dwordx4 v21, s[8:11], s30 offen offset:1024 lds
    buffer_load_dwordx4 v22, s[8:11], s30 offen offset:2048 lds
    buffer_load_dwordx4 v23, s[8:11], s30 offen offset:3072 lds
    s_add_u32 m0, s33, 0
    s_nop 0
    buffer_load_dwordx4 v24, s[12:15], s31 offen offset:0 lds
    buffer_load_dwordx4 v25, s[12:15], s31 offen offset:1024 lds
    s_add_u32 s30, s30, 262144
    s_add_u32 s31, s31, 1024
    s_add_u32 m0, s32, 24576
    s_nop 0
    buffer_load_dwordx4 v20, s[8:11], s30 offen offset:0 lds
    buffer_load_dwordx4 v21, s[8:11], s30 offen offset:1024 lds
    buffer_load_dwordx4 v22, s[8:11], s30 offen offset:2048 lds
    buffer_load_dwordx4 v23, s[8:11], s30 offen offset:3072 lds
    s_add_u32 m0, s33, 24576
    s_nop 0
    buffer_load_dwordx4 v24, s[12:15], s31 offen offset:0 lds
    buffer_load_dwordx4 v25, s[12:15], s31 offen offset:1024 lds
    s_add_u32 s30, s30, 262144
    s_add_u32 s31, s31, 1024
    s_add_u32 m0, s32, 49152
    s_nop 0
    buffer_load_dwordx4 v20, s[8:11], s30 offen offset:0 lds
    buffer_load_dwordx4 v21, s[8:11], s30 offen offset:1024 lds
    buffer_load_dwordx4 v22, s[8:11], s30 offen offset:2048 lds
    buffer_load_dwordx4 v23, s[8:11], s30 offen offset:3072 lds
    s_add_u32 m0, s33, 49152
    s_nop 0
    buffer_load_dwordx4 v24, s[12:15], s31 offen offset:0 lds
    buffer_load_dwordx4 v25, s[12:15], s31 offen offset:1024 lds
    s_add_u32 s30, s30, 262144
    s_add_u32 s31, s31, 1024
    s_add_u32 m0, s32, 73728
    s_nop 0
    buffer_load_dwordx4 v20, s[8:11], s30 offen offset:0 lds
    buffer_load_dwordx4 v21, s[8:11], s30 offen offset:1024 lds
    buffer_load_dwordx4 v22, s[8:11], s30 offen offset:2048 lds
    buffer_load_dwordx4 v23, s[8:11], s30 offen offset:3072 lds
    s_add_u32 m0, s33, 73728
    s_nop 0
    buffer_load_dwordx4 v24, s[12:15], s31 offen offset:0 lds
    buffer_load_dwordx4 v25, s[12:15], s31 offen offset:1024 lds
    s_add_u32 s30, s30, 262144
    s_add_u32 s31, s31, 1024
    v_mov_b32 v32, 0
    v_mov_b32 v33, 0
    v_mov_b32 v34, 0
    v_mov_b32 v35, 0
    v_mov_b32 v36, 0
    v_mov_b32 v37, 0
    v_mov_b32 v38, 0
    v_mov_b32 v39, 0
    v_mov_b32 v40, 0
    v_mov_b32 v41, 0
    v_mov_b32 v42, 0
    v_mov_b32 v43, 0
    v_mov_b32 v44, 0
    v_mov_b32 v45, 0
    v_mov_b32 v46, 0
    v_mov_b32 v47, 0
    v_mov_b32 v48, 0
    v_mov_b32 v49, 0
    v_mov_b32 v50, 0
    v_mov_b32 v51, 0
    v_mov_b32 v52, 0
    v_mov_b32 v53, 0
    v_mov_b32 v54, 0
    v_mov_b32 v55, 0
    v_mov_b32 v56, 0
    v_mov_b32 v57, 0
    v_mov_b32 v58, 0
    v_mov_b32 v59, 0
    v_mov_b32 v60, 0
    v_mov_b32 v61, 0
    v_mov_b32 v62, 0
    v_mov_b32 v63, 0
    v_mov_b32 v64, 0
    v_mov_b32 v65, 0
    v_mov_b32 v66, 0
    v_mov_b32 v67, 0
    v_mov_b32 v68, 0
    v_mov_b32 v69, 0
    v_mov_b32 v70, 0
    v_mov_b32 v71, 0
    v_mov_b32 v72, 0
    v_mov_b32 v73, 0
    v_mov_b32 v74, 0
    v_mov_b32 v75, 0
    v_mov_b32 v76, 0
    v_mov_b32 v77, 0
    v_mov_b32 v78, 0
    v_mov_b32 v79, 0
    v_mov_b32 v80, 0
    v_mov_b32 v81, 0
    v_mov_b32 v82, 0
    v_mov_b32 v83, 0
    v_mov_b32 v84, 0
    v_mov_b32 v85, 0
    v_mov_b32 v86, 0
    v_mov_b32 v87, 0
    v_mov_b32 v88, 0
    v_mov_b32 v89, 0
    v_mov_b32 v90, 0
    v_mov_b32 v91, 0
    v_mov_b32 v92, 0
    v_mov_b32 v93, 0
    v_mov_b32 v94, 0
    v_mov_b32 v95, 0
    v_mov_b32 v96, 0
    v_mov_b32 v97, 0
    v_mov_b32 v98, 0
    v_mov_b32 v99, 0
    v_mov_b32 v100, 0
    v_mov_b32 v101, 0
    v_mov_b32 v102, 0
    v_mov_b32 v103, 0
    v_mov_b32 v104, 0
    v_mov_b32 v105, 0
    v_mov_b32 v106, 0
    v_mov_b32 v107, 0
    v_mov_b32 v108, 0
    v_mov_b32 v109, 0
    v_mov_b32 v110, 0
    v_mov_b32 v111, 0
    v_mov_b32 v112, 0
    v_mov_b32 v113, 0
    v_mov_b32 v114, 0
    v_mov_b32 v115, 0
    v_mov_b32 v116, 0
    v_mov_b32 v117, 0
    v_mov_b32 v118, 0
    v_mov_b32 v119, 0
    v_mov_b32 v120, 0
    v_mov_b32 v121, 0
    v_mov_b32 v122, 0
    v_mov_b32 v123, 0
    v_mov_b32 v124, 0
    v_mov_b32 v125, 0
    v_mov_b32 v126, 0
    v_mov_b32 v127, 0
    v_mov_b32 v128, 0
    v_mov_b32 v129, 0
    v_mov_b32 v130, 0
    v_mov_b32 v131, 0
    v_mov_b32 v132, 0
    v_mov_b32 v133, 0
    v_mov_b32 v134, 0
    v_mov_b32 v135, 0
    v_mov_b32 v136, 0
    v_mov_b32 v137, 0
    v_mov_b32 v138, 0
    v_mov_b32 v139, 0
    v_mov_b32 v140, 0
    v_mov_b32 v141, 0
    v_mov_b32 v142, 0
    v_mov_b32 v143, 0
    v_mov_b32 v144, 0
    v_mov_b32 v145, 0
    v_mov_b32 v146, 0
    v_mov_b32 v147, 0
    v_mov_b32 v148, 0
    v_mov_b32 v149, 0
    v_mov_b32 v150, 0
    v_mov_b32 v151, 0
    v_mov_b32 v152, 0
    v_mov_b32 v153, 0
    v_mov_b32 v154, 0
    v_mov_b32 v155, 0
    v_mov_b32 v156, 0
    v_mov_b32 v157, 0
    v_mov_b32 v158, 0
    v_mov_b32 v159, 0
    s_waitcnt vmcnt(18)
    s_barrier
    ds_read_b128 a[64:67], v18 offset:0
    ds_read_b128 a[68:71], v18 offset:1024
    ds_read_b128 a[72:75], v18 offset:2048
    ds_read_b128 a[76:79], v18 offset:3072
    ds_read_b64_tr_b16 a[32:33], v2 offset:0
    ds_read_b64_tr_b16 a[34:35], v2 offset:4096
    ds_read_b64_tr_b16 a[36:37], v3 offset:0
    ds_read_b64_tr_b16 a[38:39], v3 offset:4096
    ds_read_b64_tr_b16 a[40:41], v4 offset:0
    ds_read_b64_tr_b16 a[42:43], v4 offset:4096
    ds_read_b64_tr_b16 a[44:45], v5 offset:0
    ds_read_b64_tr_b16 a[46:47], v5 offset:4096
    ds_read_b64_tr_b16 a[48:49], v6 offset:0
    ds_read_b64_tr_b16 a[50:51], v6 offset:4096
    ds_read_b64_tr_b16 a[52:53], v7 offset:0
    ds_read_b64_tr_b16 a[54:55], v7 offset:4096
    ds_read_b64_tr_b16 a[56:57], v8 offset:0
    ds_read_b64_tr_b16 a[58:59], v8 offset:4096
    ds_read_b64_tr_b16 a[60:61], v9 offset:0
    ds_read_b64_tr_b16 a[62:63], v9 offset:4096
    s_mov_b32 s34, 7
hh_loop_166:
    s_waitcnt vmcnt(12) lgkmcnt(0)
    s_barrier
    v_mfma_f32_16x16x32_bf16 v[32:35], a[32:35], a[64:67], v[32:35]
    ds_read_b128 a[112:115], v18 offset:24576
    s_add_u32 m0, s32, 0
    v_mfma_f32_16x16x32_bf16 v[36:39], a[32:35], a[68:71], v[36:39]
    ds_read_b128 a[116:119], v18 offset:25600
    v_mfma_f32_16x16x32_bf16 v[40:43], a[32:35], a[72:75], v[40:43]
    ds_read_b128 a[120:123], v18 offset:26624
    v_mfma_f32_16x16x32_bf16 v[44:47], a[32:35], a[76:79], v[44:47]
    ds_read_b128 a[124:127], v18 offset:27648
    buffer_load_dwordx4 v20, s[8:11], s30 offen offset:0 lds
    v_mfma_f32_16x16x32_bf16 v[48:51], a[36:39], a[64:67], v[48:51]
    ds_read_b64_tr_b16 a[80:81], v2 offset:24576
    v_mfma_f32_16x16x32_bf16 v[52:55], a[36:39], a[68:71], v[52:55]
    ds_read_b64_tr_b16 a[82:83], v2 offset:28672
    v_mfma_f32_16x16x32_bf16 v[56:59], a[36:39], a[72:75], v[56:59]
    ds_read_b64_tr_b16 a[84:85], v3 offset:24576
    buffer_load_dwordx4 v21, s[8:11], s30 offen offset:1024 lds
    v_mfma_f32_16x16x32_bf16 v[60:63], a[36:39], a[76:79], v[60:63]
    ds_read_b64_tr_b16 a[86:87], v3 offset:28672
    v_mfma_f32_16x16x32_bf16 v[64:67], a[40:43], a[64:67], v[64:67]
    ds_read_b64_tr_b16 a[88:89], v4 offset:24576
    v_mfma_f32_16x16x32_bf16 v[68:71], a[40:43], a[68:71], v[68:71]
    ds_read_b64_tr_b16 a[90:91], v4 offset:28672
    buffer_load_dwordx4 v22, s[8:11], s30 offen offset:2048 lds
    v_mfma_f32_16x16x32_bf16 v[72:75], a[40:43], a[72:75], v[72:75]
    ds_read_b64_tr_b16 a[92:93], v5 offset:24576
    v_mfma_f32_16x16x32_bf16 v[76:79], a[40:43], a[76:79], v[76:79]
    ds_read_b64_tr_b16 a[94:95], v5 offset:28672
    v_mfma_f32_16x16x32_bf16 v[80:83], a[44:47], a[64:67], v[80:83]
    ds_read_b64_tr_b16 a[96:97], v6 offset:24576
    buffer_load_dwordx4 v23, s[8:11], s30 offen offset:3072 lds
    v_mfma_f32_16x16x32_bf16 v[84:87], a[44:47], a[68:71], v[84:87]
    ds_read_b64_tr_b16 a[98:99], v6 offset:28672
    v_mfma_f32_16x16x32_bf16 v[88:91], a[44:47], a[72:75], v[88:91]
    ds_read_b64_tr_b16 a[100:101], v7 offset:24576
    v_mfma_f32_16x16x32_bf16 v[92:95], a[44:47], a[76:79], v[92:95]
    ds_read_b64_tr_b16 a[102:103], v7 offset:28672
    v_mfma_f32_16x16x32_bf16 v[96:99], a[48:51], a[64:67], v[96:99]
    ds_read_b64_tr_b16 a[104:105], v8 offset:24576
    s_add_u32 m0, s33, 0
    v_mfma_f32_16x16x32_bf16 v[100:103], a[48:51], a[68:71], v[100:103]
    ds_read_b64_tr_b16 a[106:107], v8 offset:28672
    v_mfma_f32_16x16x32_bf16 v[104:107], a[48:51], a[72:75], v[104:107]
    ds_read_b64_tr_b16 a[108:109], v9 offset:24576
    v_mfma_f32_16x16x32_bf16 v[108:111], a[48:51], a[76:79], v[108:111]
    ds_read_b64_tr_b16 a[110:111], v9 offset:28672
    buffer_load_dwordx4 v24, s[12:15], s31 offen offset:0 lds
    v_mfma_f32_16x16x32_bf16 v[112:115], a[52:55], a[64:67], v[112:115]
    v_mfma_f32_16x16x32_bf16 v[116:119], a[52:55], a[68:71], v[116:119]
    v_mfma_f32_16x16x32_bf16 v[120:123], a[52:55], a[72:75], v[120:123]
    buffer_load_dwordx4 v25, s[12:15], s31 offen offset:1024 lds
    v_mfma_f32_16x16x32_bf16 v[124:127], a[52:55], a[76:79], v[124:127]
    v_mfma_f32_16x16x32_bf16 v[128:131], a[56:59], a[64:67], v[128:131]
    v_mfma_f32_16x16x32_bf16 v[132:135], a[56:59], a[68:71], v[132:135]
    s_add_u32 s30, s30, 262144
    v_mfma_f32_16x16x32_bf16 v[136:139], a[56:59], a[72:75], v[136:139]
    v_mfma_f32_16x16x32_bf16 v[140:143], a[56:59], a[76:79], v[140:143]
    v_mfma_f32_16x16x32_bf16 v[144:147], a[60:63], a[64:67], v[144:147]
    s_add_u32 s31, s31, 1024
    v_mfma_f32_16x16x32_bf16 v[148:151], a[60:63], a[68:71], v[148:151]
    v_mfma_f32_16x16x32_bf16 v[152:155], a[60:63], a[72:75], v[152:155]
    v_mfma_f32_16x16x32_bf16 v[156:159], a[60:63], a[76:79], v[156:159]
    s_waitcnt vmcnt(12) lgkmcnt(0)
    s_barrier
    v_mfma_f32_16x16x32_bf16 v[32:35], a[80:83], a[112:115], v[32:35]
    ds_read_b128 a[64:67], v19 offset:0
    s_add_u32 m0, s32, 24576
    v_mfma_f32_16x16x32_bf16 v[36:39], a[80:83], a[116:119], v[36:39]
    ds_read_b128 a[68:71], v19 offset:1024
    v_mfma_f32_16x16x32_bf16 v[40:43], a[80:83], a[120:123], v[40:43]
    ds_read_b128 a[72:75], v19 offset:2048
    v_mfma_f32_16x16x32_bf16 v[44:47], a[80:83], a[124:127], v[44:47]
    ds_read_b128 a[76:79], v19 offset:3072
    buffer_load_dwordx4 v20, s[8:11], s30 offen offset:0 lds
    v_mfma_f32_16x16x32_bf16 v[48:51], a[84:87], a[112:115], v[48:51]
    ds_read_b64_tr_b16 a[32:33], v10 offset:0
    v_mfma_f32_16x16x32_bf16 v[52:55], a[84:87], a[116:119], v[52:55]
    ds_read_b64_tr_b16 a[34:35], v10 offset:4096
    v_mfma_f32_16x16x32_bf16 v[56:59], a[84:87], a[120:123], v[56:59]
    ds_read_b64_tr_b16 a[36:37], v11 offset:0
    buffer_load_dwordx4 v21, s[8:11], s30 offen offset:1024 lds
    v_mfma_f32_16x16x32_bf16 v[60:63], a[84:87], a[124:127], v[60:63]
    ds_read_b64_tr_b16 a[38:39], v11 offset:4096
    v_mfma_f32_16x16x32_bf16 v[64:67], a[88:91], a[112:115], v[64:67]
    ds_read_b64_tr_b16 a[40:41], v12 offset:0
    v_mfma_f32_16x16x32_bf16 v[68:71], a[88:91], a[116:119], v[68:71]
    ds_read_b64_tr_b16 a[42:43], v12 offset:4096
    buffer_load_dwordx4 v22, s[8:11], s30 offen offset:2048 lds
    v_mfma_f32_16x16x32_bf16 v[72:75], a[88:91], a[120:123], v[72:75]
    ds_read_b64_tr_b16 a[44:45], v13 offset:0
    v_mfma_f32_16x16x32_bf16 v[76:79], a[88:91], a[124:127], v[76:79]
    ds_read_b64_tr_b16 a[46:47], v13 offset:4096
    v_mfma_f32_16x16x32_bf16 v[80:83], a[92:95], a[112:115], v[80:83]
    ds_read_b64_tr_b16 a[48:49], v14 offset:0
    buffer_load_dwordx4 v23, s[8:11], s30 offen offset:3072 lds
    v_mfma_f32_16x16x32_bf16 v[84:87], a[92:95], a[116:119], v[84:87]
    ds_read_b64_tr_b16 a[50:51], v14 offset:4096
    v_mfma_f32_16x16x32_bf16 v[88:91], a[92:95], a[120:123], v[88:91]
    ds_read_b64_tr_b16 a[52:53], v15 offset:0
    v_mfma_f32_16x16x32_bf16 v[92:95], a[92:95], a[124:127], v[92:95]
    ds_read_b64_tr_b16 a[54:55], v15 offset:4096
    v_mfma_f32_16x16x32_bf16 v[96:99], a[96:99], a[112:115], v[96:99]
    ds_read_b64_tr_b16 a[56:57], v16 offset:0
    s_add_u32 m0, s33, 24576
    v_mfma_f32_16x16x32_bf16 v[100:103], a[96:99], a[116:119], v[100:103]
    ds_read_b64_tr_b16 a[58:59], v16 offset:4096
    v_mfma_f32_16x16x32_bf16 v[104:107], a[96:99], a[120:123], v[104:107]
    ds_read_b64_tr_b16 a[60:61], v17 offset:0
    v_mfma_f32_16x16x32_bf16 v[108:111], a[96:99], a[124:127], v[108:111]
    ds_read_b64_tr_b16 a[62:63], v17 offset:4096
    buffer_load_dwordx4 v24, s[12:15], s31 offen offset:0 lds
    v_mfma_f32_16x16x32_bf16 v[112:115], a[100:103], a[112:115], v[112:115]
    v_mfma_f32_16x16x32_bf16 v[116:119], a[100:103], a[116:119], v[116:119]
    v_mfma_f32_16x16x32_bf16 v[120:123], a[100:103], a[120:123], v[120:123]
    buffer_load_dwordx4 v25, s[12:15], s31 offen offset:1024 lds
    v_mfma_f32_16x16x32_bf16 v[124:127], a[100:103], a[124:127], v[124:127]
    v_mfma_f32_16x16x32_bf16 v[128:131], a[104:107], a[112:115], v[128:131]
    v_mfma_f32_16x16x32_bf16 v[132:135], a[104:107], a[116:119], v[132:135]
    s_add_u32 s30, s30, 262144
    v_mfma_f32_16x16x32_bf16 v[136:139], a[104:107], a[120:123], v[136:139]
    v_mfma_f32_16x16x32_bf16 v[140:143], a[104:107], a[124:127], v[140:143]
    v_mfma_f32_16x16x32_bf16 v[144:147], a[108:111], a[112:115], v[144:147]
    s_add_u32 s31, s31, 1024
    v_mfma_f32_16x16x32_bf16 v[148:151], a[108:111], a[116:119], v[148:151]
    v_mfma_f32_16x16x32_bf16 v[152:155], a[108:111], a[120:123], v[152:155]
    v_mfma_f32_16x16x32_bf16 v[156:159], a[108:111], a[124:127], v[156:159]
    s_waitcnt vmcnt(12) lgkmcnt(0)
    s_barrier
    v_mfma_f32_16x16x32_bf16 v[32:35], a[32:35], a[64:67], v[32:35]
    ds_read_b128 a[112:115], v19 offset:24576
    s_add_u32 m0, s32, 49152
    v_mfma_f32_16x16x32_bf16 v[36:39], a[32:35], a[68:71], v[36:39]
    ds_read_b128 a[116:119], v19 offset:25600
    v_mfma_f32_16x16x32_bf16 v[40:43], a[32:35], a[72:75], v[40:43]
    ds_read_b128 a[120:123], v19 offset:26624
    v_mfma_f32_16x16x32_bf16 v[44:47], a[32:35], a[76:79], v[44:47]
    ds_read_b128 a[124:127], v19 offset:27648
    buffer_load_dwordx4 v20, s[8:11], s30 offen offset:0 lds
    v_mfma_f32_16x16x32_bf16 v[48:51], a[36:39], a[64:67], v[48:51]
    ds_read_b64_tr_b16 a[80:81], v10 offset:24576
    v_mfma_f32_16x16x32_bf16 v[52:55], a[36:39], a[68:71], v[52:55]
    ds_read_b64_tr_b16 a[82:83], v10 offset:28672
    v_mfma_f32_16x16x32_bf16 v[56:59], a[36:39], a[72:75], v[56:59]
    ds_read_b64_tr_b16 a[84:85], v11 offset:24576
    buffer_load_dwordx4 v21, s[8:11], s30 offen offset:1024 lds
    v_mfma_f32_16x16x32_bf16 v[60:63], a[36:39], a[76:79], v[60:63]
    ds_read_b64_tr_b16 a[86:87], v11 offset:28672
    v_mfma_f32_16x16x32_bf16 v[64:67], a[40:43], a[64:67], v[64:67]
    ds_read_b64_tr_b16 a[88:89], v12 offset:24576
    v_mfma_f32_16x16x32_bf16 v[68:71], a[40:43], a[68:71], v[68:71]
    ds_read_b64_tr_b16 a[90:91], v12 offset:28672
    buffer_load_dwordx4 v22, s[8:11], s30 offen offset:2048 lds
    v_mfma_f32_16x16x32_bf16 v[72:75], a[40:43], a[72:75], v[72:75]
    ds_read_b64_tr_b16 a[92:93], v13 offset:24576
    v_mfma_f32_16x16x32_bf16 v[76:79], a[40:43], a[76:79], v[76:79]
    ds_read_b64_tr_b16 a[94:95], v13 offset:28672
    v_mfma_f32_16x16x32_bf16 v[80:83], a[44:47], a[64:67], v[80:83]
    ds_read_b64_tr_b16 a[96:97], v14 offset:24576
    buffer_load_dwordx4 v23, s[8:11], s30 offen offset:3072 lds
    v_mfma_f32_16x16x32_bf16 v[84:87], a[44:47], a[68:71], v[84:87]
    ds_read_b64_tr_b16 a[98:99], v14 offset:28672
    v_mfma_f32_16x16x32_bf16 v[88:91], a[44:47], a[72:75], v[88:91]
    ds_read_b64_tr_b16 a[100:101], v15 offset:24576
    v_mfma_f32_16x16x32_bf16 v[92:95], a[44:47], a[76:79], v[92:95]
    ds_read_b64_tr_b16 a[102:103], v15 offset:28672
    v_mfma_f32_16x16x32_bf16 v[96:99], a[48:51], a[64:67], v[96:99]
    ds_read_b64_tr_b16 a[104:105], v16 offset:24576
    s_add_u32 m0, s33, 49152
    v_mfma_f32_16x16x32_bf16 v[100:103], a[48:51], a[68:71], v[100:103]
    ds_read_b64_tr_b16 a[106:107], v16 offset:28672
    v_mfma_f32_16x16x32_bf16 v[104:107], a[48:51], a[72:75], v[104:107]
    ds_read_b64_tr_b16 a[108:109], v17 offset:24576
    v_mfma_f32_16x16x32_bf16 v[108:111], a[48:51], a[76:79], v[108:111]
    ds_read_b64_tr_b16 a[110:111], v17 offset:28672
    buffer_load_dwordx4 v24, s[12:15], s31 offen offset:0 lds
    v_mfma_f32_16x16x32_bf16 v[112:115], a[52:55], a[64:67], v[112:115]
    v_mfma_f32_16x16x32_bf16 v[116:119], a[52:55], a[68:71], v[116:119]
    v_mfma_f32_16x16x32_bf16 v[120:123], a[52:55], a[72:75], v[120:123]
    buffer_load_dwordx4 v25, s[12:15], s31 offen offset:1024 lds
    v_mfma_f32_16x16x32_bf16 v[124:127], a[52:55], a[76:79], v[124:127]
    v_mfma_f32_16x16x32_bf16 v[128:131], a[56:59], a[64:67], v[128:131]
    v_mfma_f32_16x16x32_bf16 v[132:135], a[56:59], a[68:71], v[132:135]
    s_add_u32 s30, s30, 262144
    v_mfma_f32_16x16x32_bf16 v[136:139], a[56:59], a[72:75], v[136:139]
    v_mfma_f32_16x16x32_bf16 v[140:143], a[56:59], a[76:79], v[140:143]
    v_mfma_f32_16x16x32_bf16 v[144:147], a[60:63], a[64:67], v[144:147]
    s_add_u32 s31, s31, 1024
    v_mfma_f32_16x16x32_bf16 v[148:151], a[60:63], a[68:71], v[148:151]
    v_mfma_f32_16x16x32_bf16 v[152:155], a[60:63], a[72:75], v[152:155]
    v_mfma_f32_16x16x32_bf16 v[156:159], a[60:63], a[76:79], v[156:159]
    s_waitcnt vmcnt(12) lgkmcnt(0)
    s_barrier
    v_mfma_f32_16x16x32_bf16 v[32:35], a[80:83], a[112:115], v[32:35]
    ds_read_b128 a[64:67], v18 offset:0
    s_add_u32 m0, s32, 73728
    v_mfma_f32_16x16x32_bf16 v[36:39], a[80:83], a[116:119], v[36:39]
    ds_read_b128 a[68:71], v18 offset:1024
    v_mfma_f32_16x16x32_bf16 v[40:43], a[80:83], a[120:123], v[40:43]
    ds_read_b128 a[72:75], v18 offset:2048
    v_mfma_f32_16x16x32_bf16 v[44:47], a[80:83], a[124:127], v[44:47]
    ds_read_b128 a[76:79], v18 offset:3072
    buffer_load_dwordx4 v20, s[8:11], s30 offen offset:0 lds
    v_mfma_f32_16x16x32_bf16 v[48:51], a[84:87], a[112:115], v[48:51]
    ds_read_b64_tr_b16 a[32:33], v2 offset:0
    v_mfma_f32_16x16x32_bf16 v[52:55], a[84:87], a[116:119], v[52:55]
    ds_read_b64_tr_b16 a[34:35], v2 offset:4096
    v_mfma_f32_16x16x32_bf16 v[56:59], a[84:87], a[120:123], v[56:59]
    ds_read_b64_tr_b16 a[36:37], v3 offset:0
    buffer_load_dwordx4 v21, s[8:11], s30 offen offset:1024 lds
    v_mfma_f32_16x16x32_bf16 v[60:63], a[84:87], a[124:127], v[60:63]
    ds_read_b64_tr_b16 a[38:39], v3 offset:4096
    v_mfma_f32_16x16x32_bf16 v[64:67], a[88:91], a[112:115], v[64:67]
    ds_read_b64_tr_b16 a[40:41], v4 offset:0
    v_mfma_f32_16x16x32_bf16 v[68:71], a[88:91], a[116:119], v[68:71]
    ds_read_b64_tr_b16 a[42:43], v4 offset:4096
    buffer_load_dwordx4 v22, s[8:11], s30 offen offset:2048 lds
    v_mfma_f32_16x16x32_bf16 v[72:75], a[88:91], a[120:123], v[72:75]
    ds_read_b64_tr_b16 a[44:45], v5 offset:0
    v_mfma_f32_16x16x32_bf16 v[76:79], a[88:91], a[124:127], v[76:79]
    ds_read_b64_tr_b16 a[46:47], v5 offset:4096
    v_mfma_f32_16x16x32_bf16 v[80:83], a[92:95], a[112:115], v[80:83]
    ds_read_b64_tr_b16 a[48:49], v6 offset:0
    buffer_load_dwordx4 v23, s[8:11], s30 offen offset:3072 lds
    v_mfma_f32_16x16x32_bf16 v[84:87], a[92:95], a[116:119], v[84:87]
    ds_read_b64_tr_b16 a[50:51], v6 offset:4096
    v_mfma_f32_16x16x32_bf16 v[88:91], a[92:95], a[120:123], v[88:91]
    ds_read_b64_tr_b16 a[52:53], v7 offset:0
    v_mfma_f32_16x16x32_bf16 v[92:95], a[92:95], a[124:127], v[92:95]
    ds_read_b64_tr_b16 a[54:55], v7 offset:4096
    v_mfma_f32_16x16x32_bf16 v[96:99], a[96:99], a[112:115], v[96:99]
    ds_read_b64_tr_b16 a[56:57], v8 offset:0
    s_add_u32 m0, s33, 73728
    v_mfma_f32_16x16x32_bf16 v[100:103], a[96:99], a[116:119], v[100:103]
    ds_read_b64_tr_b16 a[58:59], v8 offset:4096
    v_mfma_f32_16x16x32_bf16 v[104:107], a[96:99], a[120:123], v[104:107]
    ds_read_b64_tr_b16 a[60:61], v9 offset:0
    v_mfma_f32_16x16x32_bf16 v[108:111], a[96:99], a[124:127], v[108:111]
    ds_read_b64_tr_b16 a[62:63], v9 offset:4096
    buffer_load_dwordx4 v24, s[12:15], s31 offen offset:0 lds
    v_mfma_f32_16x16x32_bf16 v[112:115], a[100:103], a[112:115], v[112:115]
    v_mfma_f32_16x16x32_bf16 v[116:119], a[100:103], a[116:119], v[116:119]
    v_mfma_f32_16x16x32_bf16 v[120:123], a[100:103], a[120:123], v[120:123]
    buffer_load_dwordx4 v25, s[12:15], s31 offen offset:1024 lds
    v_mfma_f32_16x16x32_bf16 v[124:127], a[100:103], a[124:127], v[124:127]
    v_mfma_f32_16x16x32_bf16 v[128:131], a[104:107], a[112:115], v[128:131]
    v_mfma_f32_16x16x32_bf16 v[132:135], a[104:107], a[116:119], v[132:135]
    s_add_u32 s30, s30, 262144
    v_mfma_f32_16x16x32_bf16 v[136:139], a[104:107], a[120:123], v[136:139]
    v_mfma_f32_16x16x32_bf16 v[140:143], a[104:107], a[124:127], v[140:143]
    v_mfma_f32_16x16x32_bf16 v[144:147], a[108:111], a[112:115], v[144:147]
    s_add_u32 s31, s31, 1024
    v_mfma_f32_16x16x32_bf16 v[148:151], a[108:111], a[116:119], v[148:151]
    v_mfma_f32_16x16x32_bf16 v[152:155], a[108:111], a[120:123], v[152:155]
    v_mfma_f32_16x16x32_bf16 v[156:159], a[108:111], a[124:127], v[156:159]
    s_sub_u32 s34, s34, 1
    s_cmp_lg_u32 s34, 0
    s_cbranch_scc1 hh_loop_166
    s_waitcnt vmcnt(12) lgkmcnt(0)
    s_barrier
    v_mfma_f32_16x16x32_bf16 v[32:35], a[32:35], a[64:67], v[32:35]
    ds_read_b128 a[112:115], v18 offset:24576
    v_mfma_f32_16x16x32_bf16 v[36:39], a[32:35], a[68:71], v[36:39]
    ds_read_b128 a[116:119], v18 offset:25600
    v_mfma_f32_16x16x32_bf16 v[40:43], a[32:35], a[72:75], v[40:43]
    ds_read_b128 a[120:123], v18 offset:26624
    v_mfma_f32_16x16x32_bf16 v[44:47], a[32:35], a[76:79], v[44:47]
    ds_read_b128 a[124:127], v18 offset:27648
    v_mfma_f32_16x16x32_bf16 v[48:51], a[36:39], a[64:67], v[48:51]
    ds_read_b64_tr_b16 a[80:81], v2 offset:24576
    v_mfma_f32_16x16x32_bf16 v[52:55], a[36:39], a[68:71], v[52:55]
    ds_read_b64_tr_b16 a[82:83], v2 offset:28672
    v_mfma_f32_16x16x32_bf16 v[56:59], a[36:39], a[72:75], v[56:59]
    ds_read_b64_tr_b16 a[84:85], v3 offset:24576
    v_mfma_f32_16x16x32_bf16 v[60:63], a[36:39], a[76:79], v[60:63]
    ds_read_b64_tr_b16 a[86:87], v3 offset:28672
    v_mfma_f32_16x16x32_bf16 v[64:67], a[40:43], a[64:67], v[64:67]
    ds_read_b64_tr_b16 a[88:89], v4 offset:24576
    v_mfma_f32_16x16x32_bf16 v[68:71], a[40:43], a[68:71], v[68:71]
    ds_read_b64_tr_b16 a[90:91], v4 offset:28672
    v_mfma_f32_16x16x32_bf16 v[72:75], a[40:43], a[72:75], v[72:75]
    ds_read_b64_tr_b16 a[92:93], v5 offset:24576
    v_mfma_f32_16x16x32_bf16 v[76:79], a[40:43], a[76:79], v[76:79]
    ds_read_b64_tr_b16 a[94:95], v5 offset:28672
    v_mfma_f32_16x16x32_bf16 v[80:83], a[44:47], a[64:67], v[80:83]
    ds_read_b64_tr_b16 a[96:97], v6 offset:24576
    v_mfma_f32_16x16x32_bf16 v[84:87], a[44:47], a[68:71], v[84:87]
    ds_read_b64_tr_b16 a[98:99], v6 offset:28672
    v_mfma_f32_16x16x32_bf16 v[88:91], a[44:47], a[72:75], v[88:91]
    ds_read_b64_tr_b16 a[100:101], v7 offset:24576
    v_mfma_f32_16x16x32_bf16 v[92:95], a[44:47], a[76:79], v[92:95]
    ds_read_b64_tr_b16 a[102:103], v7 offset:28672
    v_mfma_f32_16x16x32_bf16 v[96:99], a[48:51], a[64:67], v[96:99]
    ds_read_b64_tr_b16 a[104:105], v8 offset:24576
    v_mfma_f32_16x16x32_bf16 v[100:103], a[48:51], a[68:71], v[100:103]
    ds_read_b64_tr_b16 a[106:107], v8 offset:28672
    v_mfma_f32_16x16x32_bf16 v[104:107], a[48:51], a[72:75], v[104:107]
    ds_read_b64_tr_b16 a[108:109], v9 offset:24576
    v_mfma_f32_16x16x32_bf16 v[108:111], a[48:51], a[76:79], v[108:111]
    ds_read_b64_tr_b16 a[110:111], v9 offset:28672
    v_mfma_f32_16x16x32_bf16 v[112:115], a[52:55], a[64:67], v[112:115]
    v_mfma_f32_16x16x32_bf16 v[116:119], a[52:55], a[68:71], v[116:119]
    v_mfma_f32_16x16x32_bf16 v[120:123], a[52:55], a[72:75], v[120:123]
    v_mfma_f32_16x16x32_bf16 v[124:127], a[52:55], a[76:79], v[124:127]
    v_mfma_f32_16x16x32_bf16 v[128:131], a[56:59], a[64:67], v[128:131]
    v_mfma_f32_16x16x32_bf16 v[132:135], a[56:59], a[68:71], v[132:135]
    v_mfma_f32_16x16x32_bf16 v[136:139], a[56:59], a[72:75], v[136:139]
    v_mfma_f32_16x16x32_bf16 v[140:143], a[56:59], a[76:79], v[140:143]
    v_mfma_f32_16x16x32_bf16 v[144:147], a[60:63], a[64:67], v[144:147]
    v_mfma_f32_16x16x32_bf16 v[148:151], a[60:63], a[68:71], v[148:151]
    v_mfma_f32_16x16x32_bf16 v[152:155], a[60:63], a[72:75], v[152:155]
    v_mfma_f32_16x16x32_bf16 v[156:159], a[60:63], a[76:79], v[156:159]
    s_waitcnt vmcnt(6) lgkmcnt(0)
    s_barrier
    v_mfma_f32_16x16x32_bf16 v[32:35], a[80:83], a[112:115], v[32:35]
    ds_read_b128 a[64:67], v19 offset:0
    v_mfma_f32_16x16x32_bf16 v[36:39], a[80:83], a[116:119], v[36:39]
    ds_read_b128 a[68:71], v19 offset:1024
    v_mfma_f32_16x16x32_bf16 v[40:43], a[80:83], a[120:123], v[40:43]
    ds_read_b128 a[72:75], v19 offset:2048
    v_mfma_f32_16x16x32_bf16 v[44:47], a[80:83], a[124:127], v[44:47]
    ds_read_b128 a[76:79], v19 offset:3072
    v_mfma_f32_16x16x32_bf16 v[48:51], a[84:87], a[112:115], v[48:51]
    ds_read_b64_tr_b16 a[32:33], v10 offset:0
    v_mfma_f32_16x16x32_bf16 v[52:55], a[84:87], a[116:119], v[52:55]
    ds_read_b64_tr_b16 a[34:35], v10 offset:4096
    v_mfma_f32_16x16x32_bf16 v[56:59], a[84:87], a[120:123], v[56:59]
    ds_read_b64_tr_b16 a[36:37], v11 offset:0
    v_mfma_f32_16x16x32_bf16 v[60:63], a[84:87], a[124:127], v[60:63]
    ds_read_b64_tr_b16 a[38:39], v11 offset:4096
    v_mfma_f32_16x16x32_bf16 v[64:67], a[88:91], a[112:115], v[64:67]
    ds_read_b64_tr_b16 a[40:41], v12 offset:0
    v_mfma_f32_16x16x32_bf16 v[68:71], a[88:91], a[116:119], v[68:71]
    ds_read_b64_tr_b16 a[42:43], v12 offset:4096
    v_mfma_f32_16x16x32_bf16 v[72:75], a[88:91], a[120:123], v[72:75]
    ds_read_b64_tr_b16 a[44:45], v13 offset:0
    v_mfma_f32_16x16x32_bf16 v[76:79], a[88:91], a[124:127], v[76:79]
    ds_read_b64_tr_b16 a[46:47], v13 offset:4096
    v_mfma_f32_16x16x32_bf16 v[80:83], a[92:95], a[112:115], v[80:83]
    ds_read_b64_tr_b16 a[48:49], v14 offset:0
    v_mfma_f32_16x16x32_bf16 v[84:87], a[92:95], a[116:119], v[84:87]
    ds_read_b64_tr_b16 a[50:51], v14 offset:4096
    v_mfma_f32_16x16x32_bf16 v[88:91], a[92:95], a[120:123], v[88:91]
    ds_read_b64_tr_b16 a[52:53], v15 offset:0
    v_mfma_f32_16x16x32_bf16 v[92:95], a[92:95], a[124:127], v[92:95]
    ds_read_b64_tr_b16 a[54:55], v15 offset:4096
    v_mfma_f32_16x16x32_bf16 v[96:99], a[96:99], a[112:115], v[96:99]
    ds_read_b64_tr_b16 a[56:57], v16 offset:0
    v_mfma_f32_16x16x32_bf16 v[100:103], a[96:99], a[116:119], v[100:103]
    ds_read_b64_tr_b16 a[58:59], v16 offset:4096
    v_mfma_f32_16x16x32_bf16 v[104:107], a[96:99], a[120:123], v[104:107]
    ds_read_b64_tr_b16 a[60:61], v17 offset:0
    v_mfma_f32_16x16x32_bf16 v[108:111], a[96:99], a[124:127], v[108:111]
    ds_read_b64_tr_b16 a[62:63], v17 offset:4096
    v_mfma_f32_16x16x32_bf16 v[112:115], a[100:103], a[112:115], v[112:115]
    v_mfma_f32_16x16x32_bf16 v[116:119], a[100:103], a[116:119], v[116:119]
    v_mfma_f32_16x16x32_bf16 v[120:123], a[100:103], a[120:123], v[120:123]
    v_mfma_f32_16x16x32_bf16 v[124:127], a[100:103], a[124:127], v[124:127]
    v_mfma_f32_16x16x32_bf16 v[128:131], a[104:107], a[112:115], v[128:131]
    v_mfma_f32_16x16x32_bf16 v[132:135], a[104:107], a[116:119], v[132:135]
    v_mfma_f32_16x16x32_bf16 v[136:139], a[104:107], a[120:123], v[136:139]
    v_mfma_f32_16x16x32_bf16 v[140:143], a[104:107], a[124:127], v[140:143]
    v_mfma_f32_16x16x32_bf16 v[144:147], a[108:111], a[112:115], v[144:147]
    v_mfma_f32_16x16x32_bf16 v[148:151], a[108:111], a[116:119], v[148:151]
    v_mfma_f32_16x16x32_bf16 v[152:155], a[108:111], a[120:123], v[152:155]
    v_mfma_f32_16x16x32_bf16 v[156:159], a[108:111], a[124:127], v[156:159]
    s_waitcnt vmcnt(0) lgkmcnt(0)
    s_barrier
    v_mfma_f32_16x16x32_bf16 v[32:35], a[32:35], a[64:67], v[32:35]
    ds_read_b128 a[112:115], v19 offset:24576
    v_mfma_f32_16x16x32_bf16 v[36:39], a[32:35], a[68:71], v[36:39]
    ds_read_b128 a[116:119], v19 offset:25600
    v_mfma_f32_16x16x32_bf16 v[40:43], a[32:35], a[72:75], v[40:43]
    ds_read_b128 a[120:123], v19 offset:26624
    v_mfma_f32_16x16x32_bf16 v[44:47], a[32:35], a[76:79], v[44:47]
    ds_read_b128 a[124:127], v19 offset:27648
    v_mfma_f32_16x16x32_bf16 v[48:51], a[36:39], a[64:67], v[48:51]
    ds_read_b64_tr_b16 a[80:81], v10 offset:24576
    v_mfma_f32_16x16x32_bf16 v[52:55], a[36:39], a[68:71], v[52:55]
    ds_read_b64_tr_b16 a[82:83], v10 offset:28672
    v_mfma_f32_16x16x32_bf16 v[56:59], a[36:39], a[72:75], v[56:59]
    ds_read_b64_tr_b16 a[84:85], v11 offset:24576
    v_mfma_f32_16x16x32_bf16 v[60:63], a[36:39], a[76:79], v[60:63]
    ds_read_b64_tr_b16 a[86:87], v11 offset:28672
    v_mfma_f32_16x16x32_bf16 v[64:67], a[40:43], a[64:67], v[64:67]
    ds_read_b64_tr_b16 a[88:89], v12 offset:24576
    v_mfma_f32_16x16x32_bf16 v[68:71], a[40:43], a[68:71], v[68:71]
    ds_read_b64_tr_b16 a[90:91], v12 offset:28672
    v_mfma_f32_16x16x32_bf16 v[72:75], a[40:43], a[72:75], v[72:75]
    ds_read_b64_tr_b16 a[92:93], v13 offset:24576
    v_mfma_f32_16x16x32_bf16 v[76:79], a[40:43], a[76:79], v[76:79]
    ds_read_b64_tr_b16 a[94:95], v13 offset:28672
    v_mfma_f32_16x16x32_bf16 v[80:83], a[44:47], a[64:67], v[80:83]
    ds_read_b64_tr_b16 a[96:97], v14 offset:24576
    v_mfma_f32_16x16x32_bf16 v[84:87], a[44:47], a[68:71], v[84:87]
    ds_read_b64_tr_b16 a[98:99], v14 offset:28672
    v_mfma_f32_16x16x32_bf16 v[88:91], a[44:47], a[72:75], v[88:91]
    ds_read_b64_tr_b16 a[100:101], v15 offset:24576
    v_mfma_f32_16x16x32_bf16 v[92:95], a[44:47], a[76:79], v[92:95]
    ds_read_b64_tr_b16 a[102:103], v15 offset:28672
    v_mfma_f32_16x16x32_bf16 v[96:99], a[48:51], a[64:67], v[96:99]
    ds_read_b64_tr_b16 a[104:105], v16 offset:24576
    v_mfma_f32_16x16x32_bf16 v[100:103], a[48:51], a[68:71], v[100:103]
    ds_read_b64_tr_b16 a[106:107], v16 offset:28672
    v_mfma_f32_16x16x32_bf16 v[104:107], a[48:51], a[72:75], v[104:107]
    ds_read_b64_tr_b16 a[108:109], v17 offset:24576
    v_mfma_f32_16x16x32_bf16 v[108:111], a[48:51], a[76:79], v[108:111]
    ds_read_b64_tr_b16 a[110:111], v17 offset:28672
    v_mfma_f32_16x16x32_bf16 v[112:115], a[52:55], a[64:67], v[112:115]
    v_mfma_f32_16x16x32_bf16 v[116:119], a[52:55], a[68:71], v[116:119]
    v_mfma_f32_16x16x32_bf16 v[120:123], a[52:55], a[72:75], v[120:123]
    v_mfma_f32_16x16x32_bf16 v[124:127], a[52:55], a[76:79], v[124:127]
    v_mfma_f32_16x16x32_bf16 v[128:131], a[56:59], a[64:67], v[128:131]
    v_mfma_f32_16x16x32_bf16 v[132:135], a[56:59], a[68:71], v[132:135]
    v_mfma_f32_16x16x32_bf16 v[136:139], a[56:59], a[72:75], v[136:139]
    v_mfma_f32_16x16x32_bf16 v[140:143], a[56:59], a[76:79], v[140:143]
    v_mfma_f32_16x16x32_bf16 v[144:147], a[60:63], a[64:67], v[144:147]
    v_mfma_f32_16x16x32_bf16 v[148:151], a[60:63], a[68:71], v[148:151]
    v_mfma_f32_16x16x32_bf16 v[152:155], a[60:63], a[72:75], v[152:155]
    v_mfma_f32_16x16x32_bf16 v[156:159], a[60:63], a[76:79], v[156:159]
    s_waitcnt lgkmcnt(0)
    v_mfma_f32_16x16x32_bf16 v[32:35], a[80:83], a[112:115], v[32:35]
    v_mfma_f32_16x16x32_bf16 v[36:39], a[80:83], a[116:119], v[36:39]
    v_mfma_f32_16x16x32_bf16 v[40:43], a[80:83], a[120:123], v[40:43]
    v_mfma_f32_16x16x32_bf16 v[44:47], a[80:83], a[124:127], v[44:47]
    v_mfma_f32_16x16x32_bf16 v[48:51], a[84:87], a[112:115], v[48:51]
    v_mfma_f32_16x16x32_bf16 v[52:55], a[84:87], a[116:119], v[52:55]
    v_mfma_f32_16x16x32_bf16 v[56:59], a[84:87], a[120:123], v[56:59]
    v_mfma_f32_16x16x32_bf16 v[60:63], a[84:87], a[124:127], v[60:63]
    v_mfma_f32_16x16x32_bf16 v[64:67], a[88:91], a[112:115], v[64:67]
    v_mfma_f32_16x16x32_bf16 v[68:71], a[88:91], a[116:119], v[68:71]
    v_mfma_f32_16x16x32_bf16 v[72:75], a[88:91], a[120:123], v[72:75]
    v_mfma_f32_16x16x32_bf16 v[76:79], a[88:91], a[124:127], v[76:79]
    v_mfma_f32_16x16x32_bf16 v[80:83], a[92:95], a[112:115], v[80:83]
    v_mfma_f32_16x16x32_bf16 v[84:87], a[92:95], a[116:119], v[84:87]
    v_mfma_f32_16x16x32_bf16 v[88:91], a[92:95], a[120:123], v[88:91]
    v_mfma_f32_16x16x32_bf16 v[92:95], a[92:95], a[124:127], v[92:95]
    v_mfma_f32_16x16x32_bf16 v[96:99], a[96:99], a[112:115], v[96:99]
    v_mfma_f32_16x16x32_bf16 v[100:103], a[96:99], a[116:119], v[100:103]
    v_mfma_f32_16x16x32_bf16 v[104:107], a[96:99], a[120:123], v[104:107]
    v_mfma_f32_16x16x32_bf16 v[108:111], a[96:99], a[124:127], v[108:111]
    v_mfma_f32_16x16x32_bf16 v[112:115], a[100:103], a[112:115], v[112:115]
    v_mfma_f32_16x16x32_bf16 v[116:119], a[100:103], a[116:119], v[116:119]
    v_mfma_f32_16x16x32_bf16 v[120:123], a[100:103], a[120:123], v[120:123]
    v_mfma_f32_16x16x32_bf16 v[124:127], a[100:103], a[124:127], v[124:127]
    v_mfma_f32_16x16x32_bf16 v[128:131], a[104:107], a[112:115], v[128:131]
    v_mfma_f32_16x16x32_bf16 v[132:135], a[104:107], a[116:119], v[132:135]
    v_mfma_f32_16x16x32_bf16 v[136:139], a[104:107], a[120:123], v[136:139]
    v_mfma_f32_16x16x32_bf16 v[140:143], a[104:107], a[124:127], v[140:143]
    v_mfma_f32_16x16x32_bf16 v[144:147], a[108:111], a[112:115], v[144:147]
    v_mfma_f32_16x16x32_bf16 v[148:151], a[108:111], a[116:119], v[148:151]
    v_mfma_f32_16x16x32_bf16 v[152:155], a[108:111], a[120:123], v[152:155]
    v_mfma_f32_16x16x32_bf16 v[156:159], a[108:111], a[124:127], v[156:159]
    s_mul_i32 s35, s26, 4
    s_add_u32 s35, s35, s28
    s_mul_i32 s35, s35, 128
    s_lshr_b32 s36, s39, 5
    s_add_u32 s35, s35, s36
    s_lshl_b32 s35, s35, 10
    v_lshlrev_b32 v2, 4, v1
    v_add_u32 v2, s35, v2
    s_mov_b32 s37, 0
    v_cvt_pk_bf16_f32 v4, v32, v33
    v_cvt_pk_bf16_f32 v5, v34, v35
    v_cvt_pk_bf16_f32 v6, v48, v49
    v_cvt_pk_bf16_f32 v7, v50, v51
    buffer_store_dwordx4 v[4:7], v2, s[16:19], s37 offen offset:0 sc1
    v_cvt_pk_bf16_f32 v8, v64, v65
    v_cvt_pk_bf16_f32 v9, v66, v67
    v_cvt_pk_bf16_f32 v10, v80, v81
    v_cvt_pk_bf16_f32 v11, v82, v83
    buffer_store_dwordx4 v[8:11], v2, s[16:19], s37 offen offset:1024 sc1
    v_cvt_pk_bf16_f32 v12, v96, v97
    v_cvt_pk_bf16_f32 v13, v98, v99
    v_cvt_pk_bf16_f32 v14, v112, v113
    v_cvt_pk_bf16_f32 v15, v114, v115
    buffer_store_dwordx4 v[12:15], v2, s[16:19], s37 offen offset:2048 sc1
    v_cvt_pk_bf16_f32 v16, v128, v129
    v_cvt_pk_bf16_f32 v17, v130, v131
    v_cvt_pk_bf16_f32 v18, v144, v145
    v_cvt_pk_bf16_f32 v19, v146, v147
    buffer_store_dwordx4 v[16:19], v2, s[16:19], s37 offen offset:3072 sc1
    s_mov_b32 s37, 131072
    v_cvt_pk_bf16_f32 v20, v36, v37
    v_cvt_pk_bf16_f32 v21, v38, v39
    v_cvt_pk_bf16_f32 v22, v52, v53
    v_cvt_pk_bf16_f32 v23, v54, v55
    buffer_store_dwordx4 v[20:23], v2, s[16:19], s37 offen offset:0 sc1
    v_cvt_pk_bf16_f32 v24, v68, v69
    v_cvt_pk_bf16_f32 v25, v70, v71
    v_cvt_pk_bf16_f32 v26, v84, v85
    v_cvt_pk_bf16_f32 v27, v86, v87
    buffer_store_dwordx4 v[24:27], v2, s[16:19], s37 offen offset:1024 sc1
    v_cvt_pk_bf16_f32 v4, v100, v101
    v_cvt_pk_bf16_f32 v5, v102, v103
    v_cvt_pk_bf16_f32 v6, v116, v117
    v_cvt_pk_bf16_f32 v7, v118, v119
    buffer_store_dwordx4 v[4:7], v2, s[16:19], s37 offen offset:2048 sc1
    v_cvt_pk_bf16_f32 v8, v132, v133
    v_cvt_pk_bf16_f32 v9, v134, v135
    v_cvt_pk_bf16_f32 v10, v148, v149
    v_cvt_pk_bf16_f32 v11, v150, v151
    buffer_store_dwordx4 v[8:11], v2, s[16:19], s37 offen offset:3072 sc1
    s_mov_b32 s37, 262144
    v_cvt_pk_bf16_f32 v12, v40, v41
    v_cvt_pk_bf16_f32 v13, v42, v43
    v_cvt_pk_bf16_f32 v14, v56, v57
    v_cvt_pk_bf16_f32 v15, v58, v59
    buffer_store_dwordx4 v[12:15], v2, s[16:19], s37 offen offset:0 sc1
    v_cvt_pk_bf16_f32 v16, v72, v73
    v_cvt_pk_bf16_f32 v17, v74, v75
    v_cvt_pk_bf16_f32 v18, v88, v89
    v_cvt_pk_bf16_f32 v19, v90, v91
    buffer_store_dwordx4 v[16:19], v2, s[16:19], s37 offen offset:1024 sc1
    v_cvt_pk_bf16_f32 v20, v104, v105
    v_cvt_pk_bf16_f32 v21, v106, v107
    v_cvt_pk_bf16_f32 v22, v120, v121
    v_cvt_pk_bf16_f32 v23, v122, v123
    buffer_store_dwordx4 v[20:23], v2, s[16:19], s37 offen offset:2048 sc1
    v_cvt_pk_bf16_f32 v24, v136, v137
    v_cvt_pk_bf16_f32 v25, v138, v139
    v_cvt_pk_bf16_f32 v26, v152, v153
    v_cvt_pk_bf16_f32 v27, v154, v155
    buffer_store_dwordx4 v[24:27], v2, s[16:19], s37 offen offset:3072 sc1
    s_mov_b32 s37, 393216
    v_cvt_pk_bf16_f32 v4, v44, v45
    v_cvt_pk_bf16_f32 v5, v46, v47
    v_cvt_pk_bf16_f32 v6, v60, v61
    v_cvt_pk_bf16_f32 v7, v62, v63
    buffer_store_dwordx4 v[4:7], v2, s[16:19], s37 offen offset:0 sc1
    v_cvt_pk_bf16_f32 v8, v76, v77
    v_cvt_pk_bf16_f32 v9, v78, v79
    v_cvt_pk_bf16_f32 v10, v92, v93
    v_cvt_pk_bf16_f32 v11, v94, v95
    buffer_store_dwordx4 v[8:11], v2, s[16:19], s37 offen offset:1024 sc1
    v_cvt_pk_bf16_f32 v12, v108, v109
    v_cvt_pk_bf16_f32 v13, v110, v111
    v_cvt_pk_bf16_f32 v14, v124, v125
    v_cvt_pk_bf16_f32 v15, v126, v127
    buffer_store_dwordx4 v[12:15], v2, s[16:19], s37 offen offset:2048 sc1
    v_cvt_pk_bf16_f32 v16, v140, v141
    v_cvt_pk_bf16_f32 v17, v142, v143
    v_cvt_pk_bf16_f32 v18, v156, v157
    v_cvt_pk_bf16_f32 v19, v158, v159
    buffer_store_dwordx4 v[16:19], v2, s[16:19], s37 offen offset:3072 sc1
    s_waitcnt vmcnt(0) lgkmcnt(0)
    s_barrier
    s_cmp_lg_u32 s90, 0
    s_cbranch_scc1 w0_167
    s_lshl_b32 s95, s88, 2
    s_add_u32 s95, s95, s79
    v_mov_b32 v2, s66
    s_mov_b64 exec, 1
    buffer_atomic_add v2, off, s[96:99], s95
    s_mov_b64 exec, -1
w0_167:
    s_add_u32 s67, s67, 1
    s_cmp_lt_u32 s67, s71
    s_cbranch_scc1 g_half
    s_cmp_lg_u32 s72, 0
    s_cbranch_scc1 g_roles
    s_mov_b32 s93, 1
g_round:
    s_cmp_lg_u32 s93, 0
    s_cbranch_scc1 rnd_169
    s_cmp_lt_u32 s92, 0
    s_cbranch_scc1 g_last
    s_sub_u32 s45, s92, 0
    s_mov_b32 s47, 1
    s_mov_b32 s48, 1
    s_mov_b32 s49, 0
    s_cmp_ge_u32 s45, 8
    s_cselect_b32 s47, 0, s47
    s_cselect_b32 s48, 0, s48
    s_cselect_b32 s49, 8, s49
    s_cmp_ge_u32 s45, 12
    s_cselect_b32 s47, 1, s47
    s_cselect_b32 s48, 0, s48
    s_cselect_b32 s49, 12, s49
    s_cmp_ge_u32 s45, 16
    s_cselect_b32 s47, 2, s47
    s_cselect_b32 s48, 1, s48
    s_cselect_b32 s49, 16, s49
    s_cmp_ge_u32 s45, 24
    s_cselect_b32 s47, 2, s47
    s_cselect_b32 s48, 0, s48
    s_cselect_b32 s49, 24, s49
    s_cmp_ge_u32 s45, 28
    s_cselect_b32 s47, 3, s47
    s_cselect_b32 s48, 0, s48
    s_cselect_b32 s49, 28, s49
    s_cmp_ge_u32 s45, 32
    s_cbranch_scc1 g_last
    s_branch g_tile_168
rnd_169:
    s_cmp_lg_u32 s93, 1
    s_cbranch_scc1 rnd_170
    s_cmp_lt_u32 s92, 2
    s_cbranch_scc1 g_last
    s_sub_u32 s45, s92, 2
    s_mov_b32 s47, 3
    s_mov_b32 s48, 1
    s_mov_b32 s49, 0
    s_cmp_ge_u32 s45, 8
    s_cselect_b32 s47, 4, s47
    s_cselect_b32 s48, 1, s48
    s_cselect_b32 s49, 8, s49
    s_cmp_ge_u32 s45, 16
    s_cselect_b32 s47, 4, s47
    s_cselect_b32 s48, 0, s48
    s_cselect_b32 s49, 16, s49
    s_cmp_ge_u32 s45, 20
    s_cselect_b32 s47, 5, s47
    s_cselect_b32 s48, 0, s48
    s_cselect_b32 s49, 20, s49
    s_cmp_ge_u32 s45, 24
    s_cselect_b32 s47, 5, s47
    s_cselect_b32 s48, 1, s48
    s_cselect_b32 s49, 24, s49
    s_cmp_ge_u32 s45, 30
    s_cbranch_scc1 g_last
    s_branch g_tile_168
rnd_170:
    s_cmp_lg_u32 s93, 2
    s_cbranch_scc1 rnd_171
    s_cmp_lt_u32 s92, 10
    s_cbranch_scc1 g_last
    s_sub_u32 s45, s92, 10
    s_mov_b32 s47, 5
    s_mov_b32 s48, 1
    s_mov_b32 s49, -6
    s_cmp_ge_u32 s45, 2
    s_cselect_b32 s47, 6, s47
    s_cselect_b32 s48, 1, s48
    s_cselect_b32 s49, 2, s49
    s_cmp_ge_u32 s45, 10
    s_cselect_b32 s47, 7, s47
    s_cselect_b32 s48, 1, s48
    s_cselect_b32 s49, 10, s49
    s_cmp_ge_u32 s45, 18
    s_cselect_b32 s47, 6, s47
    s_cselect_b32 s48, 0, s48
    s_cselect_b32 s49, 18, s49
    s_cmp_ge_u32 s45, 22
    s_cbranch_scc1 g_last
    s_branch g_tile_168
rnd_171:
    s_branch g_last
g_tile_168:
    s_sub_i32 s46, s45, s49
    s_add_u32 s50, s48, 2
    s_lshl_b32 s50, s91, s50
    s_add_u32 s46, s46, s50
    s_lshr_b32 s50, s46, 4
    s_add_u32 s48, s48, s50
    s_and_b32 s46, s46, 15
    s_mov_b32 s24, s90
    s_and_b32 s25, s90, 1
    s_lshr_b32 s26, s90, 1
    v_mbcnt_lo_u32_b32 v1, -1, 0
    v_mbcnt_hi_u32_b32 v1, -1, v1
    s_lshl_b32 s49, s48, 3
    s_add_u32 s50, s0, s49
    s_addc_u32 s51, s1, 0
    s_load_dwordx2 s[6:7], s[50:51], 16
    s_lshl_b32 s88, s47, 1
    s_waitcnt lgkmcnt(0)
    s_mov_b32 s8, s6
    s_mov_b32 s9, s7
    s_mov_b32 s10, 0x800000
    s_mov_b32 s11, 0x20000
    s_mov_b32 s12, s4
    s_mov_b32 s13, s5
    s_mov_b32 s14, 0x400000
    s_mov_b32 s15, 0x20000
    s_lshl_b32 s49, s48, 24
    s_add_u32 s50, s4, s49
    s_addc_u32 s51, s5, 0
    s_add_u32 s16, s50, 0x400000
    s_addc_u32 s17, s51, 0
    s_mov_b32 s18, 0x1000000
    s_mov_b32 s19, 0x20000
    s_mul_i32 s28, s47, 16
    s_mov_b32 s29, 0
    s_lshl_b32 s49, s46, 8
    s_lshr_b32 s50, s24, 1
    s_lshl_b32 s50, s50, 7
    s_add_u32 s50, s50, s49
    s_lshl_b32 s27, s50, 1
    s_lshl_b32 s50, s25, 7
    s_add_u32 s39, s50, s49
    s_cmp_eq_u32 s48, 0
    s_cselect_b32 s79, 64, 0
    s_cselect_b32 s66, 1, 2
    s_add_u32 s79, s79, 4096
    v_lshrrev_b32 v28, 2, v1
    v_and_b32 v29, 7, v28
    v_lshlrev_b32 v28, 8, v28
    v_and_b32 v30, 3, v1
    v_lshl_add_u32 v28, v30, 3, v28
    s_mul_i32 s35, s25, 8192
    s_add_u32 s35, s35, 0
    v_add_u32 v28, s35, v28
    v_xor_b32 v30, 0, v29
    v_lshl_add_u32 v2, v30, 5, v28
    v_add_u32 v10, 65536, v2
    v_xor_b32 v30, 1, v29
    v_lshl_add_u32 v3, v30, 5, v28
    v_add_u32 v11, 65536, v3
    v_xor_b32 v30, 2, v29
    v_lshl_add_u32 v4, v30, 5, v28
    v_add_u32 v12, 65536, v4
    v_xor_b32 v30, 3, v29
    v_lshl_add_u32 v5, v30, 5, v28
    v_add_u32 v13, 65536, v5
    v_xor_b32 v30, 4, v29
    v_lshl_add_u32 v6, v30, 5, v28
    v_add_u32 v14, 65536, v6
    v_xor_b32 v30, 5, v29
    v_lshl_add_u32 v7, v30, 5, v28
    v_add_u32 v15, 65536, v7
    v_xor_b32 v30, 6, v29
    v_lshl_add_u32 v8, v30, 5, v28
    v_add_u32 v16, 65536, v8
    v_xor_b32 v30, 7, v29
    v_lshl_add_u32 v9, v30, 5, v28
    v_add_u32 v17, 65536, v9
    s_mul_i32 s35, s26, 8192
    s_add_u32 s35, s35, 16384
    v_lshlrev_b32 v28, 4, v1
    v_add_u32 v18, s35, v28
    v_add_u32 v19, 65536, v18
    s_mul_i32 s35, s24, 4
    s_add_u32 s35, s35, 0
    s_add_u32 s35, s35, s28
    s_mul_i32 s35, s35, 32
    s_add_u32 s35, s35, s29
    s_lshl_b32 s35, s35, 10
    v_add_u32 v24, s35, v28
    s_mul_i32 s35, s24, 4
    s_add_u32 s35, s35, 1
    s_add_u32 s35, s35, s28
    s_mul_i32 s35, s35, 32
    s_add_u32 s35, s35, s29
    s_add_i32 s35, s35, -1
    s_lshl_b32 s35, s35, 10
    v_add_u32 v25, s35, v28
    s_mul_i32 s35, s24, 4
    s_add_u32 s35, s35, 2
    s_add_u32 s35, s35, s28
    s_mul_i32 s35, s35, 32
    s_add_u32 s35, s35, s29
    s_add_i32 s35, s35, -2
    s_lshl_b32 s35, s35, 10
    v_add_u32 v26, s35, v28
    s_mul_i32 s35, s24, 4
    s_add_u32 s35, s35, 3
    s_add_u32 s35, s35, s28
    s_mul_i32 s35, s35, 32
    s_add_u32 s35, s35, s29
    s_add_i32 s35, s35, -3
    s_lshl_b32 s35, s35, 10
    v_add_u32 v27, s35, v28
    s_lshl_b32 s35, s24, 2
    s_and_b32 s35, s35, 7
    s_lshl_b32 s36, s29, 3
    s_add_u32 s35, s35, s36
    s_mul_i32 s35, s35, 32768
    s_add_u32 s35, s35, s27
    v_lshrrev_b32 v28, 4, v1
    s_mov_b32 s36, 8192
    v_mul_lo_u32 v29, v28, s36
    v_add_u32 v29, s35, v29
    v_and_b32 v30, 15, v1
    v_lshlrev_b32 v31, 1, v28
    v_xor_b32 v31, v31, v30
    v_lshl_add_u32 v20, v31, 4, v29
    v_lshlrev_b32 v31, 1, v28
    v_add_u32 v31, 8, v31
    v_xor_b32 v31, v31, v30
    v_lshl_add_u32 v21, v31, 4, v29
    v_add_u32 v21, 31744, v21
    v_lshlrev_b32 v31, 1, v28
    v_xor_b32 v31, v31, v30
    v_lshl_add_u32 v22, v31, 4, v29
    v_add_u32 v22, 63488, v22
    v_lshlrev_b32 v31, 1, v28
    v_add_u32 v31, 8, v31
    v_xor_b32 v31, v31, v30
    v_lshl_add_u32 v23, v31, 4, v29
    v_add_u32 v23, 95232, v23
    s_lshl_b32 s32, s24, 12
    s_mul_i32 s33, s24, 4096
    s_add_u32 s33, s33, 16384
    s_mov_b32 s30, 0
    s_mov_b32 s31, 0
    s_add_u32 m0, s32, 0
    s_nop 0
    buffer_load_dwordx4 v20, s[8:11], s30 offen offset:0 lds
    buffer_load_dwordx4 v21, s[8:11], s30 offen offset:1024 lds
    buffer_load_dwordx4 v22, s[8:11], s30 offen offset:2048 lds
    buffer_load_dwordx4 v23, s[8:11], s30 offen offset:3072 lds
    s_add_u32 m0, s33, 0
    s_nop 0
    buffer_load_dwordx4 v24, s[12:15], s31 offen offset:0 lds
    buffer_load_dwordx4 v25, s[12:15], s31 offen offset:1024 lds
    buffer_load_dwordx4 v26, s[12:15], s31 offen offset:2048 lds
    buffer_load_dwordx4 v27, s[12:15], s31 offen offset:3072 lds
    s_add_u32 s30, s30, 262144
    s_add_u32 s31, s31, 1024
    s_add_u32 m0, s32, 32768
    s_nop 0
    buffer_load_dwordx4 v20, s[8:11], s30 offen offset:0 lds
    buffer_load_dwordx4 v21, s[8:11], s30 offen offset:1024 lds
    buffer_load_dwordx4 v22, s[8:11], s30 offen offset:2048 lds
    buffer_load_dwordx4 v23, s[8:11], s30 offen offset:3072 lds
    s_add_u32 m0, s33, 32768
    s_nop 0
    buffer_load_dwordx4 v24, s[12:15], s31 offen offset:0 lds
    buffer_load_dwordx4 v25, s[12:15], s31 offen offset:1024 lds
    buffer_load_dwordx4 v26, s[12:15], s31 offen offset:2048 lds
    buffer_load_dwordx4 v27, s[12:15], s31 offen offset:3072 lds
    s_add_u32 s30, s30, 262144
    s_add_u32 s31, s31, 1024
    s_add_u32 m0, s32, 65536
    s_nop 0
    buffer_load_dwordx4 v20, s[8:11], s30 offen offset:0 lds
    buffer_load_dwordx4 v21, s[8:11], s30 offen offset:1024 lds
    buffer_load_dwordx4 v22, s[8:11], s30 offen offset:2048 lds
    buffer_load_dwordx4 v23, s[8:11], s30 offen offset:3072 lds
    s_add_u32 m0, s33, 65536
    s_nop 0
    buffer_load_dwordx4 v24, s[12:15], s31 offen offset:0 lds
    buffer_load_dwordx4 v25, s[12:15], s31 offen offset:1024 lds
    buffer_load_dwordx4 v26, s[12:15], s31 offen offset:2048 lds
    buffer_load_dwordx4 v27, s[12:15], s31 offen offset:3072 lds
    s_add_u32 s30, s30, 262144
    s_add_u32 s31, s31, 1024
    s_add_u32 m0, s32, 98304
    s_nop 0
    buffer_load_dwordx4 v20, s[8:11], s30 offen offset:0 lds
    buffer_load_dwordx4 v21, s[8:11], s30 offen offset:1024 lds
    buffer_load_dwordx4 v22, s[8:11], s30 offen offset:2048 lds
    buffer_load_dwordx4 v23, s[8:11], s30 offen offset:3072 lds
    s_add_u32 m0, s33, 98304
    s_nop 0
    buffer_load_dwordx4 v24, s[12:15], s31 offen offset:0 lds
    buffer_load_dwordx4 v25, s[12:15], s31 offen offset:1024 lds
    buffer_load_dwordx4 v26, s[12:15], s31 offen offset:2048 lds
    buffer_load_dwordx4 v27, s[12:15], s31 offen offset:3072 lds
    s_add_u32 s30, s30, 262144
    s_add_u32 s31, s31, 1024
    v_mov_b32 v32, 0
    v_mov_b32 v33, 0
    v_mov_b32 v34, 0
    v_mov_b32 v35, 0
    v_mov_b32 v36, 0
    v_mov_b32 v37, 0
    v_mov_b32 v38, 0
    v_mov_b32 v39, 0
    v_mov_b32 v40, 0
    v_mov_b32 v41, 0
    v_mov_b32 v42, 0
    v_mov_b32 v43, 0
    v_mov_b32 v44, 0
    v_mov_b32 v45, 0
    v_mov_b32 v46, 0
    v_mov_b32 v47, 0
    v_mov_b32 v48, 0
    v_mov_b32 v49, 0
    v_mov_b32 v50, 0
    v_mov_b32 v51, 0
    v_mov_b32 v52, 0
    v_mov_b32 v53, 0
    v_mov_b32 v54, 0
    v_mov_b32 v55, 0
    v_mov_b32 v56, 0
    v_mov_b32 v57, 0
    v_mov_b32 v58, 0
    v_mov_b32 v59, 0
    v_mov_b32 v60, 0
    v_mov_b32 v61, 0
    v_mov_b32 v62, 0
    v_mov_b32 v63, 0
    v_mov_b32 v64, 0
    v_mov_b32 v65, 0
    v_mov_b32 v66, 0
    v_mov_b32 v67, 0
    v_mov_b32 v68, 0
    v_mov_b32 v69, 0
    v_mov_b32 v70, 0
    v_mov_b32 v71, 0
    v_mov_b32 v72, 0
    v_mov_b32 v73, 0
    v_mov_b32 v74, 0
    v_mov_b32 v75, 0
    v_mov_b32 v76, 0
    v_mov_b32 v77, 0
    v_mov_b32 v78, 0
    v_mov_b32 v79, 0
    v_mov_b32 v80, 0
    v_mov_b32 v81, 0
    v_mov_b32 v82, 0
    v_mov_b32 v83, 0
    v_mov_b32 v84, 0
    v_mov_b32 v85, 0
    v_mov_b32 v86, 0
    v_mov_b32 v87, 0
    v_mov_b32 v88, 0
    v_mov_b32 v89, 0
    v_mov_b32 v90, 0
    v_mov_b32 v91, 0
    v_mov_b32 v92, 0
    v_mov_b32 v93, 0
    v_mov_b32 v94, 0
    v_mov_b32 v95, 0
    v_mov_b32 v96, 0
    v_mov_b32 v97, 0
    v_mov_b32 v98, 0
    v_mov_b32 v99, 0
    v_mov_b32 v100, 0
    v_mov_b32 v101, 0
    v_mov_b32 v102, 0
    v_mov_b32 v103, 0
    v_mov_b32 v104, 0
    v_mov_b32 v105, 0
    v_mov_b32 v106, 0
    v_mov_b32 v107, 0
    v_mov_b32 v108, 0
    v_mov_b32 v109, 0
    v_mov_b32 v110, 0
    v_mov_b32 v111, 0
    v_mov_b32 v112, 0
    v_mov_b32 v113, 0
    v_mov_b32 v114, 0
    v_mov_b32 v115, 0
    v_mov_b32 v116, 0
    v_mov_b32 v117, 0
    v_mov_b32 v118, 0
    v_mov_b32 v119, 0
    v_mov_b32 v120, 0
    v_mov_b32 v121, 0
    v_mov_b32 v122, 0
    v_mov_b32 v123, 0
    v_mov_b32 v124, 0
    v_mov_b32 v125, 0
    v_mov_b32 v126, 0
    v_mov_b32 v127, 0
    v_mov_b32 v128, 0
    v_mov_b32 v129, 0
    v_mov_b32 v130, 0
    v_mov_b32 v131, 0
    v_mov_b32 v132, 0
    v_mov_b32 v133, 0
    v_mov_b32 v134, 0
    v_mov_b32 v135, 0
    v_mov_b32 v136, 0
    v_mov_b32 v137, 0
    v_mov_b32 v138, 0
    v_mov_b32 v139, 0
    v_mov_b32 v140, 0
    v_mov_b32 v141, 0
    v_mov_b32 v142, 0
    v_mov_b32 v143, 0
    v_mov_b32 v144, 0
    v_mov_b32 v145, 0
    v_mov_b32 v146, 0
    v_mov_b32 v147, 0
    v_mov_b32 v148, 0
    v_mov_b32 v149, 0
    v_mov_b32 v150, 0
    v_mov_b32 v151, 0
    v_mov_b32 v152, 0
    v_mov_b32 v153, 0
    v_mov_b32 v154, 0
    v_mov_b32 v155, 0
    v_mov_b32 v156, 0
    v_mov_b32 v157, 0
    v_mov_b32 v158, 0
    v_mov_b32 v159, 0
    v_mov_b32 v160, 0
    v_mov_b32 v161, 0
    v_mov_b32 v162, 0
    v_mov_b32 v163, 0
    v_mov_b32 v164, 0
    v_mov_b32 v165, 0
    v_mov_b32 v166, 0
    v_mov_b32 v167, 0
    v_mov_b32 v168, 0
    v_mov_b32 v169, 0
    v_mov_b32 v170, 0
    v_mov_b32 v171, 0
    v_mov_b32 v172, 0
    v_mov_b32 v173, 0
    v_mov_b32 v174, 0
    v_mov_b32 v175, 0
    v_mov_b32 v176, 0
    v_mov_b32 v177, 0
    v_mov_b32 v178, 0
    v_mov_b32 v179, 0
    v_mov_b32 v180, 0
    v_mov_b32 v181, 0
    v_mov_b32 v182, 0
    v_mov_b32 v183, 0
    v_mov_b32 v184, 0
    v_mov_b32 v185, 0
    v_mov_b32 v186, 0
    v_mov_b32 v187, 0
    v_mov_b32 v188, 0
    v_mov_b32 v189, 0
    v_mov_b32 v190, 0
    v_mov_b32 v191, 0
    v_mov_b32 v192, 0
    v_mov_b32 v193, 0
    v_mov_b32 v194, 0
    v_mov_b32 v195, 0
    v_mov_b32 v196, 0
    v_mov_b32 v197, 0
    v_mov_b32 v198, 0
    v_mov_b32 v199, 0
    v_mov_b32 v200, 0
    v_mov_b32 v201, 0
    v_mov_b32 v202, 0
    v_mov_b32 v203, 0
    v_mov_b32 v204, 0
    v_mov_b32 v205, 0
    v_mov_b32 v206, 0
    v_mov_b32 v207, 0
    v_mov_b32 v208, 0
    v_mov_b32 v209, 0
    v_mov_b32 v210, 0
    v_mov_b32 v211, 0
    v_mov_b32 v212, 0
    v_mov_b32 v213, 0
    v_mov_b32 v214, 0
    v_mov_b32 v215, 0
    v_mov_b32 v216, 0
    v_mov_b32 v217, 0
    v_mov_b32 v218, 0
    v_mov_b32 v219, 0
    v_mov_b32 v220, 0
    v_mov_b32 v221, 0
    v_mov_b32 v222, 0
    v_mov_b32 v223, 0
    v_mov_b32 v224, 0
    v_mov_b32 v225, 0
    v_mov_b32 v226, 0
    v_mov_b32 v227, 0
    v_mov_b32 v228, 0
    v_mov_b32 v229, 0
    v_mov_b32 v230, 0
    v_mov_b32 v231, 0
    v_mov_b32 v232, 0
    v_mov_b32 v233, 0
    v_mov_b32 v234, 0
    v_mov_b32 v235, 0
    v_mov_b32 v236, 0
    v_mov_b32 v237, 0
    v_mov_b32 v238, 0
    v_mov_b32 v239, 0
    v_mov_b32 v240, 0
    v_mov_b32 v241, 0
    v_mov_b32 v242, 0
    v_mov_b32 v243, 0
    v_mov_b32 v244, 0
    v_mov_b32 v245, 0
    v_mov_b32 v246, 0
    v_mov_b32 v247, 0
    v_mov_b32 v248, 0
    v_mov_b32 v249, 0
    v_mov_b32 v250, 0
    v_mov_b32 v251, 0
    v_mov_b32 v252, 0
    v_mov_b32 v253, 0
    v_mov_b32 v254, 0
    v_mov_b32 v255, 0
    v_accvgpr_write_b32 a0, 0
    v_accvgpr_write_b32 a1, 0
    v_accvgpr_write_b32 a2, 0
    v_accvgpr_write_b32 a3, 0
    v_accvgpr_write_b32 a4, 0
    v_accvgpr_write_b32 a5, 0
    v_accvgpr_write_b32 a6, 0
    v_accvgpr_write_b32 a7, 0
    v_accvgpr_write_b32 a8, 0
    v_accvgpr_write_b32 a9, 0
    v_accvgpr_write_b32 a10, 0
    v_accvgpr_write_b32 a11, 0
    v_accvgpr_write_b32 a12, 0
    v_accvgpr_write_b32 a13, 0
    v_accvgpr_write_b32 a14, 0
    v_accvgpr_write_b32 a15, 0
    v_accvgpr_write_b32 a16, 0
    v_accvgpr_write_b32 a17, 0
    v_accvgpr_write_b32 a18, 0
    v_accvgpr_write_b32 a19, 0
    v_accvgpr_write_b32 a20, 0
    v_accvgpr_write_b32 a21, 0
    v_accvgpr_write_b32 a22, 0
    v_accvgpr_write_b32 a23, 0
    v_accvgpr_write_b32 a24, 0
    v_accvgpr_write_b32 a25, 0
    v_accvgpr_write_b32 a26, 0
    v_accvgpr_write_b32 a27, 0
    v_accvgpr_write_b32 a28, 0
    v_accvgpr_write_b32 a29, 0
    v_accvgpr_write_b32 a30, 0
    v_accvgpr_write_b32 a31, 0
    s_waitcnt vmcnt(24)
    s_barrier
    ds_read_b128 a[64:67], v18 offset:0
    ds_read_b128 a[68:71], v18 offset:1024
    ds_read_b128 a[72:75], v18 offset:2048
    ds_read_b128 a[76:79], v18 offset:3072
    ds_read_b128 a[80:83], v18 offset:4096
    ds_read_b128 a[84:87], v18 offset:5120
    ds_read_b128 a[88:91], v18 offset:6144
    ds_read_b128 a[92:95], v18 offset:7168
    ds_read_b64_tr_b16 a[32:33], v2 offset:0
    ds_read_b64_tr_b16 a[34:35], v2 offset:4096
    ds_read_b64_tr_b16 a[36:37], v3 offset:0
    ds_read_b64_tr_b16 a[38:39], v3 offset:4096
    ds_read_b64_tr_b16 a[40:41], v4 offset:0
    ds_read_b64_tr_b16 a[42:43], v4 offset:4096
    ds_read_b64_tr_b16 a[44:45], v5 offset:0
    ds_read_b64_tr_b16 a[46:47], v5 offset:4096
    ds_read_b64_tr_b16 a[48:49], v6 offset:0
    ds_read_b64_tr_b16 a[50:51], v6 offset:4096
    ds_read_b64_tr_b16 a[52:53], v7 offset:0
    ds_read_b64_tr_b16 a[54:55], v7 offset:4096
    ds_read_b64_tr_b16 a[56:57], v8 offset:0
    ds_read_b64_tr_b16 a[58:59], v8 offset:4096
    ds_read_b64_tr_b16 a[60:61], v9 offset:0
    ds_read_b64_tr_b16 a[62:63], v9 offset:4096
    s_mov_b32 s34, 7
hq_loop_172:
    s_waitcnt vmcnt(16) lgkmcnt(0)
    s_barrier
    v_mfma_f32_16x16x32_bf16 v[32:35], a[32:35], a[64:67], v[32:35]
    ds_read_b128 a[128:131], v18 offset:32768
    s_add_u32 m0, s32, 0
    v_mfma_f32_16x16x32_bf16 v[36:39], a[32:35], a[68:71], v[36:39]
    ds_read_b128 a[132:135], v18 offset:33792
    v_mfma_f32_16x16x32_bf16 v[40:43], a[32:35], a[72:75], v[40:43]
    v_mfma_f32_16x16x32_bf16 v[44:47], a[32:35], a[76:79], v[44:47]
    ds_read_b128 a[136:139], v18 offset:34816
    v_mfma_f32_16x16x32_bf16 v[48:51], a[32:35], a[80:83], v[48:51]
    v_mfma_f32_16x16x32_bf16 v[52:55], a[32:35], a[84:87], v[52:55]
    ds_read_b128 a[140:143], v18 offset:35840
    buffer_load_dwordx4 v20, s[8:11], s30 offen offset:0 lds
    v_mfma_f32_16x16x32_bf16 v[56:59], a[32:35], a[88:91], v[56:59]
    ds_read_b128 a[144:147], v18 offset:36864
    v_mfma_f32_16x16x32_bf16 v[60:63], a[32:35], a[92:95], v[60:63]
    v_mfma_f32_16x16x32_bf16 v[64:67], a[36:39], a[64:67], v[64:67]
    ds_read_b128 a[148:151], v18 offset:37888
    v_mfma_f32_16x16x32_bf16 v[68:71], a[36:39], a[68:71], v[68:71]
    v_mfma_f32_16x16x32_bf16 v[72:75], a[36:39], a[72:75], v[72:75]
    ds_read_b128 a[152:155], v18 offset:38912
    buffer_load_dwordx4 v21, s[8:11], s30 offen offset:1024 lds
    v_mfma_f32_16x16x32_bf16 v[76:79], a[36:39], a[76:79], v[76:79]
    ds_read_b128 a[156:159], v18 offset:39936
    v_mfma_f32_16x16x32_bf16 v[80:83], a[36:39], a[80:83], v[80:83]
    v_mfma_f32_16x16x32_bf16 v[84:87], a[36:39], a[84:87], v[84:87]
    ds_read_b64_tr_b16 a[96:97], v2 offset:32768
    v_mfma_f32_16x16x32_bf16 v[88:91], a[36:39], a[88:91], v[88:91]
    v_mfma_f32_16x16x32_bf16 v[92:95], a[36:39], a[92:95], v[92:95]
    ds_read_b64_tr_b16 a[98:99], v2 offset:36864
    v_mfma_f32_16x16x32_bf16 v[96:99], a[40:43], a[64:67], v[96:99]
    ds_read_b64_tr_b16 a[100:101], v3 offset:32768
    buffer_load_dwordx4 v22, s[8:11], s30 offen offset:2048 lds
    v_mfma_f32_16x16x32_bf16 v[100:103], a[40:43], a[68:71], v[100:103]
    v_mfma_f32_16x16x32_bf16 v[104:107], a[40:43], a[72:75], v[104:107]
    ds_read_b64_tr_b16 a[102:103], v3 offset:36864
    v_mfma_f32_16x16x32_bf16 v[108:111], a[40:43], a[76:79], v[108:111]
    v_mfma_f32_16x16x32_bf16 v[112:115], a[40:43], a[80:83], v[112:115]
    ds_read_b64_tr_b16 a[104:105], v4 offset:32768
    v_mfma_f32_16x16x32_bf16 v[116:119], a[40:43], a[84:87], v[116:119]
    ds_read_b64_tr_b16 a[106:107], v4 offset:36864
    buffer_load_dwordx4 v23, s[8:11], s30 offen offset:3072 lds
    v_mfma_f32_16x16x32_bf16 v[120:123], a[40:43], a[88:91], v[120:123]
    v_mfma_f32_16x16x32_bf16 v[124:127], a[40:43], a[92:95], v[124:127]
    ds_read_b64_tr_b16 a[108:109], v5 offset:32768
    v_mfma_f32_16x16x32_bf16 v[128:131], a[44:47], a[64:67], v[128:131]
    v_mfma_f32_16x16x32_bf16 v[132:135], a[44:47], a[68:71], v[132:135]
    ds_read_b64_tr_b16 a[110:111], v5 offset:36864
    v_mfma_f32_16x16x32_bf16 v[136:139], a[44:47], a[72:75], v[136:139]
    ds_read_b64_tr_b16 a[112:113], v6 offset:32768
    s_add_u32 m0, s33, 0
    v_mfma_f32_16x16x32_bf16 v[140:143], a[44:47], a[76:79], v[140:143]
    v_mfma_f32_16x16x32_bf16 v[144:147], a[44:47], a[80:83], v[144:147]
    ds_read_b64_tr_b16 a[114:115], v6 offset:36864
    v_mfma_f32_16x16x32_bf16 v[148:151], a[44:47], a[84:87], v[148:151]
    v_mfma_f32_16x16x32_bf16 v[152:155], a[44:47], a[88:91], v[152:155]
    ds_read_b64_tr_b16 a[116:117], v7 offset:32768
    v_mfma_f32_16x16x32_bf16 v[156:159], a[44:47], a[92:95], v[156:159]
    ds_read_b64_tr_b16 a[118:119], v7 offset:36864
    v_mfma_f32_16x16x32_bf16 v[160:163], a[48:51], a[64:67], v[160:163]
    buffer_load_dwordx4 v24, s[12:15], s31 offen offset:0 lds
    v_mfma_f32_16x16x32_bf16 v[164:167], a[48:51], a[68:71], v[164:167]
    ds_read_b64_tr_b16 a[120:121], v8 offset:32768
    v_mfma_f32_16x16x32_bf16 v[168:171], a[48:51], a[72:75], v[168:171]
    v_mfma_f32_16x16x32_bf16 v[172:175], a[48:51], a[76:79], v[172:175]
    ds_read_b64_tr_b16 a[122:123], v8 offset:36864
    v_mfma_f32_16x16x32_bf16 v[176:179], a[48:51], a[80:83], v[176:179]
    ds_read_b64_tr_b16 a[124:125], v9 offset:32768
    v_mfma_f32_16x16x32_bf16 v[180:183], a[48:51], a[84:87], v[180:183]
    buffer_load_dwordx4 v25, s[12:15], s31 offen offset:1024 lds
    v_mfma_f32_16x16x32_bf16 v[184:187], a[48:51], a[88:91], v[184:187]
    ds_read_b64_tr_b16 a[126:127], v9 offset:36864
    v_mfma_f32_16x16x32_bf16 v[188:191], a[48:51], a[92:95], v[188:191]
    v_mfma_f32_16x16x32_bf16 v[192:195], a[52:55], a[64:67], v[192:195]
    v_mfma_f32_16x16x32_bf16 v[196:199], a[52:55], a[68:71], v[196:199]
    v_mfma_f32_16x16x32_bf16 v[200:203], a[52:55], a[72:75], v[200:203]
    buffer_load_dwordx4 v26, s[12:15], s31 offen offset:2048 lds
    v_mfma_f32_16x16x32_bf16 v[204:207], a[52:55], a[76:79], v[204:207]
    v_mfma_f32_16x16x32_bf16 v[208:211], a[52:55], a[80:83], v[208:211]
    v_mfma_f32_16x16x32_bf16 v[212:215], a[52:55], a[84:87], v[212:215]
    v_mfma_f32_16x16x32_bf16 v[216:219], a[52:55], a[88:91], v[216:219]
    v_mfma_f32_16x16x32_bf16 v[220:223], a[52:55], a[92:95], v[220:223]
    v_mfma_f32_16x16x32_bf16 v[224:227], a[56:59], a[64:67], v[224:227]
    buffer_load_dwordx4 v27, s[12:15], s31 offen offset:3072 lds
    v_mfma_f32_16x16x32_bf16 v[228:231], a[56:59], a[68:71], v[228:231]
    v_mfma_f32_16x16x32_bf16 v[232:235], a[56:59], a[72:75], v[232:235]
    v_mfma_f32_16x16x32_bf16 v[236:239], a[56:59], a[76:79], v[236:239]
    v_mfma_f32_16x16x32_bf16 v[240:243], a[56:59], a[80:83], v[240:243]
    v_mfma_f32_16x16x32_bf16 v[244:247], a[56:59], a[84:87], v[244:247]
    s_add_u32 s30, s30, 262144
    v_mfma_f32_16x16x32_bf16 v[248:251], a[56:59], a[88:91], v[248:251]
    v_mfma_f32_16x16x32_bf16 v[252:255], a[56:59], a[92:95], v[252:255]
    v_mfma_f32_16x16x32_bf16 a[0:3], a[60:63], a[64:67], a[0:3]
    v_mfma_f32_16x16x32_bf16 a[4:7], a[60:63], a[68:71], a[4:7]
    v_mfma_f32_16x16x32_bf16 a[8:11], a[60:63], a[72:75], a[8:11]
    s_add_u32 s31, s31, 1024
    v_mfma_f32_16x16x32_bf16 a[12:15], a[60:63], a[76:79], a[12:15]
    v_mfma_f32_16x16x32_bf16 a[16:19], a[60:63], a[80:83], a[16:19]
    v_mfma_f32_16x16x32_bf16 a[20:23], a[60:63], a[84:87], a[20:23]
    v_mfma_f32_16x16x32_bf16 a[24:27], a[60:63], a[88:91], a[24:27]
    v_mfma_f32_16x16x32_bf16 a[28:31], a[60:63], a[92:95], a[28:31]
    s_waitcnt vmcnt(16) lgkmcnt(0)
    s_barrier
    v_mfma_f32_16x16x32_bf16 v[32:35], a[96:99], a[128:131], v[32:35]
    ds_read_b128 a[64:67], v19 offset:0
    s_add_u32 m0, s32, 32768
    v_mfma_f32_16x16x32_bf16 v[36:39], a[96:99], a[132:135], v[36:39]
    ds_read_b128 a[68:71], v19 offset:1024
    v_mfma_f32_16x16x32_bf16 v[40:43], a[96:99], a[136:139], v[40:43]
    v_mfma_f32_16x16x32_bf16 v[44:47], a[96:99], a[140:143], v[44:47]
    ds_read_b128 a[72:75], v19 offset:2048
    v_mfma_f32_16x16x32_bf16 v[48:51], a[96:99], a[144:147], v[48:51]
    v_mfma_f32_16x16x32_bf16 v[52:55], a[96:99], a[148:151], v[52:55]
    ds_read_b128 a[76:79], v19 offset:3072
    buffer_load_dwordx4 v20, s[8:11], s30 offen offset:0 lds
    v_mfma_f32_16x16x32_bf16 v[56:59], a[96:99], a[152:155], v[56:59]
    ds_read_b128 a[80:83], v19 offset:4096
    v_mfma_f32_16x16x32_bf16 v[60:63], a[96:99], a[156:159], v[60:63]
    v_mfma_f32_16x16x32_bf16 v[64:67], a[100:103], a[128:131], v[64:67]
    ds_read_b128 a[84:87], v19 offset:5120
    v_mfma_f32_16x16x32_bf16 v[68:71], a[100:103], a[132:135], v[68:71]
    v_mfma_f32_16x16x32_bf16 v[72:75], a[100:103], a[136:139], v[72:75]
    ds_read_b128 a[88:91], v19 offset:6144
    buffer_load_dwordx4 v21, s[8:11], s30 offen offset:1024 lds
    v_mfma_f32_16x16x32_bf16 v[76:79], a[100:103], a[140:143], v[76:79]
    ds_read_b128 a[92:95], v19 offset:7168
    v_mfma_f32_16x16x32_bf16 v[80:83], a[100:103], a[144:147], v[80:83]
    v_mfma_f32_16x16x32_bf16 v[84:87], a[100:103], a[148:151], v[84:87]
    ds_read_b64_tr_b16 a[32:33], v10 offset:0
    v_mfma_f32_16x16x32_bf16 v[88:91], a[100:103], a[152:155], v[88:91]
    v_mfma_f32_16x16x32_bf16 v[92:95], a[100:103], a[156:159], v[92:95]
    ds_read_b64_tr_b16 a[34:35], v10 offset:4096
    v_mfma_f32_16x16x32_bf16 v[96:99], a[104:107], a[128:131], v[96:99]
    ds_read_b64_tr_b16 a[36:37], v11 offset:0
    buffer_load_dwordx4 v22, s[8:11], s30 offen offset:2048 lds
    v_mfma_f32_16x16x32_bf16 v[100:103], a[104:107], a[132:135], v[100:103]
    v_mfma_f32_16x16x32_bf16 v[104:107], a[104:107], a[136:139], v[104:107]
    ds_read_b64_tr_b16 a[38:39], v11 offset:4096
    v_mfma_f32_16x16x32_bf16 v[108:111], a[104:107], a[140:143], v[108:111]
    v_mfma_f32_16x16x32_bf16 v[112:115], a[104:107], a[144:147], v[112:115]
    ds_read_b64_tr_b16 a[40:41], v12 offset:0
    v_mfma_f32_16x16x32_bf16 v[116:119], a[104:107], a[148:151], v[116:119]
    ds_read_b64_tr_b16 a[42:43], v12 offset:4096
    buffer_load_dwordx4 v23, s[8:11], s30 offen offset:3072 lds
    v_mfma_f32_16x16x32_bf16 v[120:123], a[104:107], a[152:155], v[120:123]
    v_mfma_f32_16x16x32_bf16 v[124:127], a[104:107], a[156:159], v[124:127]
    ds_read_b64_tr_b16 a[44:45], v13 offset:0
    v_mfma_f32_16x16x32_bf16 v[128:131], a[108:111], a[128:131], v[128:131]
    v_mfma_f32_16x16x32_bf16 v[132:135], a[108:111], a[132:135], v[132:135]
    ds_read_b64_tr_b16 a[46:47], v13 offset:4096
    v_mfma_f32_16x16x32_bf16 v[136:139], a[108:111], a[136:139], v[136:139]
    ds_read_b64_tr_b16 a[48:49], v14 offset:0
    s_add_u32 m0, s33, 32768
    v_mfma_f32_16x16x32_bf16 v[140:143], a[108:111], a[140:143], v[140:143]
    v_mfma_f32_16x16x32_bf16 v[144:147], a[108:111], a[144:147], v[144:147]
    ds_read_b64_tr_b16 a[50:51], v14 offset:4096
    v_mfma_f32_16x16x32_bf16 v[148:151], a[108:111], a[148:151], v[148:151]
    v_mfma_f32_16x16x32_bf16 v[152:155], a[108:111], a[152:155], v[152:155]
    ds_read_b64_tr_b16 a[52:53], v15 offset:0
    v_mfma_f32_16x16x32_bf16 v[156:159], a[108:111], a[156:159], v[156:159]
    ds_read_b64_tr_b16 a[54:55], v15 offset:4096
    v_mfma_f32_16x16x32_bf16 v[160:163], a[112:115], a[128:131], v[160:163]
    buffer_load_dwordx4 v24, s[12:15], s31 offen offset:0 lds
    v_mfma_f32_16x16x32_bf16 v[164:167], a[112:115], a[132:135], v[164:167]
    ds_read_b64_tr_b16 a[56:57], v16 offset:0
    v_mfma_f32_16x16x32_bf16 v[168:171], a[112:115], a[136:139], v[168:171]
    v_mfma_f32_16x16x32_bf16 v[172:175], a[112:115], a[140:143], v[172:175]
    ds_read_b64_tr_b16 a[58:59], v16 offset:4096
    v_mfma_f32_16x16x32_bf16 v[176:179], a[112:115], a[144:147], v[176:179]
    ds_read_b64_tr_b16 a[60:61], v17 offset:0
    v_mfma_f32_16x16x32_bf16 v[180:183], a[112:115], a[148:151], v[180:183]
    buffer_load_dwordx4 v25, s[12:15], s31 offen offset:1024 lds
    v_mfma_f32_16x16x32_bf16 v[184:187], a[112:115], a[152:155], v[184:187]
    ds_read_b64_tr_b16 a[62:63], v17 offset:4096
    v_mfma_f32_16x16x32_bf16 v[188:191], a[112:115], a[156:159], v[188:191]
    v_mfma_f32_16x16x32_bf16 v[192:195], a[116:119], a[128:131], v[192:195]
    v_mfma_f32_16x16x32_bf16 v[196:199], a[116:119], a[132:135], v[196:199]
    v_mfma_f32_16x16x32_bf16 v[200:203], a[116:119], a[136:139], v[200:203]
    buffer_load_dwordx4 v26, s[12:15], s31 offen offset:2048 lds
    v_mfma_f32_16x16x32_bf16 v[204:207], a[116:119], a[140:143], v[204:207]
    v_mfma_f32_16x16x32_bf16 v[208:211], a[116:119], a[144:147], v[208:211]
    v_mfma_f32_16x16x32_bf16 v[212:215], a[116:119], a[148:151], v[212:215]
    v_mfma_f32_16x16x32_bf16 v[216:219], a[116:119], a[152:155], v[216:219]
    v_mfma_f32_16x16x32_bf16 v[220:223], a[116:119], a[156:159], v[220:223]
    v_mfma_f32_16x16x32_bf16 v[224:227], a[120:123], a[128:131], v[224:227]
    buffer_load_dwordx4 v27, s[12:15], s31 offen offset:3072 lds
    v_mfma_f32_16x16x32_bf16 v[228:231], a[120:123], a[132:135], v[228:231]
    v_mfma_f32_16x16x32_bf16 v[232:235], a[120:123], a[136:139], v[232:235]
    v_mfma_f32_16x16x32_bf16 v[236:239], a[120:123], a[140:143], v[236:239]
    v_mfma_f32_16x16x32_bf16 v[240:243], a[120:123], a[144:147], v[240:243]
    v_mfma_f32_16x16x32_bf16 v[244:247], a[120:123], a[148:151], v[244:247]
    s_add_u32 s30, s30, 262144
    v_mfma_f32_16x16x32_bf16 v[248:251], a[120:123], a[152:155], v[248:251]
    v_mfma_f32_16x16x32_bf16 v[252:255], a[120:123], a[156:159], v[252:255]
    v_mfma_f32_16x16x32_bf16 a[0:3], a[124:127], a[128:131], a[0:3]
    v_mfma_f32_16x16x32_bf16 a[4:7], a[124:127], a[132:135], a[4:7]
    v_mfma_f32_16x16x32_bf16 a[8:11], a[124:127], a[136:139], a[8:11]
    s_add_u32 s31, s31, 1024
    v_mfma_f32_16x16x32_bf16 a[12:15], a[124:127], a[140:143], a[12:15]
    v_mfma_f32_16x16x32_bf16 a[16:19], a[124:127], a[144:147], a[16:19]
    v_mfma_f32_16x16x32_bf16 a[20:23], a[124:127], a[148:151], a[20:23]
    v_mfma_f32_16x16x32_bf16 a[24:27], a[124:127], a[152:155], a[24:27]
    v_mfma_f32_16x16x32_bf16 a[28:31], a[124:127], a[156:159], a[28:31]
    s_waitcnt vmcnt(16) lgkmcnt(0)
    s_barrier
    v_mfma_f32_16x16x32_bf16 v[32:35], a[32:35], a[64:67], v[32:35]
    ds_read_b128 a[128:131], v19 offset:32768
    s_add_u32 m0, s32, 65536
    v_mfma_f32_16x16x32_bf16 v[36:39], a[32:35], a[68:71], v[36:39]
    ds_read_b128 a[132:135], v19 offset:33792
    v_mfma_f32_16x16x32_bf16 v[40:43], a[32:35], a[72:75], v[40:43]
    v_mfma_f32_16x16x32_bf16 v[44:47], a[32:35], a[76:79], v[44:47]
    ds_read_b128 a[136:139], v19 offset:34816
    v_mfma_f32_16x16x32_bf16 v[48:51], a[32:35], a[80:83], v[48:51]
    v_mfma_f32_16x16x32_bf16 v[52:55], a[32:35], a[84:87], v[52:55]
    ds_read_b128 a[140:143], v19 offset:35840
    buffer_load_dwordx4 v20, s[8:11], s30 offen offset:0 lds
    v_mfma_f32_16x16x32_bf16 v[56:59], a[32:35], a[88:91], v[56:59]
    ds_read_b128 a[144:147], v19 offset:36864
    v_mfma_f32_16x16x32_bf16 v[60:63], a[32:35], a[92:95], v[60:63]
    v_mfma_f32_16x16x32_bf16 v[64:67], a[36:39], a[64:67], v[64:67]
    ds_read_b128 a[148:151], v19 offset:37888
    v_mfma_f32_16x16x32_bf16 v[68:71], a[36:39], a[68:71], v[68:71]
    v_mfma_f32_16x16x32_bf16 v[72:75], a[36:39], a[72:75], v[72:75]
    ds_read_b128 a[152:155], v19 offset:38912
    buffer_load_dwordx4 v21, s[8:11], s30 offen offset:1024 lds
    v_mfma_f32_16x16x32_bf16 v[76:79], a[36:39], a[76:79], v[76:79]
    ds_read_b128 a[156:159], v19 offset:39936
    v_mfma_f32_16x16x32_bf16 v[80:83], a[36:39], a[80:83], v[80:83]
    v_mfma_f32_16x16x32_bf16 v[84:87], a[36:39], a[84:87], v[84:87]
    ds_read_b64_tr_b16 a[96:97], v10 offset:32768
    v_mfma_f32_16x16x32_bf16 v[88:91], a[36:39], a[88:91], v[88:91]
    v_mfma_f32_16x16x32_bf16 v[92:95], a[36:39], a[92:95], v[92:95]
    ds_read_b64_tr_b16 a[98:99], v10 offset:36864
    v_mfma_f32_16x16x32_bf16 v[96:99], a[40:43], a[64:67], v[96:99]
    ds_read_b64_tr_b16 a[100:101], v11 offset:32768
    buffer_load_dwordx4 v22, s[8:11], s30 offen offset:2048 lds
    v_mfma_f32_16x16x32_bf16 v[100:103], a[40:43], a[68:71], v[100:103]
    v_mfma_f32_16x16x32_bf16 v[104:107], a[40:43], a[72:75], v[104:107]
    ds_read_b64_tr_b16 a[102:103], v11 offset:36864
    v_mfma_f32_16x16x32_bf16 v[108:111], a[40:43], a[76:79], v[108:111]
    v_mfma_f32_16x16x32_bf16 v[112:115], a[40:43], a[80:83], v[112:115]
    ds_read_b64_tr_b16 a[104:105], v12 offset:32768
    v_mfma_f32_16x16x32_bf16 v[116:119], a[40:43], a[84:87], v[116:119]
    ds_read_b64_tr_b16 a[106:107], v12 offset:36864
    buffer_load_dwordx4 v23, s[8:11], s30 offen offset:3072 lds
    v_mfma_f32_16x16x32_bf16 v[120:123], a[40:43], a[88:91], v[120:123]
    v_mfma_f32_16x16x32_bf16 v[124:127], a[40:43], a[92:95], v[124:127]
    ds_read_b64_tr_b16 a[108:109], v13 offset:32768
    v_mfma_f32_16x16x32_bf16 v[128:131], a[44:47], a[64:67], v[128:131]
    v_mfma_f32_16x16x32_bf16 v[132:135], a[44:47], a[68:71], v[132:135]
    ds_read_b64_tr_b16 a[110:111], v13 offset:36864
    v_mfma_f32_16x16x32_bf16 v[136:139], a[44:47], a[72:75], v[136:139]
    ds_read_b64_tr_b16 a[112:113], v14 offset:32768
    s_add_u32 m0, s33, 65536
    v_mfma_f32_16x16x32_bf16 v[140:143], a[44:47], a[76:79], v[140:143]
    v_mfma_f32_16x16x32_bf16 v[144:147], a[44:47], a[80:83], v[144:147]
    ds_read_b64_tr_b16 a[114:115], v14 offset:36864
    v_mfma_f32_16x16x32_bf16 v[148:151], a[44:47], a[84:87], v[148:151]
    v_mfma_f32_16x16x32_bf16 v[152:155], a[44:47], a[88:91], v[152:155]
    ds_read_b64_tr_b16 a[116:117], v15 offset:32768
    v_mfma_f32_16x16x32_bf16 v[156:159], a[44:47], a[92:95], v[156:159]
    ds_read_b64_tr_b16 a[118:119], v15 offset:36864
    v_mfma_f32_16x16x32_bf16 v[160:163], a[48:51], a[64:67], v[160:163]
    buffer_load_dwordx4 v24, s[12:15], s31 offen offset:0 lds
    v_mfma_f32_16x16x32_bf16 v[164:167], a[48:51], a[68:71], v[164:167]
    ds_read_b64_tr_b16 a[120:121], v16 offset:32768
    v_mfma_f32_16x16x32_bf16 v[168:171], a[48:51], a[72:75], v[168:171]
    v_mfma_f32_16x16x32_bf16 v[172:175], a[48:51], a[76:79], v[172:175]
    ds_read_b64_tr_b16 a[122:123], v16 offset:36864
    v_mfma_f32_16x16x32_bf16 v[176:179], a[48:51], a[80:83], v[176:179]
    ds_read_b64_tr_b16 a[124:125], v17 offset:32768
    v_mfma_f32_16x16x32_bf16 v[180:183], a[48:51], a[84:87], v[180:183]
    buffer_load_dwordx4 v25, s[12:15], s31 offen offset:1024 lds
    v_mfma_f32_16x16x32_bf16 v[184:187], a[48:51], a[88:91], v[184:187]
    ds_read_b64_tr_b16 a[126:127], v17 offset:36864
    v_mfma_f32_16x16x32_bf16 v[188:191], a[48:51], a[92:95], v[188:191]
    v_mfma_f32_16x16x32_bf16 v[192:195], a[52:55], a[64:67], v[192:195]
    v_mfma_f32_16x16x32_bf16 v[196:199], a[52:55], a[68:71], v[196:199]
    v_mfma_f32_16x16x32_bf16 v[200:203], a[52:55], a[72:75], v[200:203]
    buffer_load_dwordx4 v26, s[12:15], s31 offen offset:2048 lds
    v_mfma_f32_16x16x32_bf16 v[204:207], a[52:55], a[76:79], v[204:207]
    v_mfma_f32_16x16x32_bf16 v[208:211], a[52:55], a[80:83], v[208:211]
    v_mfma_f32_16x16x32_bf16 v[212:215], a[52:55], a[84:87], v[212:215]
    v_mfma_f32_16x16x32_bf16 v[216:219], a[52:55], a[88:91], v[216:219]
    v_mfma_f32_16x16x32_bf16 v[220:223], a[52:55], a[92:95], v[220:223]
    v_mfma_f32_16x16x32_bf16 v[224:227], a[56:59], a[64:67], v[224:227]
    buffer_load_dwordx4 v27, s[12:15], s31 offen offset:3072 lds
    v_mfma_f32_16x16x32_bf16 v[228:231], a[56:59], a[68:71], v[228:231]
    v_mfma_f32_16x16x32_bf16 v[232:235], a[56:59], a[72:75], v[232:235]
    v_mfma_f32_16x16x32_bf16 v[236:239], a[56:59], a[76:79], v[236:239]
    v_mfma_f32_16x16x32_bf16 v[240:243], a[56:59], a[80:83], v[240:243]
    v_mfma_f32_16x16x32_bf16 v[244:247], a[56:59], a[84:87], v[244:247]
    s_add_u32 s30, s30, 262144
    v_mfma_f32_16x16x32_bf16 v[248:251], a[56:59], a[88:91], v[248:251]
    v_mfma_f32_16x16x32_bf16 v[252:255], a[56:59], a[92:95], v[252:255]
    v_mfma_f32_16x16x32_bf16 a[0:3], a[60:63], a[64:67], a[0:3]
    v_mfma_f32_16x16x32_bf16 a[4:7], a[60:63], a[68:71], a[4:7]
    v_mfma_f32_16x16x32_bf16 a[8:11], a[60:63], a[72:75], a[8:11]
    s_add_u32 s31, s31, 1024
    v_mfma_f32_16x16x32_bf16 a[12:15], a[60:63], a[76:79], a[12:15]
    v_mfma_f32_16x16x32_bf16 a[16:19], a[60:63], a[80:83], a[16:19]
    v_mfma_f32_16x16x32_bf16 a[20:23], a[60:63], a[84:87], a[20:23]
    v_mfma_f32_16x16x32_bf16 a[24:27], a[60:63], a[88:91], a[24:27]
    v_mfma_f32_16x16x32_bf16 a[28:31], a[60:63], a[92:95], a[28:31]
    s_waitcnt vmcnt(16) lgkmcnt(0)
    s_barrier
    v_mfma_f32_16x16x32_bf16 v[32:35], a[96:99], a[128:131], v[32:35]
    ds_read_b128 a[64:67], v18 offset:0
    s_add_u32 m0, s32, 98304
    v_mfma_f32_16x16x32_bf16 v[36:39], a[96:99], a[132:135], v[36:39]
    ds_read_b128 a[68:71], v18 offset:1024
    v_mfma_f32_16x16x32_bf16 v[40:43], a[96:99], a[136:139], v[40:43]
    v_mfma_f32_16x16x32_bf16 v[44:47], a[96:99], a[140:143], v[44:47]
    ds_read_b128 a[72:75], v18 offset:2048
    v_mfma_f32_16x16x32_bf16 v[48:51], a[96:99], a[144:147], v[48:51]
    v_mfma_f32_16x16x32_bf16 v[52:55], a[96:99], a[148:151], v[52:55]
    ds_read_b128 a[76:79], v18 offset:3072
    buffer_load_dwordx4 v20, s[8:11], s30 offen offset:0 lds
    v_mfma_f32_16x16x32_bf16 v[56:59], a[96:99], a[152:155], v[56:59]
    ds_read_b128 a[80:83], v18 offset:4096
    v_mfma_f32_16x16x32_bf16 v[60:63], a[96:99], a[156:159], v[60:63]
    v_mfma_f32_16x16x32_bf16 v[64:67], a[100:103], a[128:131], v[64:67]
    ds_read_b128 a[84:87], v18 offset:5120
    v_mfma_f32_16x16x32_bf16 v[68:71], a[100:103], a[132:135], v[68:71]
    v_mfma_f32_16x16x32_bf16 v[72:75], a[100:103], a[136:139], v[72:75]
    ds_read_b128 a[88:91], v18 offset:6144
    buffer_load_dwordx4 v21, s[8:11], s30 offen offset:1024 lds
    v_mfma_f32_16x16x32_bf16 v[76:79], a[100:103], a[140:143], v[76:79]
    ds_read_b128 a[92:95], v18 offset:7168
    v_mfma_f32_16x16x32_bf16 v[80:83], a[100:103], a[144:147], v[80:83]
    v_mfma_f32_16x16x32_bf16 v[84:87], a[100:103], a[148:151], v[84:87]
    ds_read_b64_tr_b16 a[32:33], v2 offset:0
    v_mfma_f32_16x16x32_bf16 v[88:91], a[100:103], a[152:155], v[88:91]
    v_mfma_f32_16x16x32_bf16 v[92:95], a[100:103], a[156:159], v[92:95]
    ds_read_b64_tr_b16 a[34:35], v2 offset:4096
    v_mfma_f32_16x16x32_bf16 v[96:99], a[104:107], a[128:131], v[96:99]
    ds_read_b64_tr_b16 a[36:37], v3 offset:0
    buffer_load_dwordx4 v22, s[8:11], s30 offen offset:2048 lds
    v_mfma_f32_16x16x32_bf16 v[100:103], a[104:107], a[132:135], v[100:103]
    v_mfma_f32_16x16x32_bf16 v[104:107], a[104:107], a[136:139], v[104:107]
    ds_read_b64_tr_b16 a[38:39], v3 offset:4096
    v_mfma_f32_16x16x32_bf16 v[108:111], a[104:107], a[140:143], v[108:111]
    v_mfma_f32_16x16x32_bf16 v[112:115], a[104:107], a[144:147], v[112:115]
    ds_read_b64_tr_b16 a[40:41], v4 offset:0
    v_mfma_f32_16x16x32_bf16 v[116:119], a[104:107], a[148:151], v[116:119]
    ds_read_b64_tr_b16 a[42:43], v4 offset:4096
    buffer_load_dwordx4 v23, s[8:11], s30 offen offset:3072 lds
    v_mfma_f32_16x16x32_bf16 v[120:123], a[104:107], a[152:155], v[120:123]
    v_mfma_f32_16x16x32_bf16 v[124:127], a[104:107], a[156:159], v[124:127]
    ds_read_b64_tr_b16 a[44:45], v5 offset:0
    v_mfma_f32_16x16x32_bf16 v[128:131], a[108:111], a[128:131], v[128:131]
    v_mfma_f32_16x16x32_bf16 v[132:135], a[108:111], a[132:135], v[132:135]
    ds_read_b64_tr_b16 a[46:47], v5 offset:4096
    v_mfma_f32_16x16x32_bf16 v[136:139], a[108:111], a[136:139], v[136:139]
    ds_read_b64_tr_b16 a[48:49], v6 offset:0
    s_add_u32 m0, s33, 98304
    v_mfma_f32_16x16x32_bf16 v[140:143], a[108:111], a[140:143], v[140:143]
    v_mfma_f32_16x16x32_bf16 v[144:147], a[108:111], a[144:147], v[144:147]
    ds_read_b64_tr_b16 a[50:51], v6 offset:4096
    v_mfma_f32_16x16x32_bf16 v[148:151], a[108:111], a[148:151], v[148:151]
    v_mfma_f32_16x16x32_bf16 v[152:155], a[108:111], a[152:155], v[152:155]
    ds_read_b64_tr_b16 a[52:53], v7 offset:0
    v_mfma_f32_16x16x32_bf16 v[156:159], a[108:111], a[156:159], v[156:159]
    ds_read_b64_tr_b16 a[54:55], v7 offset:4096
    v_mfma_f32_16x16x32_bf16 v[160:163], a[112:115], a[128:131], v[160:163]
    buffer_load_dwordx4 v24, s[12:15], s31 offen offset:0 lds
    v_mfma_f32_16x16x32_bf16 v[164:167], a[112:115], a[132:135], v[164:167]
    ds_read_b64_tr_b16 a[56:57], v8 offset:0
    v_mfma_f32_16x16x32_bf16 v[168:171], a[112:115], a[136:139], v[168:171]
    v_mfma_f32_16x16x32_bf16 v[172:175], a[112:115], a[140:143], v[172:175]
    ds_read_b64_tr_b16 a[58:59], v8 offset:4096
    v_mfma_f32_16x16x32_bf16 v[176:179], a[112:115], a[144:147], v[176:179]
    ds_read_b64_tr_b16 a[60:61], v9 offset:0
    v_mfma_f32_16x16x32_bf16 v[180:183], a[112:115], a[148:151], v[180:183]
    buffer_load_dwordx4 v25, s[12:15], s31 offen offset:1024 lds
    v_mfma_f32_16x16x32_bf16 v[184:187], a[112:115], a[152:155], v[184:187]
    ds_read_b64_tr_b16 a[62:63], v9 offset:4096
    v_mfma_f32_16x16x32_bf16 v[188:191], a[112:115], a[156:159], v[188:191]
    v_mfma_f32_16x16x32_bf16 v[192:195], a[116:119], a[128:131], v[192:195]
    v_mfma_f32_16x16x32_bf16 v[196:199], a[116:119], a[132:135], v[196:199]
    v_mfma_f32_16x16x32_bf16 v[200:203], a[116:119], a[136:139], v[200:203]
    buffer_load_dwordx4 v26, s[12:15], s31 offen offset:2048 lds
    v_mfma_f32_16x16x32_bf16 v[204:207], a[116:119], a[140:143], v[204:207]
    v_mfma_f32_16x16x32_bf16 v[208:211], a[116:119], a[144:147], v[208:211]
    v_mfma_f32_16x16x32_bf16 v[212:215], a[116:119], a[148:151], v[212:215]
    v_mfma_f32_16x16x32_bf16 v[216:219], a[116:119], a[152:155], v[216:219]
    v_mfma_f32_16x16x32_bf16 v[220:223], a[116:119], a[156:159], v[220:223]
    v_mfma_f32_16x16x32_bf16 v[224:227], a[120:123], a[128:131], v[224:227]
    buffer_load_dwordx4 v27, s[12:15], s31 offen offset:3072 lds
    v_mfma_f32_16x16x32_bf16 v[228:231], a[120:123], a[132:135], v[228:231]
    v_mfma_f32_16x16x32_bf16 v[232:235], a[120:123], a[136:139], v[232:235]
    v_mfma_f32_16x16x32_bf16 v[236:239], a[120:123], a[140:143], v[236:239]
    v_mfma_f32_16x16x32_bf16 v[240:243], a[120:123], a[144:147], v[240:243]
    v_mfma_f32_16x16x32_bf16 v[244:247], a[120:123], a[148:151], v[244:247]
    s_add_u32 s30, s30, 262144
    v_mfma_f32_16x16x32_bf16 v[248:251], a[120:123], a[152:155], v[248:251]
    v_mfma_f32_16x16x32_bf16 v[252:255], a[120:123], a[156:159], v[252:255]
    v_mfma_f32_16x16x32_bf16 a[0:3], a[124:127], a[128:131], a[0:3]
    v_mfma_f32_16x16x32_bf16 a[4:7], a[124:127], a[132:135], a[4:7]
    v_mfma_f32_16x16x32_bf16 a[8:11], a[124:127], a[136:139], a[8:11]
    s_add_u32 s31, s31, 1024
    v_mfma_f32_16x16x32_bf16 a[12:15], a[124:127], a[140:143], a[12:15]
    v_mfma_f32_16x16x32_bf16 a[16:19], a[124:127], a[144:147], a[16:19]
    v_mfma_f32_16x16x32_bf16 a[20:23], a[124:127], a[148:151], a[20:23]
    v_mfma_f32_16x16x32_bf16 a[24:27], a[124:127], a[152:155], a[24:27]
    v_mfma_f32_16x16x32_bf16 a[28:31], a[124:127], a[156:159], a[28:31]
    s_sub_u32 s34, s34, 1
    s_cmp_lg_u32 s34, 0
    s_cbranch_scc1 hq_loop_172
    s_waitcnt vmcnt(16) lgkmcnt(0)
    s_barrier
    v_mfma_f32_16x16x32_bf16 v[32:35], a[32:35], a[64:67], v[32:35]
    ds_read_b128 a[128:131], v18 offset:32768
    v_mfma_f32_16x16x32_bf16 v[36:39], a[32:35], a[68:71], v[36:39]
    ds_read_b128 a[132:135], v18 offset:33792
    v_mfma_f32_16x16x32_bf16 v[40:43], a[32:35], a[72:75], v[40:43]
    v_mfma_f32_16x16x32_bf16 v[44:47], a[32:35], a[76:79], v[44:47]
    ds_read_b128 a[136:139], v18 offset:34816
    v_mfma_f32_16x16x32_bf16 v[48:51], a[32:35], a[80:83], v[48:51]
    v_mfma_f32_16x16x32_bf16 v[52:55], a[32:35], a[84:87], v[52:55]
    ds_read_b128 a[140:143], v18 offset:35840
    v_mfma_f32_16x16x32_bf16 v[56:59], a[32:35], a[88:91], v[56:59]
    ds_read_b128 a[144:147], v18 offset:36864
    v_mfma_f32_16x16x32_bf16 v[60:63], a[32:35], a[92:95], v[60:63]
    v_mfma_f32_16x16x32_bf16 v[64:67], a[36:39], a[64:67], v[64:67]
    ds_read_b128 a[148:151], v18 offset:37888
    v_mfma_f32_16x16x32_bf16 v[68:71], a[36:39], a[68:71], v[68:71]
    v_mfma_f32_16x16x32_bf16 v[72:75], a[36:39], a[72:75], v[72:75]
    ds_read_b128 a[152:155], v18 offset:38912
    v_mfma_f32_16x16x32_bf16 v[76:79], a[36:39], a[76:79], v[76:79]
    ds_read_b128 a[156:159], v18 offset:39936
    v_mfma_f32_16x16x32_bf16 v[80:83], a[36:39], a[80:83], v[80:83]
    v_mfma_f32_16x16x32_bf16 v[84:87], a[36:39], a[84:87], v[84:87]
    ds_read_b64_tr_b16 a[96:97], v2 offset:32768
    v_mfma_f32_16x16x32_bf16 v[88:91], a[36:39], a[88:91], v[88:91]
    v_mfma_f32_16x16x32_bf16 v[92:95], a[36:39], a[92:95], v[92:95]
    ds_read_b64_tr_b16 a[98:99], v2 offset:36864
    v_mfma_f32_16x16x32_bf16 v[96:99], a[40:43], a[64:67], v[96:99]
    ds_read_b64_tr_b16 a[100:101], v3 offset:32768
    v_mfma_f32_16x16x32_bf16 v[100:103], a[40:43], a[68:71], v[100:103]
    v_mfma_f32_16x16x32_bf16 v[104:107], a[40:43], a[72:75], v[104:107]
    ds_read_b64_tr_b16 a[102:103], v3 offset:36864
    v_mfma_f32_16x16x32_bf16 v[108:111], a[40:43], a[76:79], v[108:111]
    v_mfma_f32_16x16x32_bf16 v[112:115], a[40:43], a[80:83], v[112:115]
    ds_read_b64_tr_b16 a[104:105], v4 offset:32768
    v_mfma_f32_16x16x32_bf16 v[116:119], a[40:43], a[84:87], v[116:119]
    ds_read_b64_tr_b16 a[106:107], v4 offset:36864
    v_mfma_f32_16x16x32_bf16 v[120:123], a[40:43], a[88:91], v[120:123]
    v_mfma_f32_16x16x32_bf16 v[124:127], a[40:43], a[92:95], v[124:127]
    ds_read_b64_tr_b16 a[108:109], v5 offset:32768
    v_mfma_f32_16x16x32_bf16 v[128:131], a[44:47], a[64:67], v[128:131]
    v_mfma_f32_16x16x32_bf16 v[132:135], a[44:47], a[68:71], v[132:135]
    ds_read_b64_tr_b16 a[110:111], v5 offset:36864
    v_mfma_f32_16x16x32_bf16 v[136:139], a[44:47], a[72:75], v[136:139]
    ds_read_b64_tr_b16 a[112:113], v6 offset:32768
    v_mfma_f32_16x16x32_bf16 v[140:143], a[44:47], a[76:79], v[140:143]
    v_mfma_f32_16x16x32_bf16 v[144:147], a[44:47], a[80:83], v[144:147]
    ds_read_b64_tr_b16 a[114:115], v6 offset:36864
    v_mfma_f32_16x16x32_bf16 v[148:151], a[44:47], a[84:87], v[148:151]
    v_mfma_f32_16x16x32_bf16 v[152:155], a[44:47], a[88:91], v[152:155]
    ds_read_b64_tr_b16 a[116:117], v7 offset:32768
    v_mfma_f32_16x16x32_bf16 v[156:159], a[44:47], a[92:95], v[156:159]
    ds_read_b64_tr_b16 a[118:119], v7 offset:36864
    v_mfma_f32_16x16x32_bf16 v[160:163], a[48:51], a[64:67], v[160:163]
    v_mfma_f32_16x16x32_bf16 v[164:167], a[48:51], a[68:71], v[164:167]
    ds_read_b64_tr_b16 a[120:121], v8 offset:32768
    v_mfma_f32_16x16x32_bf16 v[168:171], a[48:51], a[72:75], v[168:171]
    v_mfma_f32_16x16x32_bf16 v[172:175], a[48:51], a[76:79], v[172:175]
    ds_read_b64_tr_b16 a[122:123], v8 offset:36864
    v_mfma_f32_16x16x32_bf16 v[176:179], a[48:51], a[80:83], v[176:179]
    ds_read_b64_tr_b16 a[124:125], v9 offset:32768
    v_mfma_f32_16x16x32_bf16 v[180:183], a[48:51], a[84:87], v[180:183]
    v_mfma_f32_16x16x32_bf16 v[184:187], a[48:51], a[88:91], v[184:187]
    ds_read_b64_tr_b16 a[126:127], v9 offset:36864
    v_mfma_f32_16x16x32_bf16 v[188:191], a[48:51], a[92:95], v[188:191]
    v_mfma_f32_16x16x32_bf16 v[192:195], a[52:55], a[64:67], v[192:195]
    v_mfma_f32_16x16x32_bf16 v[196:199], a[52:55], a[68:71], v[196:199]
    v_mfma_f32_16x16x32_bf16 v[200:203], a[52:55], a[72:75], v[200:203]
    v_mfma_f32_16x16x32_bf16 v[204:207], a[52:55], a[76:79], v[204:207]
    v_mfma_f32_16x16x32_bf16 v[208:211], a[52:55], a[80:83], v[208:211]
    v_mfma_f32_16x16x32_bf16 v[212:215], a[52:55], a[84:87], v[212:215]
    v_mfma_f32_16x16x32_bf16 v[216:219], a[52:55], a[88:91], v[216:219]
    v_mfma_f32_16x16x32_bf16 v[220:223], a[52:55], a[92:95], v[220:223]
    v_mfma_f32_16x16x32_bf16 v[224:227], a[56:59], a[64:67], v[224:227]
    v_mfma_f32_16x16x32_bf16 v[228:231], a[56:59], a[68:71], v[228:231]
    v_mfma_f32_16x16x32_bf16 v[232:235], a[56:59], a[72:75], v[232:235]
    v_mfma_f32_16x16x32_bf16 v[236:239], a[56:59], a[76:79], v[236:239]
    v_mfma_f32_16x16x32_bf16 v[240:243], a[56:59], a[80:83], v[240:243]
    v_mfma_f32_16x16x32_bf16 v[244:247], a[56:59], a[84:87], v[244:247]
    v_mfma_f32_16x16x32_bf16 v[248:251], a[56:59], a[88:91], v[248:251]
    v_mfma_f32_16x16x32_bf16 v[252:255], a[56:59], a[92:95], v[252:255]
    v_mfma_f32_16x16x32_bf16 a[0:3], a[60:63], a[64:67], a[0:3]
    v_mfma_f32_16x16x32_bf16 a[4:7], a[60:63], a[68:71], a[4:7]
    v_mfma_f32_16x16x32_bf16 a[8:11], a[60:63], a[72:75], a[8:11]
    v_mfma_f32_16x16x32_bf16 a[12:15], a[60:63], a[76:79], a[12:15]
    v_mfma_f32_16x16x32_bf16 a[16:19], a[60:63], a[80:83], a[16:19]
    v_mfma_f32_16x16x32_bf16 a[20:23], a[60:63], a[84:87], a[20:23]
    v_mfma_f32_16x16x32_bf16 a[24:27], a[60:63], a[88:91], a[24:27]
    v_mfma_f32_16x16x32_bf16 a[28:31], a[60:63], a[92:95], a[28:31]
    s_waitcnt vmcnt(8) lgkmcnt(0)
    s_barrier
    v_mfma_f32_16x16x32_bf16 v[32:35], a[96:99], a[128:131], v[32:35]
    ds_read_b128 a[64:67], v19 offset:0
    v_mfma_f32_16x16x32_bf16 v[36:39], a[96:99], a[132:135], v[36:39]
    ds_read_b128 a[68:71], v19 offset:1024
    v_mfma_f32_16x16x32_bf16 v[40:43], a[96:99], a[136:139], v[40:43]
    v_mfma_f32_16x16x32_bf16 v[44:47], a[96:99], a[140:143], v[44:47]
    ds_read_b128 a[72:75], v19 offset:2048
    v_mfma_f32_16x16x32_bf16 v[48:51], a[96:99], a[144:147], v[48:51]
    v_mfma_f32_16x16x32_bf16 v[52:55], a[96:99], a[148:151], v[52:55]
    ds_read_b128 a[76:79], v19 offset:3072
    v_mfma_f32_16x16x32_bf16 v[56:59], a[96:99], a[152:155], v[56:59]
    ds_read_b128 a[80:83], v19 offset:4096
    v_mfma_f32_16x16x32_bf16 v[60:63], a[96:99], a[156:159], v[60:63]
    v_mfma_f32_16x16x32_bf16 v[64:67], a[100:103], a[128:131], v[64:67]
    ds_read_b128 a[84:87], v19 offset:5120
    v_mfma_f32_16x16x32_bf16 v[68:71], a[100:103], a[132:135], v[68:71]
    v_mfma_f32_16x16x32_bf16 v[72:75], a[100:103], a[136:139], v[72:75]
    ds_read_b128 a[88:91], v19 offset:6144
    v_mfma_f32_16x16x32_bf16 v[76:79], a[100:103], a[140:143], v[76:79]
    ds_read_b128 a[92:95], v19 offset:7168
    v_mfma_f32_16x16x32_bf16 v[80:83], a[100:103], a[144:147], v[80:83]
    v_mfma_f32_16x16x32_bf16 v[84:87], a[100:103], a[148:151], v[84:87]
    ds_read_b64_tr_b16 a[32:33], v10 offset:0
    v_mfma_f32_16x16x32_bf16 v[88:91], a[100:103], a[152:155], v[88:91]
    v_mfma_f32_16x16x32_bf16 v[92:95], a[100:103], a[156:159], v[92:95]
    ds_read_b64_tr_b16 a[34:35], v10 offset:4096
    v_mfma_f32_16x16x32_bf16 v[96:99], a[104:107], a[128:131], v[96:99]
    ds_read_b64_tr_b16 a[36:37], v11 offset:0
    v_mfma_f32_16x16x32_bf16 v[100:103], a[104:107], a[132:135], v[100:103]
    v_mfma_f32_16x16x32_bf16 v[104:107], a[104:107], a[136:139], v[104:107]
    ds_read_b64_tr_b16 a[38:39], v11 offset:4096
    v_mfma_f32_16x16x32_bf16 v[108:111], a[104:107], a[140:143], v[108:111]
    v_mfma_f32_16x16x32_bf16 v[112:115], a[104:107], a[144:147], v[112:115]
    ds_read_b64_tr_b16 a[40:41], v12 offset:0
    v_mfma_f32_16x16x32_bf16 v[116:119], a[104:107], a[148:151], v[116:119]
    ds_read_b64_tr_b16 a[42:43], v12 offset:4096
    v_mfma_f32_16x16x32_bf16 v[120:123], a[104:107], a[152:155], v[120:123]
    v_mfma_f32_16x16x32_bf16 v[124:127], a[104:107], a[156:159], v[124:127]
    ds_read_b64_tr_b16 a[44:45], v13 offset:0
    v_mfma_f32_16x16x32_bf16 v[128:131], a[108:111], a[128:131], v[128:131]
    v_mfma_f32_16x16x32_bf16 v[132:135], a[108:111], a[132:135], v[132:135]
    ds_read_b64_tr_b16 a[46:47], v13 offset:4096
    v_mfma_f32_16x16x32_bf16 v[136:139], a[108:111], a[136:139], v[136:139]
    ds_read_b64_tr_b16 a[48:49], v14 offset:0
    v_mfma_f32_16x16x32_bf16 v[140:143], a[108:111], a[140:143], v[140:143]
    v_mfma_f32_16x16x32_bf16 v[144:147], a[108:111], a[144:147], v[144:147]
    ds_read_b64_tr_b16 a[50:51], v14 offset:4096
    v_mfma_f32_16x16x32_bf16 v[148:151], a[108:111], a[148:151], v[148:151]
    v_mfma_f32_16x16x32_bf16 v[152:155], a[108:111], a[152:155], v[152:155]
    ds_read_b64_tr_b16 a[52:53], v15 offset:0
    v_mfma_f32_16x16x32_bf16 v[156:159], a[108:111], a[156:159], v[156:159]
    ds_read_b64_tr_b16 a[54:55], v15 offset:4096
    v_mfma_f32_16x16x32_bf16 v[160:163], a[112:115], a[128:131], v[160:163]
    v_mfma_f32_16x16x32_bf16 v[164:167], a[112:115], a[132:135], v[164:167]
    ds_read_b64_tr_b16 a[56:57], v16 offset:0
    v_mfma_f32_16x16x32_bf16 v[168:171], a[112:115], a[136:139], v[168:171]
    v_mfma_f32_16x16x32_bf16 v[172:175], a[112:115], a[140:143], v[172:175]
    ds_read_b64_tr_b16 a[58:59], v16 offset:4096
    v_mfma_f32_16x16x32_bf16 v[176:179], a[112:115], a[144:147], v[176:179]
    ds_read_b64_tr_b16 a[60:61], v17 offset:0
    v_mfma_f32_16x16x32_bf16 v[180:183], a[112:115], a[148:151], v[180:183]
    v_mfma_f32_16x16x32_bf16 v[184:187], a[112:115], a[152:155], v[184:187]
    ds_read_b64_tr_b16 a[62:63], v17 offset:4096
    v_mfma_f32_16x16x32_bf16 v[188:191], a[112:115], a[156:159], v[188:191]
    v_mfma_f32_16x16x32_bf16 v[192:195], a[116:119], a[128:131], v[192:195]
    v_mfma_f32_16x16x32_bf16 v[196:199], a[116:119], a[132:135], v[196:199]
    v_mfma_f32_16x16x32_bf16 v[200:203], a[116:119], a[136:139], v[200:203]
    v_mfma_f32_16x16x32_bf16 v[204:207], a[116:119], a[140:143], v[204:207]
    v_mfma_f32_16x16x32_bf16 v[208:211], a[116:119], a[144:147], v[208:211]
    v_mfma_f32_16x16x32_bf16 v[212:215], a[116:119], a[148:151], v[212:215]
    v_mfma_f32_16x16x32_bf16 v[216:219], a[116:119], a[152:155], v[216:219]
    v_mfma_f32_16x16x32_bf16 v[220:223], a[116:119], a[156:159], v[220:223]
    v_mfma_f32_16x16x32_bf16 v[224:227], a[120:123], a[128:131], v[224:227]
    v_mfma_f32_16x16x32_bf16 v[228:231], a[120:123], a[132:135], v[228:231]
    v_mfma_f32_16x16x32_bf16 v[232:235], a[120:123], a[136:139], v[232:235]
    v_mfma_f32_16x16x32_bf16 v[236:239], a[120:123], a[140:143], v[236:239]
    v_mfma_f32_16x16x32_bf16 v[240:243], a[120:123], a[144:147], v[240:243]
    v_mfma_f32_16x16x32_bf16 v[244:247], a[120:123], a[148:151], v[244:247]
    v_mfma_f32_16x16x32_bf16 v[248:251], a[120:123], a[152:155], v[248:251]
    v_mfma_f32_16x16x32_bf16 v[252:255], a[120:123], a[156:159], v[252:255]
    v_mfma_f32_16x16x32_bf16 a[0:3], a[124:127], a[128:131], a[0:3]
    v_mfma_f32_16x16x32_bf16 a[4:7], a[124:127], a[132:135], a[4:7]
    v_mfma_f32_16x16x32_bf16 a[8:11], a[124:127], a[136:139], a[8:11]
    v_mfma_f32_16x16x32_bf16 a[12:15], a[124:127], a[140:143], a[12:15]
    v_mfma_f32_16x16x32_bf16 a[16:19], a[124:127], a[144:147], a[16:19]
    v_mfma_f32_16x16x32_bf16 a[20:23], a[124:127], a[148:151], a[20:23]
    v_mfma_f32_16x16x32_bf16 a[24:27], a[124:127], a[152:155], a[24:27]
    v_mfma_f32_16x16x32_bf16 a[28:31], a[124:127], a[156:159], a[28:31]
    s_waitcnt vmcnt(0) lgkmcnt(0)
    s_barrier
    v_mfma_f32_16x16x32_bf16 v[32:35], a[32:35], a[64:67], v[32:35]
    ds_read_b128 a[128:131], v19 offset:32768
    v_mfma_f32_16x16x32_bf16 v[36:39], a[32:35], a[68:71], v[36:39]
    ds_read_b128 a[132:135], v19 offset:33792
    v_mfma_f32_16x16x32_bf16 v[40:43], a[32:35], a[72:75], v[40:43]
    v_mfma_f32_16x16x32_bf16 v[44:47], a[32:35], a[76:79], v[44:47]
    ds_read_b128 a[136:139], v19 offset:34816
    v_mfma_f32_16x16x32_bf16 v[48:51], a[32:35], a[80:83], v[48:51]
    v_mfma_f32_16x16x32_bf16 v[52:55], a[32:35], a[84:87], v[52:55]
    ds_read_b128 a[140:143], v19 offset:35840
    v_mfma_f32_16x16x32_bf16 v[56:59], a[32:35], a[88:91], v[56:59]
    ds_read_b128 a[144:147], v19 offset:36864
    v_mfma_f32_16x16x32_bf16 v[60:63], a[32:35], a[92:95], v[60:63]
    v_mfma_f32_16x16x32_bf16 v[64:67], a[36:39], a[64:67], v[64:67]
    ds_read_b128 a[148:151], v19 offset:37888
    v_mfma_f32_16x16x32_bf16 v[68:71], a[36:39], a[68:71], v[68:71]
    v_mfma_f32_16x16x32_bf16 v[72:75], a[36:39], a[72:75], v[72:75]
    ds_read_b128 a[152:155], v19 offset:38912
    v_mfma_f32_16x16x32_bf16 v[76:79], a[36:39], a[76:79], v[76:79]
    ds_read_b128 a[156:159], v19 offset:39936
    v_mfma_f32_16x16x32_bf16 v[80:83], a[36:39], a[80:83], v[80:83]
    v_mfma_f32_16x16x32_bf16 v[84:87], a[36:39], a[84:87], v[84:87]
    ds_read_b64_tr_b16 a[96:97], v10 offset:32768
    v_mfma_f32_16x16x32_bf16 v[88:91], a[36:39], a[88:91], v[88:91]
    v_mfma_f32_16x16x32_bf16 v[92:95], a[36:39], a[92:95], v[92:95]
    ds_read_b64_tr_b16 a[98:99], v10 offset:36864
    v_mfma_f32_16x16x32_bf16 v[96:99], a[40:43], a[64:67], v[96:99]
    ds_read_b64_tr_b16 a[100:101], v11 offset:32768
    v_mfma_f32_16x16x32_bf16 v[100:103], a[40:43], a[68:71], v[100:103]
    v_mfma_f32_16x16x32_bf16 v[104:107], a[40:43], a[72:75], v[104:107]
    ds_read_b64_tr_b16 a[102:103], v11 offset:36864
    v_mfma_f32_16x16x32_bf16 v[108:111], a[40:43], a[76:79], v[108:111]
    v_mfma_f32_16x16x32_bf16 v[112:115], a[40:43], a[80:83], v[112:115]
    ds_read_b64_tr_b16 a[104:105], v12 offset:32768
    v_mfma_f32_16x16x32_bf16 v[116:119], a[40:43], a[84:87], v[116:119]
    ds_read_b64_tr_b16 a[106:107], v12 offset:36864
    v_mfma_f32_16x16x32_bf16 v[120:123], a[40:43], a[88:91], v[120:123]
    v_mfma_f32_16x16x32_bf16 v[124:127], a[40:43], a[92:95], v[124:127]
    ds_read_b64_tr_b16 a[108:109], v13 offset:32768
    v_mfma_f32_16x16x32_bf16 v[128:131], a[44:47], a[64:67], v[128:131]
    v_mfma_f32_16x16x32_bf16 v[132:135], a[44:47], a[68:71], v[132:135]
    ds_read_b64_tr_b16 a[110:111], v13 offset:36864
    v_mfma_f32_16x16x32_bf16 v[136:139], a[44:47], a[72:75], v[136:139]
    ds_read_b64_tr_b16 a[112:113], v14 offset:32768
    v_mfma_f32_16x16x32_bf16 v[140:143], a[44:47], a[76:79], v[140:143]
    v_mfma_f32_16x16x32_bf16 v[144:147], a[44:47], a[80:83], v[144:147]
    ds_read_b64_tr_b16 a[114:115], v14 offset:36864
    v_mfma_f32_16x16x32_bf16 v[148:151], a[44:47], a[84:87], v[148:151]
    v_mfma_f32_16x16x32_bf16 v[152:155], a[44:47], a[88:91], v[152:155]
    ds_read_b64_tr_b16 a[116:117], v15 offset:32768
    v_mfma_f32_16x16x32_bf16 v[156:159], a[44:47], a[92:95], v[156:159]
    ds_read_b64_tr_b16 a[118:119], v15 offset:36864
    v_mfma_f32_16x16x32_bf16 v[160:163], a[48:51], a[64:67], v[160:163]
    v_mfma_f32_16x16x32_bf16 v[164:167], a[48:51], a[68:71], v[164:167]
    ds_read_b64_tr_b16 a[120:121], v16 offset:32768
    v_mfma_f32_16x16x32_bf16 v[168:171], a[48:51], a[72:75], v[168:171]
    v_mfma_f32_16x16x32_bf16 v[172:175], a[48:51], a[76:79], v[172:175]
    ds_read_b64_tr_b16 a[122:123], v16 offset:36864
    v_mfma_f32_16x16x32_bf16 v[176:179], a[48:51], a[80:83], v[176:179]
    ds_read_b64_tr_b16 a[124:125], v17 offset:32768
    v_mfma_f32_16x16x32_bf16 v[180:183], a[48:51], a[84:87], v[180:183]
    v_mfma_f32_16x16x32_bf16 v[184:187], a[48:51], a[88:91], v[184:187]
    ds_read_b64_tr_b16 a[126:127], v17 offset:36864
    v_mfma_f32_16x16x32_bf16 v[188:191], a[48:51], a[92:95], v[188:191]
    v_mfma_f32_16x16x32_bf16 v[192:195], a[52:55], a[64:67], v[192:195]
    v_mfma_f32_16x16x32_bf16 v[196:199], a[52:55], a[68:71], v[196:199]
    v_mfma_f32_16x16x32_bf16 v[200:203], a[52:55], a[72:75], v[200:203]
    v_mfma_f32_16x16x32_bf16 v[204:207], a[52:55], a[76:79], v[204:207]
    v_mfma_f32_16x16x32_bf16 v[208:211], a[52:55], a[80:83], v[208:211]
    v_mfma_f32_16x16x32_bf16 v[212:215], a[52:55], a[84:87], v[212:215]
    v_mfma_f32_16x16x32_bf16 v[216:219], a[52:55], a[88:91], v[216:219]
    v_mfma_f32_16x16x32_bf16 v[220:223], a[52:55], a[92:95], v[220:223]
    v_mfma_f32_16x16x32_bf16 v[224:227], a[56:59], a[64:67], v[224:227]
    v_mfma_f32_16x16x32_bf16 v[228:231], a[56:59], a[68:71], v[228:231]
    v_mfma_f32_16x16x32_bf16 v[232:235], a[56:59], a[72:75], v[232:235]
    v_mfma_f32_16x16x32_bf16 v[236:239], a[56:59], a[76:79], v[236:239]
    v_mfma_f32_16x16x32_bf16 v[240:243], a[56:59], a[80:83], v[240:243]
    v_mfma_f32_16x16x32_bf16 v[244:247], a[56:59], a[84:87], v[244:247]
    v_mfma_f32_16x16x32_bf16 v[248:251], a[56:59], a[88:91], v[248:251]
    v_mfma_f32_16x16x32_bf16 v[252:255], a[56:59], a[92:95], v[252:255]
    v_mfma_f32_16x16x32_bf16 a[0:3], a[60:63], a[64:67], a[0:3]
    v_mfma_f32_16x16x32_bf16 a[4:7], a[60:63], a[68:71], a[4:7]
    v_mfma_f32_16x16x32_bf16 a[8:11], a[60:63], a[72:75], a[8:11]
    v_mfma_f32_16x16x32_bf16 a[12:15], a[60:63], a[76:79], a[12:15]
    v_mfma_f32_16x16x32_bf16 a[16:19], a[60:63], a[80:83], a[16:19]
    v_mfma_f32_16x16x32_bf16 a[20:23], a[60:63], a[84:87], a[20:23]
    v_mfma_f32_16x16x32_bf16 a[24:27], a[60:63], a[88:91], a[24:27]
    v_mfma_f32_16x16x32_bf16 a[28:31], a[60:63], a[92:95], a[28:31]
    s_waitcnt lgkmcnt(0)
    v_mfma_f32_16x16x32_bf16 v[32:35], a[96:99], a[128:131], v[32:35]
    v_mfma_f32_16x16x32_bf16 v[36:39], a[96:99], a[132:135], v[36:39]
    v_mfma_f32_16x16x32_bf16 v[40:43], a[96:99], a[136:139], v[40:43]
    v_mfma_f32_16x16x32_bf16 v[44:47], a[96:99], a[140:143], v[44:47]
    v_mfma_f32_16x16x32_bf16 v[48:51], a[96:99], a[144:147], v[48:51]
    v_mfma_f32_16x16x32_bf16 v[52:55], a[96:99], a[148:151], v[52:55]
    v_mfma_f32_16x16x32_bf16 v[56:59], a[96:99], a[152:155], v[56:59]
    v_mfma_f32_16x16x32_bf16 v[60:63], a[96:99], a[156:159], v[60:63]
    v_mfma_f32_16x16x32_bf16 v[64:67], a[100:103], a[128:131], v[64:67]
    v_mfma_f32_16x16x32_bf16 v[68:71], a[100:103], a[132:135], v[68:71]
    v_mfma_f32_16x16x32_bf16 v[72:75], a[100:103], a[136:139], v[72:75]
    v_mfma_f32_16x16x32_bf16 v[76:79], a[100:103], a[140:143], v[76:79]
    v_mfma_f32_16x16x32_bf16 v[80:83], a[100:103], a[144:147], v[80:83]
    v_mfma_f32_16x16x32_bf16 v[84:87], a[100:103], a[148:151], v[84:87]
    v_mfma_f32_16x16x32_bf16 v[88:91], a[100:103], a[152:155], v[88:91]
    v_mfma_f32_16x16x32_bf16 v[92:95], a[100:103], a[156:159], v[92:95]
    v_mfma_f32_16x16x32_bf16 v[96:99], a[104:107], a[128:131], v[96:99]
    v_mfma_f32_16x16x32_bf16 v[100:103], a[104:107], a[132:135], v[100:103]
    v_mfma_f32_16x16x32_bf16 v[104:107], a[104:107], a[136:139], v[104:107]
    v_mfma_f32_16x16x32_bf16 v[108:111], a[104:107], a[140:143], v[108:111]
    v_mfma_f32_16x16x32_bf16 v[112:115], a[104:107], a[144:147], v[112:115]
    v_mfma_f32_16x16x32_bf16 v[116:119], a[104:107], a[148:151], v[116:119]
    v_mfma_f32_16x16x32_bf16 v[120:123], a[104:107], a[152:155], v[120:123]
    v_mfma_f32_16x16x32_bf16 v[124:127], a[104:107], a[156:159], v[124:127]
    v_mfma_f32_16x16x32_bf16 v[128:131], a[108:111], a[128:131], v[128:131]
    v_mfma_f32_16x16x32_bf16 v[132:135], a[108:111], a[132:135], v[132:135]
    v_mfma_f32_16x16x32_bf16 v[136:139], a[108:111], a[136:139], v[136:139]
    v_mfma_f32_16x16x32_bf16 v[140:143], a[108:111], a[140:143], v[140:143]
    v_mfma_f32_16x16x32_bf16 v[144:147], a[108:111], a[144:147], v[144:147]
    v_mfma_f32_16x16x32_bf16 v[148:151], a[108:111], a[148:151], v[148:151]
    v_mfma_f32_16x16x32_bf16 v[152:155], a[108:111], a[152:155], v[152:155]
    v_mfma_f32_16x16x32_bf16 v[156:159], a[108:111], a[156:159], v[156:159]
    v_mfma_f32_16x16x32_bf16 v[160:163], a[112:115], a[128:131], v[160:163]
    v_mfma_f32_16x16x32_bf16 v[164:167], a[112:115], a[132:135], v[164:167]
    v_mfma_f32_16x16x32_bf16 v[168:171], a[112:115], a[136:139], v[168:171]
    v_mfma_f32_16x16x32_bf16 v[172:175], a[112:115], a[140:143], v[172:175]
    v_mfma_f32_16x16x32_bf16 v[176:179], a[112:115], a[144:147], v[176:179]
    v_mfma_f32_16x16x32_bf16 v[180:183], a[112:115], a[148:151], v[180:183]
    v_mfma_f32_16x16x32_bf16 v[184:187], a[112:115], a[152:155], v[184:187]
    v_mfma_f32_16x16x32_bf16 v[188:191], a[112:115], a[156:159], v[188:191]
    v_mfma_f32_16x16x32_bf16 v[192:195], a[116:119], a[128:131], v[192:195]
    v_mfma_f32_16x16x32_bf16 v[196:199], a[116:119], a[132:135], v[196:199]
    v_mfma_f32_16x16x32_bf16 v[200:203], a[116:119], a[136:139], v[200:203]
    v_mfma_f32_16x16x32_bf16 v[204:207], a[116:119], a[140:143], v[204:207]
    v_mfma_f32_16x16x32_bf16 v[208:211], a[116:119], a[144:147], v[208:211]
    v_mfma_f32_16x16x32_bf16 v[212:215], a[116:119], a[148:151], v[212:215]
    v_mfma_f32_16x16x32_bf16 v[216:219], a[116:119], a[152:155], v[216:219]
    v_mfma_f32_16x16x32_bf16 v[220:223], a[116:119], a[156:159], v[220:223]
    v_mfma_f32_16x16x32_bf16 v[224:227], a[120:123], a[128:131], v[224:227]
    v_mfma_f32_16x16x32_bf16 v[228:231], a[120:123], a[132:135], v[228:231]
    v_mfma_f32_16x16x32_bf16 v[232:235], a[120:123], a[136:139], v[232:235]
    v_mfma_f32_16x16x32_bf16 v[236:239], a[120:123], a[140:143], v[236:239]
    v_mfma_f32_16x16x32_bf16 v[240:243], a[120:123], a[144:147], v[240:243]
    v_mfma_f32_16x16x32_bf16 v[244:247], a[120:123], a[148:151], v[244:247]
    v_mfma_f32_16x16x32_bf16 v[248:251], a[120:123], a[152:155], v[248:251]
    v_mfma_f32_16x16x32_bf16 v[252:255], a[120:123], a[156:159], v[252:255]
    v_mfma_f32_16x16x32_bf16 a[0:3], a[124:127], a[128:131], a[0:3]
    v_mfma_f32_16x16x32_bf16 a[4:7], a[124:127], a[132:135], a[4:7]
    v_mfma_f32_16x16x32_bf16 a[8:11], a[124:127], a[136:139], a[8:11]
    v_mfma_f32_16x16x32_bf16 a[12:15], a[124:127], a[140:143], a[12:15]
    v_mfma_f32_16x16x32_bf16 a[16:19], a[124:127], a[144:147], a[16:19]
    v_mfma_f32_16x16x32_bf16 a[20:23], a[124:127], a[148:151], a[20:23]
    v_mfma_f32_16x16x32_bf16 a[24:27], a[124:127], a[152:155], a[24:27]
    v_mfma_f32_16x16x32_bf16 a[28:31], a[124:127], a[156:159], a[28:31]
    s_mul_i32 s35, s26, 8
    s_add_u32 s35, s35, s28
    s_mul_i32 s35, s35, 128
    s_lshr_b32 s36, s39, 5
    s_add_u32 s35, s35, s36
    s_lshl_b32 s35, s35, 10
    v_lshlrev_b32 v2, 4, v1
    v_add_u32 v2, s35, v2
    s_mov_b32 s37, 0
    v_cvt_pk_bf16_f32 v4, v32, v33
    v_cvt_pk_bf16_f32 v5, v34, v35
    v_cvt_pk_bf16_f32 v6, v64, v65
    v_cvt_pk_bf16_f32 v7, v66, v67
    buffer_store_dwordx4 v[4:7], v2, s[16:19], s37 offen offset:0 sc1
    v_cvt_pk_bf16_f32 v8, v96, v97
    v_cvt_pk_bf16_f32 v9, v98, v99
    v_cvt_pk_bf16_f32 v10, v128, v129
    v_cvt_pk_bf16_f32 v11, v130, v131
    buffer_store_dwordx4 v[8:11], v2, s[16:19], s37 offen offset:1024 sc1
    v_cvt_pk_bf16_f32 v12, v160, v161
    v_cvt_pk_bf16_f32 v13, v162, v163
    v_cvt_pk_bf16_f32 v14, v192, v193
    v_cvt_pk_bf16_f32 v15, v194, v195
    buffer_store_dwordx4 v[12:15], v2, s[16:19], s37 offen offset:2048 sc1
    v_cvt_pk_bf16_f32 v16, v224, v225
    v_cvt_pk_bf16_f32 v17, v226, v227
    v_accvgpr_read_b32 v28, a0
    v_accvgpr_read_b32 v29, a1
    v_accvgpr_read_b32 v30, a2
    v_accvgpr_read_b32 v31, a3
    v_cvt_pk_bf16_f32 v18, v28, v29
    v_cvt_pk_bf16_f32 v19, v30, v31
    buffer_store_dwordx4 v[16:19], v2, s[16:19], s37 offen offset:3072 sc1
    s_mov_b32 s37, 131072
    v_cvt_pk_bf16_f32 v20, v36, v37
    v_cvt_pk_bf16_f32 v21, v38, v39
    v_cvt_pk_bf16_f32 v22, v68, v69
    v_cvt_pk_bf16_f32 v23, v70, v71
    buffer_store_dwordx4 v[20:23], v2, s[16:19], s37 offen offset:0 sc1
    v_cvt_pk_bf16_f32 v24, v100, v101
    v_cvt_pk_bf16_f32 v25, v102, v103
    v_cvt_pk_bf16_f32 v26, v132, v133
    v_cvt_pk_bf16_f32 v27, v134, v135
    buffer_store_dwordx4 v[24:27], v2, s[16:19], s37 offen offset:1024 sc1
    v_cvt_pk_bf16_f32 v4, v164, v165
    v_cvt_pk_bf16_f32 v5, v166, v167
    v_cvt_pk_bf16_f32 v6, v196, v197
    v_cvt_pk_bf16_f32 v7, v198, v199
    buffer_store_dwordx4 v[4:7], v2, s[16:19], s37 offen offset:2048 sc1
    v_cvt_pk_bf16_f32 v8, v228, v229
    v_cvt_pk_bf16_f32 v9, v230, v231
    v_accvgpr_read_b32 v28, a4
    v_accvgpr_read_b32 v29, a5
    v_accvgpr_read_b32 v30, a6
    v_accvgpr_read_b32 v31, a7
    v_cvt_pk_bf16_f32 v10, v28, v29
    v_cvt_pk_bf16_f32 v11, v30, v31
    buffer_store_dwordx4 v[8:11], v2, s[16:19], s37 offen offset:3072 sc1
    s_mov_b32 s37, 262144
    v_cvt_pk_bf16_f32 v12, v40, v41
    v_cvt_pk_bf16_f32 v13, v42, v43
    v_cvt_pk_bf16_f32 v14, v72, v73
    v_cvt_pk_bf16_f32 v15, v74, v75
    buffer_store_dwordx4 v[12:15], v2, s[16:19], s37 offen offset:0 sc1
    v_cvt_pk_bf16_f32 v16, v104, v105
    v_cvt_pk_bf16_f32 v17, v106, v107
    v_cvt_pk_bf16_f32 v18, v136, v137
    v_cvt_pk_bf16_f32 v19, v138, v139
    buffer_store_dwordx4 v[16:19], v2, s[16:19], s37 offen offset:1024 sc1
    v_cvt_pk_bf16_f32 v20, v168, v169
    v_cvt_pk_bf16_f32 v21, v170, v171
    v_cvt_pk_bf16_f32 v22, v200, v201
    v_cvt_pk_bf16_f32 v23, v202, v203
    buffer_store_dwordx4 v[20:23], v2, s[16:19], s37 offen offset:2048 sc1
    v_cvt_pk_bf16_f32 v24, v232, v233
    v_cvt_pk_bf16_f32 v25, v234, v235
    v_accvgpr_read_b32 v28, a8
    v_accvgpr_read_b32 v29, a9
    v_accvgpr_read_b32 v30, a10
    v_accvgpr_read_b32 v31, a11
    v_cvt_pk_bf16_f32 v26, v28, v29
    v_cvt_pk_bf16_f32 v27, v30, v31
    buffer_store_dwordx4 v[24:27], v2, s[16:19], s37 offen offset:3072 sc1
    s_mov_b32 s37, 393216
    v_cvt_pk_bf16_f32 v4, v44, v45
    v_cvt_pk_bf16_f32 v5, v46, v47
    v_cvt_pk_bf16_f32 v6, v76, v77
    v_cvt_pk_bf16_f32 v7, v78, v79
    buffer_store_dwordx4 v[4:7], v2, s[16:19], s37 offen offset:0 sc1
    v_cvt_pk_bf16_f32 v8, v108, v109
    v_cvt_pk_bf16_f32 v9, v110, v111
    v_cvt_pk_bf16_f32 v10, v140, v141
    v_cvt_pk_bf16_f32 v11, v142, v143
    buffer_store_dwordx4 v[8:11], v2, s[16:19], s37 offen offset:1024 sc1
    v_cvt_pk_bf16_f32 v12, v172, v173
    v_cvt_pk_bf16_f32 v13, v174, v175
    v_cvt_pk_bf16_f32 v14, v204, v205
    v_cvt_pk_bf16_f32 v15, v206, v207
    buffer_store_dwordx4 v[12:15], v2, s[16:19], s37 offen offset:2048 sc1
    v_cvt_pk_bf16_f32 v16, v236, v237
    v_cvt_pk_bf16_f32 v17, v238, v239
    v_accvgpr_read_b32 v28, a12
    v_accvgpr_read_b32 v29, a13
    v_accvgpr_read_b32 v30, a14
    v_accvgpr_read_b32 v31, a15
    v_cvt_pk_bf16_f32 v18, v28, v29
    v_cvt_pk_bf16_f32 v19, v30, v31
    buffer_store_dwordx4 v[16:19], v2, s[16:19], s37 offen offset:3072 sc1
    s_mov_b32 s37, 524288
    v_cvt_pk_bf16_f32 v20, v48, v49
    v_cvt_pk_bf16_f32 v21, v50, v51
    v_cvt_pk_bf16_f32 v22, v80, v81
    v_cvt_pk_bf16_f32 v23, v82, v83
    buffer_store_dwordx4 v[20:23], v2, s[16:19], s37 offen offset:0 sc1
    v_cvt_pk_bf16_f32 v24, v112, v113
    v_cvt_pk_bf16_f32 v25, v114, v115
    v_cvt_pk_bf16_f32 v26, v144, v145
    v_cvt_pk_bf16_f32 v27, v146, v147
    buffer_store_dwordx4 v[24:27], v2, s[16:19], s37 offen offset:1024 sc1
    v_cvt_pk_bf16_f32 v4, v176, v177
    v_cvt_pk_bf16_f32 v5, v178, v179
    v_cvt_pk_bf16_f32 v6, v208, v209
    v_cvt_pk_bf16_f32 v7, v210, v211
    buffer_store_dwordx4 v[4:7], v2, s[16:19], s37 offen offset:2048 sc1
    v_cvt_pk_bf16_f32 v8, v240, v241
    v_cvt_pk_bf16_f32 v9, v242, v243
    v_accvgpr_read_b32 v28, a16
    v_accvgpr_read_b32 v29, a17
    v_accvgpr_read_b32 v30, a18
    v_accvgpr_read_b32 v31, a19
    v_cvt_pk_bf16_f32 v10, v28, v29
    v_cvt_pk_bf16_f32 v11, v30, v31
    buffer_store_dwordx4 v[8:11], v2, s[16:19], s37 offen offset:3072 sc1
    s_mov_b32 s37, 655360
    v_cvt_pk_bf16_f32 v12, v52, v53
    v_cvt_pk_bf16_f32 v13, v54, v55
    v_cvt_pk_bf16_f32 v14, v84, v85
    v_cvt_pk_bf16_f32 v15, v86, v87
    buffer_store_dwordx4 v[12:15], v2, s[16:19], s37 offen offset:0 sc1
    v_cvt_pk_bf16_f32 v16, v116, v117
    v_cvt_pk_bf16_f32 v17, v118, v119
    v_cvt_pk_bf16_f32 v18, v148, v149
    v_cvt_pk_bf16_f32 v19, v150, v151
    buffer_store_dwordx4 v[16:19], v2, s[16:19], s37 offen offset:1024 sc1
    v_cvt_pk_bf16_f32 v20, v180, v181
    v_cvt_pk_bf16_f32 v21, v182, v183
    v_cvt_pk_bf16_f32 v22, v212, v213
    v_cvt_pk_bf16_f32 v23, v214, v215
    buffer_store_dwordx4 v[20:23], v2, s[16:19], s37 offen offset:2048 sc1
    v_cvt_pk_bf16_f32 v24, v244, v245
    v_cvt_pk_bf16_f32 v25, v246, v247
    v_accvgpr_read_b32 v28, a20
    v_accvgpr_read_b32 v29, a21
    v_accvgpr_read_b32 v30, a22
    v_accvgpr_read_b32 v31, a23
    v_cvt_pk_bf16_f32 v26, v28, v29
    v_cvt_pk_bf16_f32 v27, v30, v31
    buffer_store_dwordx4 v[24:27], v2, s[16:19], s37 offen offset:3072 sc1
    s_mov_b32 s37, 786432
    v_cvt_pk_bf16_f32 v4, v56, v57
    v_cvt_pk_bf16_f32 v5, v58, v59
    v_cvt_pk_bf16_f32 v6, v88, v89
    v_cvt_pk_bf16_f32 v7, v90, v91
    buffer_store_dwordx4 v[4:7], v2, s[16:19], s37 offen offset:0 sc1
    v_cvt_pk_bf16_f32 v8, v120, v121
    v_cvt_pk_bf16_f32 v9, v122, v123
    v_cvt_pk_bf16_f32 v10, v152, v153
    v_cvt_pk_bf16_f32 v11, v154, v155
    buffer_store_dwordx4 v[8:11], v2, s[16:19], s37 offen offset:1024 sc1
    v_cvt_pk_bf16_f32 v12, v184, v185
    v_cvt_pk_bf16_f32 v13, v186, v187
    v_cvt_pk_bf16_f32 v14, v216, v217
    v_cvt_pk_bf16_f32 v15, v218, v219
    buffer_store_dwordx4 v[12:15], v2, s[16:19], s37 offen offset:2048 sc1
    v_cvt_pk_bf16_f32 v16, v248, v249
    v_cvt_pk_bf16_f32 v17, v250, v251
    v_accvgpr_read_b32 v28, a24
    v_accvgpr_read_b32 v29, a25
    v_accvgpr_read_b32 v30, a26
    v_accvgpr_read_b32 v31, a27
    v_cvt_pk_bf16_f32 v18, v28, v29
    v_cvt_pk_bf16_f32 v19, v30, v31
    buffer_store_dwordx4 v[16:19], v2, s[16:19], s37 offen offset:3072 sc1
    s_mov_b32 s37, 917504
    v_cvt_pk_bf16_f32 v20, v60, v61
    v_cvt_pk_bf16_f32 v21, v62, v63
    v_cvt_pk_bf16_f32 v22, v92, v93
    v_cvt_pk_bf16_f32 v23, v94, v95
    buffer_store_dwordx4 v[20:23], v2, s[16:19], s37 offen offset:0 sc1
    v_cvt_pk_bf16_f32 v24, v124, v125
    v_cvt_pk_bf16_f32 v25, v126, v127
    v_cvt_pk_bf16_f32 v26, v156, v157
    v_cvt_pk_bf16_f32 v27, v158, v159
    buffer_store_dwordx4 v[24:27], v2, s[16:19], s37 offen offset:1024 sc1
    v_cvt_pk_bf16_f32 v4, v188, v189
    v_cvt_pk_bf16_f32 v5, v190, v191
    v_cvt_pk_bf16_f32 v6, v220, v221
    v_cvt_pk_bf16_f32 v7, v222, v223
    buffer_store_dwordx4 v[4:7], v2, s[16:19], s37 offen offset:2048 sc1
    v_cvt_pk_bf16_f32 v8, v252, v253
    v_cvt_pk_bf16_f32 v9, v254, v255
    v_accvgpr_read_b32 v28, a28
    v_accvgpr_read_b32 v29, a29
    v_accvgpr_read_b32 v30, a30
    v_accvgpr_read_b32 v31, a31
    v_cvt_pk_bf16_f32 v10, v28, v29
    v_cvt_pk_bf16_f32 v11, v30, v31
    buffer_store_dwordx4 v[8:11], v2, s[16:19], s37 offen offset:3072 sc1
    s_waitcnt vmcnt(0) lgkmcnt(0)
    s_barrier
    s_cmp_lg_u32 s90, 0
    s_cbranch_scc1 w0_173
    s_lshl_b32 s95, s88, 2
    s_add_u32 s95, s95, s79
    v_mov_b32 v2, s66
    s_mov_b64 exec, 1
    buffer_atomic_add v2, off, s[96:99], s95
    s_mov_b64 exec, -1
    s_lshl_b32 s95, s88, 2
    s_add_u32 s95, s95, s79
    s_add_u32 s95, s95, 4
    v_mov_b32 v2, s66
    s_mov_b64 exec, 1
    buffer_atomic_add v2, off, s[96:99], s95
    s_mov_b64 exec, -1
w0_173:
    s_add_u32 s93, s93, 1
    s_branch g_round
g_last:
    s_sub_u32 s45, s92, 2
    s_cmp_ge_u32 s45, 8
    s_cbranch_scc1 g_roles
    s_and_b32 s67, s45, 1
    s_add_u32 s71, s67, 1
    s_lshr_b32 s68, s45, 1
    s_lshl_b32 s45, s91, 2
    s_add_u32 s68, s68, s45
    s_mov_b32 s69, 7
    s_mov_b32 s70, 0
    s_mov_b32 s72, 1
    s_branch g_half
g_roles:
    s_mov_b32 s36, s90
    s_mov_b32 s37, s91
    s_mov_b32 s51, s92
    v_mbcnt_lo_u32_b32 v1, -1, 0
    v_mbcnt_hi_u32_b32 v1, -1, v1
    v_and_b32 v14, 15, v1
    v_lshrrev_b32 v15, 4, v1
    s_add_u32 s16, s4, 0x6600000
    s_addc_u32 s17, s5, 0
    s_mov_b32 s18, 0x28000
    s_mov_b32 s19, 0x20000
    s_mov_b32 s44, 0
    s_cmp_lt_u32 s51, 2
    s_cselect_b32 s38, s51, s38
    s_cbranch_scc1 role_att
    s_sub_u32 s38, s51, 2
    s_cmp_lt_u32 s51, 10
    s_cbranch_scc1 role_op
    s_sub_u32 s38, s51, 10
    s_cmp_lt_u32 s51, 18
    s_cbranch_scc1 role_f2
    s_sub_u32 s38, s51, 18
role_f1:
    s_mul_i32 s51, s37, 14
    s_add_u32 s38, s38, s51
    s_lshl_b32 s50, s38, 7
    s_load_dwordx2 s[6:7], s[0:1], 64
    s_load_dwordx2 s[48:49], s[0:1], 72
    s_waitcnt lgkmcnt(0)
    s_mov_b32 s20, s6
    s_mov_b32 s21, s7
    s_mov_b32 s22, 0x700000
    s_mov_b32 s23, 0x20000
    s_mov_b32 s24, s48
    s_mov_b32 s25, s49
    s_mov_b32 s26, 0x700000
    s_mov_b32 s27, 0x20000
    v_lshrrev_b32 v132, 3, v1
    s_mov_b32 s46, 7168
    v_mul_lo_u32 v133, v132, s46
    v_lshrrev_b32 v134, 4, v1
    v_lshlrev_b32 v134, 1, v134
    v_and_b32 v135, 7, v1
    v_xor_b32 v134, v134, v135
    v_lshl_add_u32 v136, v134, 4, v133
    v_bfe_u32 v132, v1, 2, 2
    v_lshrrev_b32 v133, 5, v1
    v_lshl_add_u32 v132, v133, 2, v132
    v_lshrrev_b32 v133, 1, v132
    v_xor_b32 v133, s36, v133
    v_lshlrev_b32 v132, 7, v132
    v_lshl_add_u32 v132, v133, 5, v132
    v_and_b32 v133, 3, v1
    v_lshl_add_u32 v132, v133, 3, v132
    v_bfe_u32 v133, v1, 4, 1
    v_lshl_add_u32 v140, v133, 16, v132
    s_mul_i32 s46, s36, 917504
    s_add_u32 s46, s46, s50
    s_lshl_b32 s47, s36, 14
    s_mov_b32 m0, s47
    s_nop 0
    buffer_load_dwordx4 v136, s[20:23], s46 offen lds
    s_add_u32 s46, s46, 57344
    s_add_u32 m0, m0, 1024
    s_nop 0
    buffer_load_dwordx4 v136, s[20:23], s46 offen lds
    s_add_u32 s46, s46, 57344
    s_add_u32 m0, m0, 1024
    s_nop 0
    buffer_load_dwordx4 v136, s[20:23], s46 offen lds
    s_add_u32 s46, s46, 57344
    s_add_u32 m0, m0, 1024
    s_nop 0
    buffer_load_dwordx4 v136, s[20:23], s46 offen lds
    s_add_u32 s46, s46, 57344
    s_add_u32 m0, m0, 1024
    s_nop 0
    buffer_load_dwordx4 v136, s[20:23], s46 offen lds
    s_add_u32 s46, s46, 57344
    s_add_u32 m0, m0, 1024
    s_nop 0
    buffer_load_dwordx4 v136, s[20:23], s46 offen lds
    s_add_u32 s46, s46, 57344
    s_add_u32 m0, m0, 1024
    s_nop 0
    buffer_load_dwordx4 v136, s[20:23], s46 offen lds
    s_add_u32 s46, s46, 57344
    s_add_u32 m0, m0, 1024
    s_nop 0
    buffer_load_dwordx4 v136, s[20:23], s46 offen lds
    s_add_u32 s46, s46, 57344
    s_add_u32 m0, m0, 1024
    s_nop 0
    buffer_load_dwordx4 v136, s[20:23], s46 offen lds
    s_add_u32 s46, s46, 57344
    s_add_u32 m0, m0, 1024
    s_nop 0
    buffer_load_dwordx4 v136, s[20:23], s46 offen lds
    s_add_u32 s46, s46, 57344
    s_add_u32 m0, m0, 1024
    s_nop 0
    buffer_load_dwordx4 v136, s[20:23], s46 offen lds
    s_add_u32 s46, s46, 57344
    s_add_u32 m0, m0, 1024
    s_nop 0
    buffer_load_dwordx4 v136, s[20:23], s46 offen lds
    s_add_u32 s46, s46, 57344
    s_add_u32 m0, m0, 1024
    s_nop 0
    buffer_load_dwordx4 v136, s[20:23], s46 offen lds
    s_add_u32 s46, s46, 57344
    s_add_u32 m0, m0, 1024
    s_nop 0
    buffer_load_dwordx4 v136, s[20:23], s46 offen lds
    s_add_u32 s46, s46, 57344
    s_add_u32 m0, m0, 1024
    s_nop 0
    buffer_load_dwordx4 v136, s[20:23], s46 offen lds
    s_add_u32 s46, s46, 57344
    s_add_u32 m0, m0, 1024
    s_nop 0
    buffer_load_dwordx4 v136, s[20:23], s46 offen lds
    s_mul_i32 s46, s36, 917504
    s_add_u32 s46, s46, s50
    s_lshl_b32 s47, s36, 14
    s_add_u32 s47, s47, 0x10000
    s_mov_b32 m0, s47
    s_nop 0
    buffer_load_dwordx4 v136, s[24:27], s46 offen lds
    s_add_u32 s46, s46, 57344
    s_add_u32 m0, m0, 1024
    s_nop 0
    buffer_load_dwordx4 v136, s[24:27], s46 offen lds
    s_add_u32 s46, s46, 57344
    s_add_u32 m0, m0, 1024
    s_nop 0
    buffer_load_dwordx4 v136, s[24:27], s46 offen lds
    s_add_u32 s46, s46, 57344
    s_add_u32 m0, m0, 1024
    s_nop 0
    buffer_load_dwordx4 v136, s[24:27], s46 offen lds
    s_add_u32 s46, s46, 57344
    s_add_u32 m0, m0, 1024
    s_nop 0
    buffer_load_dwordx4 v136, s[24:27], s46 offen lds
    s_add_u32 s46, s46, 57344
    s_add_u32 m0, m0, 1024
    s_nop 0
    buffer_load_dwordx4 v136, s[24:27], s46 offen lds
    s_add_u32 s46, s46, 57344
    s_add_u32 m0, m0, 1024
    s_nop 0
    buffer_load_dwordx4 v136, s[24:27], s46 offen lds
    s_add_u32 s46, s46, 57344
    s_add_u32 m0, m0, 1024
    s_nop 0
    buffer_load_dwordx4 v136, s[24:27], s46 offen lds
    s_add_u32 s46, s46, 57344
    s_add_u32 m0, m0, 1024
    s_nop 0
    buffer_load_dwordx4 v136, s[24:27], s46 offen lds
    s_add_u32 s46, s46, 57344
    s_add_u32 m0, m0, 1024
    s_nop 0
    buffer_load_dwordx4 v136, s[24:27], s46 offen lds
    s_add_u32 s46, s46, 57344
    s_add_u32 m0, m0, 1024
    s_nop 0
    buffer_load_dwordx4 v136, s[24:27], s46 offen lds
    s_add_u32 s46, s46, 57344
    s_add_u32 m0, m0, 1024
    s_nop 0
    buffer_load_dwordx4 v136, s[24:27], s46 offen lds
    s_add_u32 s46, s46, 57344
    s_add_u32 m0, m0, 1024
    s_nop 0
    buffer_load_dwordx4 v136, s[24:27], s46 offen lds
    s_add_u32 s46, s46, 57344
    s_add_u32 m0, m0, 1024
    s_nop 0
    buffer_load_dwordx4 v136, s[24:27], s46 offen lds
    s_add_u32 s46, s46, 57344
    s_add_u32 m0, m0, 1024
    s_nop 0
    buffer_load_dwordx4 v136, s[24:27], s46 offen lds
    s_add_u32 s46, s46, 57344
    s_add_u32 m0, m0, 1024
    s_nop 0
    buffer_load_dwordx4 v136, s[24:27], s46 offen lds
    s_waitcnt vmcnt(0)
    s_barrier
    ds_read_b64_tr_b16 a[0:1], v140 offset:0
    ds_read_b64_tr_b16 a[2:3], v140 offset:2048
    ds_read_b64_tr_b16 a[4:5], v140 offset:1024
    ds_read_b64_tr_b16 a[6:7], v140 offset:3072
    ds_read_b64_tr_b16 a[8:9], v140 offset:4096
    ds_read_b64_tr_b16 a[10:11], v140 offset:6144
    ds_read_b64_tr_b16 a[12:13], v140 offset:5120
    ds_read_b64_tr_b16 a[14:15], v140 offset:7168
    s_waitcnt lgkmcnt(4)
    ds_read_b64_tr_b16 a[16:17], v140 offset:8192
    ds_read_b64_tr_b16 a[18:19], v140 offset:10240
    ds_read_b64_tr_b16 a[20:21], v140 offset:9216
    ds_read_b64_tr_b16 a[22:23], v140 offset:11264
    ds_read_b64_tr_b16 a[24:25], v140 offset:12288
    ds_read_b64_tr_b16 a[26:27], v140 offset:14336
    ds_read_b64_tr_b16 a[28:29], v140 offset:13312
    ds_read_b64_tr_b16 a[30:31], v140 offset:15360
    s_waitcnt lgkmcnt(4)
    ds_read_b64_tr_b16 a[32:33], v140 offset:16384
    ds_read_b64_tr_b16 a[34:35], v140 offset:18432
    ds_read_b64_tr_b16 a[36:37], v140 offset:17408
    ds_read_b64_tr_b16 a[38:39], v140 offset:19456
    ds_read_b64_tr_b16 a[40:41], v140 offset:20480
    ds_read_b64_tr_b16 a[42:43], v140 offset:22528
    ds_read_b64_tr_b16 a[44:45], v140 offset:21504
    ds_read_b64_tr_b16 a[46:47], v140 offset:23552
    s_waitcnt lgkmcnt(4)
    ds_read_b64_tr_b16 a[48:49], v140 offset:24576
    ds_read_b64_tr_b16 a[50:51], v140 offset:26624
    ds_read_b64_tr_b16 a[52:53], v140 offset:25600
    ds_read_b64_tr_b16 a[54:55], v140 offset:27648
    ds_read_b64_tr_b16 a[56:57], v140 offset:28672
    ds_read_b64_tr_b16 a[58:59], v140 offset:30720
    ds_read_b64_tr_b16 a[60:61], v140 offset:29696
    ds_read_b64_tr_b16 a[62:63], v140 offset:31744
    s_waitcnt lgkmcnt(4)
    ds_read_b64_tr_b16 a[64:65], v140 offset:32768
    ds_read_b64_tr_b16 a[66:67], v140 offset:34816
    ds_read_b64_tr_b16 a[68:69], v140 offset:33792
    ds_read_b64_tr_b16 a[70:71], v140 offset:35840
    ds_read_b64_tr_b16 a[72:73], v140 offset:36864
    ds_read_b64_tr_b16 a[74:75], v140 offset:38912
    ds_read_b64_tr_b16 a[76:77], v140 offset:37888
    ds_read_b64_tr_b16 a[78:79], v140 offset:39936
    s_waitcnt lgkmcnt(4)
    ds_read_b64_tr_b16 a[80:81], v140 offset:40960
    ds_read_b64_tr_b16 a[82:83], v140 offset:43008
    ds_read_b64_tr_b16 a[84:85], v140 offset:41984
    ds_read_b64_tr_b16 a[86:87], v140 offset:44032
    ds_read_b64_tr_b16 a[88:89], v140 offset:45056
    ds_read_b64_tr_b16 a[90:91], v140 offset:47104
    ds_read_b64_tr_b16 a[92:93], v140 offset:46080
    ds_read_b64_tr_b16 a[94:95], v140 offset:48128
    s_waitcnt lgkmcnt(4)
    ds_read_b64_tr_b16 a[96:97], v140 offset:49152
    ds_read_b64_tr_b16 a[98:99], v140 offset:51200
    ds_read_b64_tr_b16 a[100:101], v140 offset:50176
    ds_read_b64_tr_b16 a[102:103], v140 offset:52224
    ds_read_b64_tr_b16 a[104:105], v140 offset:53248
    ds_read_b64_tr_b16 a[106:107], v140 offset:55296
    ds_read_b64_tr_b16 a[108:109], v140 offset:54272
    ds_read_b64_tr_b16 a[110:111], v140 offset:56320
    s_waitcnt lgkmcnt(4)
    ds_read_b64_tr_b16 a[112:113], v140 offset:57344
    ds_read_b64_tr_b16 a[114:115], v140 offset:59392
    ds_read_b64_tr_b16 a[116:117], v140 offset:58368
    ds_read_b64_tr_b16 a[118:119], v140 offset:60416
    ds_read_b64_tr_b16 a[120:121], v140 offset:61440
    ds_read_b64_tr_b16 a[122:123], v140 offset:63488
    ds_read_b64_tr_b16 a[124:125], v140 offset:62464
    ds_read_b64_tr_b16 a[126:127], v140 offset:64512
    s_waitcnt lgkmcnt(4)
    s_waitcnt lgkmcnt(0)
    s_barrier
    s_mul_i32 s46, s36, 917504
    s_add_u32 s46, s46, s50
    s_add_u32 s46, s46, 3670016
    s_lshl_b32 s47, s36, 14
    s_mov_b32 m0, s47
    s_nop 0
    buffer_load_dwordx4 v136, s[20:23], s46 offen lds
    s_add_u32 s46, s46, 57344
    s_add_u32 m0, m0, 1024
    s_nop 0
    buffer_load_dwordx4 v136, s[20:23], s46 offen lds
    s_add_u32 s46, s46, 57344
    s_add_u32 m0, m0, 1024
    s_nop 0
    buffer_load_dwordx4 v136, s[20:23], s46 offen lds
    s_add_u32 s46, s46, 57344
    s_add_u32 m0, m0, 1024
    s_nop 0
    buffer_load_dwordx4 v136, s[20:23], s46 offen lds
    s_add_u32 s46, s46, 57344
    s_add_u32 m0, m0, 1024
    s_nop 0
    buffer_load_dwordx4 v136, s[20:23], s46 offen lds
    s_add_u32 s46, s46, 57344
    s_add_u32 m0, m0, 1024
    s_nop 0
    buffer_load_dwordx4 v136, s[20:23], s46 offen lds
    s_add_u32 s46, s46, 57344
    s_add_u32 m0, m0, 1024
    s_nop 0
    buffer_load_dwordx4 v136, s[20:23], s46 offen lds
    s_add_u32 s46, s46, 57344
    s_add_u32 m0, m0, 1024
    s_nop 0
    buffer_load_dwordx4 v136, s[20:23], s46 offen lds
    s_add_u32 s46, s46, 57344
    s_add_u32 m0, m0, 1024
    s_nop 0
    buffer_load_dwordx4 v136, s[20:23], s46 offen lds
    s_add_u32 s46, s46, 57344
    s_add_u32 m0, m0, 1024
    s_nop 0
    buffer_load_dwordx4 v136, s[20:23], s46 offen lds
    s_add_u32 s46, s46, 57344
    s_add_u32 m0, m0, 1024
    s_nop 0
    buffer_load_dwordx4 v136, s[20:23], s46 offen lds
    s_add_u32 s46, s46, 57344
    s_add_u32 m0, m0, 1024
    s_nop 0
    buffer_load_dwordx4 v136, s[20:23], s46 offen lds
    s_add_u32 s46, s46, 57344
    s_add_u32 m0, m0, 1024
    s_nop 0
    buffer_load_dwordx4 v136, s[20:23], s46 offen lds
    s_add_u32 s46, s46, 57344
    s_add_u32 m0, m0, 1024
    s_nop 0
    buffer_load_dwordx4 v136, s[20:23], s46 offen lds
    s_add_u32 s46, s46, 57344
    s_add_u32 m0, m0, 1024
    s_nop 0
    buffer_load_dwordx4 v136, s[20:23], s46 offen lds
    s_add_u32 s46, s46, 57344
    s_add_u32 m0, m0, 1024
    s_nop 0
    buffer_load_dwordx4 v136, s[20:23], s46 offen lds
    s_mul_i32 s46, s36, 917504
    s_add_u32 s46, s46, s50
    s_add_u32 s46, s46, 3670016
    s_lshl_b32 s47, s36, 14
    s_add_u32 s47, s47, 0x10000
    s_mov_b32 m0, s47
    s_nop 0
    buffer_load_dwordx4 v136, s[24:27], s46 offen lds
    s_add_u32 s46, s46, 57344
    s_add_u32 m0, m0, 1024
    s_nop 0
    buffer_load_dwordx4 v136, s[24:27], s46 offen lds
    s_add_u32 s46, s46, 57344
    s_add_u32 m0, m0, 1024
    s_nop 0
    buffer_load_dwordx4 v136, s[24:27], s46 offen lds
    s_add_u32 s46, s46, 57344
    s_add_u32 m0, m0, 1024
    s_nop 0
    buffer_load_dwordx4 v136, s[24:27], s46 offen lds
    s_add_u32 s46, s46, 57344
    s_add_u32 m0, m0, 1024
    s_nop 0
    buffer_load_dwordx4 v136, s[24:27], s46 offen lds
    s_add_u32 s46, s46, 57344
    s_add_u32 m0, m0, 1024
    s_nop 0
    buffer_load_dwordx4 v136, s[24:27], s46 offen lds
    s_add_u32 s46, s46, 57344
    s_add_u32 m0, m0, 1024
    s_nop 0
    buffer_load_dwordx4 v136, s[24:27], s46 offen lds
    s_add_u32 s46, s46, 57344
    s_add_u32 m0, m0, 1024
    s_nop 0
    buffer_load_dwordx4 v136, s[24:27], s46 offen lds
    s_add_u32 s46, s46, 57344
    s_add_u32 m0, m0, 1024
    s_nop 0
    buffer_load_dwordx4 v136, s[24:27], s46 offen lds
    s_add_u32 s46, s46, 57344
    s_add_u32 m0, m0, 1024
    s_nop 0
    buffer_load_dwordx4 v136, s[24:27], s46 offen lds
    s_add_u32 s46, s46, 57344
    s_add_u32 m0, m0, 1024
    s_nop 0
    buffer_load_dwordx4 v136, s[24:27], s46 offen lds
    s_add_u32 s46, s46, 57344
    s_add_u32 m0, m0, 1024
    s_nop 0
    buffer_load_dwordx4 v136, s[24:27], s46 offen lds
    s_add_u32 s46, s46, 57344
    s_add_u32 m0, m0, 1024
    s_nop 0
    buffer_load_dwordx4 v136, s[24:27], s46 offen lds
    s_add_u32 s46, s46, 57344
    s_add_u32 m0, m0, 1024
    s_nop 0
    buffer_load_dwordx4 v136, s[24:27], s46 offen lds
    s_add_u32 s46, s46, 57344
    s_add_u32 m0, m0, 1024
    s_nop 0
    buffer_load_dwordx4 v136, s[24:27], s46 offen lds
    s_add_u32 s46, s46, 57344
    s_add_u32 m0, m0, 1024
    s_nop 0
    buffer_load_dwordx4 v136, s[24:27], s46 offen lds
    s_waitcnt vmcnt(0)
    s_barrier
    ds_read_b64_tr_b16 a[128:129], v140 offset:0
    ds_read_b64_tr_b16 a[130:131], v140 offset:2048
    ds_read_b64_tr_b16 a[132:133], v140 offset:1024
    ds_read_b64_tr_b16 a[134:135], v140 offset:3072
    ds_read_b64_tr_b16 a[136:137], v140 offset:4096
    ds_read_b64_tr_b16 a[138:139], v140 offset:6144
    ds_read_b64_tr_b16 a[140:141], v140 offset:5120
    ds_read_b64_tr_b16 a[142:143], v140 offset:7168
    s_waitcnt lgkmcnt(4)
    ds_read_b64_tr_b16 a[144:145], v140 offset:8192
    ds_read_b64_tr_b16 a[146:147], v140 offset:10240
    ds_read_b64_tr_b16 a[148:149], v140 offset:9216
    ds_read_b64_tr_b16 a[150:151], v140 offset:11264
    ds_read_b64_tr_b16 a[152:153], v140 offset:12288
    ds_read_b64_tr_b16 a[154:155], v140 offset:14336
    ds_read_b64_tr_b16 a[156:157], v140 offset:13312
    ds_read_b64_tr_b16 a[158:159], v140 offset:15360
    s_waitcnt lgkmcnt(4)
    ds_read_b64_tr_b16 a[160:161], v140 offset:16384
    ds_read_b64_tr_b16 a[162:163], v140 offset:18432
    ds_read_b64_tr_b16 a[164:165], v140 offset:17408
    ds_read_b64_tr_b16 a[166:167], v140 offset:19456
    ds_read_b64_tr_b16 a[168:169], v140 offset:20480
    ds_read_b64_tr_b16 a[170:171], v140 offset:22528
    ds_read_b64_tr_b16 a[172:173], v140 offset:21504
    ds_read_b64_tr_b16 a[174:175], v140 offset:23552
    s_waitcnt lgkmcnt(4)
    ds_read_b64_tr_b16 a[176:177], v140 offset:24576
    ds_read_b64_tr_b16 a[178:179], v140 offset:26624
    ds_read_b64_tr_b16 a[180:181], v140 offset:25600
    ds_read_b64_tr_b16 a[182:183], v140 offset:27648
    ds_read_b64_tr_b16 a[184:185], v140 offset:28672
    ds_read_b64_tr_b16 a[186:187], v140 offset:30720
    ds_read_b64_tr_b16 a[188:189], v140 offset:29696
    ds_read_b64_tr_b16 a[190:191], v140 offset:31744
    s_waitcnt lgkmcnt(4)
    ds_read_b64_tr_b16 a[192:193], v140 offset:32768
    ds_read_b64_tr_b16 a[194:195], v140 offset:34816
    ds_read_b64_tr_b16 a[196:197], v140 offset:33792
    ds_read_b64_tr_b16 a[198:199], v140 offset:35840
    ds_read_b64_tr_b16 a[200:201], v140 offset:36864
    ds_read_b64_tr_b16 a[202:203], v140 offset:38912
    ds_read_b64_tr_b16 a[204:205], v140 offset:37888
    ds_read_b64_tr_b16 a[206:207], v140 offset:39936
    s_waitcnt lgkmcnt(4)
    ds_read_b64_tr_b16 a[208:209], v140 offset:40960
    ds_read_b64_tr_b16 a[210:211], v140 offset:43008
    ds_read_b64_tr_b16 a[212:213], v140 offset:41984
    ds_read_b64_tr_b16 a[214:215], v140 offset:44032
    ds_read_b64_tr_b16 a[216:217], v140 offset:45056
    ds_read_b64_tr_b16 a[218:219], v140 offset:47104
    ds_read_b64_tr_b16 a[220:221], v140 offset:46080
    ds_read_b64_tr_b16 a[222:223], v140 offset:48128
    s_waitcnt lgkmcnt(4)
    ds_read_b64_tr_b16 a[224:225], v140 offset:49152
    ds_read_b64_tr_b16 a[226:227], v140 offset:51200
    ds_read_b64_tr_b16 a[228:229], v140 offset:50176
    ds_read_b64_tr_b16 a[230:231], v140 offset:52224
    ds_read_b64_tr_b16 a[232:233], v140 offset:53248
    ds_read_b64_tr_b16 a[234:235], v140 offset:55296
    ds_read_b64_tr_b16 a[236:237], v140 offset:54272
    ds_read_b64_tr_b16 a[238:239], v140 offset:56320
    s_waitcnt lgkmcnt(4)
    ds_read_b64_tr_b16 a[240:241], v140 offset:57344
    ds_read_b64_tr_b16 a[242:243], v140 offset:59392
    ds_read_b64_tr_b16 a[244:245], v140 offset:58368
    ds_read_b64_tr_b16 a[246:247], v140 offset:60416
    ds_read_b64_tr_b16 a[248:249], v140 offset:61440
    ds_read_b64_tr_b16 a[250:251], v140 offset:63488
    ds_read_b64_tr_b16 a[252:253], v140 offset:62464
    ds_read_b64_tr_b16 a[254:255], v140 offset:64512
    s_waitcnt lgkmcnt(4)
    s_waitcnt lgkmcnt(0)
    s_barrier
    v_mov_b32 v132, 0x3f803f80
    v_mov_b32 v133, 0x3f803f80
    v_mov_b32 v134, 0x3f803f80
    v_mov_b32 v135, 0x3f803f80
    s_nop 1
    v_mfma_f32_32x32x16_bf16 v[80:95], a[0:3], v[132:135], 0
    v_mfma_f32_32x32x16_bf16 v[80:95], a[4:7], v[132:135], v[80:95]
    v_mfma_f32_32x32x16_bf16 v[80:95], a[8:11], v[132:135], v[80:95]
    v_mfma_f32_32x32x16_bf16 v[80:95], a[12:15], v[132:135], v[80:95]
    v_mfma_f32_32x32x16_bf16 v[80:95], a[16:19], v[132:135], v[80:95]
    v_mfma_f32_32x32x16_bf16 v[80:95], a[20:23], v[132:135], v[80:95]
    v_mfma_f32_32x32x16_bf16 v[80:95], a[24:27], v[132:135], v[80:95]
    v_mfma_f32_32x32x16_bf16 v[80:95], a[28:31], v[132:135], v[80:95]
    v_mfma_f32_32x32x16_bf16 v[80:95], a[32:35], v[132:135], v[80:95]
    v_mfma_f32_32x32x16_bf16 v[80:95], a[36:39], v[132:135], v[80:95]
    v_mfma_f32_32x32x16_bf16 v[80:95], a[40:43], v[132:135], v[80:95]
    v_mfma_f32_32x32x16_bf16 v[80:95], a[44:47], v[132:135], v[80:95]
    v_mfma_f32_32x32x16_bf16 v[80:95], a[48:51], v[132:135], v[80:95]
    v_mfma_f32_32x32x16_bf16 v[80:95], a[52:55], v[132:135], v[80:95]
    v_mfma_f32_32x32x16_bf16 v[80:95], a[56:59], v[132:135], v[80:95]
    v_mfma_f32_32x32x16_bf16 v[80:95], a[60:63], v[132:135], v[80:95]
    v_mfma_f32_32x32x16_bf16 v[80:95], a[64:67], v[132:135], v[80:95]
    v_mfma_f32_32x32x16_bf16 v[80:95], a[68:71], v[132:135], v[80:95]
    v_mfma_f32_32x32x16_bf16 v[80:95], a[72:75], v[132:135], v[80:95]
    v_mfma_f32_32x32x16_bf16 v[80:95], a[76:79], v[132:135], v[80:95]
    v_mfma_f32_32x32x16_bf16 v[80:95], a[80:83], v[132:135], v[80:95]
    v_mfma_f32_32x32x16_bf16 v[80:95], a[84:87], v[132:135], v[80:95]
    v_mfma_f32_32x32x16_bf16 v[80:95], a[88:91], v[132:135], v[80:95]
    v_mfma_f32_32x32x16_bf16 v[80:95], a[92:95], v[132:135], v[80:95]
    v_mfma_f32_32x32x16_bf16 v[80:95], a[96:99], v[132:135], v[80:95]
    v_mfma_f32_32x32x16_bf16 v[80:95], a[100:103], v[132:135], v[80:95]
    v_mfma_f32_32x32x16_bf16 v[80:95], a[104:107], v[132:135], v[80:95]
    v_mfma_f32_32x32x16_bf16 v[80:95], a[108:111], v[132:135], v[80:95]
    v_mfma_f32_32x32x16_bf16 v[80:95], a[112:115], v[132:135], v[80:95]
    v_mfma_f32_32x32x16_bf16 v[80:95], a[116:119], v[132:135], v[80:95]
    v_mfma_f32_32x32x16_bf16 v[80:95], a[120:123], v[132:135], v[80:95]
    v_mfma_f32_32x32x16_bf16 v[80:95], a[124:127], v[132:135], v[80:95]
    v_mfma_f32_32x32x16_bf16 v[80:95], a[128:131], v[132:135], v[80:95]
    v_mfma_f32_32x32x16_bf16 v[80:95], a[132:135], v[132:135], v[80:95]
    v_mfma_f32_32x32x16_bf16 v[80:95], a[136:139], v[132:135], v[80:95]
    v_mfma_f32_32x32x16_bf16 v[80:95], a[140:143], v[132:135], v[80:95]
    v_mfma_f32_32x32x16_bf16 v[80:95], a[144:147], v[132:135], v[80:95]
    v_mfma_f32_32x32x16_bf16 v[80:95], a[148:151], v[132:135], v[80:95]
    v_mfma_f32_32x32x16_bf16 v[80:95], a[152:155], v[132:135], v[80:95]
    v_mfma_f32_32x32x16_bf16 v[80:95], a[156:159], v[132:135], v[80:95]
    v_mfma_f32_32x32x16_bf16 v[80:95], a[160:163], v[132:135], v[80:95]
    v_mfma_f32_32x32x16_bf16 v[80:95], a[164:167], v[132:135], v[80:95]
    v_mfma_f32_32x32x16_bf16 v[80:95], a[168:171], v[132:135], v[80:95]
    v_mfma_f32_32x32x16_bf16 v[80:95], a[172:175], v[132:135], v[80:95]
    v_mfma_f32_32x32x16_bf16 v[80:95], a[176:179], v[132:135], v[80:95]
    v_mfma_f32_32x32x16_bf16 v[80:95], a[180:183], v[132:135], v[80:95]
    v_mfma_f32_32x32x16_bf16 v[80:95], a[184:187], v[132:135], v[80:95]
    v_mfma_f32_32x32x16_bf16 v[80:95], a[188:191], v[132:135], v[80:95]
    v_mfma_f32_32x32x16_bf16 v[80:95], a[192:195], v[132:135], v[80:95]
    v_mfma_f32_32x32x16_bf16 v[80:95], a[196:199], v[132:135], v[80:95]
    v_mfma_f32_32x32x16_bf16 v[80:95], a[200:203], v[132:135], v[80:95]
    v_mfma_f32_32x32x16_bf16 v[80:95], a[204:207], v[132:135], v[80:95]
    v_mfma_f32_32x32x16_bf16 v[80:95], a[208:211], v[132:135], v[80:95]
    v_mfma_f32_32x32x16_bf16 v[80:95], a[212:215], v[132:135], v[80:95]
    v_mfma_f32_32x32x16_bf16 v[80:95], a[216:219], v[132:135], v[80:95]
    v_mfma_f32_32x32x16_bf16 v[80:95], a[220:223], v[132:135], v[80:95]
    v_mfma_f32_32x32x16_bf16 v[80:95], a[224:227], v[132:135], v[80:95]
    v_mfma_f32_32x32x16_bf16 v[80:95], a[228:231], v[132:135], v[80:95]
    v_mfma_f32_32x32x16_bf16 v[80:95], a[232:235], v[132:135], v[80:95]
    v_mfma_f32_32x32x16_bf16 v[80:95], a[236:239], v[132:135], v[80:95]
    v_mfma_f32_32x32x16_bf16 v[80:95], a[240:243], v[132:135], v[80:95]
    v_mfma_f32_32x32x16_bf16 v[80:95], a[244:247], v[132:135], v[80:95]
    v_mfma_f32_32x32x16_bf16 v[80:95], a[248:251], v[132:135], v[80:95]
    v_mfma_f32_32x32x16_bf16 v[80:95], a[252:255], v[132:135], v[80:95]
    s_mov_b32 s51, 0
    v_bfe_u32 v132, v1, 4, 1
    s_mov_b32 s46, 32768
    v_mul_lo_u32 v132, v132, s46
    v_lshrrev_b32 v133, 5, v1
    v_lshl_add_u32 v132, v133, 8, v132
    v_lshl_add_u32 v2, v14, 4, v132
    v_add_u32 v3, 0x10000, v2
    v_lshlrev_b32 v134, 4, v1
    s_and_b32 s46, s36, 1
    s_mul_i32 s46, s46, 8
    s_lshr_b32 s47, s36, 1
    s_mul_i32 s48, s47, 32
    s_add_u32 s48, s48, s46
    s_lshl_b32 s53, s48, 10
    s_mul_i32 s48, s47, 32
    s_add_u32 s48, s48, s46
    s_add_u32 s48, s48, s51
    s_lshl_b32 s48, s48, 10
    v_add_u32 v4, s48, v134
    v_add_u32 v5, 0x1000, v4
    s_add_u32 s8, s4, 0x4c00000
    s_addc_u32 s9, s5, 0
    s_mov_b32 s10, 0x400000
    s_mov_b32 s11, 0x20000
    s_add_u32 s12, s4, 0x5400000
    s_addc_u32 s13, s5, 0
    s_mov_b32 s14, 0xe00000
    s_mov_b32 s15, 0x20000
    s_add_u32 s32, s4, 0x5000000
    s_addc_u32 s33, s5, 0
    s_mov_b32 s34, 0x40000
    s_mov_b32 s35, 0x20000
    v_bfe_u32 v132, v1, 4, 1
    s_mov_b32 s46, 114688
    v_mul_lo_u32 v134, v132, s46
    v_lshrrev_b32 v133, 5, v1
    v_lshl_add_u32 v134, v133, 8, v134
    v_lshl_add_u32 v134, v14, 4, v134
    s_lshl_b32 s46, s38, 1
    s_lshr_b32 s47, s36, 1
    s_add_u32 s46, s46, s47
    s_lshl_b32 s46, s46, 10
    s_and_b32 s47, s36, 1
    s_lshl_b32 s47, s47, 9
    s_add_u32 s46, s46, s47
    v_add_u32 v6, s46, v134
    v_lshlrev_b32 v132, 11, v132
    v_lshl_add_u32 v132, v133, 10, v132
    v_lshl_add_u32 v156, v14, 5, v132
    v_and_b32 v132, 7, v1
    v_lshlrev_b32 v132, 2, v132
    v_add_u32 v7, 139264, v132
    s_mul_i32 s49, s37, 14
    s_sub_u32 s49, s38, s49
    s_lshl_b32 s48, s49, 2
    s_lshl_b32 s47, s37, 7
    s_add_u32 s48, s48, s47
    s_add_u32 s48, s48, 98304
    v_mov_b32 v12, 0x80000000
    v_mov_b32 v13, s48
    v_cmp_eq_u32 vcc, 0, v1
    s_nop 1
    v_cndmask_b32 v12, v12, v13, vcc
    s_mov_b32 s56, 0xbfb8aa3b
    s_mov_b32 s57, 0xbfb8aa3b
    s_mov_b32 s58, 1.0
    s_mov_b32 s59, 1.0
    s_mov_b32 s39, 0
    s_mov_b32 s40, 0
    s_mov_b32 s41, 0
    s_mov_b32 s96, 0
    s_mov_b32 s98, 0
    s_mov_b32 s43, 262144
    s_mov_b32 s42, s37
    s_mov_b32 s101, 0xffff0000
    v_mov_b32 v8, 0
    v_mov_b32 v10, 0
    v_mov_b32 v162, 131072
    s_cmp_eq_u32 s36, 0
    s_cselect_b32 s46, 0, 32
    v_add_u32 v163, s46, v162
    v_and_b32 v13, 15, v1
    v_min_u32 v13, 7, v13
    v_lshlrev_b32 v13, 2, v13
    v_bfe_u32 v14, v1, 4, 1
    v_lshl_add_u32 v13, v14, 7, v13
    v_readfirstlane_b32 s46, v7
    s_nop 1
    v_add_u32 v236, s46, v13
    s_cmp_eq_u32 s36, 0
    s_cselect_b32 s46, 0, 0x80000000
    v_or_b32 v7, s46, v7
    s_cmp_eq_u32 s36, 0
    s_cselect_b32 s46, 0, 0x80000000
    v_or_b32 v236, s46, v236
    s_cmp_eq_u32 s36, 0
    s_cselect_b32 s46, 0, 0x80000000
    v_or_b32 v12, s46, v12
    s_branch f1_blk0
f1_end0:
    s_mov_b32 s14, 0xe00000
    s_nop 7
    v_fma_f32 v16, -v96, v80, v16
    v_fma_f32 v17, -v96, v81, v17
    v_fma_f32 v18, -v96, v82, v18
    v_fma_f32 v19, -v96, v83, v19
    v_fma_f32 v20, -v96, v84, v20
    v_fma_f32 v21, -v96, v85, v21
    v_fma_f32 v22, -v96, v86, v22
    v_fma_f32 v23, -v96, v87, v23
    v_fma_f32 v24, -v96, v88, v24
    v_fma_f32 v25, -v96, v89, v25
    v_fma_f32 v26, -v96, v90, v26
    v_fma_f32 v27, -v96, v91, v27
    v_fma_f32 v28, -v96, v92, v28
    v_fma_f32 v29, -v96, v93, v29
    v_fma_f32 v30, -v96, v94, v30
    v_fma_f32 v31, -v96, v95, v31
    v_mul_f32 v16, v16, v97
    v_mul_f32 v17, v17, v97
    v_mul_f32 v18, v18, v97
    v_mul_f32 v19, v19, v97
    v_mul_f32 v20, v20, v97
    v_mul_f32 v21, v21, v97
    v_mul_f32 v22, v22, v97
    v_mul_f32 v23, v23, v97
    v_mul_f32 v24, v24, v97
    v_mul_f32 v25, v25, v97
    v_mul_f32 v26, v26, v97
    v_mul_f32 v27, v27, v97
    v_mul_f32 v28, v28, v97
    v_mul_f32 v29, v29, v97
    v_mul_f32 v30, v30, v97
    v_mul_f32 v31, v31, v97
    v_pk_mul_f32 v[144:145], v[16:17], s[56:57]
    v_pk_mul_f32 v[146:147], v[18:19], s[56:57]
    v_pk_mul_f32 v[148:149], v[20:21], s[56:57]
    v_pk_mul_f32 v[150:151], v[22:23], s[56:57]
    v_exp_f32 v144, v144
    v_exp_f32 v145, v145
    v_exp_f32 v146, v146
    v_exp_f32 v147, v147
    v_exp_f32 v148, v148
    v_exp_f32 v149, v149
    v_exp_f32 v150, v150
    v_exp_f32 v151, v151
    v_pk_mul_f32 v[16:17], v[16:17], v[24:25]
    v_pk_mul_f32 v[18:19], v[18:19], v[26:27]
    v_pk_mul_f32 v[20:21], v[20:21], v[28:29]
    v_pk_mul_f32 v[22:23], v[22:23], v[30:31]
    v_pk_add_f32 v[144:145], v[144:145], s[58:59]
    v_pk_add_f32 v[146:147], v[146:147], s[58:59]
    v_pk_add_f32 v[148:149], v[148:149], s[58:59]
    v_pk_add_f32 v[150:151], v[150:151], s[58:59]
    v_rcp_f32 v144, v144
    v_rcp_f32 v145, v145
    v_rcp_f32 v146, v146
    v_rcp_f32 v147, v147
    v_rcp_f32 v148, v148
    v_rcp_f32 v149, v149
    v_rcp_f32 v150, v150
    v_rcp_f32 v151, v151
    v_pk_mul_f32 v[16:17], v[16:17], v[144:145]
    v_pk_mul_f32 v[18:19], v[18:19], v[146:147]
    v_pk_mul_f32 v[20:21], v[20:21], v[148:149]
    v_pk_mul_f32 v[22:23], v[22:23], v[150:151]
    v_cvt_pk_bf16_f32 v140, v16, v17
    v_cvt_pk_bf16_f32 v141, v18, v19
    v_cvt_pk_bf16_f32 v142, v20, v21
    v_cvt_pk_bf16_f32 v143, v22, v23
    s_nop 0
    v_permlane32_swap_b32 v140, v142
    v_permlane32_swap_b32 v141, v143
    s_add_i32 s46, s39, 0
    s_mul_i32 s2, s46, 229376
    buffer_store_dwordx4 v[140:143], v6, s[12:15], s2 offen sc1
    s_add_u32 s39, s39, 1
    s_cmp_ge_u32 s39, 64
    s_cbranch_scc1 f1_last
    s_branch f1_blk1
f1_blk0:
    s_add_u32 s6, s39, 0
    s_lshl_b32 s6, s6, 7
    buffer_load_dword v8, v236, s[16:19], s6 offen sc1
    s_waitcnt vmcnt(0)
    v_xor_b32 v162, 4, v162
    v_xor_b32 v163, 4, v163
    s_add_u32 s7, s39, 0
    s_cmp_lt_u32 s7, 64
    s_cselect_b32 s6, 1, 0
    v_cmp_eq_u32 vcc, 0, v8
    s_nop 3
    s_and_b32 s82, vcc_lo, 0xffff
    s_cselect_b32 s6, 0, s6
    s_lshr_b32 s82, vcc_lo, 16
    s_cselect_b32 s82, 0, 4
    s_add_u32 s7, s7, 1
    s_cmp_lt_u32 s7, 64
    s_cselect_b32 s82, s82, 0
    s_or_b32 s6, s6, s82
    v_mov_b32 v13, s6
    s_mov_b64 exec, 1
    ds_write_b32 v163, v13
    s_mov_b64 exec, -1
    s_waitcnt lgkmcnt(0)
    s_barrier
    ds_read_b32 v14, v162
    s_cmp_le_u32 s39, s41
    s_cbranch_scc1 sm_174
    s_mov_b32 s41, s39
    s_sub_u32 s82, s39, 1
    s_lshl_b32 s82, s82, 9
    v_mov_b32 v11, 1
    buffer_store_dword v11, v12, s[16:19], s82 offen sc1
sm_174:
    s_waitcnt lgkmcnt(0)
    v_readfirstlane_b32 s52, v14
    s_nop 3
    s_bitcmp1_b32 s52, 0
    s_cbranch_scc1 f1_iss0
    s_sub_u32 s43, s43, 1
    s_cbranch_scc1 f1_blk0_err
    s_cmp_lg_u32 s36, 0
    s_cbranch_scc1 w0_175
    s_sleep 2
w0_175:
    s_branch f1_blk0
f1_blk0_err:
    s_mov_b32 s44, 20
    s_branch ssp_err
f1_iss0:
    s_cmp_eq_u32 0, 0
    s_cselect_b32 s10, 0x400000, 0
    s_cselect_b32 s34, 0x40000, 0
    s_add_u32 s48, s39, 0
    s_mul_i32 s84, s48, 65536
    s_add_u32 s85, s84, 16384
    s_lshl_b32 s86, s48, 12
    buffer_load_dwordx4 v[100:103], v156, s[32:35], s86 offen offset:0 sc1
    buffer_load_dwordx4 v[104:107], v156, s[32:35], s86 offen offset:16 sc1
    buffer_load_dwordx4 v[108:111], v156, s[32:35], s86 offen offset:512 sc1
    buffer_load_dwordx4 v[112:115], v156, s[32:35], s86 offen offset:528 sc1
    s_add_u32 m0, s53, 0
    s_nop 0
    buffer_load_dwordx4 v4, s[8:11], s84 offen offset:0 sc1 lds
    buffer_load_dwordx4 v4, s[8:11], s84 offen offset:1024 sc1 lds
    buffer_load_dwordx4 v4, s[8:11], s84 offen offset:2048 sc1 lds
    buffer_load_dwordx4 v4, s[8:11], s84 offen offset:3072 sc1 lds
    s_add_u32 m0, s53, 4096
    s_nop 0
    buffer_load_dwordx4 v5, s[8:11], s84 offen offset:0 sc1 lds
    buffer_load_dwordx4 v5, s[8:11], s84 offen offset:1024 sc1 lds
    buffer_load_dwordx4 v5, s[8:11], s84 offen offset:2048 sc1 lds
    buffer_load_dwordx4 v5, s[8:11], s84 offen offset:3072 sc1 lds
    s_add_u32 m0, s53, 16384
    s_nop 0
    buffer_load_dwordx4 v4, s[8:11], s85 offen offset:0 sc1 lds
    buffer_load_dwordx4 v4, s[8:11], s85 offen offset:1024 sc1 lds
    buffer_load_dwordx4 v4, s[8:11], s85 offen offset:2048 sc1 lds
    buffer_load_dwordx4 v4, s[8:11], s85 offen offset:3072 sc1 lds
    s_add_u32 m0, s53, 20480
    s_nop 0
    buffer_load_dwordx4 v5, s[8:11], s85 offen offset:0 sc1 lds
    buffer_load_dwordx4 v5, s[8:11], s85 offen offset:1024 sc1 lds
    buffer_load_dwordx4 v5, s[8:11], s85 offen offset:2048 sc1 lds
    buffer_load_dwordx4 v5, s[8:11], s85 offen offset:3072 sc1 lds
    s_mov_b32 s14, 0
    s_lshr_b32 s40, s52, 2
    s_waitcnt vmcnt(8)
    s_barrier
    ds_read_b128 v[48:51], v2 offset:0
    ds_read_b128 v[52:55], v2 offset:512
    ds_read_b128 v[56:59], v2 offset:1024
    ds_read_b128 v[60:63], v2 offset:1536
    ds_read_b128 v[64:67], v2 offset:2048
    ds_read_b128 v[68:71], v2 offset:2560
    s_cmp_lg_u32 s40, 0
    s_cselect_b32 s10, 0x400000, 0
    s_cselect_b32 s34, 0x40000, 0
    s_branch f1_LP0
f1_end1:
    s_mov_b32 s14, 0xe00000
    s_nop 7
    v_fma_f32 v32, -v96, v80, v32
    v_fma_f32 v33, -v96, v81, v33
    v_fma_f32 v34, -v96, v82, v34
    v_fma_f32 v35, -v96, v83, v35
    v_fma_f32 v36, -v96, v84, v36
    v_fma_f32 v37, -v96, v85, v37
    v_fma_f32 v38, -v96, v86, v38
    v_fma_f32 v39, -v96, v87, v39
    v_fma_f32 v40, -v96, v88, v40
    v_fma_f32 v41, -v96, v89, v41
    v_fma_f32 v42, -v96, v90, v42
    v_fma_f32 v43, -v96, v91, v43
    v_fma_f32 v44, -v96, v92, v44
    v_fma_f32 v45, -v96, v93, v45
    v_fma_f32 v46, -v96, v94, v46
    v_fma_f32 v47, -v96, v95, v47
    v_mul_f32 v32, v32, v97
    v_mul_f32 v33, v33, v97
    v_mul_f32 v34, v34, v97
    v_mul_f32 v35, v35, v97
    v_mul_f32 v36, v36, v97
    v_mul_f32 v37, v37, v97
    v_mul_f32 v38, v38, v97
    v_mul_f32 v39, v39, v97
    v_mul_f32 v40, v40, v97
    v_mul_f32 v41, v41, v97
    v_mul_f32 v42, v42, v97
    v_mul_f32 v43, v43, v97
    v_mul_f32 v44, v44, v97
    v_mul_f32 v45, v45, v97
    v_mul_f32 v46, v46, v97
    v_mul_f32 v47, v47, v97
    v_pk_mul_f32 v[144:145], v[32:33], s[56:57]
    v_pk_mul_f32 v[146:147], v[34:35], s[56:57]
    v_pk_mul_f32 v[148:149], v[36:37], s[56:57]
    v_pk_mul_f32 v[150:151], v[38:39], s[56:57]
    v_exp_f32 v144, v144
    v_exp_f32 v145, v145
    v_exp_f32 v146, v146
    v_exp_f32 v147, v147
    v_exp_f32 v148, v148
    v_exp_f32 v149, v149
    v_exp_f32 v150, v150
    v_exp_f32 v151, v151
    v_pk_mul_f32 v[32:33], v[32:33], v[40:41]
    v_pk_mul_f32 v[34:35], v[34:35], v[42:43]
    v_pk_mul_f32 v[36:37], v[36:37], v[44:45]
    v_pk_mul_f32 v[38:39], v[38:39], v[46:47]
    v_pk_add_f32 v[144:145], v[144:145], s[58:59]
    v_pk_add_f32 v[146:147], v[146:147], s[58:59]
    v_pk_add_f32 v[148:149], v[148:149], s[58:59]
    v_pk_add_f32 v[150:151], v[150:151], s[58:59]
    v_rcp_f32 v144, v144
    v_rcp_f32 v145, v145
    v_rcp_f32 v146, v146
    v_rcp_f32 v147, v147
    v_rcp_f32 v148, v148
    v_rcp_f32 v149, v149
    v_rcp_f32 v150, v150
    v_rcp_f32 v151, v151
    v_pk_mul_f32 v[32:33], v[32:33], v[144:145]
    v_pk_mul_f32 v[34:35], v[34:35], v[146:147]
    v_pk_mul_f32 v[36:37], v[36:37], v[148:149]
    v_pk_mul_f32 v[38:39], v[38:39], v[150:151]
    v_cvt_pk_bf16_f32 v140, v32, v33
    v_cvt_pk_bf16_f32 v141, v34, v35
    v_cvt_pk_bf16_f32 v142, v36, v37
    v_cvt_pk_bf16_f32 v143, v38, v39
    s_nop 0
    v_permlane32_swap_b32 v140, v142
    v_permlane32_swap_b32 v141, v143
    s_add_i32 s46, s39, 0
    s_mul_i32 s2, s46, 229376
    buffer_store_dwordx4 v[140:143], v6, s[12:15], s2 offen sc1
    s_add_u32 s39, s39, 1
    s_cmp_ge_u32 s39, 64
    s_cbranch_scc1 f1_last
    s_branch f1_blk0
f1_blk1:
    s_add_u32 s6, s39, 0
    s_lshl_b32 s6, s6, 7
    buffer_load_dword v8, v236, s[16:19], s6 offen sc1
    s_waitcnt vmcnt(0)
    v_xor_b32 v162, 4, v162
    v_xor_b32 v163, 4, v163
    s_add_u32 s7, s39, 0
    s_cmp_lt_u32 s7, 64
    s_cselect_b32 s6, 1, 0
    v_cmp_eq_u32 vcc, 0, v8
    s_nop 3
    s_and_b32 s82, vcc_lo, 0xffff
    s_cselect_b32 s6, 0, s6
    s_lshr_b32 s82, vcc_lo, 16
    s_cselect_b32 s82, 0, 4
    s_add_u32 s7, s7, 1
    s_cmp_lt_u32 s7, 64
    s_cselect_b32 s82, s82, 0
    s_or_b32 s6, s6, s82
    v_mov_b32 v13, s6
    s_mov_b64 exec, 1
    ds_write_b32 v163, v13
    s_mov_b64 exec, -1
    s_waitcnt lgkmcnt(0)
    s_barrier
    ds_read_b32 v14, v162
    s_cmp_le_u32 s39, s41
    s_cbranch_scc1 sm_176
    s_mov_b32 s41, s39
    s_sub_u32 s82, s39, 1
    s_lshl_b32 s82, s82, 9
    v_mov_b32 v11, 1
    buffer_store_dword v11, v12, s[16:19], s82 offen sc1
sm_176:
    s_waitcnt lgkmcnt(0)
    v_readfirstlane_b32 s52, v14
    s_nop 3
    s_bitcmp1_b32 s52, 0
    s_cbranch_scc1 f1_iss1
    s_sub_u32 s43, s43, 1
    s_cbranch_scc1 f1_blk1_err
    s_cmp_lg_u32 s36, 0
    s_cbranch_scc1 w0_177
    s_sleep 2
w0_177:
    s_branch f1_blk1
f1_blk1_err:
    s_mov_b32 s44, 20
    s_branch ssp_err
f1_iss1:
    s_cmp_eq_u32 0, 0
    s_cselect_b32 s10, 0x400000, 0
    s_cselect_b32 s34, 0x40000, 0
    s_add_u32 s48, s39, 0
    s_mul_i32 s84, s48, 65536
    s_add_u32 s85, s84, 16384
    s_lshl_b32 s86, s48, 12
    buffer_load_dwordx4 v[116:119], v156, s[32:35], s86 offen offset:0 sc1
    buffer_load_dwordx4 v[120:123], v156, s[32:35], s86 offen offset:16 sc1
    buffer_load_dwordx4 v[124:127], v156, s[32:35], s86 offen offset:512 sc1
    buffer_load_dwordx4 v[128:131], v156, s[32:35], s86 offen offset:528 sc1
    s_add_u32 m0, s53, 65536
    s_nop 0
    buffer_load_dwordx4 v4, s[8:11], s84 offen offset:0 sc1 lds
    buffer_load_dwordx4 v4, s[8:11], s84 offen offset:1024 sc1 lds
    buffer_load_dwordx4 v4, s[8:11], s84 offen offset:2048 sc1 lds
    buffer_load_dwordx4 v4, s[8:11], s84 offen offset:3072 sc1 lds
    s_add_u32 m0, s53, 69632
    s_nop 0
    buffer_load_dwordx4 v5, s[8:11], s84 offen offset:0 sc1 lds
    buffer_load_dwordx4 v5, s[8:11], s84 offen offset:1024 sc1 lds
    buffer_load_dwordx4 v5, s[8:11], s84 offen offset:2048 sc1 lds
    buffer_load_dwordx4 v5, s[8:11], s84 offen offset:3072 sc1 lds
    s_add_u32 m0, s53, 81920
    s_nop 0
    buffer_load_dwordx4 v4, s[8:11], s85 offen offset:0 sc1 lds
    buffer_load_dwordx4 v4, s[8:11], s85 offen offset:1024 sc1 lds
    buffer_load_dwordx4 v4, s[8:11], s85 offen offset:2048 sc1 lds
    buffer_load_dwordx4 v4, s[8:11], s85 offen offset:3072 sc1 lds
    s_add_u32 m0, s53, 86016
    s_nop 0
    buffer_load_dwordx4 v5, s[8:11], s85 offen offset:0 sc1 lds
    buffer_load_dwordx4 v5, s[8:11], s85 offen offset:1024 sc1 lds
    buffer_load_dwordx4 v5, s[8:11], s85 offen offset:2048 sc1 lds
    buffer_load_dwordx4 v5, s[8:11], s85 offen offset:3072 sc1 lds
    s_mov_b32 s14, 0
    s_lshr_b32 s40, s52, 2
    s_waitcnt vmcnt(8)
    s_barrier
    ds_read_b128 v[48:51], v3 offset:0
    ds_read_b128 v[52:55], v3 offset:512
    ds_read_b128 v[56:59], v3 offset:1024
    ds_read_b128 v[60:63], v3 offset:1536
    ds_read_b128 v[64:67], v3 offset:2048
    ds_read_b128 v[68:71], v3 offset:2560
    s_cmp_lg_u32 s40, 0
    s_cselect_b32 s10, 0x400000, 0
    s_cselect_b32 s34, 0x40000, 0
    s_branch f1_LP1
f1_last:
    s_waitcnt vmcnt(0)
    s_barrier
    s_cmp_le_u32 s39, s41
    s_cbranch_scc1 sm_178
    s_mov_b32 s41, s39
    s_sub_u32 s82, s39, 1
    s_lshl_b32 s82, s82, 9
    v_mov_b32 v11, 1
    buffer_store_dword v11, v12, s[16:19], s82 offen sc1
sm_178:
    s_branch ssp_end
f1_LP0:
    s_waitcnt lgkmcnt(4)
    v_mfma_f32_32x32x16_bf16 v[16:31], a[0:3], v[48:51], 0
    ds_read_b128 v[72:75], v2 offset:3072
    s_add_u32 s48, s39, 1
    s_mul_i32 s84, s48, 65536
    s_add_u32 s85, s84, 16384
    s_lshl_b32 s86, s48, 12
    v_mfma_f32_32x32x16_bf16 v[16:31], a[4:7], v[52:55], v[16:31]
    ds_read_b128 v[76:79], v2 offset:3584
    v_fma_f32 v32, -v96, v80, v32
    v_fma_f32 v33, -v96, v81, v33
    v_fma_f32 v34, -v96, v82, v34
    s_waitcnt lgkmcnt(4)
    v_mfma_f32_32x32x16_bf16 v[16:31], a[8:11], v[56:59], v[16:31]
    ds_read_b128 v[48:51], v2 offset:4096
    v_fma_f32 v35, -v96, v83, v35
    v_fma_f32 v36, -v96, v84, v36
    v_fma_f32 v37, -v96, v85, v37
    buffer_load_dwordx4 v[116:119], v156, s[32:35], s86 offen offset:0 sc1
    v_mfma_f32_32x32x16_bf16 v[16:31], a[12:15], v[60:63], v[16:31]
    ds_read_b128 v[52:55], v2 offset:4608
    v_fma_f32 v38, -v96, v86, v38
    v_fma_f32 v39, -v96, v87, v39
    v_fma_f32 v40, -v96, v88, v40
    s_waitcnt lgkmcnt(4)
    v_mfma_f32_32x32x16_bf16 v[16:31], a[16:19], v[64:67], v[16:31]
    ds_read_b128 v[56:59], v2 offset:5120
    v_fma_f32 v41, -v96, v89, v41
    v_fma_f32 v42, -v96, v90, v42
    v_fma_f32 v43, -v96, v91, v43
    buffer_load_dwordx4 v[120:123], v156, s[32:35], s86 offen offset:16 sc1
    v_mfma_f32_32x32x16_bf16 v[16:31], a[20:23], v[68:71], v[16:31]
    ds_read_b128 v[60:63], v2 offset:5632
    v_fma_f32 v44, -v96, v92, v44
    v_fma_f32 v45, -v96, v93, v45
    v_fma_f32 v46, -v96, v94, v46
    s_waitcnt lgkmcnt(4)
    v_mfma_f32_32x32x16_bf16 v[16:31], a[24:27], v[72:75], v[16:31]
    ds_read_b128 v[64:67], v2 offset:6144
    v_fma_f32 v47, -v96, v95, v47
    v_mul_f32 v32, v32, v97
    v_mul_f32 v33, v33, v97
    buffer_load_dwordx4 v[124:127], v156, s[32:35], s86 offen offset:512 sc1
    v_mfma_f32_32x32x16_bf16 v[16:31], a[28:31], v[76:79], v[16:31]
    ds_read_b128 v[68:71], v2 offset:6656
    v_mul_f32 v34, v34, v97
    v_mul_f32 v35, v35, v97
    v_mul_f32 v36, v36, v97
    s_waitcnt lgkmcnt(4)
    v_mfma_f32_32x32x16_bf16 v[16:31], a[32:35], v[48:51], v[16:31]
    ds_read_b128 v[72:75], v2 offset:7168
    v_mul_f32 v37, v37, v97
    v_mul_f32 v38, v38, v97
    v_mul_f32 v39, v39, v97
    buffer_load_dwordx4 v[128:131], v156, s[32:35], s86 offen offset:528 sc1
    v_mfma_f32_32x32x16_bf16 v[16:31], a[36:39], v[52:55], v[16:31]
    ds_read_b128 v[76:79], v2 offset:7680
    v_mul_f32 v40, v40, v97
    v_mul_f32 v41, v41, v97
    v_mul_f32 v42, v42, v97
    s_waitcnt lgkmcnt(4)
    v_mfma_f32_32x32x16_bf16 v[16:31], a[40:43], v[56:59], v[16:31]
    ds_read_b128 v[48:51], v2 offset:8192
    v_mul_f32 v43, v43, v97
    v_mul_f32 v44, v44, v97
    v_mul_f32 v45, v45, v97
    s_add_u32 m0, s53, 65536
    s_nop 0
    buffer_load_dwordx4 v4, s[8:11], s84 offen offset:0 sc1 lds
    v_mfma_f32_32x32x16_bf16 v[16:31], a[44:47], v[60:63], v[16:31]
    ds_read_b128 v[52:55], v2 offset:8704
    v_mul_f32 v46, v46, v97
    v_mul_f32 v47, v47, v97
    v_pk_mul_f32 v[144:145], v[32:33], s[56:57]
    s_waitcnt lgkmcnt(4)
    v_mfma_f32_32x32x16_bf16 v[16:31], a[48:51], v[64:67], v[16:31]
    ds_read_b128 v[56:59], v2 offset:9216
    v_pk_mul_f32 v[146:147], v[34:35], s[56:57]
    v_pk_mul_f32 v[148:149], v[36:37], s[56:57]
    v_pk_mul_f32 v[150:151], v[38:39], s[56:57]
    v_mfma_f32_32x32x16_bf16 v[16:31], a[52:55], v[68:71], v[16:31]
    ds_read_b128 v[60:63], v2 offset:9728
    v_exp_f32 v144, v144
    v_exp_f32 v145, v145
    v_exp_f32 v146, v146
    buffer_load_dwordx4 v4, s[8:11], s84 offen offset:1024 sc1 lds
    s_waitcnt lgkmcnt(4)
    v_mfma_f32_32x32x16_bf16 v[16:31], a[56:59], v[72:75], v[16:31]
    ds_read_b128 v[64:67], v2 offset:10240
    v_exp_f32 v147, v147
    v_exp_f32 v148, v148
    v_exp_f32 v149, v149
    v_mfma_f32_32x32x16_bf16 v[16:31], a[60:63], v[76:79], v[16:31]
    ds_read_b128 v[68:71], v2 offset:10752
    v_exp_f32 v150, v150
    v_exp_f32 v151, v151
    v_pk_mul_f32 v[32:33], v[32:33], v[40:41]
    buffer_load_dwordx4 v4, s[8:11], s84 offen offset:2048 sc1 lds
    s_waitcnt lgkmcnt(4)
    v_mfma_f32_32x32x16_bf16 v[16:31], a[64:67], v[48:51], v[16:31]
    ds_read_b128 v[72:75], v2 offset:11264
    v_pk_mul_f32 v[34:35], v[34:35], v[42:43]
    v_pk_mul_f32 v[36:37], v[36:37], v[44:45]
    v_pk_mul_f32 v[38:39], v[38:39], v[46:47]
    v_mfma_f32_32x32x16_bf16 v[16:31], a[68:71], v[52:55], v[16:31]
    ds_read_b128 v[76:79], v2 offset:11776
    v_pk_add_f32 v[144:145], v[144:145], s[58:59]
    v_pk_add_f32 v[146:147], v[146:147], s[58:59]
    v_pk_add_f32 v[148:149], v[148:149], s[58:59]
    buffer_load_dwordx4 v4, s[8:11], s84 offen offset:3072 sc1 lds
    s_waitcnt lgkmcnt(4)
    v_mfma_f32_32x32x16_bf16 v[16:31], a[72:75], v[56:59], v[16:31]
    ds_read_b128 v[48:51], v2 offset:12288
    v_pk_add_f32 v[150:151], v[150:151], s[58:59]
    v_rcp_f32 v144, v144
    v_rcp_f32 v145, v145
    v_mfma_f32_32x32x16_bf16 v[16:31], a[76:79], v[60:63], v[16:31]
    ds_read_b128 v[52:55], v2 offset:12800
    v_rcp_f32 v146, v146
    v_rcp_f32 v147, v147
    v_rcp_f32 v148, v148
    s_add_u32 m0, s53, 69632
    s_nop 0
    buffer_load_dwordx4 v5, s[8:11], s84 offen offset:0 sc1 lds
    s_waitcnt lgkmcnt(4)
    v_mfma_f32_32x32x16_bf16 v[16:31], a[80:83], v[64:67], v[16:31]
    ds_read_b128 v[56:59], v2 offset:13312
    v_rcp_f32 v149, v149
    v_rcp_f32 v150, v150
    v_rcp_f32 v151, v151
    v_mfma_f32_32x32x16_bf16 v[16:31], a[84:87], v[68:71], v[16:31]
    ds_read_b128 v[60:63], v2 offset:13824
    v_pk_mul_f32 v[32:33], v[32:33], v[144:145]
    v_pk_mul_f32 v[34:35], v[34:35], v[146:147]
    v_pk_mul_f32 v[36:37], v[36:37], v[148:149]
    s_waitcnt lgkmcnt(4)
    v_mfma_f32_32x32x16_bf16 v[16:31], a[88:91], v[72:75], v[16:31]
    ds_read_b128 v[64:67], v2 offset:14336
    v_pk_mul_f32 v[38:39], v[38:39], v[150:151]
    v_cvt_pk_bf16_f32 v140, v32, v33
    v_cvt_pk_bf16_f32 v141, v34, v35
    buffer_load_dwordx4 v5, s[8:11], s84 offen offset:1024 sc1 lds
    v_mfma_f32_32x32x16_bf16 v[16:31], a[92:95], v[76:79], v[16:31]
    ds_read_b128 v[68:71], v2 offset:14848
    v_cvt_pk_bf16_f32 v142, v36, v37
    v_cvt_pk_bf16_f32 v143, v38, v39
    s_nop 0
    v_permlane32_swap_b32 v140, v142
    s_waitcnt lgkmcnt(4)
    v_mfma_f32_32x32x16_bf16 v[16:31], a[96:99], v[48:51], v[16:31]
    ds_read_b128 v[72:75], v2 offset:15360
    v_permlane32_swap_b32 v141, v143
    s_add_i32 s46, s39, -1
    s_mul_i32 s2, s46, 229376
    buffer_store_dwordx4 v[140:143], v6, s[12:15], s2 offen sc1
    buffer_load_dwordx4 v5, s[8:11], s84 offen offset:2048 sc1 lds
    v_mfma_f32_32x32x16_bf16 v[16:31], a[100:103], v[52:55], v[16:31]
    ds_read_b128 v[76:79], v2 offset:15872
    s_waitcnt vmcnt(12)
    s_barrier
    s_waitcnt lgkmcnt(4)
    v_mfma_f32_32x32x16_bf16 v[16:31], a[104:107], v[56:59], v[16:31]
    ds_read_b128 v[48:51], v2 offset:16384
    buffer_load_dwordx4 v5, s[8:11], s84 offen offset:3072 sc1 lds
    v_mfma_f32_32x32x16_bf16 v[16:31], a[108:111], v[60:63], v[16:31]
    ds_read_b128 v[52:55], v2 offset:16896
    s_waitcnt lgkmcnt(4)
    v_mfma_f32_32x32x16_bf16 v[16:31], a[112:115], v[64:67], v[16:31]
    ds_read_b128 v[56:59], v2 offset:17408
    v_mfma_f32_32x32x16_bf16 v[16:31], a[116:119], v[68:71], v[16:31]
    ds_read_b128 v[60:63], v2 offset:17920
    s_waitcnt lgkmcnt(4)
    v_mfma_f32_32x32x16_bf16 v[16:31], a[120:123], v[72:75], v[16:31]
    ds_read_b128 v[64:67], v2 offset:18432
    v_mfma_f32_32x32x16_bf16 v[16:31], a[124:127], v[76:79], v[16:31]
    ds_read_b128 v[68:71], v2 offset:18944
    s_waitcnt lgkmcnt(4)
    v_mfma_f32_32x32x16_bf16 v[16:31], a[128:131], v[48:51], v[16:31]
    ds_read_b128 v[72:75], v2 offset:19456
    v_add_f32 v132, v100, v102
    v_add_f32 v133, v104, v106
    s_add_u32 m0, s53, 81920
    s_nop 0
    buffer_load_dwordx4 v4, s[8:11], s85 offen offset:0 sc1 lds
    v_mfma_f32_32x32x16_bf16 v[16:31], a[132:135], v[52:55], v[16:31]
    ds_read_b128 v[76:79], v2 offset:19968
    v_add_f32 v134, v108, v110
    v_add_f32 v135, v112, v114
    s_waitcnt lgkmcnt(4)
    v_mfma_f32_32x32x16_bf16 v[16:31], a[136:139], v[56:59], v[16:31]
    ds_read_b128 v[48:51], v2 offset:20480
    v_pk_add_f32 v[132:133], v[132:133], v[134:135]
    v_add_f32 v136, v101, v103
    v_mfma_f32_32x32x16_bf16 v[16:31], a[140:143], v[60:63], v[16:31]
    ds_read_b128 v[52:55], v2 offset:20992
    v_add_f32 v137, v105, v107
    buffer_load_dwordx4 v4, s[8:11], s85 offen offset:1024 sc1 lds
    s_waitcnt lgkmcnt(4)
    v_mfma_f32_32x32x16_bf16 v[16:31], a[144:147], v[64:67], v[16:31]
    ds_read_b128 v[56:59], v2 offset:21504
    s_add_u32 s6, s39, 2
    s_lshl_b32 s6, s6, 7
    buffer_load_dword v8, v7, s[16:19], s6 offen sc1
    v_add_f32 v138, v109, v111
    v_add_f32 v139, v113, v115
    v_mfma_f32_32x32x16_bf16 v[16:31], a[148:151], v[68:71], v[16:31]
    ds_read_b128 v[60:63], v2 offset:22016
    v_add_f32 v132, v132, v133
    v_pk_add_f32 v[136:137], v[136:137], v[138:139]
    s_waitcnt lgkmcnt(4)
    v_mfma_f32_32x32x16_bf16 v[16:31], a[152:155], v[72:75], v[16:31]
    ds_read_b128 v[64:67], v2 offset:22528
    v_mov_b32 v133, v132
    v_mfma_f32_32x32x16_bf16 v[16:31], a[156:159], v[76:79], v[16:31]
    ds_read_b128 v[68:71], v2 offset:23040
    v_add_f32 v136, v136, v137
    v_permlane32_swap_b32 v132, v133
    buffer_load_dwordx4 v4, s[8:11], s85 offen offset:2048 sc1 lds
    s_waitcnt lgkmcnt(4)
    v_mfma_f32_32x32x16_bf16 v[16:31], a[160:163], v[48:51], v[16:31]
    ds_read_b128 v[72:75], v2 offset:23552
    v_add_f32 v132, v132, v133
    v_mul_f32 v96, 0x3d800000, v132
    v_mfma_f32_32x32x16_bf16 v[16:31], a[164:167], v[52:55], v[16:31]
    ds_read_b128 v[76:79], v2 offset:24064
    v_sub_f32 v100, v100, v96
    v_sub_f32 v102, v102, v96
    s_waitcnt lgkmcnt(4)
    v_mfma_f32_32x32x16_bf16 v[16:31], a[168:171], v[56:59], v[16:31]
    ds_read_b128 v[48:51], v2 offset:24576
    v_sub_f32 v104, v104, v96
    v_mfma_f32_32x32x16_bf16 v[16:31], a[172:175], v[60:63], v[16:31]
    ds_read_b128 v[52:55], v2 offset:25088
    v_sub_f32 v106, v106, v96
    v_sub_f32 v108, v108, v96
    buffer_load_dwordx4 v4, s[8:11], s85 offen offset:3072 sc1 lds
    s_waitcnt lgkmcnt(4)
    v_mfma_f32_32x32x16_bf16 v[16:31], a[176:179], v[64:67], v[16:31]
    ds_read_b128 v[56:59], v2 offset:25600
    v_sub_f32 v110, v110, v96
    v_sub_f32 v112, v112, v96
    v_mfma_f32_32x32x16_bf16 v[16:31], a[180:183], v[68:71], v[16:31]
    ds_read_b128 v[60:63], v2 offset:26112
    v_sub_f32 v114, v114, v96
    s_waitcnt lgkmcnt(4)
    v_mfma_f32_32x32x16_bf16 v[16:31], a[184:187], v[72:75], v[16:31]
    ds_read_b128 v[64:67], v2 offset:26624
    v_mul_f32 v132, v100, v100
    v_mul_f32 v133, v102, v102
    v_mfma_f32_32x32x16_bf16 v[16:31], a[188:191], v[76:79], v[16:31]
    ds_read_b128 v[68:71], v2 offset:27136
    v_fma_f32 v132, v104, v104, v132
    v_fma_f32 v133, v106, v106, v133
    s_add_u32 m0, s53, 86016
    s_nop 0
    buffer_load_dwordx4 v5, s[8:11], s85 offen offset:0 sc1 lds
    s_waitcnt lgkmcnt(4)
    v_mfma_f32_32x32x16_bf16 v[16:31], a[192:195], v[48:51], v[16:31]
    ds_read_b128 v[72:75], v2 offset:27648
    v_fma_f32 v132, v108, v108, v132
    v_fma_f32 v133, v110, v110, v133
    v_mfma_f32_32x32x16_bf16 v[16:31], a[196:199], v[52:55], v[16:31]
    ds_read_b128 v[76:79], v2 offset:28160
    v_fma_f32 v132, v112, v112, v132
    s_waitcnt vmcnt(3)
    v_xor_b32 v162, 4, v162
    v_xor_b32 v163, 4, v163
    s_waitcnt lgkmcnt(4)
    v_mfma_f32_32x32x16_bf16 v[16:31], a[200:203], v[56:59], v[16:31]
    ds_read_b128 v[48:51], v2 offset:28672
    v_fma_f32 v133, v114, v114, v133
    v_add_f32 v132, v132, v133
    s_add_u32 s7, s39, 2
    s_cmp_lt_u32 s7, 64
    s_cselect_b32 s6, 1, 0
    v_mfma_f32_32x32x16_bf16 v[16:31], a[204:207], v[60:63], v[16:31]
    ds_read_b128 v[52:55], v2 offset:29184
    v_mul_f32 v132, 0x42800000, v132
    v_add_f32 v132, v132, v136
    buffer_load_dwordx4 v5, s[8:11], s85 offen offset:1024 sc1 lds
    v_cmp_eq_u32 vcc, 0, v8
    s_waitcnt lgkmcnt(4)
    v_mfma_f32_32x32x16_bf16 v[16:31], a[208:211], v[64:67], v[16:31]
    ds_read_b128 v[56:59], v2 offset:29696
    v_mov_b32 v133, v132
    s_cmp_eq_u64 vcc, 0
    s_cselect_b32 s6, s6, 0
    v_mfma_f32_32x32x16_bf16 v[16:31], a[212:215], v[68:71], v[16:31]
    ds_read_b128 v[60:63], v2 offset:30208
    v_permlane32_swap_b32 v132, v133
    v_add_f32 v132, v132, v133
    v_mov_b32 v13, s6
    s_waitcnt lgkmcnt(4)
    v_mfma_f32_32x32x16_bf16 v[16:31], a[216:219], v[72:75], v[16:31]
    ds_read_b128 v[64:67], v2 offset:30720
    v_mul_f32 v132, 0x3a800000, v132
    v_add_f32 v132, 0x3727c5ac, v132
    s_mov_b64 exec, 1
    ds_write_b32 v163, v13
    s_mov_b64 exec, -1
    v_mfma_f32_32x32x16_bf16 v[16:31], a[220:223], v[76:79], v[16:31]
    ds_read_b128 v[68:71], v2 offset:31232
    v_rsq_f32 v97, v132
    buffer_load_dwordx4 v5, s[8:11], s85 offen offset:2048 sc1 lds
    s_waitcnt lgkmcnt(5)
    v_mfma_f32_32x32x16_bf16 v[16:31], a[224:227], v[48:51], v[16:31]
    ds_read_b128 v[72:75], v2 offset:31744
    v_mfma_f32_32x32x16_bf16 v[16:31], a[228:231], v[52:55], v[16:31]
    ds_read_b128 v[76:79], v2 offset:32256
    s_waitcnt vmcnt(8)
    s_waitcnt lgkmcnt(3)
    s_barrier
    ds_read_b32 v14, v162
    s_cmp_le_u32 s39, s41
    s_cbranch_scc1 sm_179
    s_mov_b32 s41, s39
    s_sub_u32 s82, s39, 1
    s_lshl_b32 s82, s82, 9
    v_mov_b32 v11, 1
    buffer_store_dword v11, v12, s[16:19], s82 offen sc1
sm_179:
    s_waitcnt lgkmcnt(6)
    v_mfma_f32_32x32x16_bf16 v[16:31], a[232:235], v[56:59], v[16:31]
    ds_read_b128 v[48:51], v3 offset:0
    v_mfma_f32_32x32x16_bf16 v[16:31], a[236:239], v[60:63], v[16:31]
    ds_read_b128 v[52:55], v3 offset:512
    buffer_load_dwordx4 v5, s[8:11], s85 offen offset:3072 sc1 lds
    s_waitcnt lgkmcnt(5)
    v_mfma_f32_32x32x16_bf16 v[16:31], a[240:243], v[64:67], v[16:31]
    ds_read_b128 v[56:59], v3 offset:1024
    v_mfma_f32_32x32x16_bf16 v[16:31], a[244:247], v[68:71], v[16:31]
    ds_read_b128 v[60:63], v3 offset:1536
    s_waitcnt lgkmcnt(5)
    v_mfma_f32_32x32x16_bf16 v[16:31], a[248:251], v[72:75], v[16:31]
    ds_read_b128 v[64:67], v3 offset:2048
    s_waitcnt lgkmcnt(5)
    v_readfirstlane_b32 s52, v14
    v_mfma_f32_32x32x16_bf16 v[16:31], a[252:255], v[76:79], v[16:31]
    ds_read_b128 v[68:71], v3 offset:2560
    s_cmp_eq_u32 s40, 0
    s_cbranch_scc1 f1_end0
    s_add_u32 s39, s39, 1
    s_mov_b32 s14, 0xe00000
    s_and_b32 s40, s52, 1
    s_cselect_b32 s10, 0x400000, 0
    s_cselect_b32 s34, 0x40000, 0
    s_branch f1_LP1
f1_LP1:
    s_waitcnt lgkmcnt(4)
    v_mfma_f32_32x32x16_bf16 v[32:47], a[0:3], v[48:51], 0
    ds_read_b128 v[72:75], v3 offset:3072
    s_add_u32 s48, s39, 1
    s_mul_i32 s84, s48, 65536
    s_add_u32 s85, s84, 16384
    s_lshl_b32 s86, s48, 12
    v_mfma_f32_32x32x16_bf16 v[32:47], a[4:7], v[52:55], v[32:47]
    ds_read_b128 v[76:79], v3 offset:3584
    v_fma_f32 v16, -v96, v80, v16
    v_fma_f32 v17, -v96, v81, v17
    v_fma_f32 v18, -v96, v82, v18
    s_waitcnt lgkmcnt(4)
    v_mfma_f32_32x32x16_bf16 v[32:47], a[8:11], v[56:59], v[32:47]
    ds_read_b128 v[48:51], v3 offset:4096
    v_fma_f32 v19, -v96, v83, v19
    v_fma_f32 v20, -v96, v84, v20
    v_fma_f32 v21, -v96, v85, v21
    buffer_load_dwordx4 v[100:103], v156, s[32:35], s86 offen offset:0 sc1
    v_mfma_f32_32x32x16_bf16 v[32:47], a[12:15], v[60:63], v[32:47]
    ds_read_b128 v[52:55], v3 offset:4608
    v_fma_f32 v22, -v96, v86, v22
    v_fma_f32 v23, -v96, v87, v23
    v_fma_f32 v24, -v96, v88, v24
    s_waitcnt lgkmcnt(4)
    v_mfma_f32_32x32x16_bf16 v[32:47], a[16:19], v[64:67], v[32:47]
    ds_read_b128 v[56:59], v3 offset:5120
    v_fma_f32 v25, -v96, v89, v25
    v_fma_f32 v26, -v96, v90, v26
    v_fma_f32 v27, -v96, v91, v27
    buffer_load_dwordx4 v[104:107], v156, s[32:35], s86 offen offset:16 sc1
    v_mfma_f32_32x32x16_bf16 v[32:47], a[20:23], v[68:71], v[32:47]
    ds_read_b128 v[60:63], v3 offset:5632
    v_fma_f32 v28, -v96, v92, v28
    v_fma_f32 v29, -v96, v93, v29
    v_fma_f32 v30, -v96, v94, v30
    s_waitcnt lgkmcnt(4)
    v_mfma_f32_32x32x16_bf16 v[32:47], a[24:27], v[72:75], v[32:47]
    ds_read_b128 v[64:67], v3 offset:6144
    v_fma_f32 v31, -v96, v95, v31
    v_mul_f32 v16, v16, v97
    v_mul_f32 v17, v17, v97
    buffer_load_dwordx4 v[108:111], v156, s[32:35], s86 offen offset:512 sc1
    v_mfma_f32_32x32x16_bf16 v[32:47], a[28:31], v[76:79], v[32:47]
    ds_read_b128 v[68:71], v3 offset:6656
    v_mul_f32 v18, v18, v97
    v_mul_f32 v19, v19, v97
    v_mul_f32 v20, v20, v97
    s_waitcnt lgkmcnt(4)
    v_mfma_f32_32x32x16_bf16 v[32:47], a[32:35], v[48:51], v[32:47]
    ds_read_b128 v[72:75], v3 offset:7168
    v_mul_f32 v21, v21, v97
    v_mul_f32 v22, v22, v97
    v_mul_f32 v23, v23, v97
    buffer_load_dwordx4 v[112:115], v156, s[32:35], s86 offen offset:528 sc1
    v_mfma_f32_32x32x16_bf16 v[32:47], a[36:39], v[52:55], v[32:47]
    ds_read_b128 v[76:79], v3 offset:7680
    v_mul_f32 v24, v24, v97
    v_mul_f32 v25, v25, v97
    v_mul_f32 v26, v26, v97
    s_waitcnt lgkmcnt(4)
    v_mfma_f32_32x32x16_bf16 v[32:47], a[40:43], v[56:59], v[32:47]
    ds_read_b128 v[48:51], v3 offset:8192
    v_mul_f32 v27, v27, v97
    v_mul_f32 v28, v28, v97
    v_mul_f32 v29, v29, v97
    s_add_u32 m0, s53, 0
    s_nop 0
    buffer_load_dwordx4 v4, s[8:11], s84 offen offset:0 sc1 lds
    v_mfma_f32_32x32x16_bf16 v[32:47], a[44:47], v[60:63], v[32:47]
    ds_read_b128 v[52:55], v3 offset:8704
    v_mul_f32 v30, v30, v97
    v_mul_f32 v31, v31, v97
    v_pk_mul_f32 v[144:145], v[16:17], s[56:57]
    s_waitcnt lgkmcnt(4)
    v_mfma_f32_32x32x16_bf16 v[32:47], a[48:51], v[64:67], v[32:47]
    ds_read_b128 v[56:59], v3 offset:9216
    v_pk_mul_f32 v[146:147], v[18:19], s[56:57]
    v_pk_mul_f32 v[148:149], v[20:21], s[56:57]
    v_pk_mul_f32 v[150:151], v[22:23], s[56:57]
    v_mfma_f32_32x32x16_bf16 v[32:47], a[52:55], v[68:71], v[32:47]
    ds_read_b128 v[60:63], v3 offset:9728
    v_exp_f32 v144, v144
    v_exp_f32 v145, v145
    v_exp_f32 v146, v146
    buffer_load_dwordx4 v4, s[8:11], s84 offen offset:1024 sc1 lds
    s_waitcnt lgkmcnt(4)
    v_mfma_f32_32x32x16_bf16 v[32:47], a[56:59], v[72:75], v[32:47]
    ds_read_b128 v[64:67], v3 offset:10240
    v_exp_f32 v147, v147
    v_exp_f32 v148, v148
    v_exp_f32 v149, v149
    v_mfma_f32_32x32x16_bf16 v[32:47], a[60:63], v[76:79], v[32:47]
    ds_read_b128 v[68:71], v3 offset:10752
    v_exp_f32 v150, v150
    v_exp_f32 v151, v151
    v_pk_mul_f32 v[16:17], v[16:17], v[24:25]
    buffer_load_dwordx4 v4, s[8:11], s84 offen offset:2048 sc1 lds
    s_waitcnt lgkmcnt(4)
    v_mfma_f32_32x32x16_bf16 v[32:47], a[64:67], v[48:51], v[32:47]
    ds_read_b128 v[72:75], v3 offset:11264
    v_pk_mul_f32 v[18:19], v[18:19], v[26:27]
    v_pk_mul_f32 v[20:21], v[20:21], v[28:29]
    v_pk_mul_f32 v[22:23], v[22:23], v[30:31]
    v_mfma_f32_32x32x16_bf16 v[32:47], a[68:71], v[52:55], v[32:47]
    ds_read_b128 v[76:79], v3 offset:11776
    v_pk_add_f32 v[144:145], v[144:145], s[58:59]
    v_pk_add_f32 v[146:147], v[146:147], s[58:59]
    v_pk_add_f32 v[148:149], v[148:149], s[58:59]
    buffer_load_dwordx4 v4, s[8:11], s84 offen offset:3072 sc1 lds
    s_waitcnt lgkmcnt(4)
    v_mfma_f32_32x32x16_bf16 v[32:47], a[72:75], v[56:59], v[32:47]
    ds_read_b128 v[48:51], v3 offset:12288
    v_pk_add_f32 v[150:151], v[150:151], s[58:59]
    v_rcp_f32 v144, v144
    v_rcp_f32 v145, v145
    v_mfma_f32_32x32x16_bf16 v[32:47], a[76:79], v[60:63], v[32:47]
    ds_read_b128 v[52:55], v3 offset:12800
    v_rcp_f32 v146, v146
    v_rcp_f32 v147, v147
    v_rcp_f32 v148, v148
    s_add_u32 m0, s53, 4096
    s_nop 0
    buffer_load_dwordx4 v5, s[8:11], s84 offen offset:0 sc1 lds
    s_waitcnt lgkmcnt(4)
    v_mfma_f32_32x32x16_bf16 v[32:47], a[80:83], v[64:67], v[32:47]
    ds_read_b128 v[56:59], v3 offset:13312
    v_rcp_f32 v149, v149
    v_rcp_f32 v150, v150
    v_rcp_f32 v151, v151
    v_mfma_f32_32x32x16_bf16 v[32:47], a[84:87], v[68:71], v[32:47]
    ds_read_b128 v[60:63], v3 offset:13824
    v_pk_mul_f32 v[16:17], v[16:17], v[144:145]
    v_pk_mul_f32 v[18:19], v[18:19], v[146:147]
    v_pk_mul_f32 v[20:21], v[20:21], v[148:149]
    s_waitcnt lgkmcnt(4)
    v_mfma_f32_32x32x16_bf16 v[32:47], a[88:91], v[72:75], v[32:47]
    ds_read_b128 v[64:67], v3 offset:14336
    v_pk_mul_f32 v[22:23], v[22:23], v[150:151]
    v_cvt_pk_bf16_f32 v140, v16, v17
    v_cvt_pk_bf16_f32 v141, v18, v19
    buffer_load_dwordx4 v5, s[8:11], s84 offen offset:1024 sc1 lds
    v_mfma_f32_32x32x16_bf16 v[32:47], a[92:95], v[76:79], v[32:47]
    ds_read_b128 v[68:71], v3 offset:14848
    v_cvt_pk_bf16_f32 v142, v20, v21
    v_cvt_pk_bf16_f32 v143, v22, v23
    s_nop 0
    v_permlane32_swap_b32 v140, v142
    s_waitcnt lgkmcnt(4)
    v_mfma_f32_32x32x16_bf16 v[32:47], a[96:99], v[48:51], v[32:47]
    ds_read_b128 v[72:75], v3 offset:15360
    v_permlane32_swap_b32 v141, v143
    s_add_i32 s46, s39, -1
    s_mul_i32 s2, s46, 229376
    buffer_store_dwordx4 v[140:143], v6, s[12:15], s2 offen sc1
    buffer_load_dwordx4 v5, s[8:11], s84 offen offset:2048 sc1 lds
    v_mfma_f32_32x32x16_bf16 v[32:47], a[100:103], v[52:55], v[32:47]
    ds_read_b128 v[76:79], v3 offset:15872
    s_waitcnt vmcnt(12)
    s_barrier
    s_waitcnt lgkmcnt(4)
    v_mfma_f32_32x32x16_bf16 v[32:47], a[104:107], v[56:59], v[32:47]
    ds_read_b128 v[48:51], v3 offset:16384
    buffer_load_dwordx4 v5, s[8:11], s84 offen offset:3072 sc1 lds
    v_mfma_f32_32x32x16_bf16 v[32:47], a[108:111], v[60:63], v[32:47]
    ds_read_b128 v[52:55], v3 offset:16896
    s_waitcnt lgkmcnt(4)
    v_mfma_f32_32x32x16_bf16 v[32:47], a[112:115], v[64:67], v[32:47]
    ds_read_b128 v[56:59], v3 offset:17408
    v_mfma_f32_32x32x16_bf16 v[32:47], a[116:119], v[68:71], v[32:47]
    ds_read_b128 v[60:63], v3 offset:17920
    s_waitcnt lgkmcnt(4)
    v_mfma_f32_32x32x16_bf16 v[32:47], a[120:123], v[72:75], v[32:47]
    ds_read_b128 v[64:67], v3 offset:18432
    v_mfma_f32_32x32x16_bf16 v[32:47], a[124:127], v[76:79], v[32:47]
    ds_read_b128 v[68:71], v3 offset:18944
    s_waitcnt lgkmcnt(4)
    v_mfma_f32_32x32x16_bf16 v[32:47], a[128:131], v[48:51], v[32:47]
    ds_read_b128 v[72:75], v3 offset:19456
    v_add_f32 v132, v116, v118
    v_add_f32 v133, v120, v122
    s_add_u32 m0, s53, 16384
    s_nop 0
    buffer_load_dwordx4 v4, s[8:11], s85 offen offset:0 sc1 lds
    v_mfma_f32_32x32x16_bf16 v[32:47], a[132:135], v[52:55], v[32:47]
    ds_read_b128 v[76:79], v3 offset:19968
    v_add_f32 v134, v124, v126
    v_add_f32 v135, v128, v130
    s_waitcnt lgkmcnt(4)
    v_mfma_f32_32x32x16_bf16 v[32:47], a[136:139], v[56:59], v[32:47]
    ds_read_b128 v[48:51], v3 offset:20480
    v_pk_add_f32 v[132:133], v[132:133], v[134:135]
    v_add_f32 v136, v117, v119
    v_mfma_f32_32x32x16_bf16 v[32:47], a[140:143], v[60:63], v[32:47]
    ds_read_b128 v[52:55], v3 offset:20992
    v_add_f32 v137, v121, v123
    buffer_load_dwordx4 v4, s[8:11], s85 offen offset:1024 sc1 lds
    s_waitcnt lgkmcnt(4)
    v_mfma_f32_32x32x16_bf16 v[32:47], a[144:147], v[64:67], v[32:47]
    ds_read_b128 v[56:59], v3 offset:21504
    s_add_u32 s6, s39, 2
    s_lshl_b32 s6, s6, 7
    buffer_load_dword v8, v7, s[16:19], s6 offen sc1
    v_add_f32 v138, v125, v127
    v_add_f32 v139, v129, v131
    v_mfma_f32_32x32x16_bf16 v[32:47], a[148:151], v[68:71], v[32:47]
    ds_read_b128 v[60:63], v3 offset:22016
    v_add_f32 v132, v132, v133
    v_pk_add_f32 v[136:137], v[136:137], v[138:139]
    s_waitcnt lgkmcnt(4)
    v_mfma_f32_32x32x16_bf16 v[32:47], a[152:155], v[72:75], v[32:47]
    ds_read_b128 v[64:67], v3 offset:22528
    v_mov_b32 v133, v132
    v_mfma_f32_32x32x16_bf16 v[32:47], a[156:159], v[76:79], v[32:47]
    ds_read_b128 v[68:71], v3 offset:23040
    v_add_f32 v136, v136, v137
    v_permlane32_swap_b32 v132, v133
    buffer_load_dwordx4 v4, s[8:11], s85 offen offset:2048 sc1 lds
    s_waitcnt lgkmcnt(4)
    v_mfma_f32_32x32x16_bf16 v[32:47], a[160:163], v[48:51], v[32:47]
    ds_read_b128 v[72:75], v3 offset:23552
    v_add_f32 v132, v132, v133
    v_mul_f32 v96, 0x3d800000, v132
    v_mfma_f32_32x32x16_bf16 v[32:47], a[164:167], v[52:55], v[32:47]
    ds_read_b128 v[76:79], v3 offset:24064
    v_sub_f32 v116, v116, v96
    v_sub_f32 v118, v118, v96
    s_waitcnt lgkmcnt(4)
    v_mfma_f32_32x32x16_bf16 v[32:47], a[168:171], v[56:59], v[32:47]
    ds_read_b128 v[48:51], v3 offset:24576
    v_sub_f32 v120, v120, v96
    v_mfma_f32_32x32x16_bf16 v[32:47], a[172:175], v[60:63], v[32:47]
    ds_read_b128 v[52:55], v3 offset:25088
    v_sub_f32 v122, v122, v96
    v_sub_f32 v124, v124, v96
    buffer_load_dwordx4 v4, s[8:11], s85 offen offset:3072 sc1 lds
    s_waitcnt lgkmcnt(4)
    v_mfma_f32_32x32x16_bf16 v[32:47], a[176:179], v[64:67], v[32:47]
    ds_read_b128 v[56:59], v3 offset:25600
    v_sub_f32 v126, v126, v96
    v_sub_f32 v128, v128, v96
    v_mfma_f32_32x32x16_bf16 v[32:47], a[180:183], v[68:71], v[32:47]
    ds_read_b128 v[60:63], v3 offset:26112
    v_sub_f32 v130, v130, v96
    s_waitcnt lgkmcnt(4)
    v_mfma_f32_32x32x16_bf16 v[32:47], a[184:187], v[72:75], v[32:47]
    ds_read_b128 v[64:67], v3 offset:26624
    v_mul_f32 v132, v116, v116
    v_mul_f32 v133, v118, v118
    v_mfma_f32_32x32x16_bf16 v[32:47], a[188:191], v[76:79], v[32:47]
    ds_read_b128 v[68:71], v3 offset:27136
    v_fma_f32 v132, v120, v120, v132
    v_fma_f32 v133, v122, v122, v133
    s_add_u32 m0, s53, 20480
    s_nop 0
    buffer_load_dwordx4 v5, s[8:11], s85 offen offset:0 sc1 lds
    s_waitcnt lgkmcnt(4)
    v_mfma_f32_32x32x16_bf16 v[32:47], a[192:195], v[48:51], v[32:47]
    ds_read_b128 v[72:75], v3 offset:27648
    v_fma_f32 v132, v124, v124, v132
    v_fma_f32 v133, v126, v126, v133
    v_mfma_f32_32x32x16_bf16 v[32:47], a[196:199], v[52:55], v[32:47]
    ds_read_b128 v[76:79], v3 offset:28160
    v_fma_f32 v132, v128, v128, v132
    s_waitcnt vmcnt(3)
    v_xor_b32 v162, 4, v162
    v_xor_b32 v163, 4, v163
    s_waitcnt lgkmcnt(4)
    v_mfma_f32_32x32x16_bf16 v[32:47], a[200:203], v[56:59], v[32:47]
    ds_read_b128 v[48:51], v3 offset:28672
    v_fma_f32 v133, v130, v130, v133
    v_add_f32 v132, v132, v133
    s_add_u32 s7, s39, 2
    s_cmp_lt_u32 s7, 64
    s_cselect_b32 s6, 1, 0
    v_mfma_f32_32x32x16_bf16 v[32:47], a[204:207], v[60:63], v[32:47]
    ds_read_b128 v[52:55], v3 offset:29184
    v_mul_f32 v132, 0x42800000, v132
    v_add_f32 v132, v132, v136
    buffer_load_dwordx4 v5, s[8:11], s85 offen offset:1024 sc1 lds
    v_cmp_eq_u32 vcc, 0, v8
    s_waitcnt lgkmcnt(4)
    v_mfma_f32_32x32x16_bf16 v[32:47], a[208:211], v[64:67], v[32:47]
    ds_read_b128 v[56:59], v3 offset:29696
    v_mov_b32 v133, v132
    s_cmp_eq_u64 vcc, 0
    s_cselect_b32 s6, s6, 0
    v_mfma_f32_32x32x16_bf16 v[32:47], a[212:215], v[68:71], v[32:47]
    ds_read_b128 v[60:63], v3 offset:30208
    v_permlane32_swap_b32 v132, v133
    v_add_f32 v132, v132, v133
    v_mov_b32 v13, s6
    s_waitcnt lgkmcnt(4)
    v_mfma_f32_32x32x16_bf16 v[32:47], a[216:219], v[72:75], v[32:47]
    ds_read_b128 v[64:67], v3 offset:30720
    v_mul_f32 v132, 0x3a800000, v132
    v_add_f32 v132, 0x3727c5ac, v132
    s_mov_b64 exec, 1
    ds_write_b32 v163, v13
    s_mov_b64 exec, -1
    v_mfma_f32_32x32x16_bf16 v[32:47], a[220:223], v[76:79], v[32:47]
    ds_read_b128 v[68:71], v3 offset:31232
    v_rsq_f32 v97, v132
    buffer_load_dwordx4 v5, s[8:11], s85 offen offset:2048 sc1 lds
    s_waitcnt lgkmcnt(5)
    v_mfma_f32_32x32x16_bf16 v[32:47], a[224:227], v[48:51], v[32:47]
    ds_read_b128 v[72:75], v3 offset:31744
    v_mfma_f32_32x32x16_bf16 v[32:47], a[228:231], v[52:55], v[32:47]
    ds_read_b128 v[76:79], v3 offset:32256
    s_waitcnt vmcnt(8)
    s_waitcnt lgkmcnt(3)
    s_barrier
    ds_read_b32 v14, v162
    s_cmp_le_u32 s39, s41
    s_cbranch_scc1 sm_180
    s_mov_b32 s41, s39
    s_sub_u32 s82, s39, 1
    s_lshl_b32 s82, s82, 9
    v_mov_b32 v11, 1
    buffer_store_dword v11, v12, s[16:19], s82 offen sc1
sm_180:
    s_waitcnt lgkmcnt(6)
    v_mfma_f32_32x32x16_bf16 v[32:47], a[232:235], v[56:59], v[32:47]
    ds_read_b128 v[48:51], v2 offset:0
    v_mfma_f32_32x32x16_bf16 v[32:47], a[236:239], v[60:63], v[32:47]
    ds_read_b128 v[52:55], v2 offset:512
    buffer_load_dwordx4 v5, s[8:11], s85 offen offset:3072 sc1 lds
    s_waitcnt lgkmcnt(5)
    v_mfma_f32_32x32x16_bf16 v[32:47], a[240:243], v[64:67], v[32:47]
    ds_read_b128 v[56:59], v2 offset:1024
    v_mfma_f32_32x32x16_bf16 v[32:47], a[244:247], v[68:71], v[32:47]
    ds_read_b128 v[60:63], v2 offset:1536
    s_waitcnt lgkmcnt(5)
    v_mfma_f32_32x32x16_bf16 v[32:47], a[248:251], v[72:75], v[32:47]
    ds_read_b128 v[64:67], v2 offset:2048
    s_waitcnt lgkmcnt(5)
    v_readfirstlane_b32 s52, v14
    v_mfma_f32_32x32x16_bf16 v[32:47], a[252:255], v[76:79], v[32:47]
    ds_read_b128 v[68:71], v2 offset:2560
    s_cmp_eq_u32 s40, 0
    s_cbranch_scc1 f1_end1
    s_add_u32 s39, s39, 1
    s_mov_b32 s14, 0xe00000
    s_and_b32 s40, s52, 1
    s_cselect_b32 s10, 0x400000, 0
    s_cselect_b32 s34, 0x40000, 0
    s_branch f1_LP0
role_op:
    s_lshl_b32 s50, s38, 8
    s_mul_i32 s51, s37, 2097152
    s_load_dwordx2 s[6:7], s[0:1], 40
    s_waitcnt lgkmcnt(0)
    s_mov_b32 s20, s6
    s_mov_b32 s21, s7
    s_mov_b32 s22, 0x800000
    s_mov_b32 s23, 0x20000
    v_lshrrev_b32 v132, 4, v1
    v_lshlrev_b32 v133, 11, v132
    v_and_b32 v134, 15, v1
    v_lshlrev_b32 v135, 1, v132
    v_xor_b32 v135, v135, v134
    v_lshl_add_u32 v136, v135, 4, v133
    v_lshlrev_b32 v135, 1, v132
    v_add_u32 v135, 8, v135
    v_xor_b32 v135, v135, v134
    v_lshl_add_u32 v137, v135, 4, v133
    v_bfe_u32 v133, v1, 2, 2
    v_lshrrev_b32 v134, 5, v1
    v_lshl_add_u32 v132, v134, 2, v133
    v_mov_b32 v133, v132
    v_lshlrev_b32 v132, 8, v132
    v_and_b32 v135, 3, v1
    v_lshl_add_u32 v132, v135, 3, v132
    s_lshl_b32 s46, s36, 1
    v_bfe_u32 v138, v1, 4, 1
    v_add_u32 v138, s46, v138
    v_xor_b32 v135, v138, v133
    v_lshl_add_u32 v140, v135, 5, v132
    v_add_u32 v142, 0x10000, v140
    v_xor_b32 v135, v138, v133
    v_lshl_add_u32 v141, v135, 5, v132
    v_add_u32 v143, 0x10000, v141
    s_mul_i32 s46, s36, 262144
    s_add_u32 s46, s46, s51
    s_add_u32 s46, s46, s50
    s_mul_i32 s47, s36, 32768
    s_mov_b32 m0, s47
    s_nop 0
    buffer_load_dwordx4 v136, s[20:23], s46 offen lds
    s_add_u32 s46, s46, 8192
    s_add_u32 m0, m0, 1024
    s_nop 0
    buffer_load_dwordx4 v137, s[20:23], s46 offen lds
    s_add_u32 s46, s46, 8192
    s_add_u32 m0, m0, 1024
    s_nop 0
    buffer_load_dwordx4 v136, s[20:23], s46 offen lds
    s_add_u32 s46, s46, 8192
    s_add_u32 m0, m0, 1024
    s_nop 0
    buffer_load_dwordx4 v137, s[20:23], s46 offen lds
    s_add_u32 s46, s46, 8192
    s_add_u32 m0, m0, 1024
    s_nop 0
    buffer_load_dwordx4 v136, s[20:23], s46 offen lds
    s_add_u32 s46, s46, 8192
    s_add_u32 m0, m0, 1024
    s_nop 0
    buffer_load_dwordx4 v137, s[20:23], s46 offen lds
    s_add_u32 s46, s46, 8192
    s_add_u32 m0, m0, 1024
    s_nop 0
    buffer_load_dwordx4 v136, s[20:23], s46 offen lds
    s_add_u32 s46, s46, 8192
    s_add_u32 m0, m0, 1024
    s_nop 0
    buffer_load_dwordx4 v137, s[20:23], s46 offen lds
    s_add_u32 s46, s46, 8192
    s_add_u32 m0, m0, 1024
    s_nop 0
    buffer_load_dwordx4 v136, s[20:23], s46 offen lds
    s_add_u32 s46, s46, 8192
    s_add_u32 m0, m0, 1024
    s_nop 0
    buffer_load_dwordx4 v137, s[20:23], s46 offen lds
    s_add_u32 s46, s46, 8192
    s_add_u32 m0, m0, 1024
    s_nop 0
    buffer_load_dwordx4 v136, s[20:23], s46 offen lds
    s_add_u32 s46, s46, 8192
    s_add_u32 m0, m0, 1024
    s_nop 0
    buffer_load_dwordx4 v137, s[20:23], s46 offen lds
    s_add_u32 s46, s46, 8192
    s_add_u32 m0, m0, 1024
    s_nop 0
    buffer_load_dwordx4 v136, s[20:23], s46 offen lds
    s_add_u32 s46, s46, 8192
    s_add_u32 m0, m0, 1024
    s_nop 0
    buffer_load_dwordx4 v137, s[20:23], s46 offen lds
    s_add_u32 s46, s46, 8192
    s_add_u32 m0, m0, 1024
    s_nop 0
    buffer_load_dwordx4 v136, s[20:23], s46 offen lds
    s_add_u32 s46, s46, 8192
    s_add_u32 m0, m0, 1024
    s_nop 0
    buffer_load_dwordx4 v137, s[20:23], s46 offen lds
    s_add_u32 s46, s46, 8192
    s_add_u32 m0, m0, 1024
    s_nop 0
    buffer_load_dwordx4 v136, s[20:23], s46 offen lds
    s_add_u32 s46, s46, 8192
    s_add_u32 m0, m0, 1024
    s_nop 0
    buffer_load_dwordx4 v137, s[20:23], s46 offen lds
    s_add_u32 s46, s46, 8192
    s_add_u32 m0, m0, 1024
    s_nop 0
    buffer_load_dwordx4 v136, s[20:23], s46 offen lds
    s_add_u32 s46, s46, 8192
    s_add_u32 m0, m0, 1024
    s_nop 0
    buffer_load_dwordx4 v137, s[20:23], s46 offen lds
    s_add_u32 s46, s46, 8192
    s_add_u32 m0, m0, 1024
    s_nop 0
    buffer_load_dwordx4 v136, s[20:23], s46 offen lds
    s_add_u32 s46, s46, 8192
    s_add_u32 m0, m0, 1024
    s_nop 0
    buffer_load_dwordx4 v137, s[20:23], s46 offen lds
    s_add_u32 s46, s46, 8192
    s_add_u32 m0, m0, 1024
    s_nop 0
    buffer_load_dwordx4 v136, s[20:23], s46 offen lds
    s_add_u32 s46, s46, 8192
    s_add_u32 m0, m0, 1024
    s_nop 0
    buffer_load_dwordx4 v137, s[20:23], s46 offen lds
    s_add_u32 s46, s46, 8192
    s_add_u32 m0, m0, 1024
    s_nop 0
    buffer_load_dwordx4 v136, s[20:23], s46 offen lds
    s_add_u32 s46, s46, 8192
    s_add_u32 m0, m0, 1024
    s_nop 0
    buffer_load_dwordx4 v137, s[20:23], s46 offen lds
    s_add_u32 s46, s46, 8192
    s_add_u32 m0, m0, 1024
    s_nop 0
    buffer_load_dwordx4 v136, s[20:23], s46 offen lds
    s_add_u32 s46, s46, 8192
    s_add_u32 m0, m0, 1024
    s_nop 0
    buffer_load_dwordx4 v137, s[20:23], s46 offen lds
    s_add_u32 s46, s46, 8192
    s_add_u32 m0, m0, 1024
    s_nop 0
    buffer_load_dwordx4 v136, s[20:23], s46 offen lds
    s_add_u32 s46, s46, 8192
    s_add_u32 m0, m0, 1024
    s_nop 0
    buffer_load_dwordx4 v137, s[20:23], s46 offen lds
    s_add_u32 s46, s46, 8192
    s_add_u32 m0, m0, 1024
    s_nop 0
    buffer_load_dwordx4 v136, s[20:23], s46 offen lds
    s_add_u32 s46, s46, 8192
    s_add_u32 m0, m0, 1024
    s_nop 0
    buffer_load_dwordx4 v137, s[20:23], s46 offen lds
    s_waitcnt vmcnt(0)
    s_barrier
    ds_read_b64_tr_b16 a[0:1], v140 offset:0
    ds_read_b64_tr_b16 a[2:3], v141 offset:4096
    ds_read_b64_tr_b16 a[4:5], v140 offset:2048
    ds_read_b64_tr_b16 a[6:7], v141 offset:6144
    ds_read_b64_tr_b16 a[8:9], v140 offset:8192
    ds_read_b64_tr_b16 a[10:11], v141 offset:12288
    ds_read_b64_tr_b16 a[12:13], v140 offset:10240
    ds_read_b64_tr_b16 a[14:15], v141 offset:14336
    s_waitcnt lgkmcnt(4)
    ds_read_b64_tr_b16 a[16:17], v140 offset:16384
    ds_read_b64_tr_b16 a[18:19], v141 offset:20480
    ds_read_b64_tr_b16 a[20:21], v140 offset:18432
    ds_read_b64_tr_b16 a[22:23], v141 offset:22528
    ds_read_b64_tr_b16 a[24:25], v140 offset:24576
    ds_read_b64_tr_b16 a[26:27], v141 offset:28672
    ds_read_b64_tr_b16 a[28:29], v140 offset:26624
    ds_read_b64_tr_b16 a[30:31], v141 offset:30720
    s_waitcnt lgkmcnt(4)
    ds_read_b64_tr_b16 a[32:33], v140 offset:32768
    ds_read_b64_tr_b16 a[34:35], v141 offset:36864
    ds_read_b64_tr_b16 a[36:37], v140 offset:34816
    ds_read_b64_tr_b16 a[38:39], v141 offset:38912
    ds_read_b64_tr_b16 a[40:41], v140 offset:40960
    ds_read_b64_tr_b16 a[42:43], v141 offset:45056
    ds_read_b64_tr_b16 a[44:45], v140 offset:43008
    ds_read_b64_tr_b16 a[46:47], v141 offset:47104
    s_waitcnt lgkmcnt(4)
    ds_read_b64_tr_b16 a[48:49], v140 offset:49152
    ds_read_b64_tr_b16 a[50:51], v141 offset:53248
    ds_read_b64_tr_b16 a[52:53], v140 offset:51200
    ds_read_b64_tr_b16 a[54:55], v141 offset:55296
    ds_read_b64_tr_b16 a[56:57], v140 offset:57344
    ds_read_b64_tr_b16 a[58:59], v141 offset:61440
    ds_read_b64_tr_b16 a[60:61], v140 offset:59392
    ds_read_b64_tr_b16 a[62:63], v141 offset:63488
    s_waitcnt lgkmcnt(4)
    ds_read_b64_tr_b16 a[64:65], v142 offset:0
    ds_read_b64_tr_b16 a[66:67], v143 offset:4096
    ds_read_b64_tr_b16 a[68:69], v142 offset:2048
    ds_read_b64_tr_b16 a[70:71], v143 offset:6144
    ds_read_b64_tr_b16 a[72:73], v142 offset:8192
    ds_read_b64_tr_b16 a[74:75], v143 offset:12288
    ds_read_b64_tr_b16 a[76:77], v142 offset:10240
    ds_read_b64_tr_b16 a[78:79], v143 offset:14336
    s_waitcnt lgkmcnt(4)
    ds_read_b64_tr_b16 a[80:81], v142 offset:16384
    ds_read_b64_tr_b16 a[82:83], v143 offset:20480
    ds_read_b64_tr_b16 a[84:85], v142 offset:18432
    ds_read_b64_tr_b16 a[86:87], v143 offset:22528
    ds_read_b64_tr_b16 a[88:89], v142 offset:24576
    ds_read_b64_tr_b16 a[90:91], v143 offset:28672
    ds_read_b64_tr_b16 a[92:93], v142 offset:26624
    ds_read_b64_tr_b16 a[94:95], v143 offset:30720
    s_waitcnt lgkmcnt(4)
    ds_read_b64_tr_b16 a[96:97], v142 offset:32768
    ds_read_b64_tr_b16 a[98:99], v143 offset:36864
    ds_read_b64_tr_b16 a[100:101], v142 offset:34816
    ds_read_b64_tr_b16 a[102:103], v143 offset:38912
    ds_read_b64_tr_b16 a[104:105], v142 offset:40960
    ds_read_b64_tr_b16 a[106:107], v143 offset:45056
    ds_read_b64_tr_b16 a[108:109], v142 offset:43008
    ds_read_b64_tr_b16 a[110:111], v143 offset:47104
    s_waitcnt lgkmcnt(4)
    ds_read_b64_tr_b16 a[112:113], v142 offset:49152
    ds_read_b64_tr_b16 a[114:115], v143 offset:53248
    ds_read_b64_tr_b16 a[116:117], v142 offset:51200
    ds_read_b64_tr_b16 a[118:119], v143 offset:55296
    ds_read_b64_tr_b16 a[120:121], v142 offset:57344
    ds_read_b64_tr_b16 a[122:123], v143 offset:61440
    ds_read_b64_tr_b16 a[124:125], v142 offset:59392
    ds_read_b64_tr_b16 a[126:127], v143 offset:63488
    s_waitcnt lgkmcnt(4)
    s_waitcnt lgkmcnt(0)
    s_barrier
    s_mul_i32 s46, s36, 262144
    s_add_u32 s46, s46, s51
    s_add_u32 s46, s46, s50
    s_add_u32 s46, s46, 1048576
    s_mul_i32 s47, s36, 32768
    s_mov_b32 m0, s47
    s_nop 0
    buffer_load_dwordx4 v136, s[20:23], s46 offen lds
    s_add_u32 s46, s46, 8192
    s_add_u32 m0, m0, 1024
    s_nop 0
    buffer_load_dwordx4 v137, s[20:23], s46 offen lds
    s_add_u32 s46, s46, 8192
    s_add_u32 m0, m0, 1024
    s_nop 0
    buffer_load_dwordx4 v136, s[20:23], s46 offen lds
    s_add_u32 s46, s46, 8192
    s_add_u32 m0, m0, 1024
    s_nop 0
    buffer_load_dwordx4 v137, s[20:23], s46 offen lds
    s_add_u32 s46, s46, 8192
    s_add_u32 m0, m0, 1024
    s_nop 0
    buffer_load_dwordx4 v136, s[20:23], s46 offen lds
    s_add_u32 s46, s46, 8192
    s_add_u32 m0, m0, 1024
    s_nop 0
    buffer_load_dwordx4 v137, s[20:23], s46 offen lds
    s_add_u32 s46, s46, 8192
    s_add_u32 m0, m0, 1024
    s_nop 0
    buffer_load_dwordx4 v136, s[20:23], s46 offen lds
    s_add_u32 s46, s46, 8192
    s_add_u32 m0, m0, 1024
    s_nop 0
    buffer_load_dwordx4 v137, s[20:23], s46 offen lds
    s_add_u32 s46, s46, 8192
    s_add_u32 m0, m0, 1024
    s_nop 0
    buffer_load_dwordx4 v136, s[20:23], s46 offen lds
    s_add_u32 s46, s46, 8192
    s_add_u32 m0, m0, 1024
    s_nop 0
    buffer_load_dwordx4 v137, s[20:23], s46 offen lds
    s_add_u32 s46, s46, 8192
    s_add_u32 m0, m0, 1024
    s_nop 0
    buffer_load_dwordx4 v136, s[20:23], s46 offen lds
    s_add_u32 s46, s46, 8192
    s_add_u32 m0, m0, 1024
    s_nop 0
    buffer_load_dwordx4 v137, s[20:23], s46 offen lds
    s_add_u32 s46, s46, 8192
    s_add_u32 m0, m0, 1024
    s_nop 0
    buffer_load_dwordx4 v136, s[20:23], s46 offen lds
    s_add_u32 s46, s46, 8192
    s_add_u32 m0, m0, 1024
    s_nop 0
    buffer_load_dwordx4 v137, s[20:23], s46 offen lds
    s_add_u32 s46, s46, 8192
    s_add_u32 m0, m0, 1024
    s_nop 0
    buffer_load_dwordx4 v136, s[20:23], s46 offen lds
    s_add_u32 s46, s46, 8192
    s_add_u32 m0, m0, 1024
    s_nop 0
    buffer_load_dwordx4 v137, s[20:23], s46 offen lds
    s_add_u32 s46, s46, 8192
    s_add_u32 m0, m0, 1024
    s_nop 0
    buffer_load_dwordx4 v136, s[20:23], s46 offen lds
    s_add_u32 s46, s46, 8192
    s_add_u32 m0, m0, 1024
    s_nop 0
    buffer_load_dwordx4 v137, s[20:23], s46 offen lds
    s_add_u32 s46, s46, 8192
    s_add_u32 m0, m0, 1024
    s_nop 0
    buffer_load_dwordx4 v136, s[20:23], s46 offen lds
    s_add_u32 s46, s46, 8192
    s_add_u32 m0, m0, 1024
    s_nop 0
    buffer_load_dwordx4 v137, s[20:23], s46 offen lds
    s_add_u32 s46, s46, 8192
    s_add_u32 m0, m0, 1024
    s_nop 0
    buffer_load_dwordx4 v136, s[20:23], s46 offen lds
    s_add_u32 s46, s46, 8192
    s_add_u32 m0, m0, 1024
    s_nop 0
    buffer_load_dwordx4 v137, s[20:23], s46 offen lds
    s_add_u32 s46, s46, 8192
    s_add_u32 m0, m0, 1024
    s_nop 0
    buffer_load_dwordx4 v136, s[20:23], s46 offen lds
    s_add_u32 s46, s46, 8192
    s_add_u32 m0, m0, 1024
    s_nop 0
    buffer_load_dwordx4 v137, s[20:23], s46 offen lds
    s_add_u32 s46, s46, 8192
    s_add_u32 m0, m0, 1024
    s_nop 0
    buffer_load_dwordx4 v136, s[20:23], s46 offen lds
    s_add_u32 s46, s46, 8192
    s_add_u32 m0, m0, 1024
    s_nop 0
    buffer_load_dwordx4 v137, s[20:23], s46 offen lds
    s_add_u32 s46, s46, 8192
    s_add_u32 m0, m0, 1024
    s_nop 0
    buffer_load_dwordx4 v136, s[20:23], s46 offen lds
    s_add_u32 s46, s46, 8192
    s_add_u32 m0, m0, 1024
    s_nop 0
    buffer_load_dwordx4 v137, s[20:23], s46 offen lds
    s_add_u32 s46, s46, 8192
    s_add_u32 m0, m0, 1024
    s_nop 0
    buffer_load_dwordx4 v136, s[20:23], s46 offen lds
    s_add_u32 s46, s46, 8192
    s_add_u32 m0, m0, 1024
    s_nop 0
    buffer_load_dwordx4 v137, s[20:23], s46 offen lds
    s_add_u32 s46, s46, 8192
    s_add_u32 m0, m0, 1024
    s_nop 0
    buffer_load_dwordx4 v136, s[20:23], s46 offen lds
    s_add_u32 s46, s46, 8192
    s_add_u32 m0, m0, 1024
    s_nop 0
    buffer_load_dwordx4 v137, s[20:23], s46 offen lds
    s_waitcnt vmcnt(0)
    s_barrier
    ds_read_b64_tr_b16 a[128:129], v140 offset:0
    ds_read_b64_tr_b16 a[130:131], v141 offset:4096
    ds_read_b64_tr_b16 a[132:133], v140 offset:2048
    ds_read_b64_tr_b16 a[134:135], v141 offset:6144
    ds_read_b64_tr_b16 a[136:137], v140 offset:8192
    ds_read_b64_tr_b16 a[138:139], v141 offset:12288
    ds_read_b64_tr_b16 a[140:141], v140 offset:10240
    ds_read_b64_tr_b16 a[142:143], v141 offset:14336
    s_waitcnt lgkmcnt(4)
    ds_read_b64_tr_b16 a[144:145], v140 offset:16384
    ds_read_b64_tr_b16 a[146:147], v141 offset:20480
    ds_read_b64_tr_b16 a[148:149], v140 offset:18432
    ds_read_b64_tr_b16 a[150:151], v141 offset:22528
    ds_read_b64_tr_b16 a[152:153], v140 offset:24576
    ds_read_b64_tr_b16 a[154:155], v141 offset:28672
    ds_read_b64_tr_b16 a[156:157], v140 offset:26624
    ds_read_b64_tr_b16 a[158:159], v141 offset:30720
    s_waitcnt lgkmcnt(4)
    ds_read_b64_tr_b16 a[160:161], v140 offset:32768
    ds_read_b64_tr_b16 a[162:163], v141 offset:36864
    ds_read_b64_tr_b16 a[164:165], v140 offset:34816
    ds_read_b64_tr_b16 a[166:167], v141 offset:38912
    ds_read_b64_tr_b16 a[168:169], v140 offset:40960
    ds_read_b64_tr_b16 a[170:171], v141 offset:45056
    ds_read_b64_tr_b16 a[172:173], v140 offset:43008
    ds_read_b64_tr_b16 a[174:175], v141 offset:47104
    s_waitcnt lgkmcnt(4)
    ds_read_b64_tr_b16 a[176:177], v140 offset:49152
    ds_read_b64_tr_b16 a[178:179], v141 offset:53248
    ds_read_b64_tr_b16 a[180:181], v140 offset:51200
    ds_read_b64_tr_b16 a[182:183], v141 offset:55296
    ds_read_b64_tr_b16 a[184:185], v140 offset:57344
    ds_read_b64_tr_b16 a[186:187], v141 offset:61440
    ds_read_b64_tr_b16 a[188:189], v140 offset:59392
    ds_read_b64_tr_b16 a[190:191], v141 offset:63488
    s_waitcnt lgkmcnt(4)
    ds_read_b64_tr_b16 a[192:193], v142 offset:0
    ds_read_b64_tr_b16 a[194:195], v143 offset:4096
    ds_read_b64_tr_b16 a[196:197], v142 offset:2048
    ds_read_b64_tr_b16 a[198:199], v143 offset:6144
    ds_read_b64_tr_b16 a[200:201], v142 offset:8192
    ds_read_b64_tr_b16 a[202:203], v143 offset:12288
    ds_read_b64_tr_b16 a[204:205], v142 offset:10240
    ds_read_b64_tr_b16 a[206:207], v143 offset:14336
    s_waitcnt lgkmcnt(4)
    ds_read_b64_tr_b16 a[208:209], v142 offset:16384
    ds_read_b64_tr_b16 a[210:211], v143 offset:20480
    ds_read_b64_tr_b16 a[212:213], v142 offset:18432
    ds_read_b64_tr_b16 a[214:215], v143 offset:22528
    ds_read_b64_tr_b16 a[216:217], v142 offset:24576
    ds_read_b64_tr_b16 a[218:219], v143 offset:28672
    ds_read_b64_tr_b16 a[220:221], v142 offset:26624
    ds_read_b64_tr_b16 a[222:223], v143 offset:30720
    s_waitcnt lgkmcnt(4)
    ds_read_b64_tr_b16 a[224:225], v142 offset:32768
    ds_read_b64_tr_b16 a[226:227], v143 offset:36864
    ds_read_b64_tr_b16 a[228:229], v142 offset:34816
    ds_read_b64_tr_b16 a[230:231], v143 offset:38912
    ds_read_b64_tr_b16 a[232:233], v142 offset:40960
    ds_read_b64_tr_b16 a[234:235], v143 offset:45056
    ds_read_b64_tr_b16 a[236:237], v142 offset:43008
    ds_read_b64_tr_b16 a[238:239], v143 offset:47104
    s_waitcnt lgkmcnt(4)
    ds_read_b64_tr_b16 a[240:241], v142 offset:49152
    ds_read_b64_tr_b16 a[242:243], v143 offset:53248
    ds_read_b64_tr_b16 a[244:245], v142 offset:51200
    ds_read_b64_tr_b16 a[246:247], v143 offset:55296
    ds_read_b64_tr_b16 a[248:249], v142 offset:57344
    ds_read_b64_tr_b16 a[250:251], v143 offset:61440
    ds_read_b64_tr_b16 a[252:253], v142 offset:59392
    ds_read_b64_tr_b16 a[254:255], v143 offset:63488
    s_waitcnt lgkmcnt(4)
    s_waitcnt lgkmcnt(0)
    s_barrier
    s_and_b32 s46, s38, 3
    s_lshl_b32 s47, s46, 4
    s_lshl_b32 s48, s36, 2
    s_add_u32 s47, s47, s48
    v_lshlrev_b32 v132, 4, v1
    s_lshl_b32 s48, s47, 10
    v_add_u32 v157, s48, v132
    s_lshl_b32 s48, s47, 9
    v_add_u32 v159, s48, v132
    s_lshl_b32 s48, s47, 5
    v_lshlrev_b32 v132, 11, v14
    v_lshl_add_u32 v132, v15, 3, v132
    v_add_u32 v158, s48, v132
    s_lshl_b32 s48, s46, 3
    s_add_u32 s48, s48, 131072
    v_bfe_u32 v132, v1, 1, 2
    v_lshlrev_b32 v132, 5, v132
    v_and_b32 v133, 1, v1
    v_lshl_add_u32 v132, v133, 2, v132
    v_add_u32 v9, s48, v132
    s_add_u32 s20, s4, 0x7000000
    s_addc_u32 s21, s5, 0
    s_mov_b32 s22, 0x2000000
    s_mov_b32 s23, 0x20000
    s_load_dwordx2 s[6:7], s[0:1], 0
    s_lshl_b32 s48, s46, 9
    s_lshl_b32 s49, s36, 3
    s_add_u32 s48, s48, s49
    v_lshlrev_b32 v132, 5, v14
    v_add_u32 v132, s48, v132
    v_mov_b32 v133, 0x80000000
    v_cmp_gt_u32 vcc, 16, v1
    s_nop 1
    v_cndmask_b32 v160, v133, v132, vcc
    s_waitcnt lgkmcnt(0)
    s_mov_b32 s24, s6
    s_mov_b32 s25, s7
    s_mov_b32 s26, 0x400000
    s_mov_b32 s27, 0x20000
    s_add_u32 s28, s4, 0x4c00000
    s_addc_u32 s29, s5, 0
    s_mov_b32 s30, 0x400000
    s_mov_b32 s31, 0x20000
    s_add_u32 s32, s4, 0x5000000
    s_addc_u32 s33, s5, 0
    s_mov_b32 s34, 0x40000
    s_mov_b32 s35, 0x20000
    s_lshl_b32 s48, s38, 2
    s_add_u32 s48, s48, 139264
    v_mov_b32 v161, 0x80000000
    v_mov_b32 v13, s48
    v_cmp_eq_u32 vcc, 0, v1
    s_nop 1
    v_cndmask_b32 v161, v161, v13, vcc
    s_mul_i32 s51, s37, 32
    v_bfe_u32 v132, v1, 4, 1
    s_mov_b32 s46, 32768
    v_mul_lo_u32 v132, v132, s46
    v_lshrrev_b32 v133, 5, v1
    v_lshl_add_u32 v132, v133, 8, v132
    v_lshl_add_u32 v2, v14, 4, v132
    v_add_u32 v3, 0x10000, v2
    v_lshlrev_b32 v134, 4, v1
    s_and_b32 s46, s36, 1
    s_mul_i32 s46, s46, 8
    s_lshr_b32 s47, s36, 1
    s_mul_i32 s48, s47, 32
    s_add_u32 s48, s48, s46
    s_lshl_b32 s53, s48, 10
    s_mul_i32 s48, s47, 128
    s_add_u32 s48, s48, s46
    s_add_u32 s48, s48, s51
    s_lshl_b32 s48, s48, 10
    v_add_u32 v4, s48, v134
    v_add_u32 v5, 0x1000, v4
    s_add_u32 s8, s4, 0x3c00000
    s_addc_u32 s9, s5, 0
    s_mov_b32 s10, 0x1000000
    s_mov_b32 s11, 0x20000
    s_lshl_b32 s46, s37, 23
    s_add_u32 s48, s4, s46
    s_addc_u32 s49, s5, 0
    s_add_u32 s12, s48, 0x7000000
    s_addc_u32 s13, s49, 0
    s_mov_b32 s14, 0x800000
    s_mov_b32 s15, 0x20000
    s_lshl_b32 s46, s38, 3
    s_lshl_b32 s47, s36, 1
    s_add_u32 s46, s46, s47
    s_lshl_b32 s46, s46, 10
    v_bfe_u32 v132, v1, 4, 1
    v_lshlrev_b32 v132, 16, v132
    v_lshrrev_b32 v133, 5, v1
    v_lshl_add_u32 v132, v133, 8, v132
    v_lshl_add_u32 v132, v14, 4, v132
    v_add_u32 v6, s46, v132
    s_lshl_b32 s46, s37, 7
    s_add_u32 s46, s46, 65536
    v_min_u32 v132, 1, v1
    v_lshlrev_b32 v132, 2, v132
    v_add_u32 v7, s46, v132
    s_lshl_b32 s48, s38, 2
    s_lshl_b32 s47, s37, 5
    s_add_u32 s48, s48, s47
    s_add_u32 s48, s48, 131072
    v_mov_b32 v12, 0x80000000
    v_mov_b32 v13, s48
    v_cmp_eq_u32 vcc, 0, v1
    s_nop 1
    v_cndmask_b32 v12, v12, v13, vcc
    s_mov_b32 s39, 0
    s_mov_b32 s40, 0
    s_mov_b32 s41, 0
    s_mov_b32 s96, 0
    s_mov_b32 s98, 0
    s_mov_b32 s43, 262144
    s_mov_b32 s42, s37
    s_mov_b32 s101, 0xffff0000
    v_mov_b32 v8, 0
    v_mov_b32 v10, 0
    v_mov_b32 v162, 131072
    s_cmp_eq_u32 s36, 0
    s_cselect_b32 s46, 0, 32
    v_add_u32 v163, s46, v162
    v_and_b32 v13, 15, v1
    v_min_u32 v13, 1, v13
    v_lshlrev_b32 v13, 2, v13
    v_bfe_u32 v14, v1, 4, 1
    v_lshl_add_u32 v13, v14, 9, v13
    v_readfirstlane_b32 s46, v7
    s_nop 1
    v_add_u32 v236, s46, v13
    s_cmp_eq_u32 s36, 0
    s_cselect_b32 s46, 0, 0x80000000
    v_or_b32 v7, s46, v7
    s_cmp_eq_u32 s36, 0
    s_cselect_b32 s46, 0, 0x80000000
    v_or_b32 v236, s46, v236
    s_cmp_eq_u32 s36, 0
    s_cselect_b32 s46, 0, 0x80000000
    v_or_b32 v12, s46, v12
    s_cmp_eq_u32 s36, 0
    s_cselect_b32 s46, 0, 0x80000000
    v_or_b32 v9, s46, v9
    s_cmp_eq_u32 s36, 0
    s_cselect_b32 s46, 0, 0x80000000
    v_or_b32 v161, s46, v161
    s_branch op_blk0
op_end0:
    s_mov_b32 s14, 0x800000
    s_add_i32 s46, s39, 0
    s_lshl_b32 s2, s46, 17
    s_nop 5
    buffer_store_dwordx4 v[16:19], v6, s[12:15], s2 offen offset:0 sc1
    buffer_store_dwordx4 v[20:23], v6, s[12:15], s2 offen offset:512 sc1
    buffer_store_dwordx4 v[24:27], v6, s[12:15], s2 offen offset:1024 sc1
    buffer_store_dwordx4 v[28:31], v6, s[12:15], s2 offen offset:1536 sc1
    s_add_u32 s39, s39, 1
    s_cmp_ge_u32 s39, 64
    s_cbranch_scc1 op_last
    s_branch op_blk1
op_blk0:
    s_cmp_ge_u32 s42, s39
    s_cbranch_scc1 pr_181
    s_lshl_b32 s6, s42, 7
    buffer_load_dword v10, v9, s[16:19], s6 offen sc1
pr_181:
    s_add_u32 s6, s39, 0
    s_lshl_b32 s6, s6, 9
    buffer_load_dword v8, v236, s[16:19], s6 offen sc1
    s_waitcnt vmcnt(0)
    v_xor_b32 v162, 4, v162
    v_xor_b32 v163, 4, v163
    s_add_u32 s7, s39, 0
    s_cmp_lt_u32 s7, 64
    s_cselect_b32 s6, 1, 0
    v_cmp_eq_u32 vcc, 0, v8
    s_nop 3
    s_and_b32 s82, vcc_lo, 0xffff
    s_cselect_b32 s6, 0, s6
    s_lshr_b32 s82, vcc_lo, 16
    s_cselect_b32 s82, 0, 4
    s_add_u32 s7, s7, 1
    s_cmp_lt_u32 s7, 64
    s_cselect_b32 s82, s82, 0
    s_or_b32 s6, s6, s82
    v_cmp_eq_u32 vcc, 0, v10
    s_nop 3
    s_cmp_eq_u64 vcc, 0
    s_cselect_b32 s7, 2, 0
    s_cmp_lt_u32 s42, 64
    s_cselect_b32 s7, s7, 0
    s_or_b32 s6, s6, s7
    v_mov_b32 v13, s6
    s_mov_b64 exec, 1
    ds_write_b32 v163, v13
    s_mov_b64 exec, -1
    s_waitcnt lgkmcnt(0)
    s_barrier
    ds_read_b32 v14, v162
    s_cmp_le_u32 s39, s41
    s_cbranch_scc1 sm_182
    s_mov_b32 s41, s39
    s_sub_u32 s82, s39, 1
    s_lshl_b32 s82, s82, 7
    v_mov_b32 v11, 1
    buffer_store_dword v11, v12, s[16:19], s82 offen sc1
sm_182:
    s_cmp_eq_u32 s98, 0
    s_cbranch_scc1 sr_183
    s_sub_u32 s82, s98, 1
    s_lshl_b32 s82, s82, 7
    v_mov_b32 v11, 1
    buffer_store_dword v11, v161, s[16:19], s82 offen sc1
    s_mov_b32 s98, 0
sr_183:
    s_waitcnt lgkmcnt(0)
    v_readfirstlane_b32 s52, v14
    s_nop 3
    s_bitcmp1_b32 s52, 1
    s_cbranch_scc0 nored_184
    s_mov_b32 s45, 0
    s_branch op_red
nored_184:
    s_bitcmp1_b32 s52, 0
    s_cbranch_scc1 op_iss0
    s_sub_u32 s43, s43, 1
    s_cbranch_scc1 op_blk0_err
    s_cmp_lg_u32 s36, 0
    s_cbranch_scc1 w0_185
    s_sleep 2
w0_185:
    s_branch op_blk0
op_blk0_err:
    s_mov_b32 s44, 20
    s_branch ssp_err
op_iss0:
    s_cmp_eq_u32 0, 0
    s_cselect_b32 s10, 0x1000000, 0
    s_add_u32 s48, s39, 0
    s_mul_i32 s84, s48, 262144
    s_add_u32 s85, s84, 16384
    s_add_u32 m0, s53, 0
    s_nop 0
    buffer_load_dwordx4 v4, s[8:11], s84 offen offset:0 sc1 lds
    buffer_load_dwordx4 v4, s[8:11], s84 offen offset:1024 sc1 lds
    buffer_load_dwordx4 v4, s[8:11], s84 offen offset:2048 sc1 lds
    buffer_load_dwordx4 v4, s[8:11], s84 offen offset:3072 sc1 lds
    s_add_u32 m0, s53, 4096
    s_nop 0
    buffer_load_dwordx4 v5, s[8:11], s84 offen offset:0 sc1 lds
    buffer_load_dwordx4 v5, s[8:11], s84 offen offset:1024 sc1 lds
    buffer_load_dwordx4 v5, s[8:11], s84 offen offset:2048 sc1 lds
    buffer_load_dwordx4 v5, s[8:11], s84 offen offset:3072 sc1 lds
    s_add_u32 m0, s53, 16384
    s_nop 0
    buffer_load_dwordx4 v4, s[8:11], s85 offen offset:0 sc1 lds
    buffer_load_dwordx4 v4, s[8:11], s85 offen offset:1024 sc1 lds
    buffer_load_dwordx4 v4, s[8:11], s85 offen offset:2048 sc1 lds
    buffer_load_dwordx4 v4, s[8:11], s85 offen offset:3072 sc1 lds
    s_add_u32 m0, s53, 20480
    s_nop 0
    buffer_load_dwordx4 v5, s[8:11], s85 offen offset:0 sc1 lds
    buffer_load_dwordx4 v5, s[8:11], s85 offen offset:1024 sc1 lds
    buffer_load_dwordx4 v5, s[8:11], s85 offen offset:2048 sc1 lds
    buffer_load_dwordx4 v5, s[8:11], s85 offen offset:3072 sc1 lds
    s_mov_b32 s14, 0
    s_lshr_b32 s40, s52, 2
    s_waitcnt vmcnt(8)
    s_barrier
    ds_read_b128 v[48:51], v2 offset:0
    ds_read_b128 v[52:55], v2 offset:512
    ds_read_b128 v[56:59], v2 offset:1024
    ds_read_b128 v[60:63], v2 offset:1536
    ds_read_b128 v[64:67], v2 offset:2048
    ds_read_b128 v[68:71], v2 offset:2560
    s_cmp_lg_u32 s40, 0
    s_cselect_b32 s10, 0x1000000, 0
    s_branch op_LP0
op_end1:
    s_mov_b32 s14, 0x800000
    s_add_i32 s46, s39, 0
    s_lshl_b32 s2, s46, 17
    s_nop 5
    buffer_store_dwordx4 v[32:35], v6, s[12:15], s2 offen offset:0 sc1
    buffer_store_dwordx4 v[36:39], v6, s[12:15], s2 offen offset:512 sc1
    buffer_store_dwordx4 v[40:43], v6, s[12:15], s2 offen offset:1024 sc1
    buffer_store_dwordx4 v[44:47], v6, s[12:15], s2 offen offset:1536 sc1
    s_add_u32 s39, s39, 1
    s_cmp_ge_u32 s39, 64
    s_cbranch_scc1 op_last
    s_branch op_blk0
op_blk1:
    s_cmp_ge_u32 s42, s39
    s_cbranch_scc1 pr_186
    s_lshl_b32 s6, s42, 7
    buffer_load_dword v10, v9, s[16:19], s6 offen sc1
pr_186:
    s_add_u32 s6, s39, 0
    s_lshl_b32 s6, s6, 9
    buffer_load_dword v8, v236, s[16:19], s6 offen sc1
    s_waitcnt vmcnt(0)
    v_xor_b32 v162, 4, v162
    v_xor_b32 v163, 4, v163
    s_add_u32 s7, s39, 0
    s_cmp_lt_u32 s7, 64
    s_cselect_b32 s6, 1, 0
    v_cmp_eq_u32 vcc, 0, v8
    s_nop 3
    s_and_b32 s82, vcc_lo, 0xffff
    s_cselect_b32 s6, 0, s6
    s_lshr_b32 s82, vcc_lo, 16
    s_cselect_b32 s82, 0, 4
    s_add_u32 s7, s7, 1
    s_cmp_lt_u32 s7, 64
    s_cselect_b32 s82, s82, 0
    s_or_b32 s6, s6, s82
    v_cmp_eq_u32 vcc, 0, v10
    s_nop 3
    s_cmp_eq_u64 vcc, 0
    s_cselect_b32 s7, 2, 0
    s_cmp_lt_u32 s42, 64
    s_cselect_b32 s7, s7, 0
    s_or_b32 s6, s6, s7
    v_mov_b32 v13, s6
    s_mov_b64 exec, 1
    ds_write_b32 v163, v13
    s_mov_b64 exec, -1
    s_waitcnt lgkmcnt(0)
    s_barrier
    ds_read_b32 v14, v162
    s_cmp_le_u32 s39, s41
    s_cbranch_scc1 sm_187
    s_mov_b32 s41, s39
    s_sub_u32 s82, s39, 1
    s_lshl_b32 s82, s82, 7
    v_mov_b32 v11, 1
    buffer_store_dword v11, v12, s[16:19], s82 offen sc1
sm_187:
    s_cmp_eq_u32 s98, 0
    s_cbranch_scc1 sr_188
    s_sub_u32 s82, s98, 1
    s_lshl_b32 s82, s82, 7
    v_mov_b32 v11, 1
    buffer_store_dword v11, v161, s[16:19], s82 offen sc1
    s_mov_b32 s98, 0
sr_188:
    s_waitcnt lgkmcnt(0)
    v_readfirstlane_b32 s52, v14
    s_nop 3
    s_bitcmp1_b32 s52, 1
    s_cbranch_scc0 nored_189
    s_mov_b32 s45, 1
    s_branch op_red
nored_189:
    s_bitcmp1_b32 s52, 0
    s_cbranch_scc1 op_iss1
    s_sub_u32 s43, s43, 1
    s_cbranch_scc1 op_blk1_err
    s_cmp_lg_u32 s36, 0
    s_cbranch_scc1 w0_190
    s_sleep 2
w0_190:
    s_branch op_blk1
op_blk1_err:
    s_mov_b32 s44, 20
    s_branch ssp_err
op_iss1:
    s_cmp_eq_u32 0, 0
    s_cselect_b32 s10, 0x1000000, 0
    s_add_u32 s48, s39, 0
    s_mul_i32 s84, s48, 262144
    s_add_u32 s85, s84, 16384
    s_add_u32 m0, s53, 65536
    s_nop 0
    buffer_load_dwordx4 v4, s[8:11], s84 offen offset:0 sc1 lds
    buffer_load_dwordx4 v4, s[8:11], s84 offen offset:1024 sc1 lds
    buffer_load_dwordx4 v4, s[8:11], s84 offen offset:2048 sc1 lds
    buffer_load_dwordx4 v4, s[8:11], s84 offen offset:3072 sc1 lds
    s_add_u32 m0, s53, 69632
    s_nop 0
    buffer_load_dwordx4 v5, s[8:11], s84 offen offset:0 sc1 lds
    buffer_load_dwordx4 v5, s[8:11], s84 offen offset:1024 sc1 lds
    buffer_load_dwordx4 v5, s[8:11], s84 offen offset:2048 sc1 lds
    buffer_load_dwordx4 v5, s[8:11], s84 offen offset:3072 sc1 lds
    s_add_u32 m0, s53, 81920
    s_nop 0
    buffer_load_dwordx4 v4, s[8:11], s85 offen offset:0 sc1 lds
    buffer_load_dwordx4 v4, s[8:11], s85 offen offset:1024 sc1 lds
    buffer_load_dwordx4 v4, s[8:11], s85 offen offset:2048 sc1 lds
    buffer_load_dwordx4 v4, s[8:11], s85 offen offset:3072 sc1 lds
    s_add_u32 m0, s53, 86016
    s_nop 0
    buffer_load_dwordx4 v5, s[8:11], s85 offen offset:0 sc1 lds
    buffer_load_dwordx4 v5, s[8:11], s85 offen offset:1024 sc1 lds
    buffer_load_dwordx4 v5, s[8:11], s85 offen offset:2048 sc1 lds
    buffer_load_dwordx4 v5, s[8:11], s85 offen offset:3072 sc1 lds
    s_mov_b32 s14, 0
    s_lshr_b32 s40, s52, 2
    s_waitcnt vmcnt(8)
    s_barrier
    ds_read_b128 v[48:51], v3 offset:0
    ds_read_b128 v[52:55], v3 offset:512
    ds_read_b128 v[56:59], v3 offset:1024
    ds_read_b128 v[60:63], v3 offset:1536
    ds_read_b128 v[64:67], v3 offset:2048
    ds_read_b128 v[68:71], v3 offset:2560
    s_cmp_lg_u32 s40, 0
    s_cselect_b32 s10, 0x1000000, 0
    s_branch op_LP1
op_last:
    s_waitcnt vmcnt(0)
    s_barrier
    s_cmp_le_u32 s39, s41
    s_cbranch_scc1 sm_191
    s_mov_b32 s41, s39
    s_sub_u32 s82, s39, 1
    s_lshl_b32 s82, s82, 7
    v_mov_b32 v11, 1
    buffer_store_dword v11, v12, s[16:19], s82 offen sc1
sm_191:
    s_cmp_eq_u32 s98, 0
    s_cbranch_scc1 sr_192
    s_sub_u32 s82, s98, 1
    s_lshl_b32 s82, s82, 7
    v_mov_b32 v11, 1
    buffer_store_dword v11, v161, s[16:19], s82 offen sc1
    s_mov_b32 s98, 0
sr_192:
    s_branch op_fin
op_LP0:
    s_waitcnt lgkmcnt(4)
    v_mfma_f32_32x32x16_bf16 v[16:31], a[0:3], v[48:51], 0
    ds_read_b128 v[72:75], v2 offset:3072
    s_add_u32 s48, s39, 1
    s_mul_i32 s84, s48, 262144
    s_add_u32 s85, s84, 16384
    v_mfma_f32_32x32x16_bf16 v[16:31], a[4:7], v[52:55], v[16:31]
    ds_read_b128 v[76:79], v2 offset:3584
    s_add_i32 s46, s39, -1
    s_lshl_b32 s2, s46, 17
    buffer_store_dwordx4 v[32:35], v6, s[12:15], s2 offen offset:0 sc1
    s_waitcnt lgkmcnt(4)
    v_mfma_f32_32x32x16_bf16 v[16:31], a[8:11], v[56:59], v[16:31]
    ds_read_b128 v[48:51], v2 offset:4096
    s_add_u32 m0, s53, 65536
    s_nop 0
    buffer_load_dwordx4 v4, s[8:11], s84 offen offset:0 sc1 lds
    v_mfma_f32_32x32x16_bf16 v[16:31], a[12:15], v[60:63], v[16:31]
    ds_read_b128 v[52:55], v2 offset:4608
    buffer_store_dwordx4 v[36:39], v6, s[12:15], s2 offen offset:512 sc1
    s_waitcnt lgkmcnt(4)
    v_mfma_f32_32x32x16_bf16 v[16:31], a[16:19], v[64:67], v[16:31]
    ds_read_b128 v[56:59], v2 offset:5120
    v_mfma_f32_32x32x16_bf16 v[16:31], a[20:23], v[68:71], v[16:31]
    ds_read_b128 v[60:63], v2 offset:5632
    buffer_store_dwordx4 v[40:43], v6, s[12:15], s2 offen offset:1024 sc1
    buffer_load_dwordx4 v4, s[8:11], s84 offen offset:1024 sc1 lds
    s_waitcnt lgkmcnt(4)
    v_mfma_f32_32x32x16_bf16 v[16:31], a[24:27], v[72:75], v[16:31]
    ds_read_b128 v[64:67], v2 offset:6144
    v_mfma_f32_32x32x16_bf16 v[16:31], a[28:31], v[76:79], v[16:31]
    ds_read_b128 v[68:71], v2 offset:6656
    buffer_store_dwordx4 v[44:47], v6, s[12:15], s2 offen offset:1536 sc1
    s_waitcnt lgkmcnt(4)
    v_mfma_f32_32x32x16_bf16 v[16:31], a[32:35], v[48:51], v[16:31]
    ds_read_b128 v[72:75], v2 offset:7168
    buffer_load_dwordx4 v4, s[8:11], s84 offen offset:2048 sc1 lds
    v_mfma_f32_32x32x16_bf16 v[16:31], a[36:39], v[52:55], v[16:31]
    ds_read_b128 v[76:79], v2 offset:7680
    s_waitcnt lgkmcnt(4)
    v_mfma_f32_32x32x16_bf16 v[16:31], a[40:43], v[56:59], v[16:31]
    ds_read_b128 v[48:51], v2 offset:8192
    v_mfma_f32_32x32x16_bf16 v[16:31], a[44:47], v[60:63], v[16:31]
    ds_read_b128 v[52:55], v2 offset:8704
    buffer_load_dwordx4 v4, s[8:11], s84 offen offset:3072 sc1 lds
    s_waitcnt lgkmcnt(4)
    v_mfma_f32_32x32x16_bf16 v[16:31], a[48:51], v[64:67], v[16:31]
    ds_read_b128 v[56:59], v2 offset:9216
    v_mfma_f32_32x32x16_bf16 v[16:31], a[52:55], v[68:71], v[16:31]
    ds_read_b128 v[60:63], v2 offset:9728
    s_waitcnt lgkmcnt(4)
    v_mfma_f32_32x32x16_bf16 v[16:31], a[56:59], v[72:75], v[16:31]
    ds_read_b128 v[64:67], v2 offset:10240
    s_add_u32 m0, s53, 69632
    s_nop 0
    buffer_load_dwordx4 v5, s[8:11], s84 offen offset:0 sc1 lds
    v_mfma_f32_32x32x16_bf16 v[16:31], a[60:63], v[76:79], v[16:31]
    ds_read_b128 v[68:71], v2 offset:10752
    s_waitcnt lgkmcnt(4)
    v_mfma_f32_32x32x16_bf16 v[16:31], a[64:67], v[48:51], v[16:31]
    ds_read_b128 v[72:75], v2 offset:11264
    v_mfma_f32_32x32x16_bf16 v[16:31], a[68:71], v[52:55], v[16:31]
    ds_read_b128 v[76:79], v2 offset:11776
    s_waitcnt lgkmcnt(4)
    v_mfma_f32_32x32x16_bf16 v[16:31], a[72:75], v[56:59], v[16:31]
    ds_read_b128 v[48:51], v2 offset:12288
    buffer_load_dwordx4 v5, s[8:11], s84 offen offset:1024 sc1 lds
    v_mfma_f32_32x32x16_bf16 v[16:31], a[76:79], v[60:63], v[16:31]
    ds_read_b128 v[52:55], v2 offset:12800
    s_waitcnt lgkmcnt(4)
    v_mfma_f32_32x32x16_bf16 v[16:31], a[80:83], v[64:67], v[16:31]
    ds_read_b128 v[56:59], v2 offset:13312
    v_mfma_f32_32x32x16_bf16 v[16:31], a[84:87], v[68:71], v[16:31]
    ds_read_b128 v[60:63], v2 offset:13824
    buffer_load_dwordx4 v5, s[8:11], s84 offen offset:2048 sc1 lds
    s_waitcnt lgkmcnt(4)
    v_mfma_f32_32x32x16_bf16 v[16:31], a[88:91], v[72:75], v[16:31]
    ds_read_b128 v[64:67], v2 offset:14336
    v_mfma_f32_32x32x16_bf16 v[16:31], a[92:95], v[76:79], v[16:31]
    ds_read_b128 v[68:71], v2 offset:14848
    s_waitcnt lgkmcnt(4)
    v_mfma_f32_32x32x16_bf16 v[16:31], a[96:99], v[48:51], v[16:31]
    ds_read_b128 v[72:75], v2 offset:15360
    buffer_load_dwordx4 v5, s[8:11], s84 offen offset:3072 sc1 lds
    v_mfma_f32_32x32x16_bf16 v[16:31], a[100:103], v[52:55], v[16:31]
    ds_read_b128 v[76:79], v2 offset:15872
    s_waitcnt vmcnt(12)
    s_barrier
    s_waitcnt lgkmcnt(4)
    v_mfma_f32_32x32x16_bf16 v[16:31], a[104:107], v[56:59], v[16:31]
    ds_read_b128 v[48:51], v2 offset:16384
    v_mfma_f32_32x32x16_bf16 v[16:31], a[108:111], v[60:63], v[16:31]
    ds_read_b128 v[52:55], v2 offset:16896
    s_waitcnt lgkmcnt(4)
    v_mfma_f32_32x32x16_bf16 v[16:31], a[112:115], v[64:67], v[16:31]
    ds_read_b128 v[56:59], v2 offset:17408
    v_mfma_f32_32x32x16_bf16 v[16:31], a[116:119], v[68:71], v[16:31]
    ds_read_b128 v[60:63], v2 offset:17920
    s_waitcnt lgkmcnt(4)
    v_mfma_f32_32x32x16_bf16 v[16:31], a[120:123], v[72:75], v[16:31]
    ds_read_b128 v[64:67], v2 offset:18432
    v_mfma_f32_32x32x16_bf16 v[16:31], a[124:127], v[76:79], v[16:31]
    ds_read_b128 v[68:71], v2 offset:18944
    s_waitcnt lgkmcnt(4)
    v_mfma_f32_32x32x16_bf16 v[16:31], a[128:131], v[48:51], v[16:31]
    ds_read_b128 v[72:75], v2 offset:19456
    s_add_u32 m0, s53, 81920
    s_nop 0
    buffer_load_dwordx4 v4, s[8:11], s85 offen offset:0 sc1 lds
    v_mfma_f32_32x32x16_bf16 v[16:31], a[132:135], v[52:55], v[16:31]
    ds_read_b128 v[76:79], v2 offset:19968
    s_waitcnt lgkmcnt(4)
    v_mfma_f32_32x32x16_bf16 v[16:31], a[136:139], v[56:59], v[16:31]
    ds_read_b128 v[48:51], v2 offset:20480
    v_mfma_f32_32x32x16_bf16 v[16:31], a[140:143], v[60:63], v[16:31]
    ds_read_b128 v[52:55], v2 offset:20992
    buffer_load_dwordx4 v4, s[8:11], s85 offen offset:1024 sc1 lds
    s_waitcnt lgkmcnt(4)
    v_mfma_f32_32x32x16_bf16 v[16:31], a[144:147], v[64:67], v[16:31]
    ds_read_b128 v[56:59], v2 offset:21504
    s_cmp_ge_u32 s42, s39
    s_cbranch_scc1 pr_193
    s_lshl_b32 s6, s42, 7
    buffer_load_dword v10, v9, s[16:19], s6 offen sc1
pr_193:
    s_add_u32 s6, s39, 2
    s_lshl_b32 s6, s6, 9
    buffer_load_dword v8, v7, s[16:19], s6 offen sc1
    v_mfma_f32_32x32x16_bf16 v[16:31], a[148:151], v[68:71], v[16:31]
    ds_read_b128 v[60:63], v2 offset:22016
    s_waitcnt lgkmcnt(4)
    v_mfma_f32_32x32x16_bf16 v[16:31], a[152:155], v[72:75], v[16:31]
    ds_read_b128 v[64:67], v2 offset:22528
    v_mfma_f32_32x32x16_bf16 v[16:31], a[156:159], v[76:79], v[16:31]
    ds_read_b128 v[68:71], v2 offset:23040
    buffer_load_dwordx4 v4, s[8:11], s85 offen offset:2048 sc1 lds
    s_waitcnt lgkmcnt(4)
    v_mfma_f32_32x32x16_bf16 v[16:31], a[160:163], v[48:51], v[16:31]
    ds_read_b128 v[72:75], v2 offset:23552
    v_mfma_f32_32x32x16_bf16 v[16:31], a[164:167], v[52:55], v[16:31]
    ds_read_b128 v[76:79], v2 offset:24064
    s_waitcnt lgkmcnt(4)
    v_mfma_f32_32x32x16_bf16 v[16:31], a[168:171], v[56:59], v[16:31]
    ds_read_b128 v[48:51], v2 offset:24576
    v_mfma_f32_32x32x16_bf16 v[16:31], a[172:175], v[60:63], v[16:31]
    ds_read_b128 v[52:55], v2 offset:25088
    buffer_load_dwordx4 v4, s[8:11], s85 offen offset:3072 sc1 lds
    s_waitcnt lgkmcnt(4)
    v_mfma_f32_32x32x16_bf16 v[16:31], a[176:179], v[64:67], v[16:31]
    ds_read_b128 v[56:59], v2 offset:25600
    v_mfma_f32_32x32x16_bf16 v[16:31], a[180:183], v[68:71], v[16:31]
    ds_read_b128 v[60:63], v2 offset:26112
    s_waitcnt lgkmcnt(4)
    v_mfma_f32_32x32x16_bf16 v[16:31], a[184:187], v[72:75], v[16:31]
    ds_read_b128 v[64:67], v2 offset:26624
    v_mfma_f32_32x32x16_bf16 v[16:31], a[188:191], v[76:79], v[16:31]
    ds_read_b128 v[68:71], v2 offset:27136
    s_add_u32 m0, s53, 86016
    s_nop 0
    buffer_load_dwordx4 v5, s[8:11], s85 offen offset:0 sc1 lds
    s_waitcnt lgkmcnt(4)
    v_mfma_f32_32x32x16_bf16 v[16:31], a[192:195], v[48:51], v[16:31]
    ds_read_b128 v[72:75], v2 offset:27648
    v_mfma_f32_32x32x16_bf16 v[16:31], a[196:199], v[52:55], v[16:31]
    ds_read_b128 v[76:79], v2 offset:28160
    s_waitcnt vmcnt(3)
    v_xor_b32 v162, 4, v162
    v_xor_b32 v163, 4, v163
    s_waitcnt lgkmcnt(4)
    v_mfma_f32_32x32x16_bf16 v[16:31], a[200:203], v[56:59], v[16:31]
    ds_read_b128 v[48:51], v2 offset:28672
    s_add_u32 s7, s39, 2
    s_cmp_lt_u32 s7, 64
    s_cselect_b32 s6, 1, 0
    v_cmp_eq_u32 vcc, 0, v8
    v_mfma_f32_32x32x16_bf16 v[16:31], a[204:207], v[60:63], v[16:31]
    ds_read_b128 v[52:55], v2 offset:29184
    buffer_load_dwordx4 v5, s[8:11], s85 offen offset:1024 sc1 lds
    s_nop 0
    s_cmp_eq_u64 vcc, 0
    s_cselect_b32 s6, s6, 0
    v_cmp_eq_u32 vcc, 0, v10
    s_waitcnt lgkmcnt(4)
    v_mfma_f32_32x32x16_bf16 v[16:31], a[208:211], v[64:67], v[16:31]
    ds_read_b128 v[56:59], v2 offset:29696
    s_nop 0
    s_cmp_eq_u64 vcc, 0
    s_cselect_b32 s7, 2, 0
    s_cmp_lt_u32 s42, 64
    s_cselect_b32 s7, s7, 0
    s_or_b32 s6, s6, s7
    v_mfma_f32_32x32x16_bf16 v[16:31], a[212:215], v[68:71], v[16:31]
    ds_read_b128 v[60:63], v2 offset:30208
    v_mov_b32 v13, s6
    s_waitcnt lgkmcnt(4)
    v_mfma_f32_32x32x16_bf16 v[16:31], a[216:219], v[72:75], v[16:31]
    ds_read_b128 v[64:67], v2 offset:30720
    s_mov_b64 exec, 1
    ds_write_b32 v163, v13
    s_mov_b64 exec, -1
    v_mfma_f32_32x32x16_bf16 v[16:31], a[220:223], v[76:79], v[16:31]
    ds_read_b128 v[68:71], v2 offset:31232
    buffer_load_dwordx4 v5, s[8:11], s85 offen offset:2048 sc1 lds
    s_waitcnt lgkmcnt(5)
    v_mfma_f32_32x32x16_bf16 v[16:31], a[224:227], v[48:51], v[16:31]
    ds_read_b128 v[72:75], v2 offset:31744
    v_mfma_f32_32x32x16_bf16 v[16:31], a[228:231], v[52:55], v[16:31]
    ds_read_b128 v[76:79], v2 offset:32256
    s_waitcnt vmcnt(8)
    s_waitcnt lgkmcnt(3)
    s_barrier
    ds_read_b32 v14, v162
    s_cmp_le_u32 s39, s41
    s_cbranch_scc1 sm_194
    s_mov_b32 s41, s39
    s_sub_u32 s82, s39, 1
    s_lshl_b32 s82, s82, 7
    v_mov_b32 v11, 1
    buffer_store_dword v11, v12, s[16:19], s82 offen sc1
sm_194:
    s_cmp_eq_u32 s98, 0
    s_cbranch_scc1 sr_195
    s_sub_u32 s82, s98, 1
    s_lshl_b32 s82, s82, 7
    v_mov_b32 v11, 1
    buffer_store_dword v11, v161, s[16:19], s82 offen sc1
    s_mov_b32 s98, 0
sr_195:
    s_waitcnt lgkmcnt(6)
    v_mfma_f32_32x32x16_bf16 v[16:31], a[232:235], v[56:59], v[16:31]
    ds_read_b128 v[48:51], v3 offset:0
    v_mfma_f32_32x32x16_bf16 v[16:31], a[236:239], v[60:63], v[16:31]
    ds_read_b128 v[52:55], v3 offset:512
    buffer_load_dwordx4 v5, s[8:11], s85 offen offset:3072 sc1 lds
    s_waitcnt lgkmcnt(5)
    v_mfma_f32_32x32x16_bf16 v[16:31], a[240:243], v[64:67], v[16:31]
    ds_read_b128 v[56:59], v3 offset:1024
    v_mfma_f32_32x32x16_bf16 v[16:31], a[244:247], v[68:71], v[16:31]
    ds_read_b128 v[60:63], v3 offset:1536
    s_waitcnt lgkmcnt(5)
    v_mfma_f32_32x32x16_bf16 v[16:31], a[248:251], v[72:75], v[16:31]
    ds_read_b128 v[64:67], v3 offset:2048
    s_waitcnt lgkmcnt(5)
    v_readfirstlane_b32 s52, v14
    v_mfma_f32_32x32x16_bf16 v[16:31], a[252:255], v[76:79], v[16:31]
    ds_read_b128 v[68:71], v3 offset:2560
    s_cmp_eq_u32 s40, 0
    s_cbranch_scc1 op_end0
    s_add_u32 s39, s39, 1
    s_mov_b32 s14, 0x800000
    s_and_b32 s40, s52, 1
    s_cselect_b32 s10, 0x1000000, 0
    s_cmp_eq_u32 s52, 3
    s_cbranch_scc1 op_LR1
    s_branch op_LP1
op_LR0:
    s_waitcnt lgkmcnt(4)
    v_mfma_f32_32x32x16_bf16 v[16:31], a[0:3], v[48:51], 0
    ds_read_b128 v[72:75], v2 offset:3072
    s_add_u32 s48, s39, 1
    s_mul_i32 s84, s48, 262144
    s_add_u32 s85, s84, 16384
    s_lshl_b32 s100, s42, 1
    s_lshr_b32 s47, s38, 2
    s_add_u32 s100, s100, s47
    v_mfma_f32_32x32x16_bf16 v[16:31], a[4:7], v[52:55], v[16:31]
    ds_read_b128 v[76:79], v2 offset:3584
    s_lshl_b32 s86, s100, 16
    s_lshl_b32 s55, s100, 15
    s_add_u32 s87, s86, 0x800000
    s_add_u32 s88, s87, 0x800000
    s_add_u32 s89, s88, 0x800000
    s_add_i32 s46, s39, -1
    s_lshl_b32 s2, s46, 17
    buffer_store_dwordx4 v[32:35], v6, s[12:15], s2 offen offset:0 sc1
    s_waitcnt lgkmcnt(4)
    v_mfma_f32_32x32x16_bf16 v[16:31], a[8:11], v[56:59], v[16:31]
    ds_read_b128 v[48:51], v2 offset:4096
    s_add_u32 m0, s53, 65536
    s_nop 0
    buffer_load_dwordx4 v4, s[8:11], s84 offen offset:0 sc1 lds
    v_mfma_f32_32x32x16_bf16 v[16:31], a[12:15], v[60:63], v[16:31]
    ds_read_b128 v[52:55], v2 offset:4608
    buffer_store_dwordx4 v[36:39], v6, s[12:15], s2 offen offset:512 sc1
    s_waitcnt lgkmcnt(4)
    v_mfma_f32_32x32x16_bf16 v[16:31], a[16:19], v[64:67], v[16:31]
    ds_read_b128 v[56:59], v2 offset:5120
    buffer_load_dwordx4 v[172:175], v157, s[20:23], s86 offen offset:0 sc1
    v_mfma_f32_32x32x16_bf16 v[16:31], a[20:23], v[68:71], v[16:31]
    ds_read_b128 v[60:63], v2 offset:5632
    buffer_store_dwordx4 v[40:43], v6, s[12:15], s2 offen offset:1024 sc1
    buffer_load_dwordx4 v4, s[8:11], s84 offen offset:1024 sc1 lds
    s_waitcnt lgkmcnt(4)
    v_mfma_f32_32x32x16_bf16 v[16:31], a[24:27], v[72:75], v[16:31]
    ds_read_b128 v[64:67], v2 offset:6144
    buffer_load_dwordx4 v[176:179], v157, s[20:23], s86 offen offset:1024 sc1
    v_mfma_f32_32x32x16_bf16 v[16:31], a[28:31], v[76:79], v[16:31]
    ds_read_b128 v[68:71], v2 offset:6656
    buffer_store_dwordx4 v[44:47], v6, s[12:15], s2 offen offset:1536 sc1
    s_waitcnt lgkmcnt(4)
    v_mfma_f32_32x32x16_bf16 v[16:31], a[32:35], v[48:51], v[16:31]
    ds_read_b128 v[72:75], v2 offset:7168
    buffer_load_dwordx4 v4, s[8:11], s84 offen offset:2048 sc1 lds
    v_mfma_f32_32x32x16_bf16 v[16:31], a[36:39], v[52:55], v[16:31]
    ds_read_b128 v[76:79], v2 offset:7680
    buffer_load_dwordx4 v[180:183], v157, s[20:23], s86 offen offset:2048 sc1
    s_waitcnt lgkmcnt(4)
    v_mfma_f32_32x32x16_bf16 v[16:31], a[40:43], v[56:59], v[16:31]
    ds_read_b128 v[48:51], v2 offset:8192
    v_mfma_f32_32x32x16_bf16 v[16:31], a[44:47], v[60:63], v[16:31]
    ds_read_b128 v[52:55], v2 offset:8704
    buffer_load_dwordx4 v4, s[8:11], s84 offen offset:3072 sc1 lds
    s_waitcnt lgkmcnt(4)
    v_mfma_f32_32x32x16_bf16 v[16:31], a[48:51], v[64:67], v[16:31]
    ds_read_b128 v[56:59], v2 offset:9216
    buffer_load_dwordx4 v[184:187], v157, s[20:23], s86 offen offset:3072 sc1
    v_mfma_f32_32x32x16_bf16 v[16:31], a[52:55], v[68:71], v[16:31]
    ds_read_b128 v[60:63], v2 offset:9728
    s_waitcnt lgkmcnt(4)
    v_mfma_f32_32x32x16_bf16 v[16:31], a[56:59], v[72:75], v[16:31]
    ds_read_b128 v[64:67], v2 offset:10240
    s_add_u32 m0, s53, 69632
    s_nop 0
    buffer_load_dwordx4 v5, s[8:11], s84 offen offset:0 sc1 lds
    v_mfma_f32_32x32x16_bf16 v[16:31], a[60:63], v[76:79], v[16:31]
    ds_read_b128 v[68:71], v2 offset:10752
    buffer_load_dwordx4 v[188:191], v157, s[20:23], s87 offen offset:0 sc1
    s_waitcnt lgkmcnt(4)
    v_mfma_f32_32x32x16_bf16 v[16:31], a[64:67], v[48:51], v[16:31]
    ds_read_b128 v[72:75], v2 offset:11264
    v_mfma_f32_32x32x16_bf16 v[16:31], a[68:71], v[52:55], v[16:31]
    ds_read_b128 v[76:79], v2 offset:11776
    s_waitcnt lgkmcnt(4)
    v_mfma_f32_32x32x16_bf16 v[16:31], a[72:75], v[56:59], v[16:31]
    ds_read_b128 v[48:51], v2 offset:12288
    buffer_load_dwordx4 v5, s[8:11], s84 offen offset:1024 sc1 lds
    buffer_load_dwordx4 v[192:195], v157, s[20:23], s87 offen offset:1024 sc1
    v_mfma_f32_32x32x16_bf16 v[16:31], a[76:79], v[60:63], v[16:31]
    ds_read_b128 v[52:55], v2 offset:12800
    s_waitcnt lgkmcnt(4)
    v_mfma_f32_32x32x16_bf16 v[16:31], a[80:83], v[64:67], v[16:31]
    ds_read_b128 v[56:59], v2 offset:13312
    v_mfma_f32_32x32x16_bf16 v[16:31], a[84:87], v[68:71], v[16:31]
    ds_read_b128 v[60:63], v2 offset:13824
    buffer_load_dwordx4 v5, s[8:11], s84 offen offset:2048 sc1 lds
    buffer_load_dwordx4 v[196:199], v157, s[20:23], s87 offen offset:2048 sc1
    s_waitcnt lgkmcnt(4)
    v_mfma_f32_32x32x16_bf16 v[16:31], a[88:91], v[72:75], v[16:31]
    ds_read_b128 v[64:67], v2 offset:14336
    v_mfma_f32_32x32x16_bf16 v[16:31], a[92:95], v[76:79], v[16:31]
    ds_read_b128 v[68:71], v2 offset:14848
    s_waitcnt lgkmcnt(4)
    v_mfma_f32_32x32x16_bf16 v[16:31], a[96:99], v[48:51], v[16:31]
    ds_read_b128 v[72:75], v2 offset:15360
    buffer_load_dwordx4 v5, s[8:11], s84 offen offset:3072 sc1 lds
    buffer_load_dwordx4 v[200:203], v157, s[20:23], s87 offen offset:3072 sc1
    v_mfma_f32_32x32x16_bf16 v[16:31], a[100:103], v[52:55], v[16:31]
    ds_read_b128 v[76:79], v2 offset:15872
    s_waitcnt vmcnt(20)
    s_barrier
    s_waitcnt lgkmcnt(4)
    v_mfma_f32_32x32x16_bf16 v[16:31], a[104:107], v[56:59], v[16:31]
    ds_read_b128 v[48:51], v2 offset:16384
    v_mfma_f32_32x32x16_bf16 v[16:31], a[108:111], v[60:63], v[16:31]
    ds_read_b128 v[52:55], v2 offset:16896
    buffer_load_dwordx4 v[204:207], v157, s[20:23], s88 offen offset:0 sc1
    s_waitcnt lgkmcnt(4)
    v_mfma_f32_32x32x16_bf16 v[16:31], a[112:115], v[64:67], v[16:31]
    ds_read_b128 v[56:59], v2 offset:17408
    v_mfma_f32_32x32x16_bf16 v[16:31], a[116:119], v[68:71], v[16:31]
    ds_read_b128 v[60:63], v2 offset:17920
    s_waitcnt lgkmcnt(4)
    v_mfma_f32_32x32x16_bf16 v[16:31], a[120:123], v[72:75], v[16:31]
    ds_read_b128 v[64:67], v2 offset:18432
    buffer_load_dwordx4 v[208:211], v157, s[20:23], s88 offen offset:1024 sc1
    v_mfma_f32_32x32x16_bf16 v[16:31], a[124:127], v[76:79], v[16:31]
    ds_read_b128 v[68:71], v2 offset:18944
    s_waitcnt lgkmcnt(4)
    v_mfma_f32_32x32x16_bf16 v[16:31], a[128:131], v[48:51], v[16:31]
    ds_read_b128 v[72:75], v2 offset:19456
    s_add_u32 m0, s53, 81920
    s_nop 0
    buffer_load_dwordx4 v4, s[8:11], s85 offen offset:0 sc1 lds
    v_mfma_f32_32x32x16_bf16 v[16:31], a[132:135], v[52:55], v[16:31]
    ds_read_b128 v[76:79], v2 offset:19968
    buffer_load_dwordx4 v[212:215], v157, s[20:23], s88 offen offset:2048 sc1
    s_waitcnt lgkmcnt(4)
    v_mfma_f32_32x32x16_bf16 v[16:31], a[136:139], v[56:59], v[16:31]
    ds_read_b128 v[48:51], v2 offset:20480
    v_mfma_f32_32x32x16_bf16 v[16:31], a[140:143], v[60:63], v[16:31]
    ds_read_b128 v[52:55], v2 offset:20992
    buffer_load_dwordx4 v4, s[8:11], s85 offen offset:1024 sc1 lds
    s_waitcnt lgkmcnt(4)
    v_mfma_f32_32x32x16_bf16 v[16:31], a[144:147], v[64:67], v[16:31]
    ds_read_b128 v[56:59], v2 offset:21504
    s_cmp_ge_u32 s42, s39
    s_cbranch_scc1 pr_196
    s_lshl_b32 s6, s42, 7
    buffer_load_dword v10, v9, s[16:19], s6 offen sc1
pr_196:
    s_add_u32 s6, s39, 2
    s_lshl_b32 s6, s6, 9
    buffer_load_dword v8, v7, s[16:19], s6 offen sc1
    buffer_load_dwordx4 v[216:219], v157, s[20:23], s88 offen offset:3072 sc1
    v_mfma_f32_32x32x16_bf16 v[16:31], a[148:151], v[68:71], v[16:31]
    ds_read_b128 v[60:63], v2 offset:22016
    s_waitcnt lgkmcnt(4)
    v_mfma_f32_32x32x16_bf16 v[16:31], a[152:155], v[72:75], v[16:31]
    ds_read_b128 v[64:67], v2 offset:22528
    v_mfma_f32_32x32x16_bf16 v[16:31], a[156:159], v[76:79], v[16:31]
    ds_read_b128 v[68:71], v2 offset:23040
    buffer_load_dwordx4 v4, s[8:11], s85 offen offset:2048 sc1 lds
    buffer_load_dwordx4 v[220:223], v157, s[20:23], s89 offen offset:0 sc1
    s_waitcnt lgkmcnt(4)
    v_mfma_f32_32x32x16_bf16 v[16:31], a[160:163], v[48:51], v[16:31]
    ds_read_b128 v[72:75], v2 offset:23552
    v_mfma_f32_32x32x16_bf16 v[16:31], a[164:167], v[52:55], v[16:31]
    ds_read_b128 v[76:79], v2 offset:24064
    s_waitcnt lgkmcnt(4)
    v_mfma_f32_32x32x16_bf16 v[16:31], a[168:171], v[56:59], v[16:31]
    ds_read_b128 v[48:51], v2 offset:24576
    buffer_load_dwordx4 v[224:227], v157, s[20:23], s89 offen offset:1024 sc1
    v_mfma_f32_32x32x16_bf16 v[16:31], a[172:175], v[60:63], v[16:31]
    ds_read_b128 v[52:55], v2 offset:25088
    buffer_load_dwordx4 v4, s[8:11], s85 offen offset:3072 sc1 lds
    s_waitcnt lgkmcnt(4)
    v_mfma_f32_32x32x16_bf16 v[16:31], a[176:179], v[64:67], v[16:31]
    ds_read_b128 v[56:59], v2 offset:25600
    v_mfma_f32_32x32x16_bf16 v[16:31], a[180:183], v[68:71], v[16:31]
    ds_read_b128 v[60:63], v2 offset:26112
    buffer_load_dwordx4 v[228:231], v157, s[20:23], s89 offen offset:2048 sc1
    s_waitcnt lgkmcnt(4)
    v_mfma_f32_32x32x16_bf16 v[16:31], a[184:187], v[72:75], v[16:31]
    ds_read_b128 v[64:67], v2 offset:26624
    v_mfma_f32_32x32x16_bf16 v[16:31], a[188:191], v[76:79], v[16:31]
    ds_read_b128 v[68:71], v2 offset:27136
    s_add_u32 m0, s53, 86016
    s_nop 0
    buffer_load_dwordx4 v5, s[8:11], s85 offen offset:0 sc1 lds
    s_waitcnt lgkmcnt(4)
    v_mfma_f32_32x32x16_bf16 v[16:31], a[192:195], v[48:51], v[16:31]
    ds_read_b128 v[72:75], v2 offset:27648
    buffer_load_dwordx4 v[232:235], v157, s[20:23], s89 offen offset:3072 sc1
    v_mfma_f32_32x32x16_bf16 v[16:31], a[196:199], v[52:55], v[16:31]
    ds_read_b128 v[76:79], v2 offset:28160
    s_waitcnt vmcnt(8)
    v_xor_b32 v162, 4, v162
    v_xor_b32 v163, 4, v163
    s_waitcnt lgkmcnt(4)
    v_mfma_f32_32x32x16_bf16 v[16:31], a[200:203], v[56:59], v[16:31]
    ds_read_b128 v[48:51], v2 offset:28672
    s_add_u32 s7, s39, 2
    s_cmp_lt_u32 s7, 64
    s_cselect_b32 s6, 1, 0
    v_cmp_eq_u32 vcc, 0, v8
    v_mfma_f32_32x32x16_bf16 v[16:31], a[204:207], v[60:63], v[16:31]
    ds_read_b128 v[52:55], v2 offset:29184
    buffer_load_dwordx4 v5, s[8:11], s85 offen offset:1024 sc1 lds
    buffer_load_dwordx2 v[164:165], v158, s[24:27], s55 offen offset:0
    s_cmp_eq_u64 vcc, 0
    s_cselect_b32 s6, s6, 0
    v_cmp_eq_u32 vcc, 0, v10
    s_waitcnt lgkmcnt(4)
    v_mfma_f32_32x32x16_bf16 v[16:31], a[208:211], v[64:67], v[16:31]
    ds_read_b128 v[56:59], v2 offset:29696
    s_nop 0
    s_cmp_eq_u64 vcc, 0
    s_cselect_b32 s7, 2, 0
    s_cmp_lt_u32 s42, 64
    s_cselect_b32 s7, s7, 0
    s_or_b32 s6, s6, s7
    v_mfma_f32_32x32x16_bf16 v[16:31], a[212:215], v[68:71], v[16:31]
    ds_read_b128 v[60:63], v2 offset:30208
    v_mov_b32 v13, s6
    s_waitcnt lgkmcnt(4)
    v_mfma_f32_32x32x16_bf16 v[16:31], a[216:219], v[72:75], v[16:31]
    ds_read_b128 v[64:67], v2 offset:30720
    buffer_load_dwordx2 v[166:167], v158, s[24:27], s55 offen offset:32
    s_mov_b64 exec, 1
    ds_write_b32 v163, v13
    s_mov_b64 exec, -1
    v_mfma_f32_32x32x16_bf16 v[16:31], a[220:223], v[76:79], v[16:31]
    ds_read_b128 v[68:71], v2 offset:31232
    buffer_load_dwordx4 v5, s[8:11], s85 offen offset:2048 sc1 lds
    s_waitcnt lgkmcnt(5)
    v_mfma_f32_32x32x16_bf16 v[16:31], a[224:227], v[48:51], v[16:31]
    ds_read_b128 v[72:75], v2 offset:31744
    v_mfma_f32_32x32x16_bf16 v[16:31], a[228:231], v[52:55], v[16:31]
    ds_read_b128 v[76:79], v2 offset:32256
    buffer_load_dwordx2 v[168:169], v158, s[24:27], s55 offen offset:64
    s_waitcnt vmcnt(19)
    s_waitcnt lgkmcnt(3)
    s_barrier
    ds_read_b32 v14, v162
    s_cmp_le_u32 s39, s41
    s_cbranch_scc1 sm_197
    s_mov_b32 s41, s39
    s_sub_u32 s82, s39, 1
    s_lshl_b32 s82, s82, 7
    v_mov_b32 v11, 1
    buffer_store_dword v11, v12, s[16:19], s82 offen sc1
sm_197:
    s_cmp_eq_u32 s98, 0
    s_cbranch_scc1 sr_198
    s_sub_u32 s82, s98, 1
    s_lshl_b32 s82, s82, 7
    v_mov_b32 v11, 1
    buffer_store_dword v11, v161, s[16:19], s82 offen sc1
    s_mov_b32 s98, 0
sr_198:
    s_waitcnt lgkmcnt(6)
    v_mfma_f32_32x32x16_bf16 v[16:31], a[232:235], v[56:59], v[16:31]
    ds_read_b128 v[48:51], v3 offset:0
    v_mfma_f32_32x32x16_bf16 v[16:31], a[236:239], v[60:63], v[16:31]
    ds_read_b128 v[52:55], v3 offset:512
    buffer_load_dwordx4 v5, s[8:11], s85 offen offset:3072 sc1 lds
    s_waitcnt lgkmcnt(5)
    v_mfma_f32_32x32x16_bf16 v[16:31], a[240:243], v[64:67], v[16:31]
    ds_read_b128 v[56:59], v3 offset:1024
    buffer_load_dwordx2 v[170:171], v158, s[24:27], s55 offen offset:96
    v_mfma_f32_32x32x16_bf16 v[16:31], a[244:247], v[68:71], v[16:31]
    ds_read_b128 v[60:63], v3 offset:1536
    s_waitcnt lgkmcnt(5)
    v_mfma_f32_32x32x16_bf16 v[16:31], a[248:251], v[72:75], v[16:31]
    ds_read_b128 v[64:67], v3 offset:2048
    s_waitcnt lgkmcnt(5)
    v_readfirstlane_b32 s52, v14
    v_mfma_f32_32x32x16_bf16 v[16:31], a[252:255], v[76:79], v[16:31]
    ds_read_b128 v[68:71], v3 offset:2560
    s_add_u32 s39, s39, 1
    s_mov_b32 s14, 0x800000
    s_and_b32 s40, s52, 1
    s_cselect_b32 s10, 0x1000000, 0
    s_branch op_LC1
op_LC0:
    s_waitcnt lgkmcnt(4)
    v_mfma_f32_32x32x16_bf16 v[16:31], a[0:3], v[48:51], 0
    ds_read_b128 v[72:75], v2 offset:3072
    s_add_u32 s3, s42, 1
    s_add_u32 s42, s42, 4
    v_mov_b32 v10, 0
    v_mfma_f32_32x32x16_bf16 v[16:31], a[4:7], v[52:55], v[16:31]
    ds_read_b128 v[76:79], v2 offset:3584
    s_add_u32 s48, s39, 1
    s_mul_i32 s84, s48, 262144
    s_add_u32 s85, s84, 16384
    s_add_i32 s46, s39, -1
    s_lshl_b32 s2, s46, 17
    buffer_store_dwordx4 v[32:35], v6, s[12:15], s2 offen offset:0 sc1
    s_waitcnt lgkmcnt(4)
    v_mfma_f32_32x32x16_bf16 v[16:31], a[8:11], v[56:59], v[16:31]
    ds_read_b128 v[48:51], v2 offset:4096
    s_add_u32 m0, s53, 65536
    s_nop 0
    buffer_load_dwordx4 v4, s[8:11], s84 offen offset:0 sc1 lds
    v_mfma_f32_32x32x16_bf16 v[16:31], a[12:15], v[60:63], v[16:31]
    ds_read_b128 v[52:55], v2 offset:4608
    buffer_store_dwordx4 v[36:39], v6, s[12:15], s2 offen offset:512 sc1
    s_waitcnt lgkmcnt(4)
    v_mfma_f32_32x32x16_bf16 v[16:31], a[16:19], v[64:67], v[16:31]
    ds_read_b128 v[56:59], v2 offset:5120
    v_mfma_f32_32x32x16_bf16 v[16:31], a[20:23], v[68:71], v[16:31]
    ds_read_b128 v[60:63], v2 offset:5632
    buffer_store_dwordx4 v[40:43], v6, s[12:15], s2 offen offset:1024 sc1
    buffer_load_dwordx4 v4, s[8:11], s84 offen offset:1024 sc1 lds
    s_waitcnt lgkmcnt(4)
    v_mfma_f32_32x32x16_bf16 v[16:31], a[24:27], v[72:75], v[16:31]
    ds_read_b128 v[64:67], v2 offset:6144
    v_mfma_f32_32x32x16_bf16 v[16:31], a[28:31], v[76:79], v[16:31]
    ds_read_b128 v[68:71], v2 offset:6656
    buffer_store_dwordx4 v[44:47], v6, s[12:15], s2 offen offset:1536 sc1
    s_waitcnt lgkmcnt(4)
    v_mfma_f32_32x32x16_bf16 v[16:31], a[32:35], v[48:51], v[16:31]
    ds_read_b128 v[72:75], v2 offset:7168
    buffer_load_dwordx4 v4, s[8:11], s84 offen offset:2048 sc1 lds
    v_mfma_f32_32x32x16_bf16 v[16:31], a[36:39], v[52:55], v[16:31]
    ds_read_b128 v[76:79], v2 offset:7680
    s_waitcnt lgkmcnt(4)
    v_mfma_f32_32x32x16_bf16 v[16:31], a[40:43], v[56:59], v[16:31]
    ds_read_b128 v[48:51], v2 offset:8192
    v_mfma_f32_32x32x16_bf16 v[16:31], a[44:47], v[60:63], v[16:31]
    ds_read_b128 v[52:55], v2 offset:8704
    buffer_load_dwordx4 v4, s[8:11], s84 offen offset:3072 sc1 lds
    s_waitcnt lgkmcnt(4)
    v_mfma_f32_32x32x16_bf16 v[16:31], a[48:51], v[64:67], v[16:31]
    ds_read_b128 v[56:59], v2 offset:9216
    v_mfma_f32_32x32x16_bf16 v[16:31], a[52:55], v[68:71], v[16:31]
    ds_read_b128 v[60:63], v2 offset:9728
    s_waitcnt lgkmcnt(4)
    v_mfma_f32_32x32x16_bf16 v[16:31], a[56:59], v[72:75], v[16:31]
    ds_read_b128 v[64:67], v2 offset:10240
    s_add_u32 m0, s53, 69632
    s_nop 0
    buffer_load_dwordx4 v5, s[8:11], s84 offen offset:0 sc1 lds
    v_mfma_f32_32x32x16_bf16 v[16:31], a[60:63], v[76:79], v[16:31]
    ds_read_b128 v[68:71], v2 offset:10752
    s_waitcnt lgkmcnt(4)
    v_mfma_f32_32x32x16_bf16 v[16:31], a[64:67], v[48:51], v[16:31]
    ds_read_b128 v[72:75], v2 offset:11264
    v_mfma_f32_32x32x16_bf16 v[16:31], a[68:71], v[52:55], v[16:31]
    ds_read_b128 v[76:79], v2 offset:11776
    s_waitcnt lgkmcnt(4)
    v_mfma_f32_32x32x16_bf16 v[16:31], a[72:75], v[56:59], v[16:31]
    ds_read_b128 v[48:51], v2 offset:12288
    buffer_load_dwordx4 v5, s[8:11], s84 offen offset:1024 sc1 lds
    v_mfma_f32_32x32x16_bf16 v[16:31], a[76:79], v[60:63], v[16:31]
    ds_read_b128 v[52:55], v2 offset:12800
    s_waitcnt lgkmcnt(4)
    v_mfma_f32_32x32x16_bf16 v[16:31], a[80:83], v[64:67], v[16:31]
    ds_read_b128 v[56:59], v2 offset:13312
    v_mfma_f32_32x32x16_bf16 v[16:31], a[84:87], v[68:71], v[16:31]
    ds_read_b128 v[60:63], v2 offset:13824
    buffer_load_dwordx4 v5, s[8:11], s84 offen offset:2048 sc1 lds
    s_waitcnt lgkmcnt(4)
    v_mfma_f32_32x32x16_bf16 v[16:31], a[88:91], v[72:75], v[16:31]
    ds_read_b128 v[64:67], v2 offset:14336
    v_mfma_f32_32x32x16_bf16 v[16:31], a[92:95], v[76:79], v[16:31]
    ds_read_b128 v[68:71], v2 offset:14848
    s_waitcnt lgkmcnt(4)
    v_mfma_f32_32x32x16_bf16 v[16:31], a[96:99], v[48:51], v[16:31]
    ds_read_b128 v[72:75], v2 offset:15360
    buffer_load_dwordx4 v5, s[8:11], s84 offen offset:3072 sc1 lds
    v_mfma_f32_32x32x16_bf16 v[16:31], a[100:103], v[52:55], v[16:31]
    ds_read_b128 v[76:79], v2 offset:15872
    s_waitcnt vmcnt(12)
    s_barrier
    s_waitcnt lgkmcnt(4)
    v_mfma_f32_32x32x16_bf16 v[16:31], a[104:107], v[56:59], v[16:31]
    ds_read_b128 v[48:51], v2 offset:16384
    v_pk_add_f32 v[172:173], v[172:173], v[188:189]
    v_pk_add_f32 v[174:175], v[174:175], v[190:191]
    v_pk_add_f32 v[176:177], v[176:177], v[192:193]
    v_pk_add_f32 v[178:179], v[178:179], v[194:195]
    v_pk_add_f32 v[180:181], v[180:181], v[196:197]
    v_mfma_f32_32x32x16_bf16 v[16:31], a[108:111], v[60:63], v[16:31]
    ds_read_b128 v[52:55], v2 offset:16896
    v_pk_add_f32 v[182:183], v[182:183], v[198:199]
    v_pk_add_f32 v[184:185], v[184:185], v[200:201]
    v_pk_add_f32 v[186:187], v[186:187], v[202:203]
    v_pk_add_f32 v[204:205], v[204:205], v[220:221]
    s_waitcnt lgkmcnt(4)
    v_mfma_f32_32x32x16_bf16 v[16:31], a[112:115], v[64:67], v[16:31]
    ds_read_b128 v[56:59], v2 offset:17408
    v_pk_add_f32 v[206:207], v[206:207], v[222:223]
    v_pk_add_f32 v[208:209], v[208:209], v[224:225]
    v_pk_add_f32 v[210:211], v[210:211], v[226:227]
    v_pk_add_f32 v[212:213], v[212:213], v[228:229]
    v_mfma_f32_32x32x16_bf16 v[16:31], a[116:119], v[68:71], v[16:31]
    ds_read_b128 v[60:63], v2 offset:17920
    v_pk_add_f32 v[214:215], v[214:215], v[230:231]
    v_pk_add_f32 v[216:217], v[216:217], v[232:233]
    v_pk_add_f32 v[218:219], v[218:219], v[234:235]
    v_lshlrev_b32 v188, 16, v164
    v_and_b32 v189, s101, v164
    s_waitcnt lgkmcnt(4)
    v_mfma_f32_32x32x16_bf16 v[16:31], a[120:123], v[72:75], v[16:31]
    ds_read_b128 v[64:67], v2 offset:18432
    v_lshlrev_b32 v190, 16, v165
    v_and_b32 v191, s101, v165
    v_lshlrev_b32 v192, 16, v166
    v_and_b32 v193, s101, v166
    v_mfma_f32_32x32x16_bf16 v[16:31], a[124:127], v[76:79], v[16:31]
    ds_read_b128 v[68:71], v2 offset:18944
    v_lshlrev_b32 v194, 16, v167
    v_and_b32 v195, s101, v167
    v_lshlrev_b32 v196, 16, v168
    v_and_b32 v197, s101, v168
    s_waitcnt lgkmcnt(4)
    v_mfma_f32_32x32x16_bf16 v[16:31], a[128:131], v[48:51], v[16:31]
    ds_read_b128 v[72:75], v2 offset:19456
    s_add_u32 m0, s53, 81920
    s_nop 0
    buffer_load_dwordx4 v4, s[8:11], s85 offen offset:0 sc1 lds
    v_lshlrev_b32 v198, 16, v169
    v_and_b32 v199, s101, v169
    v_lshlrev_b32 v200, 16, v170
    v_and_b32 v201, s101, v170
    v_mfma_f32_32x32x16_bf16 v[16:31], a[132:135], v[52:55], v[16:31]
    ds_read_b128 v[76:79], v2 offset:19968
    v_lshlrev_b32 v202, 16, v171
    v_and_b32 v203, s101, v171
    v_pk_add_f32 v[172:173], v[172:173], v[204:205]
    v_pk_add_f32 v[174:175], v[174:175], v[206:207]
    v_pk_add_f32 v[176:177], v[176:177], v[208:209]
    s_waitcnt lgkmcnt(4)
    v_mfma_f32_32x32x16_bf16 v[16:31], a[136:139], v[56:59], v[16:31]
    ds_read_b128 v[48:51], v2 offset:20480
    v_pk_add_f32 v[178:179], v[178:179], v[210:211]
    v_pk_add_f32 v[180:181], v[180:181], v[212:213]
    v_pk_add_f32 v[182:183], v[182:183], v[214:215]
    v_pk_add_f32 v[184:185], v[184:185], v[216:217]
    v_mfma_f32_32x32x16_bf16 v[16:31], a[140:143], v[60:63], v[16:31]
    ds_read_b128 v[52:55], v2 offset:20992
    buffer_load_dwordx4 v4, s[8:11], s85 offen offset:1024 sc1 lds
    v_pk_add_f32 v[186:187], v[186:187], v[218:219]
    v_pk_add_f32 v[172:173], v[172:173], v[188:189]
    v_pk_add_f32 v[174:175], v[174:175], v[190:191]
    v_pk_add_f32 v[176:177], v[176:177], v[192:193]
    s_waitcnt lgkmcnt(4)
    v_mfma_f32_32x32x16_bf16 v[16:31], a[144:147], v[64:67], v[16:31]
    ds_read_b128 v[56:59], v2 offset:21504
    s_cmp_ge_u32 s42, s39
    s_cbranch_scc1 pr_199
    s_lshl_b32 s6, s42, 7
    buffer_load_dword v10, v9, s[16:19], s6 offen sc1
pr_199:
    s_add_u32 s6, s39, 2
    s_lshl_b32 s6, s6, 9
    buffer_load_dword v8, v7, s[16:19], s6 offen sc1
    v_pk_add_f32 v[178:179], v[178:179], v[194:195]
    v_pk_add_f32 v[180:181], v[180:181], v[196:197]
    v_pk_add_f32 v[182:183], v[182:183], v[198:199]
    v_pk_add_f32 v[184:185], v[184:185], v[200:201]
    v_pk_add_f32 v[186:187], v[186:187], v[202:203]
    v_mfma_f32_32x32x16_bf16 v[16:31], a[148:151], v[68:71], v[16:31]
    ds_read_b128 v[60:63], v2 offset:22016
    v_cvt_pk_bf16_f32 v204, v172, v173
    v_cvt_pk_bf16_f32 v205, v174, v175
    v_cvt_pk_bf16_f32 v206, v176, v177
    v_cvt_pk_bf16_f32 v207, v178, v179
    s_waitcnt lgkmcnt(4)
    v_mfma_f32_32x32x16_bf16 v[16:31], a[152:155], v[72:75], v[16:31]
    ds_read_b128 v[64:67], v2 offset:22528
    v_cvt_pk_bf16_f32 v208, v180, v181
    v_cvt_pk_bf16_f32 v209, v182, v183
    v_cvt_pk_bf16_f32 v210, v184, v185
    v_cvt_pk_bf16_f32 v211, v186, v187
    v_mfma_f32_32x32x16_bf16 v[16:31], a[156:159], v[76:79], v[16:31]
    ds_read_b128 v[68:71], v2 offset:23040
    buffer_load_dwordx4 v4, s[8:11], s85 offen offset:2048 sc1 lds
    buffer_store_dwordx4 v[204:207], v159, s[28:31], s55 offen offset:0 sc1
    buffer_store_dwordx4 v[208:211], v159, s[28:31], s55 offen offset:1024 sc1
    v_lshlrev_b32 v172, 16, v204
    v_and_b32 v173, s101, v204
    s_waitcnt lgkmcnt(4)
    v_mfma_f32_32x32x16_bf16 v[16:31], a[160:163], v[48:51], v[16:31]
    ds_read_b128 v[72:75], v2 offset:23552
    v_lshlrev_b32 v174, 16, v205
    v_and_b32 v175, s101, v205
    v_lshlrev_b32 v176, 16, v206
    v_and_b32 v177, s101, v206
    v_lshlrev_b32 v178, 16, v207
    v_mfma_f32_32x32x16_bf16 v[16:31], a[164:167], v[52:55], v[16:31]
    ds_read_b128 v[76:79], v2 offset:24064
    v_and_b32 v179, s101, v207
    v_lshlrev_b32 v180, 16, v208
    v_and_b32 v181, s101, v208
    v_lshlrev_b32 v182, 16, v209
    s_waitcnt lgkmcnt(4)
    v_mfma_f32_32x32x16_bf16 v[16:31], a[168:171], v[56:59], v[16:31]
    ds_read_b128 v[48:51], v2 offset:24576
    v_and_b32 v183, s101, v209
    v_lshlrev_b32 v184, 16, v210
    v_and_b32 v185, s101, v210
    v_lshlrev_b32 v186, 16, v211
    v_mfma_f32_32x32x16_bf16 v[16:31], a[172:175], v[60:63], v[16:31]
    ds_read_b128 v[52:55], v2 offset:25088
    buffer_load_dwordx4 v4, s[8:11], s85 offen offset:3072 sc1 lds
    v_and_b32 v187, s101, v211
    v_add_f32 v220, v172, v176
    v_add_f32 v221, v173, v177
    v_add_f32 v222, v174, v178
    v_add_f32 v223, v175, v179
    s_waitcnt lgkmcnt(4)
    v_mfma_f32_32x32x16_bf16 v[16:31], a[176:179], v[64:67], v[16:31]
    ds_read_b128 v[56:59], v2 offset:25600
    v_add_f32 v224, v180, v184
    v_add_f32 v225, v181, v185
    v_add_f32 v226, v182, v186
    v_add_f32 v227, v183, v187
    v_mfma_f32_32x32x16_bf16 v[16:31], a[180:183], v[68:71], v[16:31]
    ds_read_b128 v[60:63], v2 offset:26112
    v_add_f32 v220, v220, v224
    v_add_f32 v221, v221, v225
    v_add_f32 v222, v222, v226
    v_add_f32 v223, v223, v227
    s_waitcnt lgkmcnt(4)
    v_mfma_f32_32x32x16_bf16 v[16:31], a[184:187], v[72:75], v[16:31]
    ds_read_b128 v[64:67], v2 offset:26624
    v_add_f32 v220, v220, v221
    v_add_f32 v222, v222, v223
    v_add_f32 v220, v220, v222
    v_mov_b32 v221, v220
    v_mfma_f32_32x32x16_bf16 v[16:31], a[188:191], v[76:79], v[16:31]
    ds_read_b128 v[68:71], v2 offset:27136
    s_add_u32 m0, s53, 86016
    s_nop 0
    buffer_load_dwordx4 v5, s[8:11], s85 offen offset:0 sc1 lds
    v_permlane32_swap_b32 v220, v221
    v_add_f32 v220, v220, v221
    v_mov_b32 v221, v220
    s_nop 1
    v_permlane16_swap_b32 v220, v221
    v_add_f32 v220, v220, v221
    s_waitcnt lgkmcnt(4)
    v_mfma_f32_32x32x16_bf16 v[16:31], a[192:195], v[48:51], v[16:31]
    ds_read_b128 v[72:75], v2 offset:27648
    v_mul_f32 v164, 0x3c800000, v220
    v_sub_f32 v172, v172, v164
    v_sub_f32 v173, v173, v164
    v_sub_f32 v174, v174, v164
    v_mfma_f32_32x32x16_bf16 v[16:31], a[196:199], v[52:55], v[16:31]
    ds_read_b128 v[76:79], v2 offset:28160
    v_sub_f32 v175, v175, v164
    v_sub_f32 v176, v176, v164
    v_sub_f32 v177, v177, v164
    v_sub_f32 v178, v178, v164
    s_waitcnt vmcnt(5)
    v_xor_b32 v162, 4, v162
    v_xor_b32 v163, 4, v163
    s_waitcnt lgkmcnt(4)
    v_mfma_f32_32x32x16_bf16 v[16:31], a[200:203], v[56:59], v[16:31]
    ds_read_b128 v[48:51], v2 offset:28672
    v_sub_f32 v179, v179, v164
    v_sub_f32 v180, v180, v164
    v_sub_f32 v181, v181, v164
    v_sub_f32 v182, v182, v164
    v_sub_f32 v183, v183, v164
    s_add_u32 s7, s39, 2
    s_cmp_lt_u32 s7, 64
    s_cselect_b32 s6, 1, 0
    v_cmp_eq_u32 vcc, 0, v8
    v_mfma_f32_32x32x16_bf16 v[16:31], a[204:207], v[60:63], v[16:31]
    ds_read_b128 v[52:55], v2 offset:29184
    buffer_load_dwordx4 v5, s[8:11], s85 offen offset:1024 sc1 lds
    v_sub_f32 v184, v184, v164
    v_sub_f32 v185, v185, v164
    v_sub_f32 v186, v186, v164
    v_sub_f32 v187, v187, v164
    s_cmp_eq_u64 vcc, 0
    s_cselect_b32 s6, s6, 0
    v_cmp_eq_u32 vcc, 0, v10
    s_waitcnt lgkmcnt(4)
    v_mfma_f32_32x32x16_bf16 v[16:31], a[208:211], v[64:67], v[16:31]
    ds_read_b128 v[56:59], v2 offset:29696
    v_mul_f32 v172, v172, v172
    v_mul_f32 v173, v173, v173
    v_mul_f32 v174, v174, v174
    v_mul_f32 v175, v175, v175
    s_cmp_eq_u64 vcc, 0
    s_cselect_b32 s7, 2, 0
    s_cmp_lt_u32 s42, 64
    s_cselect_b32 s7, s7, 0
    s_or_b32 s6, s6, s7
    v_mfma_f32_32x32x16_bf16 v[16:31], a[212:215], v[68:71], v[16:31]
    ds_read_b128 v[60:63], v2 offset:30208
    v_mul_f32 v176, v176, v176
    v_mul_f32 v177, v177, v177
    v_mul_f32 v178, v178, v178
    v_mul_f32 v179, v179, v179
    v_mov_b32 v13, s6
    s_waitcnt lgkmcnt(4)
    v_mfma_f32_32x32x16_bf16 v[16:31], a[216:219], v[72:75], v[16:31]
    ds_read_b128 v[64:67], v2 offset:30720
    v_mul_f32 v180, v180, v180
    v_mul_f32 v181, v181, v181
    v_mul_f32 v182, v182, v182
    v_mul_f32 v183, v183, v183
    v_mul_f32 v184, v184, v184
    s_mov_b64 exec, 1
    ds_write_b32 v163, v13
    s_mov_b64 exec, -1
    v_mfma_f32_32x32x16_bf16 v[16:31], a[220:223], v[76:79], v[16:31]
    ds_read_b128 v[68:71], v2 offset:31232
    buffer_load_dwordx4 v5, s[8:11], s85 offen offset:2048 sc1 lds
    v_mul_f32 v185, v185, v185
    v_mul_f32 v186, v186, v186
    v_mul_f32 v187, v187, v187
    v_add_f32 v220, v172, v176
    s_waitcnt lgkmcnt(5)
    v_mfma_f32_32x32x16_bf16 v[16:31], a[224:227], v[48:51], v[16:31]
    ds_read_b128 v[72:75], v2 offset:31744
    v_add_f32 v221, v173, v177
    v_add_f32 v222, v174, v178
    v_add_f32 v223, v175, v179
    v_add_f32 v224, v180, v184
    v_mfma_f32_32x32x16_bf16 v[16:31], a[228:231], v[52:55], v[16:31]
    ds_read_b128 v[76:79], v2 offset:32256
    v_add_f32 v225, v181, v185
    v_add_f32 v226, v182, v186
    v_add_f32 v227, v183, v187
    v_add_f32 v220, v220, v224
    v_add_f32 v221, v221, v225
    s_waitcnt vmcnt(10)
    s_waitcnt lgkmcnt(3)
    s_barrier
    ds_read_b32 v14, v162
    s_cmp_le_u32 s39, s41
    s_cbranch_scc1 sm_200
    s_mov_b32 s41, s39
    s_sub_u32 s82, s39, 1
    s_lshl_b32 s82, s82, 7
    v_mov_b32 v11, 1
    buffer_store_dword v11, v12, s[16:19], s82 offen sc1
sm_200:
    s_cmp_eq_u32 s98, 0
    s_cbranch_scc1 sr_201
    s_sub_u32 s82, s98, 1
    s_lshl_b32 s82, s82, 7
    v_mov_b32 v11, 1
    buffer_store_dword v11, v161, s[16:19], s82 offen sc1
    s_mov_b32 s98, 0
sr_201:
    s_waitcnt lgkmcnt(6)
    v_mfma_f32_32x32x16_bf16 v[16:31], a[232:235], v[56:59], v[16:31]
    ds_read_b128 v[48:51], v3 offset:0
    v_add_f32 v222, v222, v226
    v_add_f32 v223, v223, v227
    v_add_f32 v220, v220, v221
    v_add_f32 v222, v222, v223
    v_mfma_f32_32x32x16_bf16 v[16:31], a[236:239], v[60:63], v[16:31]
    ds_read_b128 v[52:55], v3 offset:512
    buffer_load_dwordx4 v5, s[8:11], s85 offen offset:3072 sc1 lds
    v_add_f32 v220, v220, v222
    v_mov_b32 v221, v220
    s_nop 1
    v_permlane32_swap_b32 v220, v221
    v_add_f32 v220, v220, v221
    s_waitcnt lgkmcnt(5)
    v_mfma_f32_32x32x16_bf16 v[16:31], a[240:243], v[64:67], v[16:31]
    ds_read_b128 v[56:59], v3 offset:1024
    v_mov_b32 v221, v220
    s_nop 1
    v_permlane16_swap_b32 v220, v221
    v_add_f32 v220, v220, v221
    v_mov_b32 v165, v220
    v_mfma_f32_32x32x16_bf16 v[16:31], a[244:247], v[68:71], v[16:31]
    ds_read_b128 v[60:63], v3 offset:1536
    s_waitcnt lgkmcnt(5)
    v_mfma_f32_32x32x16_bf16 v[16:31], a[248:251], v[72:75], v[16:31]
    ds_read_b128 v[64:67], v3 offset:2048
    s_lshl_b32 s47, s100, 11
    buffer_store_dwordx2 v[164:165], v160, s[32:35], s47 offen sc1
    s_waitcnt lgkmcnt(5)
    v_readfirstlane_b32 s52, v14
    v_mfma_f32_32x32x16_bf16 v[16:31], a[252:255], v[76:79], v[16:31]
    ds_read_b128 v[68:71], v3 offset:2560
    s_mov_b32 s98, s3
    s_cmp_eq_u32 s40, 0
    s_cbranch_scc1 op_end0
    s_add_u32 s39, s39, 1
    s_mov_b32 s14, 0x800000
    s_and_b32 s40, s52, 1
    s_cselect_b32 s10, 0x1000000, 0
    s_cmp_eq_u32 s52, 3
    s_cbranch_scc1 op_LR1
    s_branch op_LP1
op_LP1:
    s_waitcnt lgkmcnt(4)
    v_mfma_f32_32x32x16_bf16 v[32:47], a[0:3], v[48:51], 0
    ds_read_b128 v[72:75], v3 offset:3072
    s_add_u32 s48, s39, 1
    s_mul_i32 s84, s48, 262144
    s_add_u32 s85, s84, 16384
    v_mfma_f32_32x32x16_bf16 v[32:47], a[4:7], v[52:55], v[32:47]
    ds_read_b128 v[76:79], v3 offset:3584
    s_add_i32 s46, s39, -1
    s_lshl_b32 s2, s46, 17
    buffer_store_dwordx4 v[16:19], v6, s[12:15], s2 offen offset:0 sc1
    s_waitcnt lgkmcnt(4)
    v_mfma_f32_32x32x16_bf16 v[32:47], a[8:11], v[56:59], v[32:47]
    ds_read_b128 v[48:51], v3 offset:4096
    s_add_u32 m0, s53, 0
    s_nop 0
    buffer_load_dwordx4 v4, s[8:11], s84 offen offset:0 sc1 lds
    v_mfma_f32_32x32x16_bf16 v[32:47], a[12:15], v[60:63], v[32:47]
    ds_read_b128 v[52:55], v3 offset:4608
    buffer_store_dwordx4 v[20:23], v6, s[12:15], s2 offen offset:512 sc1
    s_waitcnt lgkmcnt(4)
    v_mfma_f32_32x32x16_bf16 v[32:47], a[16:19], v[64:67], v[32:47]
    ds_read_b128 v[56:59], v3 offset:5120
    v_mfma_f32_32x32x16_bf16 v[32:47], a[20:23], v[68:71], v[32:47]
    ds_read_b128 v[60:63], v3 offset:5632
    buffer_store_dwordx4 v[24:27], v6, s[12:15], s2 offen offset:1024 sc1
    buffer_load_dwordx4 v4, s[8:11], s84 offen offset:1024 sc1 lds
    s_waitcnt lgkmcnt(4)
    v_mfma_f32_32x32x16_bf16 v[32:47], a[24:27], v[72:75], v[32:47]
    ds_read_b128 v[64:67], v3 offset:6144
    v_mfma_f32_32x32x16_bf16 v[32:47], a[28:31], v[76:79], v[32:47]
    ds_read_b128 v[68:71], v3 offset:6656
    buffer_store_dwordx4 v[28:31], v6, s[12:15], s2 offen offset:1536 sc1
    s_waitcnt lgkmcnt(4)
    v_mfma_f32_32x32x16_bf16 v[32:47], a[32:35], v[48:51], v[32:47]
    ds_read_b128 v[72:75], v3 offset:7168
    buffer_load_dwordx4 v4, s[8:11], s84 offen offset:2048 sc1 lds
    v_mfma_f32_32x32x16_bf16 v[32:47], a[36:39], v[52:55], v[32:47]
    ds_read_b128 v[76:79], v3 offset:7680
    s_waitcnt lgkmcnt(4)
    v_mfma_f32_32x32x16_bf16 v[32:47], a[40:43], v[56:59], v[32:47]
    ds_read_b128 v[48:51], v3 offset:8192
    v_mfma_f32_32x32x16_bf16 v[32:47], a[44:47], v[60:63], v[32:47]
    ds_read_b128 v[52:55], v3 offset:8704
    buffer_load_dwordx4 v4, s[8:11], s84 offen offset:3072 sc1 lds
    s_waitcnt lgkmcnt(4)
    v_mfma_f32_32x32x16_bf16 v[32:47], a[48:51], v[64:67], v[32:47]
    ds_read_b128 v[56:59], v3 offset:9216
    v_mfma_f32_32x32x16_bf16 v[32:47], a[52:55], v[68:71], v[32:47]
    ds_read_b128 v[60:63], v3 offset:9728
    s_waitcnt lgkmcnt(4)
    v_mfma_f32_32x32x16_bf16 v[32:47], a[56:59], v[72:75], v[32:47]
    ds_read_b128 v[64:67], v3 offset:10240
    s_add_u32 m0, s53, 4096
    s_nop 0
    buffer_load_dwordx4 v5, s[8:11], s84 offen offset:0 sc1 lds
    v_mfma_f32_32x32x16_bf16 v[32:47], a[60:63], v[76:79], v[32:47]
    ds_read_b128 v[68:71], v3 offset:10752
    s_waitcnt lgkmcnt(4)
    v_mfma_f32_32x32x16_bf16 v[32:47], a[64:67], v[48:51], v[32:47]
    ds_read_b128 v[72:75], v3 offset:11264
    v_mfma_f32_32x32x16_bf16 v[32:47], a[68:71], v[52:55], v[32:47]
    ds_read_b128 v[76:79], v3 offset:11776
    s_waitcnt lgkmcnt(4)
    v_mfma_f32_32x32x16_bf16 v[32:47], a[72:75], v[56:59], v[32:47]
    ds_read_b128 v[48:51], v3 offset:12288
    buffer_load_dwordx4 v5, s[8:11], s84 offen offset:1024 sc1 lds
    v_mfma_f32_32x32x16_bf16 v[32:47], a[76:79], v[60:63], v[32:47]
    ds_read_b128 v[52:55], v3 offset:12800
    s_waitcnt lgkmcnt(4)
    v_mfma_f32_32x32x16_bf16 v[32:47], a[80:83], v[64:67], v[32:47]
    ds_read_b128 v[56:59], v3 offset:13312
    v_mfma_f32_32x32x16_bf16 v[32:47], a[84:87], v[68:71], v[32:47]
    ds_read_b128 v[60:63], v3 offset:13824
    buffer_load_dwordx4 v5, s[8:11], s84 offen offset:2048 sc1 lds
    s_waitcnt lgkmcnt(4)
    v_mfma_f32_32x32x16_bf16 v[32:47], a[88:91], v[72:75], v[32:47]
    ds_read_b128 v[64:67], v3 offset:14336
    v_mfma_f32_32x32x16_bf16 v[32:47], a[92:95], v[76:79], v[32:47]
    ds_read_b128 v[68:71], v3 offset:14848
    s_waitcnt lgkmcnt(4)
    v_mfma_f32_32x32x16_bf16 v[32:47], a[96:99], v[48:51], v[32:47]
    ds_read_b128 v[72:75], v3 offset:15360
    buffer_load_dwordx4 v5, s[8:11], s84 offen offset:3072 sc1 lds
    v_mfma_f32_32x32x16_bf16 v[32:47], a[100:103], v[52:55], v[32:47]
    ds_read_b128 v[76:79], v3 offset:15872
    s_waitcnt vmcnt(12)
    s_barrier
    s_waitcnt lgkmcnt(4)
    v_mfma_f32_32x32x16_bf16 v[32:47], a[104:107], v[56:59], v[32:47]
    ds_read_b128 v[48:51], v3 offset:16384
    v_mfma_f32_32x32x16_bf16 v[32:47], a[108:111], v[60:63], v[32:47]
    ds_read_b128 v[52:55], v3 offset:16896
    s_waitcnt lgkmcnt(4)
    v_mfma_f32_32x32x16_bf16 v[32:47], a[112:115], v[64:67], v[32:47]
    ds_read_b128 v[56:59], v3 offset:17408
    v_mfma_f32_32x32x16_bf16 v[32:47], a[116:119], v[68:71], v[32:47]
    ds_read_b128 v[60:63], v3 offset:17920
    s_waitcnt lgkmcnt(4)
    v_mfma_f32_32x32x16_bf16 v[32:47], a[120:123], v[72:75], v[32:47]
    ds_read_b128 v[64:67], v3 offset:18432
    v_mfma_f32_32x32x16_bf16 v[32:47], a[124:127], v[76:79], v[32:47]
    ds_read_b128 v[68:71], v3 offset:18944
    s_waitcnt lgkmcnt(4)
    v_mfma_f32_32x32x16_bf16 v[32:47], a[128:131], v[48:51], v[32:47]
    ds_read_b128 v[72:75], v3 offset:19456
    s_add_u32 m0, s53, 16384
    s_nop 0
    buffer_load_dwordx4 v4, s[8:11], s85 offen offset:0 sc1 lds
    v_mfma_f32_32x32x16_bf16 v[32:47], a[132:135], v[52:55], v[32:47]
    ds_read_b128 v[76:79], v3 offset:19968
    s_waitcnt lgkmcnt(4)
    v_mfma_f32_32x32x16_bf16 v[32:47], a[136:139], v[56:59], v[32:47]
    ds_read_b128 v[48:51], v3 offset:20480
    v_mfma_f32_32x32x16_bf16 v[32:47], a[140:143], v[60:63], v[32:47]
    ds_read_b128 v[52:55], v3 offset:20992
    buffer_load_dwordx4 v4, s[8:11], s85 offen offset:1024 sc1 lds
    s_waitcnt lgkmcnt(4)
    v_mfma_f32_32x32x16_bf16 v[32:47], a[144:147], v[64:67], v[32:47]
    ds_read_b128 v[56:59], v3 offset:21504
    s_cmp_ge_u32 s42, s39
    s_cbranch_scc1 pr_202
    s_lshl_b32 s6, s42, 7
    buffer_load_dword v10, v9, s[16:19], s6 offen sc1
pr_202:
    s_add_u32 s6, s39, 2
    s_lshl_b32 s6, s6, 9
    buffer_load_dword v8, v7, s[16:19], s6 offen sc1
    v_mfma_f32_32x32x16_bf16 v[32:47], a[148:151], v[68:71], v[32:47]
    ds_read_b128 v[60:63], v3 offset:22016
    s_waitcnt lgkmcnt(4)
    v_mfma_f32_32x32x16_bf16 v[32:47], a[152:155], v[72:75], v[32:47]
    ds_read_b128 v[64:67], v3 offset:22528
    v_mfma_f32_32x32x16_bf16 v[32:47], a[156:159], v[76:79], v[32:47]
    ds_read_b128 v[68:71], v3 offset:23040
    buffer_load_dwordx4 v4, s[8:11], s85 offen offset:2048 sc1 lds
    s_waitcnt lgkmcnt(4)
    v_mfma_f32_32x32x16_bf16 v[32:47], a[160:163], v[48:51], v[32:47]
    ds_read_b128 v[72:75], v3 offset:23552
    v_mfma_f32_32x32x16_bf16 v[32:47], a[164:167], v[52:55], v[32:47]
    ds_read_b128 v[76:79], v3 offset:24064
    s_waitcnt lgkmcnt(4)
    v_mfma_f32_32x32x16_bf16 v[32:47], a[168:171], v[56:59], v[32:47]
    ds_read_b128 v[48:51], v3 offset:24576
    v_mfma_f32_32x32x16_bf16 v[32:47], a[172:175], v[60:63], v[32:47]
    ds_read_b128 v[52:55], v3 offset:25088
    buffer_load_dwordx4 v4, s[8:11], s85 offen offset:3072 sc1 lds
    s_waitcnt lgkmcnt(4)
    v_mfma_f32_32x32x16_bf16 v[32:47], a[176:179], v[64:67], v[32:47]
    ds_read_b128 v[56:59], v3 offset:25600
    v_mfma_f32_32x32x16_bf16 v[32:47], a[180:183], v[68:71], v[32:47]
    ds_read_b128 v[60:63], v3 offset:26112
    s_waitcnt lgkmcnt(4)
    v_mfma_f32_32x32x16_bf16 v[32:47], a[184:187], v[72:75], v[32:47]
    ds_read_b128 v[64:67], v3 offset:26624
    v_mfma_f32_32x32x16_bf16 v[32:47], a[188:191], v[76:79], v[32:47]
    ds_read_b128 v[68:71], v3 offset:27136
    s_add_u32 m0, s53, 20480
    s_nop 0
    buffer_load_dwordx4 v5, s[8:11], s85 offen offset:0 sc1 lds
    s_waitcnt lgkmcnt(4)
    v_mfma_f32_32x32x16_bf16 v[32:47], a[192:195], v[48:51], v[32:47]
    ds_read_b128 v[72:75], v3 offset:27648
    v_mfma_f32_32x32x16_bf16 v[32:47], a[196:199], v[52:55], v[32:47]
    ds_read_b128 v[76:79], v3 offset:28160
    s_waitcnt vmcnt(3)
    v_xor_b32 v162, 4, v162
    v_xor_b32 v163, 4, v163
    s_waitcnt lgkmcnt(4)
    v_mfma_f32_32x32x16_bf16 v[32:47], a[200:203], v[56:59], v[32:47]
    ds_read_b128 v[48:51], v3 offset:28672
    s_add_u32 s7, s39, 2
    s_cmp_lt_u32 s7, 64
    s_cselect_b32 s6, 1, 0
    v_cmp_eq_u32 vcc, 0, v8
    v_mfma_f32_32x32x16_bf16 v[32:47], a[204:207], v[60:63], v[32:47]
    ds_read_b128 v[52:55], v3 offset:29184
    buffer_load_dwordx4 v5, s[8:11], s85 offen offset:1024 sc1 lds
    s_nop 0
    s_cmp_eq_u64 vcc, 0
    s_cselect_b32 s6, s6, 0
    v_cmp_eq_u32 vcc, 0, v10
    s_waitcnt lgkmcnt(4)
    v_mfma_f32_32x32x16_bf16 v[32:47], a[208:211], v[64:67], v[32:47]
    ds_read_b128 v[56:59], v3 offset:29696
    s_nop 0
    s_cmp_eq_u64 vcc, 0
    s_cselect_b32 s7, 2, 0
    s_cmp_lt_u32 s42, 64
    s_cselect_b32 s7, s7, 0
    s_or_b32 s6, s6, s7
    v_mfma_f32_32x32x16_bf16 v[32:47], a[212:215], v[68:71], v[32:47]
    ds_read_b128 v[60:63], v3 offset:30208
    v_mov_b32 v13, s6
    s_waitcnt lgkmcnt(4)
    v_mfma_f32_32x32x16_bf16 v[32:47], a[216:219], v[72:75], v[32:47]
    ds_read_b128 v[64:67], v3 offset:30720
    s_mov_b64 exec, 1
    ds_write_b32 v163, v13
    s_mov_b64 exec, -1
    v_mfma_f32_32x32x16_bf16 v[32:47], a[220:223], v[76:79], v[32:47]
    ds_read_b128 v[68:71], v3 offset:31232
    buffer_load_dwordx4 v5, s[8:11], s85 offen offset:2048 sc1 lds
    s_waitcnt lgkmcnt(5)
    v_mfma_f32_32x32x16_bf16 v[32:47], a[224:227], v[48:51], v[32:47]
    ds_read_b128 v[72:75], v3 offset:31744
    v_mfma_f32_32x32x16_bf16 v[32:47], a[228:231], v[52:55], v[32:47]
    ds_read_b128 v[76:79], v3 offset:32256
    s_waitcnt vmcnt(8)
    s_waitcnt lgkmcnt(3)
    s_barrier
    ds_read_b32 v14, v162
    s_cmp_le_u32 s39, s41
    s_cbranch_scc1 sm_203
    s_mov_b32 s41, s39
    s_sub_u32 s82, s39, 1
    s_lshl_b32 s82, s82, 7
    v_mov_b32 v11, 1
    buffer_store_dword v11, v12, s[16:19], s82 offen sc1
sm_203:
    s_cmp_eq_u32 s98, 0
    s_cbranch_scc1 sr_204
    s_sub_u32 s82, s98, 1
    s_lshl_b32 s82, s82, 7
    v_mov_b32 v11, 1
    buffer_store_dword v11, v161, s[16:19], s82 offen sc1
    s_mov_b32 s98, 0
sr_204:
    s_waitcnt lgkmcnt(6)
    v_mfma_f32_32x32x16_bf16 v[32:47], a[232:235], v[56:59], v[32:47]
    ds_read_b128 v[48:51], v2 offset:0
    v_mfma_f32_32x32x16_bf16 v[32:47], a[236:239], v[60:63], v[32:47]
    ds_read_b128 v[52:55], v2 offset:512
    buffer_load_dwordx4 v5, s[8:11], s85 offen offset:3072 sc1 lds
    s_waitcnt lgkmcnt(5)
    v_mfma_f32_32x32x16_bf16 v[32:47], a[240:243], v[64:67], v[32:47]
    ds_read_b128 v[56:59], v2 offset:1024
    v_mfma_f32_32x32x16_bf16 v[32:47], a[244:247], v[68:71], v[32:47]
    ds_read_b128 v[60:63], v2 offset:1536
    s_waitcnt lgkmcnt(5)
    v_mfma_f32_32x32x16_bf16 v[32:47], a[248:251], v[72:75], v[32:47]
    ds_read_b128 v[64:67], v2 offset:2048
    s_waitcnt lgkmcnt(5)
    v_readfirstlane_b32 s52, v14
    v_mfma_f32_32x32x16_bf16 v[32:47], a[252:255], v[76:79], v[32:47]
    ds_read_b128 v[68:71], v2 offset:2560
    s_cmp_eq_u32 s40, 0
    s_cbranch_scc1 op_end1
    s_add_u32 s39, s39, 1
    s_mov_b32 s14, 0x800000
    s_and_b32 s40, s52, 1
    s_cselect_b32 s10, 0x1000000, 0
    s_cmp_eq_u32 s52, 3
    s_cbranch_scc1 op_LR0
    s_branch op_LP0
op_LR1:
    s_waitcnt lgkmcnt(4)
    v_mfma_f32_32x32x16_bf16 v[32:47], a[0:3], v[48:51], 0
    ds_read_b128 v[72:75], v3 offset:3072
    s_add_u32 s48, s39, 1
    s_mul_i32 s84, s48, 262144
    s_add_u32 s85, s84, 16384
    s_lshl_b32 s100, s42, 1
    s_lshr_b32 s47, s38, 2
    s_add_u32 s100, s100, s47
    v_mfma_f32_32x32x16_bf16 v[32:47], a[4:7], v[52:55], v[32:47]
    ds_read_b128 v[76:79], v3 offset:3584
    s_lshl_b32 s86, s100, 16
    s_lshl_b32 s55, s100, 15
    s_add_u32 s87, s86, 0x800000
    s_add_u32 s88, s87, 0x800000
    s_add_u32 s89, s88, 0x800000
    s_add_i32 s46, s39, -1
    s_lshl_b32 s2, s46, 17
    buffer_store_dwordx4 v[16:19], v6, s[12:15], s2 offen offset:0 sc1
    s_waitcnt lgkmcnt(4)
    v_mfma_f32_32x32x16_bf16 v[32:47], a[8:11], v[56:59], v[32:47]
    ds_read_b128 v[48:51], v3 offset:4096
    s_add_u32 m0, s53, 0
    s_nop 0
    buffer_load_dwordx4 v4, s[8:11], s84 offen offset:0 sc1 lds
    v_mfma_f32_32x32x16_bf16 v[32:47], a[12:15], v[60:63], v[32:47]
    ds_read_b128 v[52:55], v3 offset:4608
    buffer_store_dwordx4 v[20:23], v6, s[12:15], s2 offen offset:512 sc1
    s_waitcnt lgkmcnt(4)
    v_mfma_f32_32x32x16_bf16 v[32:47], a[16:19], v[64:67], v[32:47]
    ds_read_b128 v[56:59], v3 offset:5120
    buffer_load_dwordx4 v[172:175], v157, s[20:23], s86 offen offset:0 sc1
    v_mfma_f32_32x32x16_bf16 v[32:47], a[20:23], v[68:71], v[32:47]
    ds_read_b128 v[60:63], v3 offset:5632
    buffer_store_dwordx4 v[24:27], v6, s[12:15], s2 offen offset:1024 sc1
    buffer_load_dwordx4 v4, s[8:11], s84 offen offset:1024 sc1 lds
    s_waitcnt lgkmcnt(4)
    v_mfma_f32_32x32x16_bf16 v[32:47], a[24:27], v[72:75], v[32:47]
    ds_read_b128 v[64:67], v3 offset:6144
    buffer_load_dwordx4 v[176:179], v157, s[20:23], s86 offen offset:1024 sc1
    v_mfma_f32_32x32x16_bf16 v[32:47], a[28:31], v[76:79], v[32:47]
    ds_read_b128 v[68:71], v3 offset:6656
    buffer_store_dwordx4 v[28:31], v6, s[12:15], s2 offen offset:1536 sc1
    s_waitcnt lgkmcnt(4)
    v_mfma_f32_32x32x16_bf16 v[32:47], a[32:35], v[48:51], v[32:47]
    ds_read_b128 v[72:75], v3 offset:7168
    buffer_load_dwordx4 v4, s[8:11], s84 offen offset:2048 sc1 lds
    v_mfma_f32_32x32x16_bf16 v[32:47], a[36:39], v[52:55], v[32:47]
    ds_read_b128 v[76:79], v3 offset:7680
    buffer_load_dwordx4 v[180:183], v157, s[20:23], s86 offen offset:2048 sc1
    s_waitcnt lgkmcnt(4)
    v_mfma_f32_32x32x16_bf16 v[32:47], a[40:43], v[56:59], v[32:47]
    ds_read_b128 v[48:51], v3 offset:8192
    v_mfma_f32_32x32x16_bf16 v[32:47], a[44:47], v[60:63], v[32:47]
    ds_read_b128 v[52:55], v3 offset:8704
    buffer_load_dwordx4 v4, s[8:11], s84 offen offset:3072 sc1 lds
    s_waitcnt lgkmcnt(4)
    v_mfma_f32_32x32x16_bf16 v[32:47], a[48:51], v[64:67], v[32:47]
    ds_read_b128 v[56:59], v3 offset:9216
    buffer_load_dwordx4 v[184:187], v157, s[20:23], s86 offen offset:3072 sc1
    v_mfma_f32_32x32x16_bf16 v[32:47], a[52:55], v[68:71], v[32:47]
    ds_read_b128 v[60:63], v3 offset:9728
    s_waitcnt lgkmcnt(4)
    v_mfma_f32_32x32x16_bf16 v[32:47], a[56:59], v[72:75], v[32:47]
    ds_read_b128 v[64:67], v3 offset:10240
    s_add_u32 m0, s53, 4096
    s_nop 0
    buffer_load_dwordx4 v5, s[8:11], s84 offen offset:0 sc1 lds
    v_mfma_f32_32x32x16_bf16 v[32:47], a[60:63], v[76:79], v[32:47]
    ds_read_b128 v[68:71], v3 offset:10752
    buffer_load_dwordx4 v[188:191], v157, s[20:23], s87 offen offset:0 sc1
    s_waitcnt lgkmcnt(4)
    v_mfma_f32_32x32x16_bf16 v[32:47], a[64:67], v[48:51], v[32:47]
    ds_read_b128 v[72:75], v3 offset:11264
    v_mfma_f32_32x32x16_bf16 v[32:47], a[68:71], v[52:55], v[32:47]
    ds_read_b128 v[76:79], v3 offset:11776
    s_waitcnt lgkmcnt(4)
    v_mfma_f32_32x32x16_bf16 v[32:47], a[72:75], v[56:59], v[32:47]
    ds_read_b128 v[48:51], v3 offset:12288
    buffer_load_dwordx4 v5, s[8:11], s84 offen offset:1024 sc1 lds
    buffer_load_dwordx4 v[192:195], v157, s[20:23], s87 offen offset:1024 sc1
    v_mfma_f32_32x32x16_bf16 v[32:47], a[76:79], v[60:63], v[32:47]
    ds_read_b128 v[52:55], v3 offset:12800
    s_waitcnt lgkmcnt(4)
    v_mfma_f32_32x32x16_bf16 v[32:47], a[80:83], v[64:67], v[32:47]
    ds_read_b128 v[56:59], v3 offset:13312
    v_mfma_f32_32x32x16_bf16 v[32:47], a[84:87], v[68:71], v[32:47]
    ds_read_b128 v[60:63], v3 offset:13824
    buffer_load_dwordx4 v5, s[8:11], s84 offen offset:2048 sc1 lds
    buffer_load_dwordx4 v[196:199], v157, s[20:23], s87 offen offset:2048 sc1
    s_waitcnt lgkmcnt(4)
    v_mfma_f32_32x32x16_bf16 v[32:47], a[88:91], v[72:75], v[32:47]
    ds_read_b128 v[64:67], v3 offset:14336
    v_mfma_f32_32x32x16_bf16 v[32:47], a[92:95], v[76:79], v[32:47]
    ds_read_b128 v[68:71], v3 offset:14848
    s_waitcnt lgkmcnt(4)
    v_mfma_f32_32x32x16_bf16 v[32:47], a[96:99], v[48:51], v[32:47]
    ds_read_b128 v[72:75], v3 offset:15360
    buffer_load_dwordx4 v5, s[8:11], s84 offen offset:3072 sc1 lds
    buffer_load_dwordx4 v[200:203], v157, s[20:23], s87 offen offset:3072 sc1
    v_mfma_f32_32x32x16_bf16 v[32:47], a[100:103], v[52:55], v[32:47]
    ds_read_b128 v[76:79], v3 offset:15872
    s_waitcnt vmcnt(20)
    s_barrier
    s_waitcnt lgkmcnt(4)
    v_mfma_f32_32x32x16_bf16 v[32:47], a[104:107], v[56:59], v[32:47]
    ds_read_b128 v[48:51], v3 offset:16384
    v_mfma_f32_32x32x16_bf16 v[32:47], a[108:111], v[60:63], v[32:47]
    ds_read_b128 v[52:55], v3 offset:16896
    buffer_load_dwordx4 v[204:207], v157, s[20:23], s88 offen offset:0 sc1
    s_waitcnt lgkmcnt(4)
    v_mfma_f32_32x32x16_bf16 v[32:47], a[112:115], v[64:67], v[32:47]
    ds_read_b128 v[56:59], v3 offset:17408
    v_mfma_f32_32x32x16_bf16 v[32:47], a[116:119], v[68:71], v[32:47]
    ds_read_b128 v[60:63], v3 offset:17920
    s_waitcnt lgkmcnt(4)
    v_mfma_f32_32x32x16_bf16 v[32:47], a[120:123], v[72:75], v[32:47]
    ds_read_b128 v[64:67], v3 offset:18432
    buffer_load_dwordx4 v[208:211], v157, s[20:23], s88 offen offset:1024 sc1
    v_mfma_f32_32x32x16_bf16 v[32:47], a[124:127], v[76:79], v[32:47]
    ds_read_b128 v[68:71], v3 offset:18944
    s_waitcnt lgkmcnt(4)
    v_mfma_f32_32x32x16_bf16 v[32:47], a[128:131], v[48:51], v[32:47]
    ds_read_b128 v[72:75], v3 offset:19456
    s_add_u32 m0, s53, 16384
    s_nop 0
    buffer_load_dwordx4 v4, s[8:11], s85 offen offset:0 sc1 lds
    v_mfma_f32_32x32x16_bf16 v[32:47], a[132:135], v[52:55], v[32:47]
    ds_read_b128 v[76:79], v3 offset:19968
    buffer_load_dwordx4 v[212:215], v157, s[20:23], s88 offen offset:2048 sc1
    s_waitcnt lgkmcnt(4)
    v_mfma_f32_32x32x16_bf16 v[32:47], a[136:139], v[56:59], v[32:47]
    ds_read_b128 v[48:51], v3 offset:20480
    v_mfma_f32_32x32x16_bf16 v[32:47], a[140:143], v[60:63], v[32:47]
    ds_read_b128 v[52:55], v3 offset:20992
    buffer_load_dwordx4 v4, s[8:11], s85 offen offset:1024 sc1 lds
    s_waitcnt lgkmcnt(4)
    v_mfma_f32_32x32x16_bf16 v[32:47], a[144:147], v[64:67], v[32:47]
    ds_read_b128 v[56:59], v3 offset:21504
    s_cmp_ge_u32 s42, s39
    s_cbranch_scc1 pr_205
    s_lshl_b32 s6, s42, 7
    buffer_load_dword v10, v9, s[16:19], s6 offen sc1
pr_205:
    s_add_u32 s6, s39, 2
    s_lshl_b32 s6, s6, 9
    buffer_load_dword v8, v7, s[16:19], s6 offen sc1
    buffer_load_dwordx4 v[216:219], v157, s[20:23], s88 offen offset:3072 sc1
    v_mfma_f32_32x32x16_bf16 v[32:47], a[148:151], v[68:71], v[32:47]
    ds_read_b128 v[60:63], v3 offset:22016
    s_waitcnt lgkmcnt(4)
    v_mfma_f32_32x32x16_bf16 v[32:47], a[152:155], v[72:75], v[32:47]
    ds_read_b128 v[64:67], v3 offset:22528
    v_mfma_f32_32x32x16_bf16 v[32:47], a[156:159], v[76:79], v[32:47]
    ds_read_b128 v[68:71], v3 offset:23040
    buffer_load_dwordx4 v4, s[8:11], s85 offen offset:2048 sc1 lds
    buffer_load_dwordx4 v[220:223], v157, s[20:23], s89 offen offset:0 sc1
    s_waitcnt lgkmcnt(4)
    v_mfma_f32_32x32x16_bf16 v[32:47], a[160:163], v[48:51], v[32:47]
    ds_read_b128 v[72:75], v3 offset:23552
    v_mfma_f32_32x32x16_bf16 v[32:47], a[164:167], v[52:55], v[32:47]
    ds_read_b128 v[76:79], v3 offset:24064
    s_waitcnt lgkmcnt(4)
    v_mfma_f32_32x32x16_bf16 v[32:47], a[168:171], v[56:59], v[32:47]
    ds_read_b128 v[48:51], v3 offset:24576
    buffer_load_dwordx4 v[224:227], v157, s[20:23], s89 offen offset:1024 sc1
    v_mfma_f32_32x32x16_bf16 v[32:47], a[172:175], v[60:63], v[32:47]
    ds_read_b128 v[52:55], v3 offset:25088
    buffer_load_dwordx4 v4, s[8:11], s85 offen offset:3072 sc1 lds
    s_waitcnt lgkmcnt(4)
    v_mfma_f32_32x32x16_bf16 v[32:47], a[176:179], v[64:67], v[32:47]
    ds_read_b128 v[56:59], v3 offset:25600
    v_mfma_f32_32x32x16_bf16 v[32:47], a[180:183], v[68:71], v[32:47]
    ds_read_b128 v[60:63], v3 offset:26112
    buffer_load_dwordx4 v[228:231], v157, s[20:23], s89 offen offset:2048 sc1
    s_waitcnt lgkmcnt(4)
    v_mfma_f32_32x32x16_bf16 v[32:47], a[184:187], v[72:75], v[32:47]
    ds_read_b128 v[64:67], v3 offset:26624
    v_mfma_f32_32x32x16_bf16 v[32:47], a[188:191], v[76:79], v[32:47]
    ds_read_b128 v[68:71], v3 offset:27136
    s_add_u32 m0, s53, 20480
    s_nop 0
    buffer_load_dwordx4 v5, s[8:11], s85 offen offset:0 sc1 lds
    s_waitcnt lgkmcnt(4)
    v_mfma_f32_32x32x16_bf16 v[32:47], a[192:195], v[48:51], v[32:47]
    ds_read_b128 v[72:75], v3 offset:27648
    buffer_load_dwordx4 v[232:235], v157, s[20:23], s89 offen offset:3072 sc1
    v_mfma_f32_32x32x16_bf16 v[32:47], a[196:199], v[52:55], v[32:47]
    ds_read_b128 v[76:79], v3 offset:28160
    s_waitcnt vmcnt(8)
    v_xor_b32 v162, 4, v162
    v_xor_b32 v163, 4, v163
    s_waitcnt lgkmcnt(4)
    v_mfma_f32_32x32x16_bf16 v[32:47], a[200:203], v[56:59], v[32:47]
    ds_read_b128 v[48:51], v3 offset:28672
    s_add_u32 s7, s39, 2
    s_cmp_lt_u32 s7, 64
    s_cselect_b32 s6, 1, 0
    v_cmp_eq_u32 vcc, 0, v8
    v_mfma_f32_32x32x16_bf16 v[32:47], a[204:207], v[60:63], v[32:47]
    ds_read_b128 v[52:55], v3 offset:29184
    buffer_load_dwordx4 v5, s[8:11], s85 offen offset:1024 sc1 lds
    buffer_load_dwordx2 v[164:165], v158, s[24:27], s55 offen offset:0
    s_cmp_eq_u64 vcc, 0
    s_cselect_b32 s6, s6, 0
    v_cmp_eq_u32 vcc, 0, v10
    s_waitcnt lgkmcnt(4)
    v_mfma_f32_32x32x16_bf16 v[32:47], a[208:211], v[64:67], v[32:47]
    ds_read_b128 v[56:59], v3 offset:29696
    s_nop 0
    s_cmp_eq_u64 vcc, 0
    s_cselect_b32 s7, 2, 0
    s_cmp_lt_u32 s42, 64
    s_cselect_b32 s7, s7, 0
    s_or_b32 s6, s6, s7
    v_mfma_f32_32x32x16_bf16 v[32:47], a[212:215], v[68:71], v[32:47]
    ds_read_b128 v[60:63], v3 offset:30208
    v_mov_b32 v13, s6
    s_waitcnt lgkmcnt(4)
    v_mfma_f32_32x32x16_bf16 v[32:47], a[216:219], v[72:75], v[32:47]
    ds_read_b128 v[64:67], v3 offset:30720
    buffer_load_dwordx2 v[166:167], v158, s[24:27], s55 offen offset:32
    s_mov_b64 exec, 1
    ds_write_b32 v163, v13
    s_mov_b64 exec, -1
    v_mfma_f32_32x32x16_bf16 v[32:47], a[220:223], v[76:79], v[32:47]
    ds_read_b128 v[68:71], v3 offset:31232
    buffer_load_dwordx4 v5, s[8:11], s85 offen offset:2048 sc1 lds
    s_waitcnt lgkmcnt(5)
    v_mfma_f32_32x32x16_bf16 v[32:47], a[224:227], v[48:51], v[32:47]
    ds_read_b128 v[72:75], v3 offset:31744
    v_mfma_f32_32x32x16_bf16 v[32:47], a[228:231], v[52:55], v[32:47]
    ds_read_b128 v[76:79], v3 offset:32256
    buffer_load_dwordx2 v[168:169], v158, s[24:27], s55 offen offset:64
    s_waitcnt vmcnt(19)
    s_waitcnt lgkmcnt(3)
    s_barrier
    ds_read_b32 v14, v162
    s_cmp_le_u32 s39, s41
    s_cbranch_scc1 sm_206
    s_mov_b32 s41, s39
    s_sub_u32 s82, s39, 1
    s_lshl_b32 s82, s82, 7
    v_mov_b32 v11, 1
    buffer_store_dword v11, v12, s[16:19], s82 offen sc1
sm_206:
    s_cmp_eq_u32 s98, 0
    s_cbranch_scc1 sr_207
    s_sub_u32 s82, s98, 1
    s_lshl_b32 s82, s82, 7
    v_mov_b32 v11, 1
    buffer_store_dword v11, v161, s[16:19], s82 offen sc1
    s_mov_b32 s98, 0
sr_207:
    s_waitcnt lgkmcnt(6)
    v_mfma_f32_32x32x16_bf16 v[32:47], a[232:235], v[56:59], v[32:47]
    ds_read_b128 v[48:51], v2 offset:0
    v_mfma_f32_32x32x16_bf16 v[32:47], a[236:239], v[60:63], v[32:47]
    ds_read_b128 v[52:55], v2 offset:512
    buffer_load_dwordx4 v5, s[8:11], s85 offen offset:3072 sc1 lds
    s_waitcnt lgkmcnt(5)
    v_mfma_f32_32x32x16_bf16 v[32:47], a[240:243], v[64:67], v[32:47]
    ds_read_b128 v[56:59], v2 offset:1024
    buffer_load_dwordx2 v[170:171], v158, s[24:27], s55 offen offset:96
    v_mfma_f32_32x32x16_bf16 v[32:47], a[244:247], v[68:71], v[32:47]
    ds_read_b128 v[60:63], v2 offset:1536
    s_waitcnt lgkmcnt(5)
    v_mfma_f32_32x32x16_bf16 v[32:47], a[248:251], v[72:75], v[32:47]
    ds_read_b128 v[64:67], v2 offset:2048
    s_waitcnt lgkmcnt(5)
    v_readfirstlane_b32 s52, v14
    v_mfma_f32_32x32x16_bf16 v[32:47], a[252:255], v[76:79], v[32:47]
    ds_read_b128 v[68:71], v2 offset:2560
    s_add_u32 s39, s39, 1
    s_mov_b32 s14, 0x800000
    s_and_b32 s40, s52, 1
    s_cselect_b32 s10, 0x1000000, 0
    s_branch op_LC0
op_LC1:
    s_waitcnt lgkmcnt(4)
    v_mfma_f32_32x32x16_bf16 v[32:47], a[0:3], v[48:51], 0
    ds_read_b128 v[72:75], v3 offset:3072
    s_add_u32 s3, s42, 1
    s_add_u32 s42, s42, 4
    v_mov_b32 v10, 0
    v_mfma_f32_32x32x16_bf16 v[32:47], a[4:7], v[52:55], v[32:47]
    ds_read_b128 v[76:79], v3 offset:3584
    s_add_u32 s48, s39, 1
    s_mul_i32 s84, s48, 262144
    s_add_u32 s85, s84, 16384
    s_add_i32 s46, s39, -1
    s_lshl_b32 s2, s46, 17
    buffer_store_dwordx4 v[16:19], v6, s[12:15], s2 offen offset:0 sc1
    s_waitcnt lgkmcnt(4)
    v_mfma_f32_32x32x16_bf16 v[32:47], a[8:11], v[56:59], v[32:47]
    ds_read_b128 v[48:51], v3 offset:4096
    s_add_u32 m0, s53, 0
    s_nop 0
    buffer_load_dwordx4 v4, s[8:11], s84 offen offset:0 sc1 lds
    v_mfma_f32_32x32x16_bf16 v[32:47], a[12:15], v[60:63], v[32:47]
    ds_read_b128 v[52:55], v3 offset:4608
    buffer_store_dwordx4 v[20:23], v6, s[12:15], s2 offen offset:512 sc1
    s_waitcnt lgkmcnt(4)
    v_mfma_f32_32x32x16_bf16 v[32:47], a[16:19], v[64:67], v[32:47]
    ds_read_b128 v[56:59], v3 offset:5120
    v_mfma_f32_32x32x16_bf16 v[32:47], a[20:23], v[68:71], v[32:47]
    ds_read_b128 v[60:63], v3 offset:5632
    buffer_store_dwordx4 v[24:27], v6, s[12:15], s2 offen offset:1024 sc1
    buffer_load_dwordx4 v4, s[8:11], s84 offen offset:1024 sc1 lds
    s_waitcnt lgkmcnt(4)
    v_mfma_f32_32x32x16_bf16 v[32:47], a[24:27], v[72:75], v[32:47]
    ds_read_b128 v[64:67], v3 offset:6144
    v_mfma_f32_32x32x16_bf16 v[32:47], a[28:31], v[76:79], v[32:47]
    ds_read_b128 v[68:71], v3 offset:6656
    buffer_store_dwordx4 v[28:31], v6, s[12:15], s2 offen offset:1536 sc1
    s_waitcnt lgkmcnt(4)
    v_mfma_f32_32x32x16_bf16 v[32:47], a[32:35], v[48:51], v[32:47]
    ds_read_b128 v[72:75], v3 offset:7168
    buffer_load_dwordx4 v4, s[8:11], s84 offen offset:2048 sc1 lds
    v_mfma_f32_32x32x16_bf16 v[32:47], a[36:39], v[52:55], v[32:47]
    ds_read_b128 v[76:79], v3 offset:7680
    s_waitcnt lgkmcnt(4)
    v_mfma_f32_32x32x16_bf16 v[32:47], a[40:43], v[56:59], v[32:47]
    ds_read_b128 v[48:51], v3 offset:8192
    v_mfma_f32_32x32x16_bf16 v[32:47], a[44:47], v[60:63], v[32:47]
    ds_read_b128 v[52:55], v3 offset:8704
    buffer_load_dwordx4 v4, s[8:11], s84 offen offset:3072 sc1 lds
    s_waitcnt lgkmcnt(4)
    v_mfma_f32_32x32x16_bf16 v[32:47], a[48:51], v[64:67], v[32:47]
    ds_read_b128 v[56:59], v3 offset:9216
    v_mfma_f32_32x32x16_bf16 v[32:47], a[52:55], v[68:71], v[32:47]
    ds_read_b128 v[60:63], v3 offset:9728
    s_waitcnt lgkmcnt(4)
    v_mfma_f32_32x32x16_bf16 v[32:47], a[56:59], v[72:75], v[32:47]
    ds_read_b128 v[64:67], v3 offset:10240
    s_add_u32 m0, s53, 4096
    s_nop 0
    buffer_load_dwordx4 v5, s[8:11], s84 offen offset:0 sc1 lds
    v_mfma_f32_32x32x16_bf16 v[32:47], a[60:63], v[76:79], v[32:47]
    ds_read_b128 v[68:71], v3 offset:10752
    s_waitcnt lgkmcnt(4)
    v_mfma_f32_32x32x16_bf16 v[32:47], a[64:67], v[48:51], v[32:47]
    ds_read_b128 v[72:75], v3 offset:11264
    v_mfma_f32_32x32x16_bf16 v[32:47], a[68:71], v[52:55], v[32:47]
    ds_read_b128 v[76:79], v3 offset:11776
    s_waitcnt lgkmcnt(4)
    v_mfma_f32_32x32x16_bf16 v[32:47], a[72:75], v[56:59], v[32:47]
    ds_read_b128 v[48:51], v3 offset:12288
    buffer_load_dwordx4 v5, s[8:11], s84 offen offset:1024 sc1 lds
    v_mfma_f32_32x32x16_bf16 v[32:47], a[76:79], v[60:63], v[32:47]
    ds_read_b128 v[52:55], v3 offset:12800
    s_waitcnt lgkmcnt(4)
    v_mfma_f32_32x32x16_bf16 v[32:47], a[80:83], v[64:67], v[32:47]
    ds_read_b128 v[56:59], v3 offset:13312
    v_mfma_f32_32x32x16_bf16 v[32:47], a[84:87], v[68:71], v[32:47]
    ds_read_b128 v[60:63], v3 offset:13824
    buffer_load_dwordx4 v5, s[8:11], s84 offen offset:2048 sc1 lds
    s_waitcnt lgkmcnt(4)
    v_mfma_f32_32x32x16_bf16 v[32:47], a[88:91], v[72:75], v[32:47]
    ds_read_b128 v[64:67], v3 offset:14336
    v_mfma_f32_32x32x16_bf16 v[32:47], a[92:95], v[76:79], v[32:47]
    ds_read_b128 v[68:71], v3 offset:14848
    s_waitcnt lgkmcnt(4)
    v_mfma_f32_32x32x16_bf16 v[32:47], a[96:99], v[48:51], v[32:47]
    ds_read_b128 v[72:75], v3 offset:15360
    buffer_load_dwordx4 v5, s[8:11], s84 offen offset:3072 sc1 lds
    v_mfma_f32_32x32x16_bf16 v[32:47], a[100:103], v[52:55], v[32:47]
    ds_read_b128 v[76:79], v3 offset:15872
    s_waitcnt vmcnt(12)
    s_barrier
    s_waitcnt lgkmcnt(4)
    v_mfma_f32_32x32x16_bf16 v[32:47], a[104:107], v[56:59], v[32:47]
    ds_read_b128 v[48:51], v3 offset:16384
    v_pk_add_f32 v[172:173], v[172:173], v[188:189]
    v_pk_add_f32 v[174:175], v[174:175], v[190:191]
    v_pk_add_f32 v[176:177], v[176:177], v[192:193]
    v_pk_add_f32 v[178:179], v[178:179], v[194:195]
    v_pk_add_f32 v[180:181], v[180:181], v[196:197]
    v_mfma_f32_32x32x16_bf16 v[32:47], a[108:111], v[60:63], v[32:47]
    ds_read_b128 v[52:55], v3 offset:16896
    v_pk_add_f32 v[182:183], v[182:183], v[198:199]
    v_pk_add_f32 v[184:185], v[184:185], v[200:201]
    v_pk_add_f32 v[186:187], v[186:187], v[202:203]
    v_pk_add_f32 v[204:205], v[204:205], v[220:221]
    s_waitcnt lgkmcnt(4)
    v_mfma_f32_32x32x16_bf16 v[32:47], a[112:115], v[64:67], v[32:47]
    ds_read_b128 v[56:59], v3 offset:17408
    v_pk_add_f32 v[206:207], v[206:207], v[222:223]
    v_pk_add_f32 v[208:209], v[208:209], v[224:225]
    v_pk_add_f32 v[210:211], v[210:211], v[226:227]
    v_pk_add_f32 v[212:213], v[212:213], v[228:229]
    v_mfma_f32_32x32x16_bf16 v[32:47], a[116:119], v[68:71], v[32:47]
    ds_read_b128 v[60:63], v3 offset:17920
    v_pk_add_f32 v[214:215], v[214:215], v[230:231]
    v_pk_add_f32 v[216:217], v[216:217], v[232:233]
    v_pk_add_f32 v[218:219], v[218:219], v[234:235]
    v_lshlrev_b32 v188, 16, v164
    v_and_b32 v189, s101, v164
    s_waitcnt lgkmcnt(4)
    v_mfma_f32_32x32x16_bf16 v[32:47], a[120:123], v[72:75], v[32:47]
    ds_read_b128 v[64:67], v3 offset:18432
    v_lshlrev_b32 v190, 16, v165
    v_and_b32 v191, s101, v165
    v_lshlrev_b32 v192, 16, v166
    v_and_b32 v193, s101, v166
    v_mfma_f32_32x32x16_bf16 v[32:47], a[124:127], v[76:79], v[32:47]
    ds_read_b128 v[68:71], v3 offset:18944
    v_lshlrev_b32 v194, 16, v167
    v_and_b32 v195, s101, v167
    v_lshlrev_b32 v196, 16, v168
    v_and_b32 v197, s101, v168
    s_waitcnt lgkmcnt(4)
    v_mfma_f32_32x32x16_bf16 v[32:47], a[128:131], v[48:51], v[32:47]
    ds_read_b128 v[72:75], v3 offset:19456
    s_add_u32 m0, s53, 16384
    s_nop 0
    buffer_load_dwordx4 v4, s[8:11], s85 offen offset:0 sc1 lds
    v_lshlrev_b32 v198, 16, v169
    v_and_b32 v199, s101, v169
    v_lshlrev_b32 v200, 16, v170
    v_and_b32 v201, s101, v170
    v_mfma_f32_32x32x16_bf16 v[32:47], a[132:135], v[52:55], v[32:47]
    ds_read_b128 v[76:79], v3 offset:19968
    v_lshlrev_b32 v202, 16, v171
    v_and_b32 v203, s101, v171
    v_pk_add_f32 v[172:173], v[172:173], v[204:205]
    v_pk_add_f32 v[174:175], v[174:175], v[206:207]
    v_pk_add_f32 v[176:177], v[176:177], v[208:209]
    s_waitcnt lgkmcnt(4)
    v_mfma_f32_32x32x16_bf16 v[32:47], a[136:139], v[56:59], v[32:47]
    ds_read_b128 v[48:51], v3 offset:20480
    v_pk_add_f32 v[178:179], v[178:179], v[210:211]
    v_pk_add_f32 v[180:181], v[180:181], v[212:213]
    v_pk_add_f32 v[182:183], v[182:183], v[214:215]
    v_pk_add_f32 v[184:185], v[184:185], v[216:217]
    v_mfma_f32_32x32x16_bf16 v[32:47], a[140:143], v[60:63], v[32:47]
    ds_read_b128 v[52:55], v3 offset:20992
    buffer_load_dwordx4 v4, s[8:11], s85 offen offset:1024 sc1 lds
    v_pk_add_f32 v[186:187], v[186:187], v[218:219]
    v_pk_add_f32 v[172:173], v[172:173], v[188:189]
    v_pk_add_f32 v[174:175], v[174:175], v[190:191]
    v_pk_add_f32 v[176:177], v[176:177], v[192:193]
    s_waitcnt lgkmcnt(4)
    v_mfma_f32_32x32x16_bf16 v[32:47], a[144:147], v[64:67], v[32:47]
    ds_read_b128 v[56:59], v3 offset:21504
    s_cmp_ge_u32 s42, s39
    s_cbranch_scc1 pr_208
    s_lshl_b32 s6, s42, 7
    buffer_load_dword v10, v9, s[16:19], s6 offen sc1
pr_208:
    s_add_u32 s6, s39, 2
    s_lshl_b32 s6, s6, 9
    buffer_load_dword v8, v7, s[16:19], s6 offen sc1
    v_pk_add_f32 v[178:179], v[178:179], v[194:195]
    v_pk_add_f32 v[180:181], v[180:181], v[196:197]
    v_pk_add_f32 v[182:183], v[182:183], v[198:199]
    v_pk_add_f32 v[184:185], v[184:185], v[200:201]
    v_pk_add_f32 v[186:187], v[186:187], v[202:203]
    v_mfma_f32_32x32x16_bf16 v[32:47], a[148:151], v[68:71], v[32:47]
    ds_read_b128 v[60:63], v3 offset:22016
    v_cvt_pk_bf16_f32 v204, v172, v173
    v_cvt_pk_bf16_f32 v205, v174, v175
    v_cvt_pk_bf16_f32 v206, v176, v177
    v_cvt_pk_bf16_f32 v207, v178, v179
    s_waitcnt lgkmcnt(4)
    v_mfma_f32_32x32x16_bf16 v[32:47], a[152:155], v[72:75], v[32:47]
    ds_read_b128 v[64:67], v3 offset:22528
    v_cvt_pk_bf16_f32 v208, v180, v181
    v_cvt_pk_bf16_f32 v209, v182, v183
    v_cvt_pk_bf16_f32 v210, v184, v185
    v_cvt_pk_bf16_f32 v211, v186, v187
    v_mfma_f32_32x32x16_bf16 v[32:47], a[156:159], v[76:79], v[32:47]
    ds_read_b128 v[68:71], v3 offset:23040
    buffer_load_dwordx4 v4, s[8:11], s85 offen offset:2048 sc1 lds
    buffer_store_dwordx4 v[204:207], v159, s[28:31], s55 offen offset:0 sc1
    buffer_store_dwordx4 v[208:211], v159, s[28:31], s55 offen offset:1024 sc1
    v_lshlrev_b32 v172, 16, v204
    v_and_b32 v173, s101, v204
    s_waitcnt lgkmcnt(4)
    v_mfma_f32_32x32x16_bf16 v[32:47], a[160:163], v[48:51], v[32:47]
    ds_read_b128 v[72:75], v3 offset:23552
    v_lshlrev_b32 v174, 16, v205
    v_and_b32 v175, s101, v205
    v_lshlrev_b32 v176, 16, v206
    v_and_b32 v177, s101, v206
    v_lshlrev_b32 v178, 16, v207
    v_mfma_f32_32x32x16_bf16 v[32:47], a[164:167], v[52:55], v[32:47]
    ds_read_b128 v[76:79], v3 offset:24064
    v_and_b32 v179, s101, v207
    v_lshlrev_b32 v180, 16, v208
    v_and_b32 v181, s101, v208
    v_lshlrev_b32 v182, 16, v209
    s_waitcnt lgkmcnt(4)
    v_mfma_f32_32x32x16_bf16 v[32:47], a[168:171], v[56:59], v[32:47]
    ds_read_b128 v[48:51], v3 offset:24576
    v_and_b32 v183, s101, v209
    v_lshlrev_b32 v184, 16, v210
    v_and_b32 v185, s101, v210
    v_lshlrev_b32 v186, 16, v211
    v_mfma_f32_32x32x16_bf16 v[32:47], a[172:175], v[60:63], v[32:47]
    ds_read_b128 v[52:55], v3 offset:25088
    buffer_load_dwordx4 v4, s[8:11], s85 offen offset:3072 sc1 lds
    v_and_b32 v187, s101, v211
    v_add_f32 v220, v172, v176
    v_add_f32 v221, v173, v177
    v_add_f32 v222, v174, v178
    v_add_f32 v223, v175, v179
    s_waitcnt lgkmcnt(4)
    v_mfma_f32_32x32x16_bf16 v[32:47], a[176:179], v[64:67], v[32:47]
    ds_read_b128 v[56:59], v3 offset:25600
    v_add_f32 v224, v180, v184
    v_add_f32 v225, v181, v185
    v_add_f32 v226, v182, v186
    v_add_f32 v227, v183, v187
    v_mfma_f32_32x32x16_bf16 v[32:47], a[180:183], v[68:71], v[32:47]
    ds_read_b128 v[60:63], v3 offset:26112
    v_add_f32 v220, v220, v224
    v_add_f32 v221, v221, v225
    v_add_f32 v222, v222, v226
    v_add_f32 v223, v223, v227
    s_waitcnt lgkmcnt(4)
    v_mfma_f32_32x32x16_bf16 v[32:47], a[184:187], v[72:75], v[32:47]
    ds_read_b128 v[64:67], v3 offset:26624
    v_add_f32 v220, v220, v221
    v_add_f32 v222, v222, v223
    v_add_f32 v220, v220, v222
    v_mov_b32 v221, v220
    v_mfma_f32_32x32x16_bf16 v[32:47], a[188:191], v[76:79], v[32:47]
    ds_read_b128 v[68:71], v3 offset:27136
    s_add_u32 m0, s53, 20480
    s_nop 0
    buffer_load_dwordx4 v5, s[8:11], s85 offen offset:0 sc1 lds
    v_permlane32_swap_b32 v220, v221
    v_add_f32 v220, v220, v221
    v_mov_b32 v221, v220
    s_nop 1
    v_permlane16_swap_b32 v220, v221
    v_add_f32 v220, v220, v221
    s_waitcnt lgkmcnt(4)
    v_mfma_f32_32x32x16_bf16 v[32:47], a[192:195], v[48:51], v[32:47]
    ds_read_b128 v[72:75], v3 offset:27648
    v_mul_f32 v164, 0x3c800000, v220
    v_sub_f32 v172, v172, v164
    v_sub_f32 v173, v173, v164
    v_sub_f32 v174, v174, v164
    v_mfma_f32_32x32x16_bf16 v[32:47], a[196:199], v[52:55], v[32:47]
    ds_read_b128 v[76:79], v3 offset:28160
    v_sub_f32 v175, v175, v164
    v_sub_f32 v176, v176, v164
    v_sub_f32 v177, v177, v164
    v_sub_f32 v178, v178, v164
    s_waitcnt vmcnt(5)
    v_xor_b32 v162, 4, v162
    v_xor_b32 v163, 4, v163
    s_waitcnt lgkmcnt(4)
    v_mfma_f32_32x32x16_bf16 v[32:47], a[200:203], v[56:59], v[32:47]
    ds_read_b128 v[48:51], v3 offset:28672
    v_sub_f32 v179, v179, v164
    v_sub_f32 v180, v180, v164
    v_sub_f32 v181, v181, v164
    v_sub_f32 v182, v182, v164
    v_sub_f32 v183, v183, v164
    s_add_u32 s7, s39, 2
    s_cmp_lt_u32 s7, 64
    s_cselect_b32 s6, 1, 0
    v_cmp_eq_u32 vcc, 0, v8
    v_mfma_f32_32x32x16_bf16 v[32:47], a[204:207], v[60:63], v[32:47]
    ds_read_b128 v[52:55], v3 offset:29184
    buffer_load_dwordx4 v5, s[8:11], s85 offen offset:1024 sc1 lds
    v_sub_f32 v184, v184, v164
    v_sub_f32 v185, v185, v164
    v_sub_f32 v186, v186, v164
    v_sub_f32 v187, v187, v164
    s_cmp_eq_u64 vcc, 0
    s_cselect_b32 s6, s6, 0
    v_cmp_eq_u32 vcc, 0, v10
    s_waitcnt lgkmcnt(4)
    v_mfma_f32_32x32x16_bf16 v[32:47], a[208:211], v[64:67], v[32:47]
    ds_read_b128 v[56:59], v3 offset:29696
    v_mul_f32 v172, v172, v172
    v_mul_f32 v173, v173, v173
    v_mul_f32 v174, v174, v174
    v_mul_f32 v175, v175, v175
    s_cmp_eq_u64 vcc, 0
    s_cselect_b32 s7, 2, 0
    s_cmp_lt_u32 s42, 64
    s_cselect_b32 s7, s7, 0
    s_or_b32 s6, s6, s7
    v_mfma_f32_32x32x16_bf16 v[32:47], a[212:215], v[68:71], v[32:47]
    ds_read_b128 v[60:63], v3 offset:30208
    v_mul_f32 v176, v176, v176
    v_mul_f32 v177, v177, v177
    v_mul_f32 v178, v178, v178
    v_mul_f32 v179, v179, v179
    v_mov_b32 v13, s6
    s_waitcnt lgkmcnt(4)
    v_mfma_f32_32x32x16_bf16 v[32:47], a[216:219], v[72:75], v[32:47]
    ds_read_b128 v[64:67], v3 offset:30720
    v_mul_f32 v180, v180, v180
    v_mul_f32 v181, v181, v181
    v_mul_f32 v182, v182, v182
    v_mul_f32 v183, v183, v183
    v_mul_f32 v184, v184, v184
    s_mov_b64 exec, 1
    ds_write_b32 v163, v13
    s_mov_b64 exec, -1
    v_mfma_f32_32x32x16_bf16 v[32:47], a[220:223], v[76:79], v[32:47]
    ds_read_b128 v[68:71], v3 offset:31232
    buffer_load_dwordx4 v5, s[8:11], s85 offen offset:2048 sc1 lds
    v_mul_f32 v185, v185, v185
    v_mul_f32 v186, v186, v186
    v_mul_f32 v187, v187, v187
    v_add_f32 v220, v172, v176
    s_waitcnt lgkmcnt(5)
    v_mfma_f32_32x32x16_bf16 v[32:47], a[224:227], v[48:51], v[32:47]
    ds_read_b128 v[72:75], v3 offset:31744
    v_add_f32 v221, v173, v177
    v_add_f32 v222, v174, v178
    v_add_f32 v223, v175, v179
    v_add_f32 v224, v180, v184
    v_mfma_f32_32x32x16_bf16 v[32:47], a[228:231], v[52:55], v[32:47]
    ds_read_b128 v[76:79], v3 offset:32256
    v_add_f32 v225, v181, v185
    v_add_f32 v226, v182, v186
    v_add_f32 v227, v183, v187
    v_add_f32 v220, v220, v224
    v_add_f32 v221, v221, v225
    s_waitcnt vmcnt(10)
    s_waitcnt lgkmcnt(3)
    s_barrier
    ds_read_b32 v14, v162
    s_cmp_le_u32 s39, s41
    s_cbranch_scc1 sm_209
    s_mov_b32 s41, s39
    s_sub_u32 s82, s39, 1
    s_lshl_b32 s82, s82, 7
    v_mov_b32 v11, 1
    buffer_store_dword v11, v12, s[16:19], s82 offen sc1
sm_209:
    s_cmp_eq_u32 s98, 0
    s_cbranch_scc1 sr_210
    s_sub_u32 s82, s98, 1
    s_lshl_b32 s82, s82, 7
    v_mov_b32 v11, 1
    buffer_store_dword v11, v161, s[16:19], s82 offen sc1
    s_mov_b32 s98, 0
sr_210:
    s_waitcnt lgkmcnt(6)
    v_mfma_f32_32x32x16_bf16 v[32:47], a[232:235], v[56:59], v[32:47]
    ds_read_b128 v[48:51], v2 offset:0
    v_add_f32 v222, v222, v226
    v_add_f32 v223, v223, v227
    v_add_f32 v220, v220, v221
    v_add_f32 v222, v222, v223
    v_mfma_f32_32x32x16_bf16 v[32:47], a[236:239], v[60:63], v[32:47]
    ds_read_b128 v[52:55], v2 offset:512
    buffer_load_dwordx4 v5, s[8:11], s85 offen offset:3072 sc1 lds
    v_add_f32 v220, v220, v222
    v_mov_b32 v221, v220
    s_nop 1
    v_permlane32_swap_b32 v220, v221
    v_add_f32 v220, v220, v221
    s_waitcnt lgkmcnt(5)
    v_mfma_f32_32x32x16_bf16 v[32:47], a[240:243], v[64:67], v[32:47]
    ds_read_b128 v[56:59], v2 offset:1024
    v_mov_b32 v221, v220
    s_nop 1
    v_permlane16_swap_b32 v220, v221
    v_add_f32 v220, v220, v221
    v_mov_b32 v165, v220
    v_mfma_f32_32x32x16_bf16 v[32:47], a[244:247], v[68:71], v[32:47]
    ds_read_b128 v[60:63], v2 offset:1536
    s_waitcnt lgkmcnt(5)
    v_mfma_f32_32x32x16_bf16 v[32:47], a[248:251], v[72:75], v[32:47]
    ds_read_b128 v[64:67], v2 offset:2048
    s_lshl_b32 s47, s100, 11
    buffer_store_dwordx2 v[164:165], v160, s[32:35], s47 offen sc1
    s_waitcnt lgkmcnt(5)
    v_readfirstlane_b32 s52, v14
    v_mfma_f32_32x32x16_bf16 v[32:47], a[252:255], v[76:79], v[32:47]
    ds_read_b128 v[68:71], v2 offset:2560
    s_mov_b32 s98, s3
    s_cmp_eq_u32 s40, 0
    s_cbranch_scc1 op_end1
    s_add_u32 s39, s39, 1
    s_mov_b32 s14, 0x800000
    s_and_b32 s40, s52, 1
    s_cselect_b32 s10, 0x1000000, 0
    s_cmp_eq_u32 s52, 3
    s_cbranch_scc1 op_LR0
    s_branch op_LP0
op_fin:
    s_cmp_ge_u32 s42, 64
    s_cbranch_scc1 op_exit
    s_cmp_ge_u32 s42, s39
    s_cbranch_scc1 pr_211
    s_lshl_b32 s6, s42, 7
    buffer_load_dword v10, v9, s[16:19], s6 offen sc1
pr_211:
    s_waitcnt vmcnt(0)
    v_xor_b32 v162, 4, v162
    v_xor_b32 v163, 4, v163
    s_add_u32 s7, s39, 0
    s_cmp_lt_u32 s7, 64
    s_cselect_b32 s6, 1, 0
    v_cmp_eq_u32 vcc, 0, v8
    s_nop 3
    s_cmp_eq_u64 vcc, 0
    s_cselect_b32 s6, s6, 0
    v_cmp_eq_u32 vcc, 0, v10
    s_nop 3
    s_cmp_eq_u64 vcc, 0
    s_cselect_b32 s7, 2, 0
    s_cmp_lt_u32 s42, 64
    s_cselect_b32 s7, s7, 0
    s_or_b32 s6, s6, s7
    v_mov_b32 v13, s6
    s_mov_b64 exec, 1
    ds_write_b32 v163, v13
    s_mov_b64 exec, -1
    s_waitcnt lgkmcnt(0)
    s_barrier
    ds_read_b32 v14, v162
    s_cmp_eq_u32 s98, 0
    s_cbranch_scc1 sr_212
    s_sub_u32 s82, s98, 1
    s_lshl_b32 s82, s82, 7
    v_mov_b32 v11, 1
    buffer_store_dword v11, v161, s[16:19], s82 offen sc1
    s_mov_b32 s98, 0
sr_212:
    s_waitcnt lgkmcnt(0)
    v_readfirstlane_b32 s52, v14
    s_mov_b32 s45, 2
    s_nop 2
    s_bitcmp1_b32 s52, 1
    s_cbranch_scc1 op_red
    s_sub_u32 s43, s43, 1
    s_cbranch_scc1 op_fin_err
    s_cmp_lg_u32 s36, 0
    s_cbranch_scc1 w0_213
    s_sleep 2
w0_213:
    s_branch op_fin
op_fin_err:
    s_mov_b32 s44, 21
    s_branch ssp_err
op_exit:
    s_waitcnt vmcnt(0)
    s_barrier
    s_cmp_eq_u32 s98, 0
    s_cbranch_scc1 sr_214
    s_sub_u32 s82, s98, 1
    s_lshl_b32 s82, s82, 7
    v_mov_b32 v11, 1
    buffer_store_dword v11, v161, s[16:19], s82 offen sc1
    s_mov_b32 s98, 0
sr_214:
    s_branch ssp_end
op_red:
    s_lshl_b32 s100, s42, 1
    s_lshr_b32 s47, s38, 2
    s_add_u32 s100, s100, s47
    s_lshl_b32 s86, s100, 16
    s_lshl_b32 s55, s100, 15
    s_add_u32 s87, s86, 0x800000
    s_add_u32 s88, s87, 0x800000
    s_add_u32 s89, s88, 0x800000
    buffer_load_dwordx4 v[172:175], v157, s[20:23], s86 offen offset:0 sc1
    buffer_load_dwordx4 v[176:179], v157, s[20:23], s86 offen offset:1024 sc1
    buffer_load_dwordx4 v[180:183], v157, s[20:23], s86 offen offset:2048 sc1
    buffer_load_dwordx4 v[184:187], v157, s[20:23], s86 offen offset:3072 sc1
    buffer_load_dwordx4 v[188:191], v157, s[20:23], s87 offen offset:0 sc1
    buffer_load_dwordx4 v[192:195], v157, s[20:23], s87 offen offset:1024 sc1
    buffer_load_dwordx4 v[196:199], v157, s[20:23], s87 offen offset:2048 sc1
    buffer_load_dwordx4 v[200:203], v157, s[20:23], s87 offen offset:3072 sc1
    buffer_load_dwordx4 v[204:207], v157, s[20:23], s88 offen offset:0 sc1
    buffer_load_dwordx4 v[208:211], v157, s[20:23], s88 offen offset:1024 sc1
    buffer_load_dwordx4 v[212:215], v157, s[20:23], s88 offen offset:2048 sc1
    buffer_load_dwordx4 v[216:219], v157, s[20:23], s88 offen offset:3072 sc1
    buffer_load_dwordx4 v[220:223], v157, s[20:23], s89 offen offset:0 sc1
    buffer_load_dwordx4 v[224:227], v157, s[20:23], s89 offen offset:1024 sc1
    buffer_load_dwordx4 v[228:231], v157, s[20:23], s89 offen offset:2048 sc1
    buffer_load_dwordx4 v[232:235], v157, s[20:23], s89 offen offset:3072 sc1
    buffer_load_dwordx2 v[164:165], v158, s[24:27], s55 offen offset:0
    buffer_load_dwordx2 v[166:167], v158, s[24:27], s55 offen offset:32
    buffer_load_dwordx2 v[168:169], v158, s[24:27], s55 offen offset:64
    buffer_load_dwordx2 v[170:171], v158, s[24:27], s55 offen offset:96
    s_add_u32 s3, s42, 1
    s_add_u32 s42, s42, 4
    v_mov_b32 v10, 0
    s_waitcnt vmcnt(0)
    v_pk_add_f32 v[172:173], v[172:173], v[188:189]
    v_pk_add_f32 v[174:175], v[174:175], v[190:191]
    v_pk_add_f32 v[176:177], v[176:177], v[192:193]
    v_pk_add_f32 v[178:179], v[178:179], v[194:195]
    v_pk_add_f32 v[180:181], v[180:181], v[196:197]
    v_pk_add_f32 v[182:183], v[182:183], v[198:199]
    v_pk_add_f32 v[184:185], v[184:185], v[200:201]
    v_pk_add_f32 v[186:187], v[186:187], v[202:203]
    v_pk_add_f32 v[204:205], v[204:205], v[220:221]
    v_pk_add_f32 v[206:207], v[206:207], v[222:223]
    v_pk_add_f32 v[208:209], v[208:209], v[224:225]
    v_pk_add_f32 v[210:211], v[210:211], v[226:227]
    v_pk_add_f32 v[212:213], v[212:213], v[228:229]
    v_pk_add_f32 v[214:215], v[214:215], v[230:231]
    v_pk_add_f32 v[216:217], v[216:217], v[232:233]
    v_pk_add_f32 v[218:219], v[218:219], v[234:235]
    v_lshlrev_b32 v188, 16, v164
    v_and_b32 v189, s101, v164
    v_lshlrev_b32 v190, 16, v165
    v_and_b32 v191, s101, v165
    v_lshlrev_b32 v192, 16, v166
    v_and_b32 v193, s101, v166
    v_lshlrev_b32 v194, 16, v167
    v_and_b32 v195, s101, v167
    v_lshlrev_b32 v196, 16, v168
    v_and_b32 v197, s101, v168
    v_lshlrev_b32 v198, 16, v169
    v_and_b32 v199, s101, v169
    v_lshlrev_b32 v200, 16, v170
    v_and_b32 v201, s101, v170
    v_lshlrev_b32 v202, 16, v171
    v_and_b32 v203, s101, v171
    v_pk_add_f32 v[172:173], v[172:173], v[204:205]
    v_pk_add_f32 v[174:175], v[174:175], v[206:207]
    v_pk_add_f32 v[176:177], v[176:177], v[208:209]
    v_pk_add_f32 v[178:179], v[178:179], v[210:211]
    v_pk_add_f32 v[180:181], v[180:181], v[212:213]
    v_pk_add_f32 v[182:183], v[182:183], v[214:215]
    v_pk_add_f32 v[184:185], v[184:185], v[216:217]
    v_pk_add_f32 v[186:187], v[186:187], v[218:219]
    v_pk_add_f32 v[172:173], v[172:173], v[188:189]
    v_pk_add_f32 v[174:175], v[174:175], v[190:191]
    v_pk_add_f32 v[176:177], v[176:177], v[192:193]
    v_pk_add_f32 v[178:179], v[178:179], v[194:195]
    v_pk_add_f32 v[180:181], v[180:181], v[196:197]
    v_pk_add_f32 v[182:183], v[182:183], v[198:199]
    v_pk_add_f32 v[184:185], v[184:185], v[200:201]
    v_pk_add_f32 v[186:187], v[186:187], v[202:203]
    v_cvt_pk_bf16_f32 v204, v172, v173
    v_cvt_pk_bf16_f32 v205, v174, v175
    v_cvt_pk_bf16_f32 v206, v176, v177
    v_cvt_pk_bf16_f32 v207, v178, v179
    v_cvt_pk_bf16_f32 v208, v180, v181
    v_cvt_pk_bf16_f32 v209, v182, v183
    v_cvt_pk_bf16_f32 v210, v184, v185
    v_cvt_pk_bf16_f32 v211, v186, v187
    buffer_store_dwordx4 v[204:207], v159, s[28:31], s55 offen offset:0 sc1
    buffer_store_dwordx4 v[208:211], v159, s[28:31], s55 offen offset:1024 sc1
    v_lshlrev_b32 v172, 16, v204
    v_and_b32 v173, s101, v204
    v_lshlrev_b32 v174, 16, v205
    v_and_b32 v175, s101, v205
    v_lshlrev_b32 v176, 16, v206
    v_and_b32 v177, s101, v206
    v_lshlrev_b32 v178, 16, v207
    v_and_b32 v179, s101, v207
    v_lshlrev_b32 v180, 16, v208
    v_and_b32 v181, s101, v208
    v_lshlrev_b32 v182, 16, v209
    v_and_b32 v183, s101, v209
    v_lshlrev_b32 v184, 16, v210
    v_and_b32 v185, s101, v210
    v_lshlrev_b32 v186, 16, v211
    v_and_b32 v187, s101, v211
    v_add_f32 v220, v172, v176
    v_add_f32 v221, v173, v177
    v_add_f32 v222, v174, v178
    v_add_f32 v223, v175, v179
    v_add_f32 v224, v180, v184
    v_add_f32 v225, v181, v185
    v_add_f32 v226, v182, v186
    v_add_f32 v227, v183, v187
    v_add_f32 v220, v220, v224
    v_add_f32 v221, v221, v225
    v_add_f32 v222, v222, v226
    v_add_f32 v223, v223, v227
    v_add_f32 v220, v220, v221
    v_add_f32 v222, v222, v223
    v_add_f32 v220, v220, v222
    v_mov_b32 v221, v220
    s_nop 1
    v_permlane32_swap_b32 v220, v221
    v_add_f32 v220, v220, v221
    v_mov_b32 v221, v220
    s_nop 1
    v_permlane16_swap_b32 v220, v221
    v_add_f32 v220, v220, v221
    v_mul_f32 v164, 0x3c800000, v220
    v_sub_f32 v172, v172, v164
    v_sub_f32 v173, v173, v164
    v_sub_f32 v174, v174, v164
    v_sub_f32 v175, v175, v164
    v_sub_f32 v176, v176, v164
    v_sub_f32 v177, v177, v164
    v_sub_f32 v178, v178, v164
    v_sub_f32 v179, v179, v164
    v_sub_f32 v180, v180, v164
    v_sub_f32 v181, v181, v164
    v_sub_f32 v182, v182, v164
    v_sub_f32 v183, v183, v164
    v_sub_f32 v184, v184, v164
    v_sub_f32 v185, v185, v164
    v_sub_f32 v186, v186, v164
    v_sub_f32 v187, v187, v164
    v_mul_f32 v172, v172, v172
    v_mul_f32 v173, v173, v173
    v_mul_f32 v174, v174, v174
    v_mul_f32 v175, v175, v175
    v_mul_f32 v176, v176, v176
    v_mul_f32 v177, v177, v177
    v_mul_f32 v178, v178, v178
    v_mul_f32 v179, v179, v179
    v_mul_f32 v180, v180, v180
    v_mul_f32 v181, v181, v181
    v_mul_f32 v182, v182, v182
    v_mul_f32 v183, v183, v183
    v_mul_f32 v184, v184, v184
    v_mul_f32 v185, v185, v185
    v_mul_f32 v186, v186, v186
    v_mul_f32 v187, v187, v187
    v_add_f32 v220, v172, v176
    v_add_f32 v221, v173, v177
    v_add_f32 v222, v174, v178
    v_add_f32 v223, v175, v179
    v_add_f32 v224, v180, v184
    v_add_f32 v225, v181, v185
    v_add_f32 v226, v182, v186
    v_add_f32 v227, v183, v187
    v_add_f32 v220, v220, v224
    v_add_f32 v221, v221, v225
    v_add_f32 v222, v222, v226
    v_add_f32 v223, v223, v227
    v_add_f32 v220, v220, v221
    v_add_f32 v222, v222, v223
    v_add_f32 v220, v220, v222
    v_mov_b32 v221, v220
    s_nop 1
    v_permlane32_swap_b32 v220, v221
    v_add_f32 v220, v220, v221
    v_mov_b32 v221, v220
    s_nop 1
    v_permlane16_swap_b32 v220, v221
    v_add_f32 v220, v220, v221
    v_mov_b32 v165, v220
    s_lshl_b32 s47, s100, 11
    buffer_store_dwordx2 v[164:165], v160, s[32:35], s47 offen sc1
    s_mov_b32 s98, s3
    s_cmp_eq_u32 s45, 0
    s_cbranch_scc1 op_blk0
    s_cmp_eq_u32 s45, 1
    s_cbranch_scc1 op_blk1
    s_branch op_fin
role_f2:
    s_lshl_b32 s50, s38, 8
    s_mul_i32 s51, s37, 1835008
    s_load_dwordx2 s[6:7], s[0:1], 80
    s_waitcnt lgkmcnt(0)
    s_mov_b32 s20, s6
    s_mov_b32 s21, s7
    s_mov_b32 s22, 0x700000
    s_mov_b32 s23, 0x20000
    v_lshrrev_b32 v132, 4, v1
    v_lshlrev_b32 v133, 11, v132
    v_and_b32 v134, 15, v1
    v_lshlrev_b32 v135, 1, v132
    v_xor_b32 v135, v135, v134
    v_lshl_add_u32 v136, v135, 4, v133
    v_lshlrev_b32 v135, 1, v132
    v_add_u32 v135, 8, v135
    v_xor_b32 v135, v135, v134
    v_lshl_add_u32 v137, v135, 4, v133
    v_bfe_u32 v133, v1, 2, 2
    v_lshrrev_b32 v134, 5, v1
    v_lshl_add_u32 v132, v134, 3, v133
    v_add_u32 v134, 4, v133
    v_lshlrev_b32 v132, 8, v132
    v_and_b32 v135, 3, v1
    v_lshl_add_u32 v132, v135, 3, v132
    s_lshl_b32 s46, s36, 1
    v_bfe_u32 v138, v1, 4, 1
    v_add_u32 v138, s46, v138
    v_xor_b32 v135, v138, v133
    v_lshl_add_u32 v140, v135, 5, v132
    v_add_u32 v142, 0x10000, v140
    v_xor_b32 v135, v138, v134
    v_lshl_add_u32 v141, v135, 5, v132
    v_add_u32 v143, 0x10000, v141
    s_mul_i32 s46, s36, 229376
    s_add_u32 s46, s46, s51
    s_add_u32 s46, s46, s50
    s_mul_i32 s47, s36, 28672
    s_mov_b32 m0, s47
    s_nop 0
    buffer_load_dwordx4 v136, s[20:23], s46 offen lds
    s_add_u32 s46, s46, 8192
    s_add_u32 m0, m0, 1024
    s_nop 0
    buffer_load_dwordx4 v137, s[20:23], s46 offen lds
    s_add_u32 s46, s46, 8192
    s_add_u32 m0, m0, 1024
    s_nop 0
    buffer_load_dwordx4 v136, s[20:23], s46 offen lds
    s_add_u32 s46, s46, 8192
    s_add_u32 m0, m0, 1024
    s_nop 0
    buffer_load_dwordx4 v137, s[20:23], s46 offen lds
    s_add_u32 s46, s46, 8192
    s_add_u32 m0, m0, 1024
    s_nop 0
    buffer_load_dwordx4 v136, s[20:23], s46 offen lds
    s_add_u32 s46, s46, 8192
    s_add_u32 m0, m0, 1024
    s_nop 0
    buffer_load_dwordx4 v137, s[20:23], s46 offen lds
    s_add_u32 s46, s46, 8192
    s_add_u32 m0, m0, 1024
    s_nop 0
    buffer_load_dwordx4 v136, s[20:23], s46 offen lds
    s_add_u32 s46, s46, 8192
    s_add_u32 m0, m0, 1024
    s_nop 0
    buffer_load_dwordx4 v137, s[20:23], s46 offen lds
    s_add_u32 s46, s46, 8192
    s_add_u32 m0, m0, 1024
    s_nop 0
    buffer_load_dwordx4 v136, s[20:23], s46 offen lds
    s_add_u32 s46, s46, 8192
    s_add_u32 m0, m0, 1024
    s_nop 0
    buffer_load_dwordx4 v137, s[20:23], s46 offen lds
    s_add_u32 s46, s46, 8192
    s_add_u32 m0, m0, 1024
    s_nop 0
    buffer_load_dwordx4 v136, s[20:23], s46 offen lds
    s_add_u32 s46, s46, 8192
    s_add_u32 m0, m0, 1024
    s_nop 0
    buffer_load_dwordx4 v137, s[20:23], s46 offen lds
    s_add_u32 s46, s46, 8192
    s_add_u32 m0, m0, 1024
    s_nop 0
    buffer_load_dwordx4 v136, s[20:23], s46 offen lds
    s_add_u32 s46, s46, 8192
    s_add_u32 m0, m0, 1024
    s_nop 0
    buffer_load_dwordx4 v137, s[20:23], s46 offen lds
    s_add_u32 s46, s46, 8192
    s_add_u32 m0, m0, 1024
    s_nop 0
    buffer_load_dwordx4 v136, s[20:23], s46 offen lds
    s_add_u32 s46, s46, 8192
    s_add_u32 m0, m0, 1024
    s_nop 0
    buffer_load_dwordx4 v137, s[20:23], s46 offen lds
    s_add_u32 s46, s46, 8192
    s_add_u32 m0, m0, 1024
    s_nop 0
    buffer_load_dwordx4 v136, s[20:23], s46 offen lds
    s_add_u32 s46, s46, 8192
    s_add_u32 m0, m0, 1024
    s_nop 0
    buffer_load_dwordx4 v137, s[20:23], s46 offen lds
    s_add_u32 s46, s46, 8192
    s_add_u32 m0, m0, 1024
    s_nop 0
    buffer_load_dwordx4 v136, s[20:23], s46 offen lds
    s_add_u32 s46, s46, 8192
    s_add_u32 m0, m0, 1024
    s_nop 0
    buffer_load_dwordx4 v137, s[20:23], s46 offen lds
    s_add_u32 s46, s46, 8192
    s_add_u32 m0, m0, 1024
    s_nop 0
    buffer_load_dwordx4 v136, s[20:23], s46 offen lds
    s_add_u32 s46, s46, 8192
    s_add_u32 m0, m0, 1024
    s_nop 0
    buffer_load_dwordx4 v137, s[20:23], s46 offen lds
    s_add_u32 s46, s46, 8192
    s_add_u32 m0, m0, 1024
    s_nop 0
    buffer_load_dwordx4 v136, s[20:23], s46 offen lds
    s_add_u32 s46, s46, 8192
    s_add_u32 m0, m0, 1024
    s_nop 0
    buffer_load_dwordx4 v137, s[20:23], s46 offen lds
    s_add_u32 s46, s46, 8192
    s_add_u32 m0, m0, 1024
    s_nop 0
    buffer_load_dwordx4 v136, s[20:23], s46 offen lds
    s_add_u32 s46, s46, 8192
    s_add_u32 m0, m0, 1024
    s_nop 0
    buffer_load_dwordx4 v137, s[20:23], s46 offen lds
    s_add_u32 s46, s46, 8192
    s_add_u32 m0, m0, 1024
    s_nop 0
    buffer_load_dwordx4 v136, s[20:23], s46 offen lds
    s_add_u32 s46, s46, 8192
    s_add_u32 m0, m0, 1024
    s_nop 0
    buffer_load_dwordx4 v137, s[20:23], s46 offen lds
    s_waitcnt vmcnt(0)
    s_barrier
    ds_read_b64_tr_b16 a[0:1], v140 offset:0
    ds_read_b64_tr_b16 a[2:3], v141 offset:1024
    ds_read_b64_tr_b16 a[4:5], v140 offset:4096
    ds_read_b64_tr_b16 a[6:7], v141 offset:5120
    ds_read_b64_tr_b16 a[8:9], v140 offset:8192
    ds_read_b64_tr_b16 a[10:11], v141 offset:9216
    ds_read_b64_tr_b16 a[12:13], v140 offset:12288
    ds_read_b64_tr_b16 a[14:15], v141 offset:13312
    s_waitcnt lgkmcnt(4)
    ds_read_b64_tr_b16 a[16:17], v140 offset:16384
    ds_read_b64_tr_b16 a[18:19], v141 offset:17408
    ds_read_b64_tr_b16 a[20:21], v140 offset:20480
    ds_read_b64_tr_b16 a[22:23], v141 offset:21504
    ds_read_b64_tr_b16 a[24:25], v140 offset:24576
    ds_read_b64_tr_b16 a[26:27], v141 offset:25600
    ds_read_b64_tr_b16 a[28:29], v140 offset:28672
    ds_read_b64_tr_b16 a[30:31], v141 offset:29696
    s_waitcnt lgkmcnt(4)
    ds_read_b64_tr_b16 a[32:33], v140 offset:32768
    ds_read_b64_tr_b16 a[34:35], v141 offset:33792
    ds_read_b64_tr_b16 a[36:37], v140 offset:36864
    ds_read_b64_tr_b16 a[38:39], v141 offset:37888
    ds_read_b64_tr_b16 a[40:41], v140 offset:40960
    ds_read_b64_tr_b16 a[42:43], v141 offset:41984
    ds_read_b64_tr_b16 a[44:45], v140 offset:45056
    ds_read_b64_tr_b16 a[46:47], v141 offset:46080
    s_waitcnt lgkmcnt(4)
    ds_read_b64_tr_b16 a[48:49], v140 offset:49152
    ds_read_b64_tr_b16 a[50:51], v141 offset:50176
    ds_read_b64_tr_b16 a[52:53], v140 offset:53248
    ds_read_b64_tr_b16 a[54:55], v141 offset:54272
    ds_read_b64_tr_b16 a[56:57], v140 offset:57344
    ds_read_b64_tr_b16 a[58:59], v141 offset:58368
    ds_read_b64_tr_b16 a[60:61], v140 offset:61440
    ds_read_b64_tr_b16 a[62:63], v141 offset:62464
    s_waitcnt lgkmcnt(4)
    ds_read_b64_tr_b16 a[64:65], v142 offset:0
    ds_read_b64_tr_b16 a[66:67], v143 offset:1024
    ds_read_b64_tr_b16 a[68:69], v142 offset:4096
    ds_read_b64_tr_b16 a[70:71], v143 offset:5120
    ds_read_b64_tr_b16 a[72:73], v142 offset:8192
    ds_read_b64_tr_b16 a[74:75], v143 offset:9216
    ds_read_b64_tr_b16 a[76:77], v142 offset:12288
    ds_read_b64_tr_b16 a[78:79], v143 offset:13312
    s_waitcnt lgkmcnt(4)
    ds_read_b64_tr_b16 a[80:81], v142 offset:16384
    ds_read_b64_tr_b16 a[82:83], v143 offset:17408
    ds_read_b64_tr_b16 a[84:85], v142 offset:20480
    ds_read_b64_tr_b16 a[86:87], v143 offset:21504
    ds_read_b64_tr_b16 a[88:89], v142 offset:24576
    ds_read_b64_tr_b16 a[90:91], v143 offset:25600
    ds_read_b64_tr_b16 a[92:93], v142 offset:28672
    ds_read_b64_tr_b16 a[94:95], v143 offset:29696
    s_waitcnt lgkmcnt(4)
    ds_read_b64_tr_b16 a[96:97], v142 offset:32768
    ds_read_b64_tr_b16 a[98:99], v143 offset:33792
    ds_read_b64_tr_b16 a[100:101], v142 offset:36864
    ds_read_b64_tr_b16 a[102:103], v143 offset:37888
    ds_read_b64_tr_b16 a[104:105], v142 offset:40960
    ds_read_b64_tr_b16 a[106:107], v143 offset:41984
    ds_read_b64_tr_b16 a[108:109], v142 offset:45056
    ds_read_b64_tr_b16 a[110:111], v143 offset:46080
    s_waitcnt lgkmcnt(4)
    s_waitcnt lgkmcnt(0)
    s_barrier
    s_mul_i32 s46, s36, 229376
    s_add_u32 s46, s46, s51
    s_add_u32 s46, s46, s50
    s_add_u32 s46, s46, 917504
    s_mul_i32 s47, s36, 28672
    s_mov_b32 m0, s47
    s_nop 0
    buffer_load_dwordx4 v136, s[20:23], s46 offen lds
    s_add_u32 s46, s46, 8192
    s_add_u32 m0, m0, 1024
    s_nop 0
    buffer_load_dwordx4 v137, s[20:23], s46 offen lds
    s_add_u32 s46, s46, 8192
    s_add_u32 m0, m0, 1024
    s_nop 0
    buffer_load_dwordx4 v136, s[20:23], s46 offen lds
    s_add_u32 s46, s46, 8192
    s_add_u32 m0, m0, 1024
    s_nop 0
    buffer_load_dwordx4 v137, s[20:23], s46 offen lds
    s_add_u32 s46, s46, 8192
    s_add_u32 m0, m0, 1024
    s_nop 0
    buffer_load_dwordx4 v136, s[20:23], s46 offen lds
    s_add_u32 s46, s46, 8192
    s_add_u32 m0, m0, 1024
    s_nop 0
    buffer_load_dwordx4 v137, s[20:23], s46 offen lds
    s_add_u32 s46, s46, 8192
    s_add_u32 m0, m0, 1024
    s_nop 0
    buffer_load_dwordx4 v136, s[20:23], s46 offen lds
    s_add_u32 s46, s46, 8192
    s_add_u32 m0, m0, 1024
    s_nop 0
    buffer_load_dwordx4 v137, s[20:23], s46 offen lds
    s_add_u32 s46, s46, 8192
    s_add_u32 m0, m0, 1024
    s_nop 0
    buffer_load_dwordx4 v136, s[20:23], s46 offen lds
    s_add_u32 s46, s46, 8192
    s_add_u32 m0, m0, 1024
    s_nop 0
    buffer_load_dwordx4 v137, s[20:23], s46 offen lds
    s_add_u32 s46, s46, 8192
    s_add_u32 m0, m0, 1024
    s_nop 0
    buffer_load_dwordx4 v136, s[20:23], s46 offen lds
    s_add_u32 s46, s46, 8192
    s_add_u32 m0, m0, 1024
    s_nop 0
    buffer_load_dwordx4 v137, s[20:23], s46 offen lds
    s_add_u32 s46, s46, 8192
    s_add_u32 m0, m0, 1024
    s_nop 0
    buffer_load_dwordx4 v136, s[20:23], s46 offen lds
    s_add_u32 s46, s46, 8192
    s_add_u32 m0, m0, 1024
    s_nop 0
    buffer_load_dwordx4 v137, s[20:23], s46 offen lds
    s_add_u32 s46, s46, 8192
    s_add_u32 m0, m0, 1024
    s_nop 0
    buffer_load_dwordx4 v136, s[20:23], s46 offen lds
    s_add_u32 s46, s46, 8192
    s_add_u32 m0, m0, 1024
    s_nop 0
    buffer_load_dwordx4 v137, s[20:23], s46 offen lds
    s_add_u32 s46, s46, 8192
    s_add_u32 m0, m0, 1024
    s_nop 0
    buffer_load_dwordx4 v136, s[20:23], s46 offen lds
    s_add_u32 s46, s46, 8192
    s_add_u32 m0, m0, 1024
    s_nop 0
    buffer_load_dwordx4 v137, s[20:23], s46 offen lds
    s_add_u32 s46, s46, 8192
    s_add_u32 m0, m0, 1024
    s_nop 0
    buffer_load_dwordx4 v136, s[20:23], s46 offen lds
    s_add_u32 s46, s46, 8192
    s_add_u32 m0, m0, 1024
    s_nop 0
    buffer_load_dwordx4 v137, s[20:23], s46 offen lds
    s_add_u32 s46, s46, 8192
    s_add_u32 m0, m0, 1024
    s_nop 0
    buffer_load_dwordx4 v136, s[20:23], s46 offen lds
    s_add_u32 s46, s46, 8192
    s_add_u32 m0, m0, 1024
    s_nop 0
    buffer_load_dwordx4 v137, s[20:23], s46 offen lds
    s_add_u32 s46, s46, 8192
    s_add_u32 m0, m0, 1024
    s_nop 0
    buffer_load_dwordx4 v136, s[20:23], s46 offen lds
    s_add_u32 s46, s46, 8192
    s_add_u32 m0, m0, 1024
    s_nop 0
    buffer_load_dwordx4 v137, s[20:23], s46 offen lds
    s_add_u32 s46, s46, 8192
    s_add_u32 m0, m0, 1024
    s_nop 0
    buffer_load_dwordx4 v136, s[20:23], s46 offen lds
    s_add_u32 s46, s46, 8192
    s_add_u32 m0, m0, 1024
    s_nop 0
    buffer_load_dwordx4 v137, s[20:23], s46 offen lds
    s_add_u32 s46, s46, 8192
    s_add_u32 m0, m0, 1024
    s_nop 0
    buffer_load_dwordx4 v136, s[20:23], s46 offen lds
    s_add_u32 s46, s46, 8192
    s_add_u32 m0, m0, 1024
    s_nop 0
    buffer_load_dwordx4 v137, s[20:23], s46 offen lds
    s_waitcnt vmcnt(0)
    s_barrier
    ds_read_b64_tr_b16 a[112:113], v140 offset:0
    ds_read_b64_tr_b16 a[114:115], v141 offset:1024
    ds_read_b64_tr_b16 a[116:117], v140 offset:4096
    ds_read_b64_tr_b16 a[118:119], v141 offset:5120
    ds_read_b64_tr_b16 a[120:121], v140 offset:8192
    ds_read_b64_tr_b16 a[122:123], v141 offset:9216
    ds_read_b64_tr_b16 a[124:125], v140 offset:12288
    ds_read_b64_tr_b16 a[126:127], v141 offset:13312
    s_waitcnt lgkmcnt(4)
    ds_read_b64_tr_b16 a[128:129], v140 offset:16384
    ds_read_b64_tr_b16 a[130:131], v141 offset:17408
    ds_read_b64_tr_b16 a[132:133], v140 offset:20480
    ds_read_b64_tr_b16 a[134:135], v141 offset:21504
    ds_read_b64_tr_b16 a[136:137], v140 offset:24576
    ds_read_b64_tr_b16 a[138:139], v141 offset:25600
    ds_read_b64_tr_b16 a[140:141], v140 offset:28672
    ds_read_b64_tr_b16 a[142:143], v141 offset:29696
    s_waitcnt lgkmcnt(4)
    ds_read_b64_tr_b16 a[144:145], v140 offset:32768
    ds_read_b64_tr_b16 a[146:147], v141 offset:33792
    ds_read_b64_tr_b16 a[148:149], v140 offset:36864
    ds_read_b64_tr_b16 a[150:151], v141 offset:37888
    ds_read_b64_tr_b16 a[152:153], v140 offset:40960
    ds_read_b64_tr_b16 a[154:155], v141 offset:41984
    ds_read_b64_tr_b16 a[156:157], v140 offset:45056
    ds_read_b64_tr_b16 a[158:159], v141 offset:46080
    s_waitcnt lgkmcnt(4)
    ds_read_b64_tr_b16 a[160:161], v140 offset:49152
    ds_read_b64_tr_b16 a[162:163], v141 offset:50176
    ds_read_b64_tr_b16 a[164:165], v140 offset:53248
    ds_read_b64_tr_b16 a[166:167], v141 offset:54272
    ds_read_b64_tr_b16 a[168:169], v140 offset:57344
    ds_read_b64_tr_b16 a[170:171], v141 offset:58368
    ds_read_b64_tr_b16 a[172:173], v140 offset:61440
    ds_read_b64_tr_b16 a[174:175], v141 offset:62464
    s_waitcnt lgkmcnt(4)
    ds_read_b64_tr_b16 a[176:177], v142 offset:0
    ds_read_b64_tr_b16 a[178:179], v143 offset:1024
    ds_read_b64_tr_b16 a[180:181], v142 offset:4096
    ds_read_b64_tr_b16 a[182:183], v143 offset:5120
    ds_read_b64_tr_b16 a[184:185], v142 offset:8192
    ds_read_b64_tr_b16 a[186:187], v143 offset:9216
    ds_read_b64_tr_b16 a[188:189], v142 offset:12288
    ds_read_b64_tr_b16 a[190:191], v143 offset:13312
    s_waitcnt lgkmcnt(4)
    ds_read_b64_tr_b16 a[192:193], v142 offset:16384
    ds_read_b64_tr_b16 a[194:195], v143 offset:17408
    ds_read_b64_tr_b16 a[196:197], v142 offset:20480
    ds_read_b64_tr_b16 a[198:199], v143 offset:21504
    ds_read_b64_tr_b16 a[200:201], v142 offset:24576
    ds_read_b64_tr_b16 a[202:203], v143 offset:25600
    ds_read_b64_tr_b16 a[204:205], v142 offset:28672
    ds_read_b64_tr_b16 a[206:207], v143 offset:29696
    s_waitcnt lgkmcnt(4)
    ds_read_b64_tr_b16 a[208:209], v142 offset:32768
    ds_read_b64_tr_b16 a[210:211], v143 offset:33792
    ds_read_b64_tr_b16 a[212:213], v142 offset:36864
    ds_read_b64_tr_b16 a[214:215], v143 offset:37888
    ds_read_b64_tr_b16 a[216:217], v142 offset:40960
    ds_read_b64_tr_b16 a[218:219], v143 offset:41984
    ds_read_b64_tr_b16 a[220:221], v142 offset:45056
    ds_read_b64_tr_b16 a[222:223], v143 offset:46080
    s_waitcnt lgkmcnt(4)
    s_waitcnt lgkmcnt(0)
    s_barrier
    s_and_b32 s46, s38, 3
    s_lshl_b32 s47, s46, 4
    s_lshl_b32 s48, s36, 2
    s_add_u32 s47, s47, s48
    v_lshlrev_b32 v132, 4, v1
    s_lshl_b32 s48, s47, 10
    v_add_u32 v157, s48, v132
    s_lshl_b32 s48, s47, 9
    v_add_u32 v159, s48, v132
    s_lshl_b32 s48, s47, 5
    v_lshlrev_b32 v132, 11, v14
    v_lshl_add_u32 v132, v15, 4, v132
    v_add_u32 v158, s48, v132
    s_lshl_b32 s48, s46, 3
    s_add_u32 s48, s48, 147456
    v_bfe_u32 v132, v1, 1, 2
    v_lshlrev_b32 v132, 5, v132
    v_and_b32 v133, 1, v1
    v_lshl_add_u32 v132, v133, 2, v132
    v_add_u32 v9, s48, v132
    s_add_u32 s20, s4, 0xb000000
    s_addc_u32 s21, s5, 0
    s_mov_b32 s22, 0x2000000
    s_mov_b32 s23, 0x20000
    s_load_dwordx2 s[6:7], s[0:1], 88
    s_waitcnt lgkmcnt(0)
    s_add_u32 s24, s4, 0x4c00000
    s_addc_u32 s25, s5, 0
    s_mov_b32 s26, 0x400000
    s_mov_b32 s27, 0x20000
    s_mov_b32 s28, s6
    s_mov_b32 s29, s7
    s_mov_b32 s30, 0x400000
    s_mov_b32 s31, 0x20000
    s_mul_i32 s51, s37, 28
    v_bfe_u32 v132, v1, 4, 1
    s_mov_b32 s46, 28672
    v_mul_lo_u32 v132, v132, s46
    v_lshrrev_b32 v133, 5, v1
    v_lshl_add_u32 v132, v133, 8, v132
    v_lshl_add_u32 v2, v14, 4, v132
    v_add_u32 v3, 0x10000, v2
    v_lshlrev_b32 v134, 4, v1
    s_and_b32 s46, s36, 1
    s_mul_i32 s46, s46, 7
    s_lshr_b32 s47, s36, 1
    s_mul_i32 s48, s47, 28
    s_add_u32 s48, s48, s46
    s_lshl_b32 s53, s48, 10
    s_mul_i32 s48, s47, 112
    s_add_u32 s48, s48, s46
    s_add_u32 s48, s48, s51
    s_lshl_b32 s48, s48, 10
    v_add_u32 v4, s48, v134
    v_add_u32 v5, 0x1000, v4
    s_add_u32 s8, s4, 0x5400000
    s_addc_u32 s9, s5, 0
    s_mov_b32 s10, 0xe00000
    s_mov_b32 s11, 0x20000
    s_lshl_b32 s46, s37, 23
    s_add_u32 s48, s4, s46
    s_addc_u32 s49, s5, 0
    s_add_u32 s12, s48, 0xb000000
    s_addc_u32 s13, s49, 0
    s_mov_b32 s14, 0x800000
    s_mov_b32 s15, 0x20000
    s_lshl_b32 s46, s38, 3
    s_lshl_b32 s47, s36, 1
    s_add_u32 s46, s46, s47
    s_lshl_b32 s46, s46, 10
    v_bfe_u32 v132, v1, 4, 1
    v_lshlrev_b32 v132, 16, v132
    v_lshrrev_b32 v133, 5, v1
    v_lshl_add_u32 v132, v133, 8, v132
    v_lshl_add_u32 v132, v14, 4, v132
    v_add_u32 v6, s46, v132
    s_lshl_b32 s46, s37, 7
    s_add_u32 s46, s46, 98304
    v_min_u32 v132, 13, v1
    v_lshlrev_b32 v132, 2, v132
    v_add_u32 v7, s46, v132
    s_lshl_b32 s48, s38, 2
    s_lshl_b32 s47, s37, 5
    s_add_u32 s48, s48, s47
    s_add_u32 s48, s48, 147456
    v_mov_b32 v12, 0x80000000
    v_mov_b32 v13, s48
    v_cmp_eq_u32 vcc, 0, v1
    s_nop 1
    v_cndmask_b32 v12, v12, v13, vcc
    s_mov_b32 s39, 0
    s_mov_b32 s40, 0
    s_mov_b32 s41, 0
    s_mov_b32 s96, 0
    s_mov_b32 s98, 0
    s_mov_b32 s43, 262144
    s_mov_b32 s42, s37
    s_mov_b32 s101, 0xffff0000
    v_mov_b32 v8, 0
    v_mov_b32 v10, 0
    v_mov_b32 v162, 131072
    s_cmp_eq_u32 s36, 0
    s_cselect_b32 s46, 0, 32
    v_add_u32 v163, s46, v162
    v_and_b32 v13, 15, v1
    v_min_u32 v13, 13, v13
    v_lshlrev_b32 v13, 2, v13
    v_bfe_u32 v14, v1, 4, 1
    v_lshl_add_u32 v13, v14, 9, v13
    v_readfirstlane_b32 s46, v7
    s_nop 1
    v_add_u32 v236, s46, v13
    s_cmp_eq_u32 s36, 0
    s_cselect_b32 s46, 0, 0x80000000
    v_or_b32 v7, s46, v7
    s_cmp_eq_u32 s36, 0
    s_cselect_b32 s46, 0, 0x80000000
    v_or_b32 v236, s46, v236
    s_cmp_eq_u32 s36, 0
    s_cselect_b32 s46, 0, 0x80000000
    v_or_b32 v12, s46, v12
    s_cmp_eq_u32 s36, 0
    s_cselect_b32 s46, 0, 0x80000000
    v_or_b32 v9, s46, v9
    s_branch f2_blk0
f2_end0:
    s_mov_b32 s14, 0x800000
    s_add_i32 s46, s39, 0
    s_lshl_b32 s2, s46, 17
    s_nop 5
    buffer_store_dwordx4 v[16:19], v6, s[12:15], s2 offen offset:0 sc1
    buffer_store_dwordx4 v[20:23], v6, s[12:15], s2 offen offset:512 sc1
    buffer_store_dwordx4 v[24:27], v6, s[12:15], s2 offen offset:1024 sc1
    buffer_store_dwordx4 v[28:31], v6, s[12:15], s2 offen offset:1536 sc1
    s_add_u32 s39, s39, 1
    s_cmp_ge_u32 s39, 64
    s_cbranch_scc1 f2_last
    s_branch f2_blk1
f2_blk0:
    s_cmp_ge_u32 s42, s39
    s_cbranch_scc1 pr_215
    s_lshl_b32 s6, s42, 7
    buffer_load_dword v10, v9, s[16:19], s6 offen sc1
pr_215:
    s_add_u32 s6, s39, 0
    s_lshl_b32 s6, s6, 9
    buffer_load_dword v8, v236, s[16:19], s6 offen sc1
    s_waitcnt vmcnt(0)
    v_xor_b32 v162, 4, v162
    v_xor_b32 v163, 4, v163
    s_add_u32 s7, s39, 0
    s_cmp_lt_u32 s7, 64
    s_cselect_b32 s6, 1, 0
    v_cmp_eq_u32 vcc, 0, v8
    s_nop 3
    s_and_b32 s82, vcc_lo, 0xffff
    s_cselect_b32 s6, 0, s6
    s_lshr_b32 s82, vcc_lo, 16
    s_cselect_b32 s82, 0, 4
    s_add_u32 s7, s7, 1
    s_cmp_lt_u32 s7, 64
    s_cselect_b32 s82, s82, 0
    s_or_b32 s6, s6, s82
    v_cmp_eq_u32 vcc, 0, v10
    s_nop 3
    s_cmp_eq_u64 vcc, 0
    s_cselect_b32 s7, 2, 0
    s_cmp_lt_u32 s42, 64
    s_cselect_b32 s7, s7, 0
    s_or_b32 s6, s6, s7
    v_mov_b32 v13, s6
    s_mov_b64 exec, 1
    ds_write_b32 v163, v13
    s_mov_b64 exec, -1
    s_waitcnt lgkmcnt(0)
    s_barrier
    ds_read_b32 v14, v162
    s_cmp_le_u32 s39, s41
    s_cbranch_scc1 sm_216
    s_mov_b32 s41, s39
    s_sub_u32 s82, s39, 1
    s_lshl_b32 s82, s82, 7
    v_mov_b32 v11, 1
    buffer_store_dword v11, v12, s[16:19], s82 offen sc1
sm_216:
    s_waitcnt lgkmcnt(0)
    v_readfirstlane_b32 s52, v14
    s_nop 3
    s_bitcmp1_b32 s52, 1
    s_cbranch_scc0 nored_217
    s_mov_b32 s45, 0
    s_branch f2_red
nored_217:
    s_bitcmp1_b32 s52, 0
    s_cbranch_scc1 f2_iss0
    s_sub_u32 s43, s43, 1
    s_cbranch_scc1 f2_blk0_err
    s_cmp_lg_u32 s36, 0
    s_cbranch_scc1 w0_218
    s_sleep 2
w0_218:
    s_branch f2_blk0
f2_blk0_err:
    s_mov_b32 s44, 20
    s_branch ssp_err
f2_iss0:
    s_cmp_eq_u32 0, 0
    s_cselect_b32 s10, 0xe00000, 0
    s_add_u32 s48, s39, 0
    s_mul_i32 s84, s48, 229376
    s_add_u32 s85, s84, 14336
    s_add_u32 m0, s53, 0
    s_nop 0
    buffer_load_dwordx4 v4, s[8:11], s84 offen offset:0 sc1 lds
    buffer_load_dwordx4 v4, s[8:11], s84 offen offset:1024 sc1 lds
    buffer_load_dwordx4 v4, s[8:11], s84 offen offset:2048 sc1 lds
    buffer_load_dwordx4 v4, s[8:11], s84 offen offset:3072 sc1 lds
    s_add_u32 m0, s53, 4096
    s_nop 0
    buffer_load_dwordx4 v5, s[8:11], s84 offen offset:0 sc1 lds
    buffer_load_dwordx4 v5, s[8:11], s84 offen offset:1024 sc1 lds
    buffer_load_dwordx4 v5, s[8:11], s84 offen offset:2048 sc1 lds
    s_add_u32 m0, s53, 14336
    s_nop 0
    buffer_load_dwordx4 v4, s[8:11], s85 offen offset:0 sc1 lds
    buffer_load_dwordx4 v4, s[8:11], s85 offen offset:1024 sc1 lds
    buffer_load_dwordx4 v4, s[8:11], s85 offen offset:2048 sc1 lds
    buffer_load_dwordx4 v4, s[8:11], s85 offen offset:3072 sc1 lds
    s_add_u32 m0, s53, 18432
    s_nop 0
    buffer_load_dwordx4 v5, s[8:11], s85 offen offset:0 sc1 lds
    buffer_load_dwordx4 v5, s[8:11], s85 offen offset:1024 sc1 lds
    buffer_load_dwordx4 v5, s[8:11], s85 offen offset:2048 sc1 lds
    s_mov_b32 s14, 0
    s_lshr_b32 s40, s52, 2
    s_waitcnt vmcnt(7)
    s_barrier
    ds_read_b128 v[48:51], v2 offset:0
    ds_read_b128 v[52:55], v2 offset:512
    ds_read_b128 v[56:59], v2 offset:1024
    ds_read_b128 v[60:63], v2 offset:1536
    ds_read_b128 v[64:67], v2 offset:2048
    ds_read_b128 v[68:71], v2 offset:2560
    s_cmp_lg_u32 s40, 0
    s_cselect_b32 s10, 0xe00000, 0
    s_branch f2_LP0
f2_end1:
    s_mov_b32 s14, 0x800000
    s_add_i32 s46, s39, 0
    s_lshl_b32 s2, s46, 17
    s_nop 5
    buffer_store_dwordx4 v[32:35], v6, s[12:15], s2 offen offset:0 sc1
    buffer_store_dwordx4 v[36:39], v6, s[12:15], s2 offen offset:512 sc1
    buffer_store_dwordx4 v[40:43], v6, s[12:15], s2 offen offset:1024 sc1
    buffer_store_dwordx4 v[44:47], v6, s[12:15], s2 offen offset:1536 sc1
    s_add_u32 s39, s39, 1
    s_cmp_ge_u32 s39, 64
    s_cbranch_scc1 f2_last
    s_branch f2_blk0
f2_blk1:
    s_cmp_ge_u32 s42, s39
    s_cbranch_scc1 pr_219
    s_lshl_b32 s6, s42, 7
    buffer_load_dword v10, v9, s[16:19], s6 offen sc1
pr_219:
    s_add_u32 s6, s39, 0
    s_lshl_b32 s6, s6, 9
    buffer_load_dword v8, v236, s[16:19], s6 offen sc1
    s_waitcnt vmcnt(0)
    v_xor_b32 v162, 4, v162
    v_xor_b32 v163, 4, v163
    s_add_u32 s7, s39, 0
    s_cmp_lt_u32 s7, 64
    s_cselect_b32 s6, 1, 0
    v_cmp_eq_u32 vcc, 0, v8
    s_nop 3
    s_and_b32 s82, vcc_lo, 0xffff
    s_cselect_b32 s6, 0, s6
    s_lshr_b32 s82, vcc_lo, 16
    s_cselect_b32 s82, 0, 4
    s_add_u32 s7, s7, 1
    s_cmp_lt_u32 s7, 64
    s_cselect_b32 s82, s82, 0
    s_or_b32 s6, s6, s82
    v_cmp_eq_u32 vcc, 0, v10
    s_nop 3
    s_cmp_eq_u64 vcc, 0
    s_cselect_b32 s7, 2, 0
    s_cmp_lt_u32 s42, 64
    s_cselect_b32 s7, s7, 0
    s_or_b32 s6, s6, s7
    v_mov_b32 v13, s6
    s_mov_b64 exec, 1
    ds_write_b32 v163, v13
    s_mov_b64 exec, -1
    s_waitcnt lgkmcnt(0)
    s_barrier
    ds_read_b32 v14, v162
    s_cmp_le_u32 s39, s41
    s_cbranch_scc1 sm_220
    s_mov_b32 s41, s39
    s_sub_u32 s82, s39, 1
    s_lshl_b32 s82, s82, 7
    v_mov_b32 v11, 1
    buffer_store_dword v11, v12, s[16:19], s82 offen sc1
sm_220:
    s_waitcnt lgkmcnt(0)
    v_readfirstlane_b32 s52, v14
    s_nop 3
    s_bitcmp1_b32 s52, 1
    s_cbranch_scc0 nored_221
    s_mov_b32 s45, 1
    s_branch f2_red
nored_221:
    s_bitcmp1_b32 s52, 0
    s_cbranch_scc1 f2_iss1
    s_sub_u32 s43, s43, 1
    s_cbranch_scc1 f2_blk1_err
    s_cmp_lg_u32 s36, 0
    s_cbranch_scc1 w0_222
    s_sleep 2
w0_222:
    s_branch f2_blk1
f2_blk1_err:
    s_mov_b32 s44, 20
    s_branch ssp_err
f2_iss1:
    s_cmp_eq_u32 0, 0
    s_cselect_b32 s10, 0xe00000, 0
    s_add_u32 s48, s39, 0
    s_mul_i32 s84, s48, 229376
    s_add_u32 s85, s84, 14336
    s_add_u32 m0, s53, 65536
    s_nop 0
    buffer_load_dwordx4 v4, s[8:11], s84 offen offset:0 sc1 lds
    buffer_load_dwordx4 v4, s[8:11], s84 offen offset:1024 sc1 lds
    buffer_load_dwordx4 v4, s[8:11], s84 offen offset:2048 sc1 lds
    buffer_load_dwordx4 v4, s[8:11], s84 offen offset:3072 sc1 lds
    s_add_u32 m0, s53, 69632
    s_nop 0
    buffer_load_dwordx4 v5, s[8:11], s84 offen offset:0 sc1 lds
    buffer_load_dwordx4 v5, s[8:11], s84 offen offset:1024 sc1 lds
    buffer_load_dwordx4 v5, s[8:11], s84 offen offset:2048 sc1 lds
    s_add_u32 m0, s53, 79872
    s_nop 0
    buffer_load_dwordx4 v4, s[8:11], s85 offen offset:0 sc1 lds
    buffer_load_dwordx4 v4, s[8:11], s85 offen offset:1024 sc1 lds
    buffer_load_dwordx4 v4, s[8:11], s85 offen offset:2048 sc1 lds
    buffer_load_dwordx4 v4, s[8:11], s85 offen offset:3072 sc1 lds
    s_add_u32 m0, s53, 83968
    s_nop 0
    buffer_load_dwordx4 v5, s[8:11], s85 offen offset:0 sc1 lds
    buffer_load_dwordx4 v5, s[8:11], s85 offen offset:1024 sc1 lds
    buffer_load_dwordx4 v5, s[8:11], s85 offen offset:2048 sc1 lds
    s_mov_b32 s14, 0
    s_lshr_b32 s40, s52, 2
    s_waitcnt vmcnt(7)
    s_barrier
    ds_read_b128 v[48:51], v3 offset:0
    ds_read_b128 v[52:55], v3 offset:512
    ds_read_b128 v[56:59], v3 offset:1024
    ds_read_b128 v[60:63], v3 offset:1536
    ds_read_b128 v[64:67], v3 offset:2048
    ds_read_b128 v[68:71], v3 offset:2560
    s_cmp_lg_u32 s40, 0
    s_cselect_b32 s10, 0xe00000, 0
    s_branch f2_LP1
f2_last:
    s_waitcnt vmcnt(0)
    s_barrier
    s_cmp_le_u32 s39, s41
    s_cbranch_scc1 sm_223
    s_mov_b32 s41, s39
    s_sub_u32 s82, s39, 1
    s_lshl_b32 s82, s82, 7
    v_mov_b32 v11, 1
    buffer_store_dword v11, v12, s[16:19], s82 offen sc1
sm_223:
    s_branch f2_fin
f2_LP0:
    s_waitcnt lgkmcnt(4)
    v_mfma_f32_32x32x16_bf16 v[16:31], a[0:3], v[48:51], 0
    ds_read_b128 v[72:75], v2 offset:3072
    s_add_u32 s48, s39, 1
    s_mul_i32 s84, s48, 229376
    s_add_u32 s85, s84, 14336
    v_mfma_f32_32x32x16_bf16 v[16:31], a[4:7], v[52:55], v[16:31]
    ds_read_b128 v[76:79], v2 offset:3584
    s_add_i32 s46, s39, -1
    s_lshl_b32 s2, s46, 17
    buffer_store_dwordx4 v[32:35], v6, s[12:15], s2 offen offset:0 sc1
    s_waitcnt lgkmcnt(4)
    v_mfma_f32_32x32x16_bf16 v[16:31], a[8:11], v[56:59], v[16:31]
    ds_read_b128 v[48:51], v2 offset:4096
    s_add_u32 m0, s53, 65536
    s_nop 0
    buffer_load_dwordx4 v4, s[8:11], s84 offen offset:0 sc1 lds
    v_mfma_f32_32x32x16_bf16 v[16:31], a[12:15], v[60:63], v[16:31]
    ds_read_b128 v[52:55], v2 offset:4608
    buffer_store_dwordx4 v[36:39], v6, s[12:15], s2 offen offset:512 sc1
    s_waitcnt lgkmcnt(4)
    v_mfma_f32_32x32x16_bf16 v[16:31], a[16:19], v[64:67], v[16:31]
    ds_read_b128 v[56:59], v2 offset:5120
    v_mfma_f32_32x32x16_bf16 v[16:31], a[20:23], v[68:71], v[16:31]
    ds_read_b128 v[60:63], v2 offset:5632
    buffer_store_dwordx4 v[40:43], v6, s[12:15], s2 offen offset:1024 sc1
    buffer_load_dwordx4 v4, s[8:11], s84 offen offset:1024 sc1 lds
    s_waitcnt lgkmcnt(4)
    v_mfma_f32_32x32x16_bf16 v[16:31], a[24:27], v[72:75], v[16:31]
    ds_read_b128 v[64:67], v2 offset:6144
    v_mfma_f32_32x32x16_bf16 v[16:31], a[28:31], v[76:79], v[16:31]
    ds_read_b128 v[68:71], v2 offset:6656
    buffer_store_dwordx4 v[44:47], v6, s[12:15], s2 offen offset:1536 sc1
    s_waitcnt lgkmcnt(4)
    v_mfma_f32_32x32x16_bf16 v[16:31], a[32:35], v[48:51], v[16:31]
    ds_read_b128 v[72:75], v2 offset:7168
    buffer_load_dwordx4 v4, s[8:11], s84 offen offset:2048 sc1 lds
    v_mfma_f32_32x32x16_bf16 v[16:31], a[36:39], v[52:55], v[16:31]
    ds_read_b128 v[76:79], v2 offset:7680
    s_waitcnt lgkmcnt(4)
    v_mfma_f32_32x32x16_bf16 v[16:31], a[40:43], v[56:59], v[16:31]
    ds_read_b128 v[48:51], v2 offset:8192
    v_mfma_f32_32x32x16_bf16 v[16:31], a[44:47], v[60:63], v[16:31]
    ds_read_b128 v[52:55], v2 offset:8704
    buffer_load_dwordx4 v4, s[8:11], s84 offen offset:3072 sc1 lds
    s_waitcnt lgkmcnt(4)
    v_mfma_f32_32x32x16_bf16 v[16:31], a[48:51], v[64:67], v[16:31]
    ds_read_b128 v[56:59], v2 offset:9216
    v_mfma_f32_32x32x16_bf16 v[16:31], a[52:55], v[68:71], v[16:31]
    ds_read_b128 v[60:63], v2 offset:9728
    s_waitcnt lgkmcnt(4)
    v_mfma_f32_32x32x16_bf16 v[16:31], a[56:59], v[72:75], v[16:31]
    ds_read_b128 v[64:67], v2 offset:10240
    s_add_u32 m0, s53, 69632
    s_nop 0
    buffer_load_dwordx4 v5, s[8:11], s84 offen offset:0 sc1 lds
    v_mfma_f32_32x32x16_bf16 v[16:31], a[60:63], v[76:79], v[16:31]
    ds_read_b128 v[68:71], v2 offset:10752
    s_waitcnt lgkmcnt(4)
    v_mfma_f32_32x32x16_bf16 v[16:31], a[64:67], v[48:51], v[16:31]
    ds_read_b128 v[72:75], v2 offset:11264
    v_mfma_f32_32x32x16_bf16 v[16:31], a[68:71], v[52:55], v[16:31]
    ds_read_b128 v[76:79], v2 offset:11776
    buffer_load_dwordx4 v5, s[8:11], s84 offen offset:1024 sc1 lds
    s_waitcnt lgkmcnt(4)
    v_mfma_f32_32x32x16_bf16 v[16:31], a[72:75], v[56:59], v[16:31]
    ds_read_b128 v[48:51], v2 offset:12288
    v_mfma_f32_32x32x16_bf16 v[16:31], a[76:79], v[60:63], v[16:31]
    ds_read_b128 v[52:55], v2 offset:12800
    s_waitcnt lgkmcnt(4)
    v_mfma_f32_32x32x16_bf16 v[16:31], a[80:83], v[64:67], v[16:31]
    ds_read_b128 v[56:59], v2 offset:13312
    buffer_load_dwordx4 v5, s[8:11], s84 offen offset:2048 sc1 lds
    v_mfma_f32_32x32x16_bf16 v[16:31], a[84:87], v[68:71], v[16:31]
    ds_read_b128 v[60:63], v2 offset:13824
    s_waitcnt vmcnt(11)
    s_barrier
    s_waitcnt lgkmcnt(4)
    v_mfma_f32_32x32x16_bf16 v[16:31], a[88:91], v[72:75], v[16:31]
    ds_read_b128 v[64:67], v2 offset:14336
    v_mfma_f32_32x32x16_bf16 v[16:31], a[92:95], v[76:79], v[16:31]
    ds_read_b128 v[68:71], v2 offset:14848
    s_waitcnt lgkmcnt(4)
    v_mfma_f32_32x32x16_bf16 v[16:31], a[96:99], v[48:51], v[16:31]
    ds_read_b128 v[72:75], v2 offset:15360
    v_mfma_f32_32x32x16_bf16 v[16:31], a[100:103], v[52:55], v[16:31]
    ds_read_b128 v[76:79], v2 offset:15872
    s_waitcnt lgkmcnt(4)
    v_mfma_f32_32x32x16_bf16 v[16:31], a[104:107], v[56:59], v[16:31]
    ds_read_b128 v[48:51], v2 offset:16384
    v_mfma_f32_32x32x16_bf16 v[16:31], a[108:111], v[60:63], v[16:31]
    ds_read_b128 v[52:55], v2 offset:16896
    s_waitcnt lgkmcnt(4)
    v_mfma_f32_32x32x16_bf16 v[16:31], a[112:115], v[64:67], v[16:31]
    ds_read_b128 v[56:59], v2 offset:17408
    s_add_u32 m0, s53, 79872
    s_nop 0
    buffer_load_dwordx4 v4, s[8:11], s85 offen offset:0 sc1 lds
    v_mfma_f32_32x32x16_bf16 v[16:31], a[116:119], v[68:71], v[16:31]
    ds_read_b128 v[60:63], v2 offset:17920
    s_waitcnt lgkmcnt(4)
    v_mfma_f32_32x32x16_bf16 v[16:31], a[120:123], v[72:75], v[16:31]
    ds_read_b128 v[64:67], v2 offset:18432
    v_mfma_f32_32x32x16_bf16 v[16:31], a[124:127], v[76:79], v[16:31]
    ds_read_b128 v[68:71], v2 offset:18944
    s_cmp_ge_u32 s42, s39
    s_cbranch_scc1 pr_224
    s_lshl_b32 s6, s42, 7
    buffer_load_dword v10, v9, s[16:19], s6 offen sc1
pr_224:
    s_add_u32 s6, s39, 2
    s_lshl_b32 s6, s6, 9
    buffer_load_dword v8, v7, s[16:19], s6 offen sc1
    buffer_load_dwordx4 v4, s[8:11], s85 offen offset:1024 sc1 lds
    s_waitcnt lgkmcnt(4)
    v_mfma_f32_32x32x16_bf16 v[16:31], a[128:131], v[48:51], v[16:31]
    ds_read_b128 v[72:75], v2 offset:19456
    v_mfma_f32_32x32x16_bf16 v[16:31], a[132:135], v[52:55], v[16:31]
    ds_read_b128 v[76:79], v2 offset:19968
    s_waitcnt lgkmcnt(4)
    v_mfma_f32_32x32x16_bf16 v[16:31], a[136:139], v[56:59], v[16:31]
    ds_read_b128 v[48:51], v2 offset:20480
    v_mfma_f32_32x32x16_bf16 v[16:31], a[140:143], v[60:63], v[16:31]
    ds_read_b128 v[52:55], v2 offset:20992
    buffer_load_dwordx4 v4, s[8:11], s85 offen offset:2048 sc1 lds
    s_waitcnt lgkmcnt(4)
    v_mfma_f32_32x32x16_bf16 v[16:31], a[144:147], v[64:67], v[16:31]
    ds_read_b128 v[56:59], v2 offset:21504
    v_mfma_f32_32x32x16_bf16 v[16:31], a[148:151], v[68:71], v[16:31]
    ds_read_b128 v[60:63], v2 offset:22016
    s_waitcnt lgkmcnt(4)
    v_mfma_f32_32x32x16_bf16 v[16:31], a[152:155], v[72:75], v[16:31]
    ds_read_b128 v[64:67], v2 offset:22528
    v_mfma_f32_32x32x16_bf16 v[16:31], a[156:159], v[76:79], v[16:31]
    ds_read_b128 v[68:71], v2 offset:23040
    buffer_load_dwordx4 v4, s[8:11], s85 offen offset:3072 sc1 lds
    s_waitcnt lgkmcnt(4)
    v_mfma_f32_32x32x16_bf16 v[16:31], a[160:163], v[48:51], v[16:31]
    ds_read_b128 v[72:75], v2 offset:23552
    v_mfma_f32_32x32x16_bf16 v[16:31], a[164:167], v[52:55], v[16:31]
    ds_read_b128 v[76:79], v2 offset:24064
    s_waitcnt vmcnt(3)
    v_xor_b32 v162, 4, v162
    v_xor_b32 v163, 4, v163
    s_waitcnt lgkmcnt(4)
    v_mfma_f32_32x32x16_bf16 v[16:31], a[168:171], v[56:59], v[16:31]
    ds_read_b128 v[48:51], v2 offset:24576
    s_add_u32 s7, s39, 2
    s_cmp_lt_u32 s7, 64
    s_cselect_b32 s6, 1, 0
    v_cmp_eq_u32 vcc, 0, v8
    v_mfma_f32_32x32x16_bf16 v[16:31], a[172:175], v[60:63], v[16:31]
    ds_read_b128 v[52:55], v2 offset:25088
    s_add_u32 m0, s53, 83968
    s_nop 0
    buffer_load_dwordx4 v5, s[8:11], s85 offen offset:0 sc1 lds
    s_cmp_eq_u64 vcc, 0
    s_cselect_b32 s6, s6, 0
    v_cmp_eq_u32 vcc, 0, v10
    s_waitcnt lgkmcnt(4)
    v_mfma_f32_32x32x16_bf16 v[16:31], a[176:179], v[64:67], v[16:31]
    ds_read_b128 v[56:59], v2 offset:25600
    s_nop 0
    s_cmp_eq_u64 vcc, 0
    s_cselect_b32 s7, 2, 0
    s_cmp_lt_u32 s42, 64
    s_cselect_b32 s7, s7, 0
    s_or_b32 s6, s6, s7
    v_mfma_f32_32x32x16_bf16 v[16:31], a[180:183], v[68:71], v[16:31]
    ds_read_b128 v[60:63], v2 offset:26112
    v_mov_b32 v13, s6
    s_waitcnt lgkmcnt(4)
    v_mfma_f32_32x32x16_bf16 v[16:31], a[184:187], v[72:75], v[16:31]
    ds_read_b128 v[64:67], v2 offset:26624
    s_mov_b64 exec, 1
    ds_write_b32 v163, v13
    s_mov_b64 exec, -1
    v_mfma_f32_32x32x16_bf16 v[16:31], a[188:191], v[76:79], v[16:31]
    ds_read_b128 v[68:71], v2 offset:27136
    buffer_load_dwordx4 v5, s[8:11], s85 offen offset:1024 sc1 lds
    s_waitcnt lgkmcnt(5)
    v_mfma_f32_32x32x16_bf16 v[16:31], a[192:195], v[48:51], v[16:31]
    ds_read_b128 v[72:75], v2 offset:27648
    v_mfma_f32_32x32x16_bf16 v[16:31], a[196:199], v[52:55], v[16:31]
    ds_read_b128 v[76:79], v2 offset:28160
    s_waitcnt vmcnt(7)
    s_waitcnt lgkmcnt(3)
    s_barrier
    ds_read_b32 v14, v162
    s_cmp_le_u32 s39, s41
    s_cbranch_scc1 sm_225
    s_mov_b32 s41, s39
    s_sub_u32 s82, s39, 1
    s_lshl_b32 s82, s82, 7
    v_mov_b32 v11, 1
    buffer_store_dword v11, v12, s[16:19], s82 offen sc1
sm_225:
    s_waitcnt lgkmcnt(6)
    v_mfma_f32_32x32x16_bf16 v[16:31], a[200:203], v[56:59], v[16:31]
    ds_read_b128 v[48:51], v3 offset:0
    v_mfma_f32_32x32x16_bf16 v[16:31], a[204:207], v[60:63], v[16:31]
    ds_read_b128 v[52:55], v3 offset:512
    buffer_load_dwordx4 v5, s[8:11], s85 offen offset:2048 sc1 lds
    s_waitcnt lgkmcnt(5)
    v_mfma_f32_32x32x16_bf16 v[16:31], a[208:211], v[64:67], v[16:31]
    ds_read_b128 v[56:59], v3 offset:1024
    v_mfma_f32_32x32x16_bf16 v[16:31], a[212:215], v[68:71], v[16:31]
    ds_read_b128 v[60:63], v3 offset:1536
    s_waitcnt lgkmcnt(5)
    v_mfma_f32_32x32x16_bf16 v[16:31], a[216:219], v[72:75], v[16:31]
    ds_read_b128 v[64:67], v3 offset:2048
    s_waitcnt lgkmcnt(5)
    v_readfirstlane_b32 s52, v14
    v_mfma_f32_32x32x16_bf16 v[16:31], a[220:223], v[76:79], v[16:31]
    ds_read_b128 v[68:71], v3 offset:2560
    s_cmp_eq_u32 s40, 0
    s_cbranch_scc1 f2_end0
    s_add_u32 s39, s39, 1
    s_mov_b32 s14, 0x800000
    s_and_b32 s40, s52, 1
    s_cselect_b32 s10, 0xe00000, 0
    s_cmp_eq_u32 s52, 3
    s_cbranch_scc1 f2_LR1
    s_branch f2_LP1
f2_LR0:
    s_waitcnt lgkmcnt(4)
    v_mfma_f32_32x32x16_bf16 v[16:31], a[0:3], v[48:51], 0
    ds_read_b128 v[72:75], v2 offset:3072
    s_add_u32 s48, s39, 1
    s_mul_i32 s84, s48, 229376
    s_add_u32 s85, s84, 14336
    s_lshl_b32 s100, s42, 1
    s_lshr_b32 s47, s38, 2
    s_add_u32 s100, s100, s47
    v_mfma_f32_32x32x16_bf16 v[16:31], a[4:7], v[52:55], v[16:31]
    ds_read_b128 v[76:79], v2 offset:3584
    s_lshl_b32 s86, s100, 16
    s_lshl_b32 s55, s100, 15
    s_add_u32 s87, s86, 0x800000
    s_add_u32 s88, s87, 0x800000
    s_add_u32 s89, s88, 0x800000
    s_add_i32 s46, s39, -1
    s_lshl_b32 s2, s46, 17
    buffer_store_dwordx4 v[32:35], v6, s[12:15], s2 offen offset:0 sc1
    s_waitcnt lgkmcnt(4)
    v_mfma_f32_32x32x16_bf16 v[16:31], a[8:11], v[56:59], v[16:31]
    ds_read_b128 v[48:51], v2 offset:4096
    s_add_u32 m0, s53, 65536
    s_nop 0
    buffer_load_dwordx4 v4, s[8:11], s84 offen offset:0 sc1 lds
    v_mfma_f32_32x32x16_bf16 v[16:31], a[12:15], v[60:63], v[16:31]
    ds_read_b128 v[52:55], v2 offset:4608
    buffer_store_dwordx4 v[36:39], v6, s[12:15], s2 offen offset:512 sc1
    s_waitcnt lgkmcnt(4)
    v_mfma_f32_32x32x16_bf16 v[16:31], a[16:19], v[64:67], v[16:31]
    ds_read_b128 v[56:59], v2 offset:5120
    buffer_load_dwordx4 v[172:175], v157, s[20:23], s86 offen offset:0 sc1
    v_mfma_f32_32x32x16_bf16 v[16:31], a[20:23], v[68:71], v[16:31]
    ds_read_b128 v[60:63], v2 offset:5632
    buffer_store_dwordx4 v[40:43], v6, s[12:15], s2 offen offset:1024 sc1
    buffer_load_dwordx4 v4, s[8:11], s84 offen offset:1024 sc1 lds
    s_waitcnt lgkmcnt(4)
    v_mfma_f32_32x32x16_bf16 v[16:31], a[24:27], v[72:75], v[16:31]
    ds_read_b128 v[64:67], v2 offset:6144
    buffer_load_dwordx4 v[176:179], v157, s[20:23], s86 offen offset:1024 sc1
    v_mfma_f32_32x32x16_bf16 v[16:31], a[28:31], v[76:79], v[16:31]
    ds_read_b128 v[68:71], v2 offset:6656
    buffer_store_dwordx4 v[44:47], v6, s[12:15], s2 offen offset:1536 sc1
    s_waitcnt lgkmcnt(4)
    v_mfma_f32_32x32x16_bf16 v[16:31], a[32:35], v[48:51], v[16:31]
    ds_read_b128 v[72:75], v2 offset:7168
    buffer_load_dwordx4 v4, s[8:11], s84 offen offset:2048 sc1 lds
    v_mfma_f32_32x32x16_bf16 v[16:31], a[36:39], v[52:55], v[16:31]
    ds_read_b128 v[76:79], v2 offset:7680
    buffer_load_dwordx4 v[180:183], v157, s[20:23], s86 offen offset:2048 sc1
    s_waitcnt lgkmcnt(4)
    v_mfma_f32_32x32x16_bf16 v[16:31], a[40:43], v[56:59], v[16:31]
    ds_read_b128 v[48:51], v2 offset:8192
    v_mfma_f32_32x32x16_bf16 v[16:31], a[44:47], v[60:63], v[16:31]
    ds_read_b128 v[52:55], v2 offset:8704
    buffer_load_dwordx4 v4, s[8:11], s84 offen offset:3072 sc1 lds
    s_waitcnt lgkmcnt(4)
    v_mfma_f32_32x32x16_bf16 v[16:31], a[48:51], v[64:67], v[16:31]
    ds_read_b128 v[56:59], v2 offset:9216
    buffer_load_dwordx4 v[184:187], v157, s[20:23], s86 offen offset:3072 sc1
    v_mfma_f32_32x32x16_bf16 v[16:31], a[52:55], v[68:71], v[16:31]
    ds_read_b128 v[60:63], v2 offset:9728
    s_waitcnt lgkmcnt(4)
    v_mfma_f32_32x32x16_bf16 v[16:31], a[56:59], v[72:75], v[16:31]
    ds_read_b128 v[64:67], v2 offset:10240
    s_add_u32 m0, s53, 69632
    s_nop 0
    buffer_load_dwordx4 v5, s[8:11], s84 offen offset:0 sc1 lds
    v_mfma_f32_32x32x16_bf16 v[16:31], a[60:63], v[76:79], v[16:31]
    ds_read_b128 v[68:71], v2 offset:10752
    buffer_load_dwordx4 v[188:191], v157, s[20:23], s87 offen offset:0 sc1
    s_waitcnt lgkmcnt(4)
    v_mfma_f32_32x32x16_bf16 v[16:31], a[64:67], v[48:51], v[16:31]
    ds_read_b128 v[72:75], v2 offset:11264
    v_mfma_f32_32x32x16_bf16 v[16:31], a[68:71], v[52:55], v[16:31]
    ds_read_b128 v[76:79], v2 offset:11776
    buffer_load_dwordx4 v5, s[8:11], s84 offen offset:1024 sc1 lds
    s_waitcnt lgkmcnt(4)
    v_mfma_f32_32x32x16_bf16 v[16:31], a[72:75], v[56:59], v[16:31]
    ds_read_b128 v[48:51], v2 offset:12288
    buffer_load_dwordx4 v[192:195], v157, s[20:23], s87 offen offset:1024 sc1
    v_mfma_f32_32x32x16_bf16 v[16:31], a[76:79], v[60:63], v[16:31]
    ds_read_b128 v[52:55], v2 offset:12800
    s_waitcnt lgkmcnt(4)
    v_mfma_f32_32x32x16_bf16 v[16:31], a[80:83], v[64:67], v[16:31]
    ds_read_b128 v[56:59], v2 offset:13312
    buffer_load_dwordx4 v5, s[8:11], s84 offen offset:2048 sc1 lds
    v_mfma_f32_32x32x16_bf16 v[16:31], a[84:87], v[68:71], v[16:31]
    ds_read_b128 v[60:63], v2 offset:13824
    buffer_load_dwordx4 v[196:199], v157, s[20:23], s87 offen offset:2048 sc1
    s_waitcnt vmcnt(18)
    s_barrier
    s_waitcnt lgkmcnt(4)
    v_mfma_f32_32x32x16_bf16 v[16:31], a[88:91], v[72:75], v[16:31]
    ds_read_b128 v[64:67], v2 offset:14336
    v_mfma_f32_32x32x16_bf16 v[16:31], a[92:95], v[76:79], v[16:31]
    ds_read_b128 v[68:71], v2 offset:14848
    buffer_load_dwordx4 v[200:203], v157, s[20:23], s87 offen offset:3072 sc1
    s_waitcnt lgkmcnt(4)
    v_mfma_f32_32x32x16_bf16 v[16:31], a[96:99], v[48:51], v[16:31]
    ds_read_b128 v[72:75], v2 offset:15360
    v_mfma_f32_32x32x16_bf16 v[16:31], a[100:103], v[52:55], v[16:31]
    ds_read_b128 v[76:79], v2 offset:15872
    s_waitcnt lgkmcnt(4)
    v_mfma_f32_32x32x16_bf16 v[16:31], a[104:107], v[56:59], v[16:31]
    ds_read_b128 v[48:51], v2 offset:16384
    buffer_load_dwordx4 v[204:207], v157, s[20:23], s88 offen offset:0 sc1
    v_mfma_f32_32x32x16_bf16 v[16:31], a[108:111], v[60:63], v[16:31]
    ds_read_b128 v[52:55], v2 offset:16896
    s_waitcnt lgkmcnt(4)
    v_mfma_f32_32x32x16_bf16 v[16:31], a[112:115], v[64:67], v[16:31]
    ds_read_b128 v[56:59], v2 offset:17408
    s_add_u32 m0, s53, 79872
    s_nop 0
    buffer_load_dwordx4 v4, s[8:11], s85 offen offset:0 sc1 lds
    v_mfma_f32_32x32x16_bf16 v[16:31], a[116:119], v[68:71], v[16:31]
    ds_read_b128 v[60:63], v2 offset:17920
    buffer_load_dwordx4 v[208:211], v157, s[20:23], s88 offen offset:1024 sc1
    s_waitcnt lgkmcnt(4)
    v_mfma_f32_32x32x16_bf16 v[16:31], a[120:123], v[72:75], v[16:31]
    ds_read_b128 v[64:67], v2 offset:18432
    v_mfma_f32_32x32x16_bf16 v[16:31], a[124:127], v[76:79], v[16:31]
    ds_read_b128 v[68:71], v2 offset:18944
    s_cmp_ge_u32 s42, s39
    s_cbranch_scc1 pr_226
    s_lshl_b32 s6, s42, 7
    buffer_load_dword v10, v9, s[16:19], s6 offen sc1
pr_226:
    s_add_u32 s6, s39, 2
    s_lshl_b32 s6, s6, 9
    buffer_load_dword v8, v7, s[16:19], s6 offen sc1
    buffer_load_dwordx4 v4, s[8:11], s85 offen offset:1024 sc1 lds
    s_waitcnt lgkmcnt(4)
    v_mfma_f32_32x32x16_bf16 v[16:31], a[128:131], v[48:51], v[16:31]
    ds_read_b128 v[72:75], v2 offset:19456
    buffer_load_dwordx4 v[212:215], v157, s[20:23], s88 offen offset:2048 sc1
    v_mfma_f32_32x32x16_bf16 v[16:31], a[132:135], v[52:55], v[16:31]
    ds_read_b128 v[76:79], v2 offset:19968
    s_waitcnt lgkmcnt(4)
    v_mfma_f32_32x32x16_bf16 v[16:31], a[136:139], v[56:59], v[16:31]
    ds_read_b128 v[48:51], v2 offset:20480
    v_mfma_f32_32x32x16_bf16 v[16:31], a[140:143], v[60:63], v[16:31]
    ds_read_b128 v[52:55], v2 offset:20992
    buffer_load_dwordx4 v4, s[8:11], s85 offen offset:2048 sc1 lds
    buffer_load_dwordx4 v[216:219], v157, s[20:23], s88 offen offset:3072 sc1
    s_waitcnt lgkmcnt(4)
    v_mfma_f32_32x32x16_bf16 v[16:31], a[144:147], v[64:67], v[16:31]
    ds_read_b128 v[56:59], v2 offset:21504
    v_mfma_f32_32x32x16_bf16 v[16:31], a[148:151], v[68:71], v[16:31]
    ds_read_b128 v[60:63], v2 offset:22016
    s_waitcnt lgkmcnt(4)
    v_mfma_f32_32x32x16_bf16 v[16:31], a[152:155], v[72:75], v[16:31]
    ds_read_b128 v[64:67], v2 offset:22528
    buffer_load_dwordx4 v[220:223], v157, s[20:23], s89 offen offset:0 sc1
    v_mfma_f32_32x32x16_bf16 v[16:31], a[156:159], v[76:79], v[16:31]
    ds_read_b128 v[68:71], v2 offset:23040
    buffer_load_dwordx4 v4, s[8:11], s85 offen offset:3072 sc1 lds
    s_waitcnt lgkmcnt(4)
    v_mfma_f32_32x32x16_bf16 v[16:31], a[160:163], v[48:51], v[16:31]
    ds_read_b128 v[72:75], v2 offset:23552
    buffer_load_dwordx4 v[224:227], v157, s[20:23], s89 offen offset:1024 sc1
    v_mfma_f32_32x32x16_bf16 v[16:31], a[164:167], v[52:55], v[16:31]
    ds_read_b128 v[76:79], v2 offset:24064
    s_waitcnt vmcnt(7)
    v_xor_b32 v162, 4, v162
    v_xor_b32 v163, 4, v163
    s_waitcnt lgkmcnt(4)
    v_mfma_f32_32x32x16_bf16 v[16:31], a[168:171], v[56:59], v[16:31]
    ds_read_b128 v[48:51], v2 offset:24576
    s_add_u32 s7, s39, 2
    s_cmp_lt_u32 s7, 64
    s_cselect_b32 s6, 1, 0
    v_cmp_eq_u32 vcc, 0, v8
    v_mfma_f32_32x32x16_bf16 v[16:31], a[172:175], v[60:63], v[16:31]
    ds_read_b128 v[52:55], v2 offset:25088
    s_add_u32 m0, s53, 83968
    s_nop 0
    buffer_load_dwordx4 v5, s[8:11], s85 offen offset:0 sc1 lds
    buffer_load_dwordx4 v[228:231], v157, s[20:23], s89 offen offset:2048 sc1
    s_cmp_eq_u64 vcc, 0
    s_cselect_b32 s6, s6, 0
    v_cmp_eq_u32 vcc, 0, v10
    s_waitcnt lgkmcnt(4)
    v_mfma_f32_32x32x16_bf16 v[16:31], a[176:179], v[64:67], v[16:31]
    ds_read_b128 v[56:59], v2 offset:25600
    s_nop 0
    s_cmp_eq_u64 vcc, 0
    s_cselect_b32 s7, 2, 0
    s_cmp_lt_u32 s42, 64
    s_cselect_b32 s7, s7, 0
    s_or_b32 s6, s6, s7
    v_mfma_f32_32x32x16_bf16 v[16:31], a[180:183], v[68:71], v[16:31]
    ds_read_b128 v[60:63], v2 offset:26112
    v_mov_b32 v13, s6
    s_waitcnt lgkmcnt(4)
    v_mfma_f32_32x32x16_bf16 v[16:31], a[184:187], v[72:75], v[16:31]
    ds_read_b128 v[64:67], v2 offset:26624
    buffer_load_dwordx4 v[232:235], v157, s[20:23], s89 offen offset:3072 sc1
    s_mov_b64 exec, 1
    ds_write_b32 v163, v13
    s_mov_b64 exec, -1
    v_mfma_f32_32x32x16_bf16 v[16:31], a[188:191], v[76:79], v[16:31]
    ds_read_b128 v[68:71], v2 offset:27136
    buffer_load_dwordx4 v5, s[8:11], s85 offen offset:1024 sc1 lds
    s_waitcnt lgkmcnt(5)
    v_mfma_f32_32x32x16_bf16 v[16:31], a[192:195], v[48:51], v[16:31]
    ds_read_b128 v[72:75], v2 offset:27648
    v_mfma_f32_32x32x16_bf16 v[16:31], a[196:199], v[52:55], v[16:31]
    ds_read_b128 v[76:79], v2 offset:28160
    buffer_load_dwordx4 v[164:167], v159, s[24:27], s55 offen offset:0 sc1
    s_waitcnt vmcnt(17)
    s_waitcnt lgkmcnt(3)
    s_barrier
    ds_read_b32 v14, v162
    s_cmp_le_u32 s39, s41
    s_cbranch_scc1 sm_227
    s_mov_b32 s41, s39
    s_sub_u32 s82, s39, 1
    s_lshl_b32 s82, s82, 7
    v_mov_b32 v11, 1
    buffer_store_dword v11, v12, s[16:19], s82 offen sc1
sm_227:
    s_waitcnt lgkmcnt(6)
    v_mfma_f32_32x32x16_bf16 v[16:31], a[200:203], v[56:59], v[16:31]
    ds_read_b128 v[48:51], v3 offset:0
    v_mfma_f32_32x32x16_bf16 v[16:31], a[204:207], v[60:63], v[16:31]
    ds_read_b128 v[52:55], v3 offset:512
    buffer_load_dwordx4 v5, s[8:11], s85 offen offset:2048 sc1 lds
    s_waitcnt lgkmcnt(5)
    v_mfma_f32_32x32x16_bf16 v[16:31], a[208:211], v[64:67], v[16:31]
    ds_read_b128 v[56:59], v3 offset:1024
    buffer_load_dwordx4 v[168:171], v159, s[24:27], s55 offen offset:1024 sc1
    v_mfma_f32_32x32x16_bf16 v[16:31], a[212:215], v[68:71], v[16:31]
    ds_read_b128 v[60:63], v3 offset:1536
    s_waitcnt lgkmcnt(5)
    v_mfma_f32_32x32x16_bf16 v[16:31], a[216:219], v[72:75], v[16:31]
    ds_read_b128 v[64:67], v3 offset:2048
    s_waitcnt lgkmcnt(5)
    v_readfirstlane_b32 s52, v14
    v_mfma_f32_32x32x16_bf16 v[16:31], a[220:223], v[76:79], v[16:31]
    ds_read_b128 v[68:71], v3 offset:2560
    s_add_u32 s39, s39, 1
    s_mov_b32 s14, 0x800000
    s_and_b32 s40, s52, 1
    s_cselect_b32 s10, 0xe00000, 0
    s_branch f2_LC1
f2_LC0:
    s_waitcnt lgkmcnt(4)
    v_mfma_f32_32x32x16_bf16 v[16:31], a[0:3], v[48:51], 0
    ds_read_b128 v[72:75], v2 offset:3072
    s_add_u32 s3, s42, 1
    s_add_u32 s42, s42, 4
    v_mov_b32 v10, 0
    v_mfma_f32_32x32x16_bf16 v[16:31], a[4:7], v[52:55], v[16:31]
    ds_read_b128 v[76:79], v2 offset:3584
    s_add_u32 s48, s39, 1
    s_mul_i32 s84, s48, 229376
    s_add_u32 s85, s84, 14336
    s_add_i32 s46, s39, -1
    s_lshl_b32 s2, s46, 17
    buffer_store_dwordx4 v[32:35], v6, s[12:15], s2 offen offset:0 sc1
    s_waitcnt lgkmcnt(4)
    v_mfma_f32_32x32x16_bf16 v[16:31], a[8:11], v[56:59], v[16:31]
    ds_read_b128 v[48:51], v2 offset:4096
    s_add_u32 m0, s53, 65536
    s_nop 0
    buffer_load_dwordx4 v4, s[8:11], s84 offen offset:0 sc1 lds
    v_mfma_f32_32x32x16_bf16 v[16:31], a[12:15], v[60:63], v[16:31]
    ds_read_b128 v[52:55], v2 offset:4608
    buffer_store_dwordx4 v[36:39], v6, s[12:15], s2 offen offset:512 sc1
    s_waitcnt lgkmcnt(4)
    v_mfma_f32_32x32x16_bf16 v[16:31], a[16:19], v[64:67], v[16:31]
    ds_read_b128 v[56:59], v2 offset:5120
    v_mfma_f32_32x32x16_bf16 v[16:31], a[20:23], v[68:71], v[16:31]
    ds_read_b128 v[60:63], v2 offset:5632
    buffer_store_dwordx4 v[40:43], v6, s[12:15], s2 offen offset:1024 sc1
    buffer_load_dwordx4 v4, s[8:11], s84 offen offset:1024 sc1 lds
    s_waitcnt lgkmcnt(4)
    v_mfma_f32_32x32x16_bf16 v[16:31], a[24:27], v[72:75], v[16:31]
    ds_read_b128 v[64:67], v2 offset:6144
    v_mfma_f32_32x32x16_bf16 v[16:31], a[28:31], v[76:79], v[16:31]
    ds_read_b128 v[68:71], v2 offset:6656
    buffer_store_dwordx4 v[44:47], v6, s[12:15], s2 offen offset:1536 sc1
    s_waitcnt lgkmcnt(4)
    v_mfma_f32_32x32x16_bf16 v[16:31], a[32:35], v[48:51], v[16:31]
    ds_read_b128 v[72:75], v2 offset:7168
    buffer_load_dwordx4 v4, s[8:11], s84 offen offset:2048 sc1 lds
    v_mfma_f32_32x32x16_bf16 v[16:31], a[36:39], v[52:55], v[16:31]
    ds_read_b128 v[76:79], v2 offset:7680
    s_waitcnt lgkmcnt(4)
    v_mfma_f32_32x32x16_bf16 v[16:31], a[40:43], v[56:59], v[16:31]
    ds_read_b128 v[48:51], v2 offset:8192
    v_mfma_f32_32x32x16_bf16 v[16:31], a[44:47], v[60:63], v[16:31]
    ds_read_b128 v[52:55], v2 offset:8704
    buffer_load_dwordx4 v4, s[8:11], s84 offen offset:3072 sc1 lds
    s_waitcnt lgkmcnt(4)
    v_mfma_f32_32x32x16_bf16 v[16:31], a[48:51], v[64:67], v[16:31]
    ds_read_b128 v[56:59], v2 offset:9216
    v_mfma_f32_32x32x16_bf16 v[16:31], a[52:55], v[68:71], v[16:31]
    ds_read_b128 v[60:63], v2 offset:9728
    s_waitcnt lgkmcnt(4)
    v_mfma_f32_32x32x16_bf16 v[16:31], a[56:59], v[72:75], v[16:31]
    ds_read_b128 v[64:67], v2 offset:10240
    s_add_u32 m0, s53, 69632
    s_nop 0
    buffer_load_dwordx4 v5, s[8:11], s84 offen offset:0 sc1 lds
    v_mfma_f32_32x32x16_bf16 v[16:31], a[60:63], v[76:79], v[16:31]
    ds_read_b128 v[68:71], v2 offset:10752
    s_waitcnt lgkmcnt(4)
    v_mfma_f32_32x32x16_bf16 v[16:31], a[64:67], v[48:51], v[16:31]
    ds_read_b128 v[72:75], v2 offset:11264
    v_mfma_f32_32x32x16_bf16 v[16:31], a[68:71], v[52:55], v[16:31]
    ds_read_b128 v[76:79], v2 offset:11776
    buffer_load_dwordx4 v5, s[8:11], s84 offen offset:1024 sc1 lds
    s_waitcnt lgkmcnt(4)
    v_mfma_f32_32x32x16_bf16 v[16:31], a[72:75], v[56:59], v[16:31]
    ds_read_b128 v[48:51], v2 offset:12288
    v_mfma_f32_32x32x16_bf16 v[16:31], a[76:79], v[60:63], v[16:31]
    ds_read_b128 v[52:55], v2 offset:12800
    s_waitcnt lgkmcnt(4)
    v_mfma_f32_32x32x16_bf16 v[16:31], a[80:83], v[64:67], v[16:31]
    ds_read_b128 v[56:59], v2 offset:13312
    buffer_load_dwordx4 v5, s[8:11], s84 offen offset:2048 sc1 lds
    v_mfma_f32_32x32x16_bf16 v[16:31], a[84:87], v[68:71], v[16:31]
    ds_read_b128 v[60:63], v2 offset:13824
    s_waitcnt vmcnt(11)
    s_barrier
    s_waitcnt lgkmcnt(4)
    v_mfma_f32_32x32x16_bf16 v[16:31], a[88:91], v[72:75], v[16:31]
    ds_read_b128 v[64:67], v2 offset:14336
    v_pk_add_f32 v[172:173], v[172:173], v[188:189]
    v_pk_add_f32 v[174:175], v[174:175], v[190:191]
    v_pk_add_f32 v[176:177], v[176:177], v[192:193]
    v_mfma_f32_32x32x16_bf16 v[16:31], a[92:95], v[76:79], v[16:31]
    ds_read_b128 v[68:71], v2 offset:14848
    v_pk_add_f32 v[178:179], v[178:179], v[194:195]
    v_pk_add_f32 v[180:181], v[180:181], v[196:197]
    s_waitcnt lgkmcnt(4)
    v_mfma_f32_32x32x16_bf16 v[16:31], a[96:99], v[48:51], v[16:31]
    ds_read_b128 v[72:75], v2 offset:15360
    v_pk_add_f32 v[182:183], v[182:183], v[198:199]
    v_pk_add_f32 v[184:185], v[184:185], v[200:201]
    v_mfma_f32_32x32x16_bf16 v[16:31], a[100:103], v[52:55], v[16:31]
    ds_read_b128 v[76:79], v2 offset:15872
    v_pk_add_f32 v[186:187], v[186:187], v[202:203]
    v_pk_add_f32 v[204:205], v[204:205], v[220:221]
    s_waitcnt lgkmcnt(4)
    v_mfma_f32_32x32x16_bf16 v[16:31], a[104:107], v[56:59], v[16:31]
    ds_read_b128 v[48:51], v2 offset:16384
    v_pk_add_f32 v[206:207], v[206:207], v[222:223]
    v_pk_add_f32 v[208:209], v[208:209], v[224:225]
    v_mfma_f32_32x32x16_bf16 v[16:31], a[108:111], v[60:63], v[16:31]
    ds_read_b128 v[52:55], v2 offset:16896
    v_pk_add_f32 v[210:211], v[210:211], v[226:227]
    v_pk_add_f32 v[212:213], v[212:213], v[228:229]
    s_waitcnt lgkmcnt(4)
    v_mfma_f32_32x32x16_bf16 v[16:31], a[112:115], v[64:67], v[16:31]
    ds_read_b128 v[56:59], v2 offset:17408
    s_add_u32 m0, s53, 79872
    s_nop 0
    buffer_load_dwordx4 v4, s[8:11], s85 offen offset:0 sc1 lds
    v_pk_add_f32 v[214:215], v[214:215], v[230:231]
    v_pk_add_f32 v[216:217], v[216:217], v[232:233]
    v_mfma_f32_32x32x16_bf16 v[16:31], a[116:119], v[68:71], v[16:31]
    ds_read_b128 v[60:63], v2 offset:17920
    v_pk_add_f32 v[218:219], v[218:219], v[234:235]
    v_lshlrev_b32 v188, 16, v164
    s_waitcnt lgkmcnt(4)
    v_mfma_f32_32x32x16_bf16 v[16:31], a[120:123], v[72:75], v[16:31]
    ds_read_b128 v[64:67], v2 offset:18432
    v_and_b32 v189, s101, v164
    v_lshlrev_b32 v190, 16, v165
    v_mfma_f32_32x32x16_bf16 v[16:31], a[124:127], v[76:79], v[16:31]
    ds_read_b128 v[68:71], v2 offset:18944
    s_cmp_ge_u32 s42, s39
    s_cbranch_scc1 pr_228
    s_lshl_b32 s6, s42, 7
    buffer_load_dword v10, v9, s[16:19], s6 offen sc1
pr_228:
    s_add_u32 s6, s39, 2
    s_lshl_b32 s6, s6, 9
    buffer_load_dword v8, v7, s[16:19], s6 offen sc1
    buffer_load_dwordx4 v4, s[8:11], s85 offen offset:1024 sc1 lds
    v_and_b32 v191, s101, v165
    v_lshlrev_b32 v192, 16, v166
    s_waitcnt lgkmcnt(4)
    v_mfma_f32_32x32x16_bf16 v[16:31], a[128:131], v[48:51], v[16:31]
    ds_read_b128 v[72:75], v2 offset:19456
    v_and_b32 v193, s101, v166
    v_lshlrev_b32 v194, 16, v167
    v_mfma_f32_32x32x16_bf16 v[16:31], a[132:135], v[52:55], v[16:31]
    ds_read_b128 v[76:79], v2 offset:19968
    v_and_b32 v195, s101, v167
    v_lshlrev_b32 v196, 16, v168
    s_waitcnt lgkmcnt(4)
    v_mfma_f32_32x32x16_bf16 v[16:31], a[136:139], v[56:59], v[16:31]
    ds_read_b128 v[48:51], v2 offset:20480
    v_and_b32 v197, s101, v168
    v_lshlrev_b32 v198, 16, v169
    v_mfma_f32_32x32x16_bf16 v[16:31], a[140:143], v[60:63], v[16:31]
    ds_read_b128 v[52:55], v2 offset:20992
    buffer_load_dwordx4 v4, s[8:11], s85 offen offset:2048 sc1 lds
    v_and_b32 v199, s101, v169
    v_lshlrev_b32 v200, 16, v170
    s_waitcnt lgkmcnt(4)
    v_mfma_f32_32x32x16_bf16 v[16:31], a[144:147], v[64:67], v[16:31]
    ds_read_b128 v[56:59], v2 offset:21504
    v_and_b32 v201, s101, v170
    v_lshlrev_b32 v202, 16, v171
    v_mfma_f32_32x32x16_bf16 v[16:31], a[148:151], v[68:71], v[16:31]
    ds_read_b128 v[60:63], v2 offset:22016
    v_and_b32 v203, s101, v171
    v_pk_add_f32 v[172:173], v[172:173], v[204:205]
    v_pk_add_f32 v[174:175], v[174:175], v[206:207]
    s_waitcnt lgkmcnt(4)
    v_mfma_f32_32x32x16_bf16 v[16:31], a[152:155], v[72:75], v[16:31]
    ds_read_b128 v[64:67], v2 offset:22528
    v_pk_add_f32 v[176:177], v[176:177], v[208:209]
    v_pk_add_f32 v[178:179], v[178:179], v[210:211]
    v_mfma_f32_32x32x16_bf16 v[16:31], a[156:159], v[76:79], v[16:31]
    ds_read_b128 v[68:71], v2 offset:23040
    buffer_load_dwordx4 v4, s[8:11], s85 offen offset:3072 sc1 lds
    v_pk_add_f32 v[180:181], v[180:181], v[212:213]
    v_pk_add_f32 v[182:183], v[182:183], v[214:215]
    s_waitcnt lgkmcnt(4)
    v_mfma_f32_32x32x16_bf16 v[16:31], a[160:163], v[48:51], v[16:31]
    ds_read_b128 v[72:75], v2 offset:23552
    v_pk_add_f32 v[184:185], v[184:185], v[216:217]
    v_pk_add_f32 v[186:187], v[186:187], v[218:219]
    v_mfma_f32_32x32x16_bf16 v[16:31], a[164:167], v[52:55], v[16:31]
    ds_read_b128 v[76:79], v2 offset:24064
    v_pk_add_f32 v[172:173], v[172:173], v[188:189]
    v_pk_add_f32 v[174:175], v[174:175], v[190:191]
    s_waitcnt vmcnt(3)
    v_xor_b32 v162, 4, v162
    v_xor_b32 v163, 4, v163
    s_waitcnt lgkmcnt(4)
    v_mfma_f32_32x32x16_bf16 v[16:31], a[168:171], v[56:59], v[16:31]
    ds_read_b128 v[48:51], v2 offset:24576
    v_pk_add_f32 v[176:177], v[176:177], v[192:193]
    v_pk_add_f32 v[178:179], v[178:179], v[194:195]
    s_add_u32 s7, s39, 2
    s_cmp_lt_u32 s7, 64
    s_cselect_b32 s6, 1, 0
    v_cmp_eq_u32 vcc, 0, v8
    v_mfma_f32_32x32x16_bf16 v[16:31], a[172:175], v[60:63], v[16:31]
    ds_read_b128 v[52:55], v2 offset:25088
    s_add_u32 m0, s53, 83968
    s_nop 0
    buffer_load_dwordx4 v5, s[8:11], s85 offen offset:0 sc1 lds
    v_pk_add_f32 v[180:181], v[180:181], v[196:197]
    v_pk_add_f32 v[182:183], v[182:183], v[198:199]
    s_cmp_eq_u64 vcc, 0
    s_cselect_b32 s6, s6, 0
    v_cmp_eq_u32 vcc, 0, v10
    s_waitcnt lgkmcnt(4)
    v_mfma_f32_32x32x16_bf16 v[16:31], a[176:179], v[64:67], v[16:31]
    ds_read_b128 v[56:59], v2 offset:25600
    v_pk_add_f32 v[184:185], v[184:185], v[200:201]
    v_pk_add_f32 v[186:187], v[186:187], v[202:203]
    s_cmp_eq_u64 vcc, 0
    s_cselect_b32 s7, 2, 0
    s_cmp_lt_u32 s42, 64
    s_cselect_b32 s7, s7, 0
    s_or_b32 s6, s6, s7
    v_mfma_f32_32x32x16_bf16 v[16:31], a[180:183], v[68:71], v[16:31]
    ds_read_b128 v[60:63], v2 offset:26112
    v_cvt_pk_bf16_f32 v204, v172, v173
    v_cvt_pk_bf16_f32 v205, v174, v175
    v_mov_b32 v13, s6
    s_waitcnt lgkmcnt(4)
    v_mfma_f32_32x32x16_bf16 v[16:31], a[184:187], v[72:75], v[16:31]
    ds_read_b128 v[64:67], v2 offset:26624
    v_cvt_pk_bf16_f32 v206, v176, v177
    v_cvt_pk_bf16_f32 v207, v178, v179
    s_mov_b64 exec, 1
    ds_write_b32 v163, v13
    s_mov_b64 exec, -1
    v_mfma_f32_32x32x16_bf16 v[16:31], a[188:191], v[76:79], v[16:31]
    ds_read_b128 v[68:71], v2 offset:27136
    buffer_load_dwordx4 v5, s[8:11], s85 offen offset:1024 sc1 lds
    v_cvt_pk_bf16_f32 v208, v180, v181
    v_cvt_pk_bf16_f32 v209, v182, v183
    s_waitcnt lgkmcnt(5)
    v_mfma_f32_32x32x16_bf16 v[16:31], a[192:195], v[48:51], v[16:31]
    ds_read_b128 v[72:75], v2 offset:27648
    v_cvt_pk_bf16_f32 v210, v184, v185
    v_cvt_pk_bf16_f32 v211, v186, v187
    v_mfma_f32_32x32x16_bf16 v[16:31], a[196:199], v[52:55], v[16:31]
    ds_read_b128 v[76:79], v2 offset:28160
    v_permlane32_swap_b32 v204, v206
    v_permlane32_swap_b32 v205, v207
    s_waitcnt vmcnt(7)
    s_waitcnt lgkmcnt(3)
    s_barrier
    ds_read_b32 v14, v162
    s_cmp_le_u32 s39, s41
    s_cbranch_scc1 sm_229
    s_mov_b32 s41, s39
    s_sub_u32 s82, s39, 1
    s_lshl_b32 s82, s82, 7
    v_mov_b32 v11, 1
    buffer_store_dword v11, v12, s[16:19], s82 offen sc1
sm_229:
    s_waitcnt lgkmcnt(6)
    v_mfma_f32_32x32x16_bf16 v[16:31], a[200:203], v[56:59], v[16:31]
    ds_read_b128 v[48:51], v3 offset:0
    v_permlane16_swap_b32 v204, v206
    v_permlane16_swap_b32 v205, v207
    v_mfma_f32_32x32x16_bf16 v[16:31], a[204:207], v[60:63], v[16:31]
    ds_read_b128 v[52:55], v3 offset:512
    buffer_load_dwordx4 v5, s[8:11], s85 offen offset:2048 sc1 lds
    v_permlane32_swap_b32 v208, v210
    v_permlane32_swap_b32 v209, v211
    s_waitcnt lgkmcnt(5)
    v_mfma_f32_32x32x16_bf16 v[16:31], a[208:211], v[64:67], v[16:31]
    ds_read_b128 v[56:59], v3 offset:1024
    v_permlane16_swap_b32 v208, v210
    v_permlane16_swap_b32 v209, v211
    v_mfma_f32_32x32x16_bf16 v[16:31], a[212:215], v[68:71], v[16:31]
    ds_read_b128 v[60:63], v3 offset:1536
    s_waitcnt lgkmcnt(5)
    v_mfma_f32_32x32x16_bf16 v[16:31], a[216:219], v[72:75], v[16:31]
    ds_read_b128 v[64:67], v3 offset:2048
    buffer_store_dwordx4 v[204:207], v158, s[28:31], s55 offen offset:0
    buffer_store_dwordx4 v[208:211], v158, s[28:31], s55 offen offset:64
    s_waitcnt lgkmcnt(5)
    v_readfirstlane_b32 s52, v14
    v_mfma_f32_32x32x16_bf16 v[16:31], a[220:223], v[76:79], v[16:31]
    ds_read_b128 v[68:71], v3 offset:2560
    s_cmp_eq_u32 s40, 0
    s_cbranch_scc1 f2_end0
    s_add_u32 s39, s39, 1
    s_mov_b32 s14, 0x800000
    s_and_b32 s40, s52, 1
    s_cselect_b32 s10, 0xe00000, 0
    s_cmp_eq_u32 s52, 3
    s_cbranch_scc1 f2_LR1
    s_branch f2_LP1
f2_LP1:
    s_waitcnt lgkmcnt(4)
    v_mfma_f32_32x32x16_bf16 v[32:47], a[0:3], v[48:51], 0
    ds_read_b128 v[72:75], v3 offset:3072
    s_add_u32 s48, s39, 1
    s_mul_i32 s84, s48, 229376
    s_add_u32 s85, s84, 14336
    v_mfma_f32_32x32x16_bf16 v[32:47], a[4:7], v[52:55], v[32:47]
    ds_read_b128 v[76:79], v3 offset:3584
    s_add_i32 s46, s39, -1
    s_lshl_b32 s2, s46, 17
    buffer_store_dwordx4 v[16:19], v6, s[12:15], s2 offen offset:0 sc1
    s_waitcnt lgkmcnt(4)
    v_mfma_f32_32x32x16_bf16 v[32:47], a[8:11], v[56:59], v[32:47]
    ds_read_b128 v[48:51], v3 offset:4096
    s_add_u32 m0, s53, 0
    s_nop 0
    buffer_load_dwordx4 v4, s[8:11], s84 offen offset:0 sc1 lds
    v_mfma_f32_32x32x16_bf16 v[32:47], a[12:15], v[60:63], v[32:47]
    ds_read_b128 v[52:55], v3 offset:4608
    buffer_store_dwordx4 v[20:23], v6, s[12:15], s2 offen offset:512 sc1
    s_waitcnt lgkmcnt(4)
    v_mfma_f32_32x32x16_bf16 v[32:47], a[16:19], v[64:67], v[32:47]
    ds_read_b128 v[56:59], v3 offset:5120
    v_mfma_f32_32x32x16_bf16 v[32:47], a[20:23], v[68:71], v[32:47]
    ds_read_b128 v[60:63], v3 offset:5632
    buffer_store_dwordx4 v[24:27], v6, s[12:15], s2 offen offset:1024 sc1
    buffer_load_dwordx4 v4, s[8:11], s84 offen offset:1024 sc1 lds
    s_waitcnt lgkmcnt(4)
    v_mfma_f32_32x32x16_bf16 v[32:47], a[24:27], v[72:75], v[32:47]
    ds_read_b128 v[64:67], v3 offset:6144
    v_mfma_f32_32x32x16_bf16 v[32:47], a[28:31], v[76:79], v[32:47]
    ds_read_b128 v[68:71], v3 offset:6656
    buffer_store_dwordx4 v[28:31], v6, s[12:15], s2 offen offset:1536 sc1
    s_waitcnt lgkmcnt(4)
    v_mfma_f32_32x32x16_bf16 v[32:47], a[32:35], v[48:51], v[32:47]
    ds_read_b128 v[72:75], v3 offset:7168
    buffer_load_dwordx4 v4, s[8:11], s84 offen offset:2048 sc1 lds
    v_mfma_f32_32x32x16_bf16 v[32:47], a[36:39], v[52:55], v[32:47]
    ds_read_b128 v[76:79], v3 offset:7680
    s_waitcnt lgkmcnt(4)
    v_mfma_f32_32x32x16_bf16 v[32:47], a[40:43], v[56:59], v[32:47]
    ds_read_b128 v[48:51], v3 offset:8192
    v_mfma_f32_32x32x16_bf16 v[32:47], a[44:47], v[60:63], v[32:47]
    ds_read_b128 v[52:55], v3 offset:8704
    buffer_load_dwordx4 v4, s[8:11], s84 offen offset:3072 sc1 lds
    s_waitcnt lgkmcnt(4)
    v_mfma_f32_32x32x16_bf16 v[32:47], a[48:51], v[64:67], v[32:47]
    ds_read_b128 v[56:59], v3 offset:9216
    v_mfma_f32_32x32x16_bf16 v[32:47], a[52:55], v[68:71], v[32:47]
    ds_read_b128 v[60:63], v3 offset:9728
    s_waitcnt lgkmcnt(4)
    v_mfma_f32_32x32x16_bf16 v[32:47], a[56:59], v[72:75], v[32:47]
    ds_read_b128 v[64:67], v3 offset:10240
    s_add_u32 m0, s53, 4096
    s_nop 0
    buffer_load_dwordx4 v5, s[8:11], s84 offen offset:0 sc1 lds
    v_mfma_f32_32x32x16_bf16 v[32:47], a[60:63], v[76:79], v[32:47]
    ds_read_b128 v[68:71], v3 offset:10752
    s_waitcnt lgkmcnt(4)
    v_mfma_f32_32x32x16_bf16 v[32:47], a[64:67], v[48:51], v[32:47]
    ds_read_b128 v[72:75], v3 offset:11264
    v_mfma_f32_32x32x16_bf16 v[32:47], a[68:71], v[52:55], v[32:47]
    ds_read_b128 v[76:79], v3 offset:11776
    buffer_load_dwordx4 v5, s[8:11], s84 offen offset:1024 sc1 lds
    s_waitcnt lgkmcnt(4)
    v_mfma_f32_32x32x16_bf16 v[32:47], a[72:75], v[56:59], v[32:47]
    ds_read_b128 v[48:51], v3 offset:12288
    v_mfma_f32_32x32x16_bf16 v[32:47], a[76:79], v[60:63], v[32:47]
    ds_read_b128 v[52:55], v3 offset:12800
    s_waitcnt lgkmcnt(4)
    v_mfma_f32_32x32x16_bf16 v[32:47], a[80:83], v[64:67], v[32:47]
    ds_read_b128 v[56:59], v3 offset:13312
    buffer_load_dwordx4 v5, s[8:11], s84 offen offset:2048 sc1 lds
    v_mfma_f32_32x32x16_bf16 v[32:47], a[84:87], v[68:71], v[32:47]
    ds_read_b128 v[60:63], v3 offset:13824
    s_waitcnt vmcnt(11)
    s_barrier
    s_waitcnt lgkmcnt(4)
    v_mfma_f32_32x32x16_bf16 v[32:47], a[88:91], v[72:75], v[32:47]
    ds_read_b128 v[64:67], v3 offset:14336
    v_mfma_f32_32x32x16_bf16 v[32:47], a[92:95], v[76:79], v[32:47]
    ds_read_b128 v[68:71], v3 offset:14848
    s_waitcnt lgkmcnt(4)
    v_mfma_f32_32x32x16_bf16 v[32:47], a[96:99], v[48:51], v[32:47]
    ds_read_b128 v[72:75], v3 offset:15360
    v_mfma_f32_32x32x16_bf16 v[32:47], a[100:103], v[52:55], v[32:47]
    ds_read_b128 v[76:79], v3 offset:15872
    s_waitcnt lgkmcnt(4)
    v_mfma_f32_32x32x16_bf16 v[32:47], a[104:107], v[56:59], v[32:47]
    ds_read_b128 v[48:51], v3 offset:16384
    v_mfma_f32_32x32x16_bf16 v[32:47], a[108:111], v[60:63], v[32:47]
    ds_read_b128 v[52:55], v3 offset:16896
    s_waitcnt lgkmcnt(4)
    v_mfma_f32_32x32x16_bf16 v[32:47], a[112:115], v[64:67], v[32:47]
    ds_read_b128 v[56:59], v3 offset:17408
    s_add_u32 m0, s53, 14336
    s_nop 0
    buffer_load_dwordx4 v4, s[8:11], s85 offen offset:0 sc1 lds
    v_mfma_f32_32x32x16_bf16 v[32:47], a[116:119], v[68:71], v[32:47]
    ds_read_b128 v[60:63], v3 offset:17920
    s_waitcnt lgkmcnt(4)
    v_mfma_f32_32x32x16_bf16 v[32:47], a[120:123], v[72:75], v[32:47]
    ds_read_b128 v[64:67], v3 offset:18432
    v_mfma_f32_32x32x16_bf16 v[32:47], a[124:127], v[76:79], v[32:47]
    ds_read_b128 v[68:71], v3 offset:18944
    s_cmp_ge_u32 s42, s39
    s_cbranch_scc1 pr_230
    s_lshl_b32 s6, s42, 7
    buffer_load_dword v10, v9, s[16:19], s6 offen sc1
pr_230:
    s_add_u32 s6, s39, 2
    s_lshl_b32 s6, s6, 9
    buffer_load_dword v8, v7, s[16:19], s6 offen sc1
    buffer_load_dwordx4 v4, s[8:11], s85 offen offset:1024 sc1 lds
    s_waitcnt lgkmcnt(4)
    v_mfma_f32_32x32x16_bf16 v[32:47], a[128:131], v[48:51], v[32:47]
    ds_read_b128 v[72:75], v3 offset:19456
    v_mfma_f32_32x32x16_bf16 v[32:47], a[132:135], v[52:55], v[32:47]
    ds_read_b128 v[76:79], v3 offset:19968
    s_waitcnt lgkmcnt(4)
    v_mfma_f32_32x32x16_bf16 v[32:47], a[136:139], v[56:59], v[32:47]
    ds_read_b128 v[48:51], v3 offset:20480
    v_mfma_f32_32x32x16_bf16 v[32:47], a[140:143], v[60:63], v[32:47]
    ds_read_b128 v[52:55], v3 offset:20992
    buffer_load_dwordx4 v4, s[8:11], s85 offen offset:2048 sc1 lds
    s_waitcnt lgkmcnt(4)
    v_mfma_f32_32x32x16_bf16 v[32:47], a[144:147], v[64:67], v[32:47]
    ds_read_b128 v[56:59], v3 offset:21504
    v_mfma_f32_32x32x16_bf16 v[32:47], a[148:151], v[68:71], v[32:47]
    ds_read_b128 v[60:63], v3 offset:22016
    s_waitcnt lgkmcnt(4)
    v_mfma_f32_32x32x16_bf16 v[32:47], a[152:155], v[72:75], v[32:47]
    ds_read_b128 v[64:67], v3 offset:22528
    v_mfma_f32_32x32x16_bf16 v[32:47], a[156:159], v[76:79], v[32:47]
    ds_read_b128 v[68:71], v3 offset:23040
    buffer_load_dwordx4 v4, s[8:11], s85 offen offset:3072 sc1 lds
    s_waitcnt lgkmcnt(4)
    v_mfma_f32_32x32x16_bf16 v[32:47], a[160:163], v[48:51], v[32:47]
    ds_read_b128 v[72:75], v3 offset:23552
    v_mfma_f32_32x32x16_bf16 v[32:47], a[164:167], v[52:55], v[32:47]
    ds_read_b128 v[76:79], v3 offset:24064
    s_waitcnt vmcnt(3)
    v_xor_b32 v162, 4, v162
    v_xor_b32 v163, 4, v163
    s_waitcnt lgkmcnt(4)
    v_mfma_f32_32x32x16_bf16 v[32:47], a[168:171], v[56:59], v[32:47]
    ds_read_b128 v[48:51], v3 offset:24576
    s_add_u32 s7, s39, 2
    s_cmp_lt_u32 s7, 64
    s_cselect_b32 s6, 1, 0
    v_cmp_eq_u32 vcc, 0, v8
    v_mfma_f32_32x32x16_bf16 v[32:47], a[172:175], v[60:63], v[32:47]
    ds_read_b128 v[52:55], v3 offset:25088
    s_add_u32 m0, s53, 18432
    s_nop 0
    buffer_load_dwordx4 v5, s[8:11], s85 offen offset:0 sc1 lds
    s_cmp_eq_u64 vcc, 0
    s_cselect_b32 s6, s6, 0
    v_cmp_eq_u32 vcc, 0, v10
    s_waitcnt lgkmcnt(4)
    v_mfma_f32_32x32x16_bf16 v[32:47], a[176:179], v[64:67], v[32:47]
    ds_read_b128 v[56:59], v3 offset:25600
    s_nop 0
    s_cmp_eq_u64 vcc, 0
    s_cselect_b32 s7, 2, 0
    s_cmp_lt_u32 s42, 64
    s_cselect_b32 s7, s7, 0
    s_or_b32 s6, s6, s7
    v_mfma_f32_32x32x16_bf16 v[32:47], a[180:183], v[68:71], v[32:47]
    ds_read_b128 v[60:63], v3 offset:26112
    v_mov_b32 v13, s6
    s_waitcnt lgkmcnt(4)
    v_mfma_f32_32x32x16_bf16 v[32:47], a[184:187], v[72:75], v[32:47]
    ds_read_b128 v[64:67], v3 offset:26624
    s_mov_b64 exec, 1
    ds_write_b32 v163, v13
    s_mov_b64 exec, -1
    v_mfma_f32_32x32x16_bf16 v[32:47], a[188:191], v[76:79], v[32:47]
    ds_read_b128 v[68:71], v3 offset:27136
    buffer_load_dwordx4 v5, s[8:11], s85 offen offset:1024 sc1 lds
    s_waitcnt lgkmcnt(5)
    v_mfma_f32_32x32x16_bf16 v[32:47], a[192:195], v[48:51], v[32:47]
    ds_read_b128 v[72:75], v3 offset:27648
    v_mfma_f32_32x32x16_bf16 v[32:47], a[196:199], v[52:55], v[32:47]
    ds_read_b128 v[76:79], v3 offset:28160
    s_waitcnt vmcnt(7)
    s_waitcnt lgkmcnt(3)
    s_barrier
    ds_read_b32 v14, v162
    s_cmp_le_u32 s39, s41
    s_cbranch_scc1 sm_231
    s_mov_b32 s41, s39
    s_sub_u32 s82, s39, 1
    s_lshl_b32 s82, s82, 7
    v_mov_b32 v11, 1
    buffer_store_dword v11, v12, s[16:19], s82 offen sc1
sm_231:
    s_waitcnt lgkmcnt(6)
    v_mfma_f32_32x32x16_bf16 v[32:47], a[200:203], v[56:59], v[32:47]
    ds_read_b128 v[48:51], v2 offset:0
    v_mfma_f32_32x32x16_bf16 v[32:47], a[204:207], v[60:63], v[32:47]
    ds_read_b128 v[52:55], v2 offset:512
    buffer_load_dwordx4 v5, s[8:11], s85 offen offset:2048 sc1 lds
    s_waitcnt lgkmcnt(5)
    v_mfma_f32_32x32x16_bf16 v[32:47], a[208:211], v[64:67], v[32:47]
    ds_read_b128 v[56:59], v2 offset:1024
    v_mfma_f32_32x32x16_bf16 v[32:47], a[212:215], v[68:71], v[32:47]
    ds_read_b128 v[60:63], v2 offset:1536
    s_waitcnt lgkmcnt(5)
    v_mfma_f32_32x32x16_bf16 v[32:47], a[216:219], v[72:75], v[32:47]
    ds_read_b128 v[64:67], v2 offset:2048
    s_waitcnt lgkmcnt(5)
    v_readfirstlane_b32 s52, v14
    v_mfma_f32_32x32x16_bf16 v[32:47], a[220:223], v[76:79], v[32:47]
    ds_read_b128 v[68:71], v2 offset:2560
    s_cmp_eq_u32 s40, 0
    s_cbranch_scc1 f2_end1
    s_add_u32 s39, s39, 1
    s_mov_b32 s14, 0x800000
    s_and_b32 s40, s52, 1
    s_cselect_b32 s10, 0xe00000, 0
    s_cmp_eq_u32 s52, 3
    s_cbranch_scc1 f2_LR0
    s_branch f2_LP0
f2_LR1:
    s_waitcnt lgkmcnt(4)
    v_mfma_f32_32x32x16_bf16 v[32:47], a[0:3], v[48:51], 0
    ds_read_b128 v[72:75], v3 offset:3072
    s_add_u32 s48, s39, 1
    s_mul_i32 s84, s48, 229376
    s_add_u32 s85, s84, 14336
    s_lshl_b32 s100, s42, 1
    s_lshr_b32 s47, s38, 2
    s_add_u32 s100, s100, s47
    v_mfma_f32_32x32x16_bf16 v[32:47], a[4:7], v[52:55], v[32:47]
    ds_read_b128 v[76:79], v3 offset:3584
    s_lshl_b32 s86, s100, 16
    s_lshl_b32 s55, s100, 15
    s_add_u32 s87, s86, 0x800000
    s_add_u32 s88, s87, 0x800000
    s_add_u32 s89, s88, 0x800000
    s_add_i32 s46, s39, -1
    s_lshl_b32 s2, s46, 17
    buffer_store_dwordx4 v[16:19], v6, s[12:15], s2 offen offset:0 sc1
    s_waitcnt lgkmcnt(4)
    v_mfma_f32_32x32x16_bf16 v[32:47], a[8:11], v[56:59], v[32:47]
    ds_read_b128 v[48:51], v3 offset:4096
    s_add_u32 m0, s53, 0
    s_nop 0
    buffer_load_dwordx4 v4, s[8:11], s84 offen offset:0 sc1 lds
    v_mfma_f32_32x32x16_bf16 v[32:47], a[12:15], v[60:63], v[32:47]
    ds_read_b128 v[52:55], v3 offset:4608
    buffer_store_dwordx4 v[20:23], v6, s[12:15], s2 offen offset:512 sc1
    s_waitcnt lgkmcnt(4)
    v_mfma_f32_32x32x16_bf16 v[32:47], a[16:19], v[64:67], v[32:47]
    ds_read_b128 v[56:59], v3 offset:5120
    buffer_load_dwordx4 v[172:175], v157, s[20:23], s86 offen offset:0 sc1
    v_mfma_f32_32x32x16_bf16 v[32:47], a[20:23], v[68:71], v[32:47]
    ds_read_b128 v[60:63], v3 offset:5632
    buffer_store_dwordx4 v[24:27], v6, s[12:15], s2 offen offset:1024 sc1
    buffer_load_dwordx4 v4, s[8:11], s84 offen offset:1024 sc1 lds
    s_waitcnt lgkmcnt(4)
    v_mfma_f32_32x32x16_bf16 v[32:47], a[24:27], v[72:75], v[32:47]
    ds_read_b128 v[64:67], v3 offset:6144
    buffer_load_dwordx4 v[176:179], v157, s[20:23], s86 offen offset:1024 sc1
    v_mfma_f32_32x32x16_bf16 v[32:47], a[28:31], v[76:79], v[32:47]
    ds_read_b128 v[68:71], v3 offset:6656
    buffer_store_dwordx4 v[28:31], v6, s[12:15], s2 offen offset:1536 sc1
    s_waitcnt lgkmcnt(4)
    v_mfma_f32_32x32x16_bf16 v[32:47], a[32:35], v[48:51], v[32:47]
    ds_read_b128 v[72:75], v3 offset:7168
    buffer_load_dwordx4 v4, s[8:11], s84 offen offset:2048 sc1 lds
    v_mfma_f32_32x32x16_bf16 v[32:47], a[36:39], v[52:55], v[32:47]
    ds_read_b128 v[76:79], v3 offset:7680
    buffer_load_dwordx4 v[180:183], v157, s[20:23], s86 offen offset:2048 sc1
    s_waitcnt lgkmcnt(4)
    v_mfma_f32_32x32x16_bf16 v[32:47], a[40:43], v[56:59], v[32:47]
    ds_read_b128 v[48:51], v3 offset:8192
    v_mfma_f32_32x32x16_bf16 v[32:47], a[44:47], v[60:63], v[32:47]
    ds_read_b128 v[52:55], v3 offset:8704
    buffer_load_dwordx4 v4, s[8:11], s84 offen offset:3072 sc1 lds
    s_waitcnt lgkmcnt(4)
    v_mfma_f32_32x32x16_bf16 v[32:47], a[48:51], v[64:67], v[32:47]
    ds_read_b128 v[56:59], v3 offset:9216
    buffer_load_dwordx4 v[184:187], v157, s[20:23], s86 offen offset:3072 sc1
    v_mfma_f32_32x32x16_bf16 v[32:47], a[52:55], v[68:71], v[32:47]
    ds_read_b128 v[60:63], v3 offset:9728
    s_waitcnt lgkmcnt(4)
    v_mfma_f32_32x32x16_bf16 v[32:47], a[56:59], v[72:75], v[32:47]
    ds_read_b128 v[64:67], v3 offset:10240
    s_add_u32 m0, s53, 4096
    s_nop 0
    buffer_load_dwordx4 v5, s[8:11], s84 offen offset:0 sc1 lds
    v_mfma_f32_32x32x16_bf16 v[32:47], a[60:63], v[76:79], v[32:47]
    ds_read_b128 v[68:71], v3 offset:10752
    buffer_load_dwordx4 v[188:191], v157, s[20:23], s87 offen offset:0 sc1
    s_waitcnt lgkmcnt(4)
    v_mfma_f32_32x32x16_bf16 v[32:47], a[64:67], v[48:51], v[32:47]
    ds_read_b128 v[72:75], v3 offset:11264
    v_mfma_f32_32x32x16_bf16 v[32:47], a[68:71], v[52:55], v[32:47]
    ds_read_b128 v[76:79], v3 offset:11776
    buffer_load_dwordx4 v5, s[8:11], s84 offen offset:1024 sc1 lds
    s_waitcnt lgkmcnt(4)
    v_mfma_f32_32x32x16_bf16 v[32:47], a[72:75], v[56:59], v[32:47]
    ds_read_b128 v[48:51], v3 offset:12288
    buffer_load_dwordx4 v[192:195], v157, s[20:23], s87 offen offset:1024 sc1
    v_mfma_f32_32x32x16_bf16 v[32:47], a[76:79], v[60:63], v[32:47]
    ds_read_b128 v[52:55], v3 offset:12800
    s_waitcnt lgkmcnt(4)
    v_mfma_f32_32x32x16_bf16 v[32:47], a[80:83], v[64:67], v[32:47]
    ds_read_b128 v[56:59], v3 offset:13312
    buffer_load_dwordx4 v5, s[8:11], s84 offen offset:2048 sc1 lds
    v_mfma_f32_32x32x16_bf16 v[32:47], a[84:87], v[68:71], v[32:47]
    ds_read_b128 v[60:63], v3 offset:13824
    buffer_load_dwordx4 v[196:199], v157, s[20:23], s87 offen offset:2048 sc1
    s_waitcnt vmcnt(18)
    s_barrier
    s_waitcnt lgkmcnt(4)
    v_mfma_f32_32x32x16_bf16 v[32:47], a[88:91], v[72:75], v[32:47]
    ds_read_b128 v[64:67], v3 offset:14336
    v_mfma_f32_32x32x16_bf16 v[32:47], a[92:95], v[76:79], v[32:47]
    ds_read_b128 v[68:71], v3 offset:14848
    buffer_load_dwordx4 v[200:203], v157, s[20:23], s87 offen offset:3072 sc1
    s_waitcnt lgkmcnt(4)
    v_mfma_f32_32x32x16_bf16 v[32:47], a[96:99], v[48:51], v[32:47]
    ds_read_b128 v[72:75], v3 offset:15360
    v_mfma_f32_32x32x16_bf16 v[32:47], a[100:103], v[52:55], v[32:47]
    ds_read_b128 v[76:79], v3 offset:15872
    s_waitcnt lgkmcnt(4)
    v_mfma_f32_32x32x16_bf16 v[32:47], a[104:107], v[56:59], v[32:47]
    ds_read_b128 v[48:51], v3 offset:16384
    buffer_load_dwordx4 v[204:207], v157, s[20:23], s88 offen offset:0 sc1
    v_mfma_f32_32x32x16_bf16 v[32:47], a[108:111], v[60:63], v[32:47]
    ds_read_b128 v[52:55], v3 offset:16896
    s_waitcnt lgkmcnt(4)
    v_mfma_f32_32x32x16_bf16 v[32:47], a[112:115], v[64:67], v[32:47]
    ds_read_b128 v[56:59], v3 offset:17408
    s_add_u32 m0, s53, 14336
    s_nop 0
    buffer_load_dwordx4 v4, s[8:11], s85 offen offset:0 sc1 lds
    v_mfma_f32_32x32x16_bf16 v[32:47], a[116:119], v[68:71], v[32:47]
    ds_read_b128 v[60:63], v3 offset:17920
    buffer_load_dwordx4 v[208:211], v157, s[20:23], s88 offen offset:1024 sc1
    s_waitcnt lgkmcnt(4)
    v_mfma_f32_32x32x16_bf16 v[32:47], a[120:123], v[72:75], v[32:47]
    ds_read_b128 v[64:67], v3 offset:18432
    v_mfma_f32_32x32x16_bf16 v[32:47], a[124:127], v[76:79], v[32:47]
    ds_read_b128 v[68:71], v3 offset:18944
    s_cmp_ge_u32 s42, s39
    s_cbranch_scc1 pr_232
    s_lshl_b32 s6, s42, 7
    buffer_load_dword v10, v9, s[16:19], s6 offen sc1
pr_232:
    s_add_u32 s6, s39, 2
    s_lshl_b32 s6, s6, 9
    buffer_load_dword v8, v7, s[16:19], s6 offen sc1
    buffer_load_dwordx4 v4, s[8:11], s85 offen offset:1024 sc1 lds
    s_waitcnt lgkmcnt(4)
    v_mfma_f32_32x32x16_bf16 v[32:47], a[128:131], v[48:51], v[32:47]
    ds_read_b128 v[72:75], v3 offset:19456
    buffer_load_dwordx4 v[212:215], v157, s[20:23], s88 offen offset:2048 sc1
    v_mfma_f32_32x32x16_bf16 v[32:47], a[132:135], v[52:55], v[32:47]
    ds_read_b128 v[76:79], v3 offset:19968
    s_waitcnt lgkmcnt(4)
    v_mfma_f32_32x32x16_bf16 v[32:47], a[136:139], v[56:59], v[32:47]
    ds_read_b128 v[48:51], v3 offset:20480
    v_mfma_f32_32x32x16_bf16 v[32:47], a[140:143], v[60:63], v[32:47]
    ds_read_b128 v[52:55], v3 offset:20992
    buffer_load_dwordx4 v4, s[8:11], s85 offen offset:2048 sc1 lds
    buffer_load_dwordx4 v[216:219], v157, s[20:23], s88 offen offset:3072 sc1
    s_waitcnt lgkmcnt(4)
    v_mfma_f32_32x32x16_bf16 v[32:47], a[144:147], v[64:67], v[32:47]
    ds_read_b128 v[56:59], v3 offset:21504
    v_mfma_f32_32x32x16_bf16 v[32:47], a[148:151], v[68:71], v[32:47]
    ds_read_b128 v[60:63], v3 offset:22016
    s_waitcnt lgkmcnt(4)
    v_mfma_f32_32x32x16_bf16 v[32:47], a[152:155], v[72:75], v[32:47]
    ds_read_b128 v[64:67], v3 offset:22528
    buffer_load_dwordx4 v[220:223], v157, s[20:23], s89 offen offset:0 sc1
    v_mfma_f32_32x32x16_bf16 v[32:47], a[156:159], v[76:79], v[32:47]
    ds_read_b128 v[68:71], v3 offset:23040
    buffer_load_dwordx4 v4, s[8:11], s85 offen offset:3072 sc1 lds
    s_waitcnt lgkmcnt(4)
    v_mfma_f32_32x32x16_bf16 v[32:47], a[160:163], v[48:51], v[32:47]
    ds_read_b128 v[72:75], v3 offset:23552
    buffer_load_dwordx4 v[224:227], v157, s[20:23], s89 offen offset:1024 sc1
    v_mfma_f32_32x32x16_bf16 v[32:47], a[164:167], v[52:55], v[32:47]
    ds_read_b128 v[76:79], v3 offset:24064
    s_waitcnt vmcnt(7)
    v_xor_b32 v162, 4, v162
    v_xor_b32 v163, 4, v163
    s_waitcnt lgkmcnt(4)
    v_mfma_f32_32x32x16_bf16 v[32:47], a[168:171], v[56:59], v[32:47]
    ds_read_b128 v[48:51], v3 offset:24576
    s_add_u32 s7, s39, 2
    s_cmp_lt_u32 s7, 64
    s_cselect_b32 s6, 1, 0
    v_cmp_eq_u32 vcc, 0, v8
    v_mfma_f32_32x32x16_bf16 v[32:47], a[172:175], v[60:63], v[32:47]
    ds_read_b128 v[52:55], v3 offset:25088
    s_add_u32 m0, s53, 18432
    s_nop 0
    buffer_load_dwordx4 v5, s[8:11], s85 offen offset:0 sc1 lds
    buffer_load_dwordx4 v[228:231], v157, s[20:23], s89 offen offset:2048 sc1
    s_cmp_eq_u64 vcc, 0
    s_cselect_b32 s6, s6, 0
    v_cmp_eq_u32 vcc, 0, v10
    s_waitcnt lgkmcnt(4)
    v_mfma_f32_32x32x16_bf16 v[32:47], a[176:179], v[64:67], v[32:47]
    ds_read_b128 v[56:59], v3 offset:25600
    s_nop 0
    s_cmp_eq_u64 vcc, 0
    s_cselect_b32 s7, 2, 0
    s_cmp_lt_u32 s42, 64
    s_cselect_b32 s7, s7, 0
    s_or_b32 s6, s6, s7
    v_mfma_f32_32x32x16_bf16 v[32:47], a[180:183], v[68:71], v[32:47]
    ds_read_b128 v[60:63], v3 offset:26112
    v_mov_b32 v13, s6
    s_waitcnt lgkmcnt(4)
    v_mfma_f32_32x32x16_bf16 v[32:47], a[184:187], v[72:75], v[32:47]
    ds_read_b128 v[64:67], v3 offset:26624
    buffer_load_dwordx4 v[232:235], v157, s[20:23], s89 offen offset:3072 sc1
    s_mov_b64 exec, 1
    ds_write_b32 v163, v13
    s_mov_b64 exec, -1
    v_mfma_f32_32x32x16_bf16 v[32:47], a[188:191], v[76:79], v[32:47]
    ds_read_b128 v[68:71], v3 offset:27136
    buffer_load_dwordx4 v5, s[8:11], s85 offen offset:1024 sc1 lds
    s_waitcnt lgkmcnt(5)
    v_mfma_f32_32x32x16_bf16 v[32:47], a[192:195], v[48:51], v[32:47]
    ds_read_b128 v[72:75], v3 offset:27648
    v_mfma_f32_32x32x16_bf16 v[32:47], a[196:199], v[52:55], v[32:47]
    ds_read_b128 v[76:79], v3 offset:28160
    buffer_load_dwordx4 v[164:167], v159, s[24:27], s55 offen offset:0 sc1
    s_waitcnt vmcnt(17)
    s_waitcnt lgkmcnt(3)
    s_barrier
    ds_read_b32 v14, v162
    s_cmp_le_u32 s39, s41
    s_cbranch_scc1 sm_233
    s_mov_b32 s41, s39
    s_sub_u32 s82, s39, 1
    s_lshl_b32 s82, s82, 7
    v_mov_b32 v11, 1
    buffer_store_dword v11, v12, s[16:19], s82 offen sc1
sm_233:
    s_waitcnt lgkmcnt(6)
    v_mfma_f32_32x32x16_bf16 v[32:47], a[200:203], v[56:59], v[32:47]
    ds_read_b128 v[48:51], v2 offset:0
    v_mfma_f32_32x32x16_bf16 v[32:47], a[204:207], v[60:63], v[32:47]
    ds_read_b128 v[52:55], v2 offset:512
    buffer_load_dwordx4 v5, s[8:11], s85 offen offset:2048 sc1 lds
    s_waitcnt lgkmcnt(5)
    v_mfma_f32_32x32x16_bf16 v[32:47], a[208:211], v[64:67], v[32:47]
    ds_read_b128 v[56:59], v2 offset:1024
    buffer_load_dwordx4 v[168:171], v159, s[24:27], s55 offen offset:1024 sc1
    v_mfma_f32_32x32x16_bf16 v[32:47], a[212:215], v[68:71], v[32:47]
    ds_read_b128 v[60:63], v2 offset:1536
    s_waitcnt lgkmcnt(5)
    v_mfma_f32_32x32x16_bf16 v[32:47], a[216:219], v[72:75], v[32:47]
    ds_read_b128 v[64:67], v2 offset:2048
    s_waitcnt lgkmcnt(5)
    v_readfirstlane_b32 s52, v14
    v_mfma_f32_32x32x16_bf16 v[32:47], a[220:223], v[76:79], v[32:47]
    ds_read_b128 v[68:71], v2 offset:2560
    s_add_u32 s39, s39, 1
    s_mov_b32 s14, 0x800000
    s_and_b32 s40, s52, 1
    s_cselect_b32 s10, 0xe00000, 0
    s_branch f2_LC0
f2_LC1:
    s_waitcnt lgkmcnt(4)
    v_mfma_f32_32x32x16_bf16 v[32:47], a[0:3], v[48:51], 0
    ds_read_b128 v[72:75], v3 offset:3072
    s_add_u32 s3, s42, 1
    s_add_u32 s42, s42, 4
    v_mov_b32 v10, 0
    v_mfma_f32_32x32x16_bf16 v[32:47], a[4:7], v[52:55], v[32:47]
    ds_read_b128 v[76:79], v3 offset:3584
    s_add_u32 s48, s39, 1
    s_mul_i32 s84, s48, 229376
    s_add_u32 s85, s84, 14336
    s_add_i32 s46, s39, -1
    s_lshl_b32 s2, s46, 17
    buffer_store_dwordx4 v[16:19], v6, s[12:15], s2 offen offset:0 sc1
    s_waitcnt lgkmcnt(4)
    v_mfma_f32_32x32x16_bf16 v[32:47], a[8:11], v[56:59], v[32:47]
    ds_read_b128 v[48:51], v3 offset:4096
    s_add_u32 m0, s53, 0
    s_nop 0
    buffer_load_dwordx4 v4, s[8:11], s84 offen offset:0 sc1 lds
    v_mfma_f32_32x32x16_bf16 v[32:47], a[12:15], v[60:63], v[32:47]
    ds_read_b128 v[52:55], v3 offset:4608
    buffer_store_dwordx4 v[20:23], v6, s[12:15], s2 offen offset:512 sc1
    s_waitcnt lgkmcnt(4)
    v_mfma_f32_32x32x16_bf16 v[32:47], a[16:19], v[64:67], v[32:47]
    ds_read_b128 v[56:59], v3 offset:5120
    v_mfma_f32_32x32x16_bf16 v[32:47], a[20:23], v[68:71], v[32:47]
    ds_read_b128 v[60:63], v3 offset:5632
    buffer_store_dwordx4 v[24:27], v6, s[12:15], s2 offen offset:1024 sc1
    buffer_load_dwordx4 v4, s[8:11], s84 offen offset:1024 sc1 lds
    s_waitcnt lgkmcnt(4)
    v_mfma_f32_32x32x16_bf16 v[32:47], a[24:27], v[72:75], v[32:47]
    ds_read_b128 v[64:67], v3 offset:6144
    v_mfma_f32_32x32x16_bf16 v[32:47], a[28:31], v[76:79], v[32:47]
    ds_read_b128 v[68:71], v3 offset:6656
    buffer_store_dwordx4 v[28:31], v6, s[12:15], s2 offen offset:1536 sc1
    s_waitcnt lgkmcnt(4)
    v_mfma_f32_32x32x16_bf16 v[32:47], a[32:35], v[48:51], v[32:47]
    ds_read_b128 v[72:75], v3 offset:7168
    buffer_load_dwordx4 v4, s[8:11], s84 offen offset:2048 sc1 lds
    v_mfma_f32_32x32x16_bf16 v[32:47], a[36:39], v[52:55], v[32:47]
    ds_read_b128 v[76:79], v3 offset:7680
    s_waitcnt lgkmcnt(4)
    v_mfma_f32_32x32x16_bf16 v[32:47], a[40:43], v[56:59], v[32:47]
    ds_read_b128 v[48:51], v3 offset:8192
    v_mfma_f32_32x32x16_bf16 v[32:47], a[44:47], v[60:63], v[32:47]
    ds_read_b128 v[52:55], v3 offset:8704
    buffer_load_dwordx4 v4, s[8:11], s84 offen offset:3072 sc1 lds
    s_waitcnt lgkmcnt(4)
    v_mfma_f32_32x32x16_bf16 v[32:47], a[48:51], v[64:67], v[32:47]
    ds_read_b128 v[56:59], v3 offset:9216
    v_mfma_f32_32x32x16_bf16 v[32:47], a[52:55], v[68:71], v[32:47]
    ds_read_b128 v[60:63], v3 offset:9728
    s_waitcnt lgkmcnt(4)
    v_mfma_f32_32x32x16_bf16 v[32:47], a[56:59], v[72:75], v[32:47]
    ds_read_b128 v[64:67], v3 offset:10240
    s_add_u32 m0, s53, 4096
    s_nop 0
    buffer_load_dwordx4 v5, s[8:11], s84 offen offset:0 sc1 lds
    v_mfma_f32_32x32x16_bf16 v[32:47], a[60:63], v[76:79], v[32:47]
    ds_read_b128 v[68:71], v3 offset:10752
    s_waitcnt lgkmcnt(4)
    v_mfma_f32_32x32x16_bf16 v[32:47], a[64:67], v[48:51], v[32:47]
    ds_read_b128 v[72:75], v3 offset:11264
    v_mfma_f32_32x32x16_bf16 v[32:47], a[68:71], v[52:55], v[32:47]
    ds_read_b128 v[76:79], v3 offset:11776
    buffer_load_dwordx4 v5, s[8:11], s84 offen offset:1024 sc1 lds
    s_waitcnt lgkmcnt(4)
    v_mfma_f32_32x32x16_bf16 v[32:47], a[72:75], v[56:59], v[32:47]
    ds_read_b128 v[48:51], v3 offset:12288
    v_mfma_f32_32x32x16_bf16 v[32:47], a[76:79], v[60:63], v[32:47]
    ds_read_b128 v[52:55], v3 offset:12800
    s_waitcnt lgkmcnt(4)
    v_mfma_f32_32x32x16_bf16 v[32:47], a[80:83], v[64:67], v[32:47]
    ds_read_b128 v[56:59], v3 offset:13312
    buffer_load_dwordx4 v5, s[8:11], s84 offen offset:2048 sc1 lds
    v_mfma_f32_32x32x16_bf16 v[32:47], a[84:87], v[68:71], v[32:47]
    ds_read_b128 v[60:63], v3 offset:13824
    s_waitcnt vmcnt(11)
    s_barrier
    s_waitcnt lgkmcnt(4)
    v_mfma_f32_32x32x16_bf16 v[32:47], a[88:91], v[72:75], v[32:47]
    ds_read_b128 v[64:67], v3 offset:14336
    v_pk_add_f32 v[172:173], v[172:173], v[188:189]
    v_pk_add_f32 v[174:175], v[174:175], v[190:191]
    v_pk_add_f32 v[176:177], v[176:177], v[192:193]
    v_mfma_f32_32x32x16_bf16 v[32:47], a[92:95], v[76:79], v[32:47]
    ds_read_b128 v[68:71], v3 offset:14848
    v_pk_add_f32 v[178:179], v[178:179], v[194:195]
    v_pk_add_f32 v[180:181], v[180:181], v[196:197]
    s_waitcnt lgkmcnt(4)
    v_mfma_f32_32x32x16_bf16 v[32:47], a[96:99], v[48:51], v[32:47]
    ds_read_b128 v[72:75], v3 offset:15360
    v_pk_add_f32 v[182:183], v[182:183], v[198:199]
    v_pk_add_f32 v[184:185], v[184:185], v[200:201]
    v_mfma_f32_32x32x16_bf16 v[32:47], a[100:103], v[52:55], v[32:47]
    ds_read_b128 v[76:79], v3 offset:15872
    v_pk_add_f32 v[186:187], v[186:187], v[202:203]
    v_pk_add_f32 v[204:205], v[204:205], v[220:221]
    s_waitcnt lgkmcnt(4)
    v_mfma_f32_32x32x16_bf16 v[32:47], a[104:107], v[56:59], v[32:47]
    ds_read_b128 v[48:51], v3 offset:16384
    v_pk_add_f32 v[206:207], v[206:207], v[222:223]
    v_pk_add_f32 v[208:209], v[208:209], v[224:225]
    v_mfma_f32_32x32x16_bf16 v[32:47], a[108:111], v[60:63], v[32:47]
    ds_read_b128 v[52:55], v3 offset:16896
    v_pk_add_f32 v[210:211], v[210:211], v[226:227]
    v_pk_add_f32 v[212:213], v[212:213], v[228:229]
    s_waitcnt lgkmcnt(4)
    v_mfma_f32_32x32x16_bf16 v[32:47], a[112:115], v[64:67], v[32:47]
    ds_read_b128 v[56:59], v3 offset:17408
    s_add_u32 m0, s53, 14336
    s_nop 0
    buffer_load_dwordx4 v4, s[8:11], s85 offen offset:0 sc1 lds
    v_pk_add_f32 v[214:215], v[214:215], v[230:231]
    v_pk_add_f32 v[216:217], v[216:217], v[232:233]
    v_mfma_f32_32x32x16_bf16 v[32:47], a[116:119], v[68:71], v[32:47]
    ds_read_b128 v[60:63], v3 offset:17920
    v_pk_add_f32 v[218:219], v[218:219], v[234:235]
    v_lshlrev_b32 v188, 16, v164
    s_waitcnt lgkmcnt(4)
    v_mfma_f32_32x32x16_bf16 v[32:47], a[120:123], v[72:75], v[32:47]
    ds_read_b128 v[64:67], v3 offset:18432
    v_and_b32 v189, s101, v164
    v_lshlrev_b32 v190, 16, v165
    v_mfma_f32_32x32x16_bf16 v[32:47], a[124:127], v[76:79], v[32:47]
    ds_read_b128 v[68:71], v3 offset:18944
    s_cmp_ge_u32 s42, s39
    s_cbranch_scc1 pr_234
    s_lshl_b32 s6, s42, 7
    buffer_load_dword v10, v9, s[16:19], s6 offen sc1
pr_234:
    s_add_u32 s6, s39, 2
    s_lshl_b32 s6, s6, 9
    buffer_load_dword v8, v7, s[16:19], s6 offen sc1
    buffer_load_dwordx4 v4, s[8:11], s85 offen offset:1024 sc1 lds
    v_and_b32 v191, s101, v165
    v_lshlrev_b32 v192, 16, v166
    s_waitcnt lgkmcnt(4)
    v_mfma_f32_32x32x16_bf16 v[32:47], a[128:131], v[48:51], v[32:47]
    ds_read_b128 v[72:75], v3 offset:19456
    v_and_b32 v193, s101, v166
    v_lshlrev_b32 v194, 16, v167
    v_mfma_f32_32x32x16_bf16 v[32:47], a[132:135], v[52:55], v[32:47]
    ds_read_b128 v[76:79], v3 offset:19968
    v_and_b32 v195, s101, v167
    v_lshlrev_b32 v196, 16, v168
    s_waitcnt lgkmcnt(4)
    v_mfma_f32_32x32x16_bf16 v[32:47], a[136:139], v[56:59], v[32:47]
    ds_read_b128 v[48:51], v3 offset:20480
    v_and_b32 v197, s101, v168
    v_lshlrev_b32 v198, 16, v169
    v_mfma_f32_32x32x16_bf16 v[32:47], a[140:143], v[60:63], v[32:47]
    ds_read_b128 v[52:55], v3 offset:20992
    buffer_load_dwordx4 v4, s[8:11], s85 offen offset:2048 sc1 lds
    v_and_b32 v199, s101, v169
    v_lshlrev_b32 v200, 16, v170
    s_waitcnt lgkmcnt(4)
    v_mfma_f32_32x32x16_bf16 v[32:47], a[144:147], v[64:67], v[32:47]
    ds_read_b128 v[56:59], v3 offset:21504
    v_and_b32 v201, s101, v170
    v_lshlrev_b32 v202, 16, v171
    v_mfma_f32_32x32x16_bf16 v[32:47], a[148:151], v[68:71], v[32:47]
    ds_read_b128 v[60:63], v3 offset:22016
    v_and_b32 v203, s101, v171
    v_pk_add_f32 v[172:173], v[172:173], v[204:205]
    v_pk_add_f32 v[174:175], v[174:175], v[206:207]
    s_waitcnt lgkmcnt(4)
    v_mfma_f32_32x32x16_bf16 v[32:47], a[152:155], v[72:75], v[32:47]
    ds_read_b128 v[64:67], v3 offset:22528
    v_pk_add_f32 v[176:177], v[176:177], v[208:209]
    v_pk_add_f32 v[178:179], v[178:179], v[210:211]
    v_mfma_f32_32x32x16_bf16 v[32:47], a[156:159], v[76:79], v[32:47]
    ds_read_b128 v[68:71], v3 offset:23040
    buffer_load_dwordx4 v4, s[8:11], s85 offen offset:3072 sc1 lds
    v_pk_add_f32 v[180:181], v[180:181], v[212:213]
    v_pk_add_f32 v[182:183], v[182:183], v[214:215]
    s_waitcnt lgkmcnt(4)
    v_mfma_f32_32x32x16_bf16 v[32:47], a[160:163], v[48:51], v[32:47]
    ds_read_b128 v[72:75], v3 offset:23552
    v_pk_add_f32 v[184:185], v[184:185], v[216:217]
    v_pk_add_f32 v[186:187], v[186:187], v[218:219]
    v_mfma_f32_32x32x16_bf16 v[32:47], a[164:167], v[52:55], v[32:47]
    ds_read_b128 v[76:79], v3 offset:24064
    v_pk_add_f32 v[172:173], v[172:173], v[188:189]
    v_pk_add_f32 v[174:175], v[174:175], v[190:191]
    s_waitcnt vmcnt(3)
    v_xor_b32 v162, 4, v162
    v_xor_b32 v163, 4, v163
    s_waitcnt lgkmcnt(4)
    v_mfma_f32_32x32x16_bf16 v[32:47], a[168:171], v[56:59], v[32:47]
    ds_read_b128 v[48:51], v3 offset:24576
    v_pk_add_f32 v[176:177], v[176:177], v[192:193]
    v_pk_add_f32 v[178:179], v[178:179], v[194:195]
    s_add_u32 s7, s39, 2
    s_cmp_lt_u32 s7, 64
    s_cselect_b32 s6, 1, 0
    v_cmp_eq_u32 vcc, 0, v8
    v_mfma_f32_32x32x16_bf16 v[32:47], a[172:175], v[60:63], v[32:47]
    ds_read_b128 v[52:55], v3 offset:25088
    s_add_u32 m0, s53, 18432
    s_nop 0
    buffer_load_dwordx4 v5, s[8:11], s85 offen offset:0 sc1 lds
    v_pk_add_f32 v[180:181], v[180:181], v[196:197]
    v_pk_add_f32 v[182:183], v[182:183], v[198:199]
    s_cmp_eq_u64 vcc, 0
    s_cselect_b32 s6, s6, 0
    v_cmp_eq_u32 vcc, 0, v10
    s_waitcnt lgkmcnt(4)
    v_mfma_f32_32x32x16_bf16 v[32:47], a[176:179], v[64:67], v[32:47]
    ds_read_b128 v[56:59], v3 offset:25600
    v_pk_add_f32 v[184:185], v[184:185], v[200:201]
    v_pk_add_f32 v[186:187], v[186:187], v[202:203]
    s_cmp_eq_u64 vcc, 0
    s_cselect_b32 s7, 2, 0
    s_cmp_lt_u32 s42, 64
    s_cselect_b32 s7, s7, 0
    s_or_b32 s6, s6, s7
    v_mfma_f32_32x32x16_bf16 v[32:47], a[180:183], v[68:71], v[32:47]
    ds_read_b128 v[60:63], v3 offset:26112
    v_cvt_pk_bf16_f32 v204, v172, v173
    v_cvt_pk_bf16_f32 v205, v174, v175
    v_mov_b32 v13, s6
    s_waitcnt lgkmcnt(4)
    v_mfma_f32_32x32x16_bf16 v[32:47], a[184:187], v[72:75], v[32:47]
    ds_read_b128 v[64:67], v3 offset:26624
    v_cvt_pk_bf16_f32 v206, v176, v177
    v_cvt_pk_bf16_f32 v207, v178, v179
    s_mov_b64 exec, 1
    ds_write_b32 v163, v13
    s_mov_b64 exec, -1
    v_mfma_f32_32x32x16_bf16 v[32:47], a[188:191], v[76:79], v[32:47]
    ds_read_b128 v[68:71], v3 offset:27136
    buffer_load_dwordx4 v5, s[8:11], s85 offen offset:1024 sc1 lds
    v_cvt_pk_bf16_f32 v208, v180, v181
    v_cvt_pk_bf16_f32 v209, v182, v183
    s_waitcnt lgkmcnt(5)
    v_mfma_f32_32x32x16_bf16 v[32:47], a[192:195], v[48:51], v[32:47]
    ds_read_b128 v[72:75], v3 offset:27648
    v_cvt_pk_bf16_f32 v210, v184, v185
    v_cvt_pk_bf16_f32 v211, v186, v187
    v_mfma_f32_32x32x16_bf16 v[32:47], a[196:199], v[52:55], v[32:47]
    ds_read_b128 v[76:79], v3 offset:28160
    v_permlane32_swap_b32 v204, v206
    v_permlane32_swap_b32 v205, v207
    s_waitcnt vmcnt(7)
    s_waitcnt lgkmcnt(3)
    s_barrier
    ds_read_b32 v14, v162
    s_cmp_le_u32 s39, s41
    s_cbranch_scc1 sm_235
    s_mov_b32 s41, s39
    s_sub_u32 s82, s39, 1
    s_lshl_b32 s82, s82, 7
    v_mov_b32 v11, 1
    buffer_store_dword v11, v12, s[16:19], s82 offen sc1
sm_235:
    s_waitcnt lgkmcnt(6)
    v_mfma_f32_32x32x16_bf16 v[32:47], a[200:203], v[56:59], v[32:47]
    ds_read_b128 v[48:51], v2 offset:0
    v_permlane16_swap_b32 v204, v206
    v_permlane16_swap_b32 v205, v207
    v_mfma_f32_32x32x16_bf16 v[32:47], a[204:207], v[60:63], v[32:47]
    ds_read_b128 v[52:55], v2 offset:512
    buffer_load_dwordx4 v5, s[8:11], s85 offen offset:2048 sc1 lds
    v_permlane32_swap_b32 v208, v210
    v_permlane32_swap_b32 v209, v211
    s_waitcnt lgkmcnt(5)
    v_mfma_f32_32x32x16_bf16 v[32:47], a[208:211], v[64:67], v[32:47]
    ds_read_b128 v[56:59], v2 offset:1024
    v_permlane16_swap_b32 v208, v210
    v_permlane16_swap_b32 v209, v211
    v_mfma_f32_32x32x16_bf16 v[32:47], a[212:215], v[68:71], v[32:47]
    ds_read_b128 v[60:63], v2 offset:1536
    s_waitcnt lgkmcnt(5)
    v_mfma_f32_32x32x16_bf16 v[32:47], a[216:219], v[72:75], v[32:47]
    ds_read_b128 v[64:67], v2 offset:2048
    buffer_store_dwordx4 v[204:207], v158, s[28:31], s55 offen offset:0
    buffer_store_dwordx4 v[208:211], v158, s[28:31], s55 offen offset:64
    s_waitcnt lgkmcnt(5)
    v_readfirstlane_b32 s52, v14
    v_mfma_f32_32x32x16_bf16 v[32:47], a[220:223], v[76:79], v[32:47]
    ds_read_b128 v[68:71], v2 offset:2560
    s_cmp_eq_u32 s40, 0
    s_cbranch_scc1 f2_end1
    s_add_u32 s39, s39, 1
    s_mov_b32 s14, 0x800000
    s_and_b32 s40, s52, 1
    s_cselect_b32 s10, 0xe00000, 0
    s_cmp_eq_u32 s52, 3
    s_cbranch_scc1 f2_LR0
    s_branch f2_LP0
f2_fin:
    s_cmp_ge_u32 s42, 64
    s_cbranch_scc1 f2_exit
    s_cmp_ge_u32 s42, s39
    s_cbranch_scc1 pr_236
    s_lshl_b32 s6, s42, 7
    buffer_load_dword v10, v9, s[16:19], s6 offen sc1
pr_236:
    s_waitcnt vmcnt(0)
    v_xor_b32 v162, 4, v162
    v_xor_b32 v163, 4, v163
    s_add_u32 s7, s39, 0
    s_cmp_lt_u32 s7, 64
    s_cselect_b32 s6, 1, 0
    v_cmp_eq_u32 vcc, 0, v8
    s_nop 3
    s_cmp_eq_u64 vcc, 0
    s_cselect_b32 s6, s6, 0
    v_cmp_eq_u32 vcc, 0, v10
    s_nop 3
    s_cmp_eq_u64 vcc, 0
    s_cselect_b32 s7, 2, 0
    s_cmp_lt_u32 s42, 64
    s_cselect_b32 s7, s7, 0
    s_or_b32 s6, s6, s7
    v_mov_b32 v13, s6
    s_mov_b64 exec, 1
    ds_write_b32 v163, v13
    s_mov_b64 exec, -1
    s_waitcnt lgkmcnt(0)
    s_barrier
    ds_read_b32 v14, v162
    s_waitcnt lgkmcnt(0)
    v_readfirstlane_b32 s52, v14
    s_mov_b32 s45, 2
    s_nop 2
    s_bitcmp1_b32 s52, 1
    s_cbranch_scc1 f2_red
    s_sub_u32 s43, s43, 1
    s_cbranch_scc1 f2_fin_err
    s_cmp_lg_u32 s36, 0
    s_cbranch_scc1 w0_237
    s_sleep 2
w0_237:
    s_branch f2_fin
f2_fin_err:
    s_mov_b32 s44, 21
    s_branch ssp_err
f2_exit:
    s_branch ssp_end
f2_red:
    s_lshl_b32 s100, s42, 1
    s_lshr_b32 s47, s38, 2
    s_add_u32 s100, s100, s47
    s_lshl_b32 s86, s100, 16
    s_lshl_b32 s55, s100, 15
    s_add_u32 s87, s86, 0x800000
    s_add_u32 s88, s87, 0x800000
    s_add_u32 s89, s88, 0x800000
    buffer_load_dwordx4 v[172:175], v157, s[20:23], s86 offen offset:0 sc1
    buffer_load_dwordx4 v[176:179], v157, s[20:23], s86 offen offset:1024 sc1
    buffer_load_dwordx4 v[180:183], v157, s[20:23], s86 offen offset:2048 sc1
    buffer_load_dwordx4 v[184:187], v157, s[20:23], s86 offen offset:3072 sc1
    buffer_load_dwordx4 v[188:191], v157, s[20:23], s87 offen offset:0 sc1
    buffer_load_dwordx4 v[192:195], v157, s[20:23], s87 offen offset:1024 sc1
    buffer_load_dwordx4 v[196:199], v157, s[20:23], s87 offen offset:2048 sc1
    buffer_load_dwordx4 v[200:203], v157, s[20:23], s87 offen offset:3072 sc1
    buffer_load_dwordx4 v[204:207], v157, s[20:23], s88 offen offset:0 sc1
    buffer_load_dwordx4 v[208:211], v157, s[20:23], s88 offen offset:1024 sc1
    buffer_load_dwordx4 v[212:215], v157, s[20:23], s88 offen offset:2048 sc1
    buffer_load_dwordx4 v[216:219], v157, s[20:23], s88 offen offset:3072 sc1
    buffer_load_dwordx4 v[220:223], v157, s[20:23], s89 offen offset:0 sc1
    buffer_load_dwordx4 v[224:227], v157, s[20:23], s89 offen offset:1024 sc1
    buffer_load_dwordx4 v[228:231], v157, s[20:23], s89 offen offset:2048 sc1
    buffer_load_dwordx4 v[232:235], v157, s[20:23], s89 offen offset:3072 sc1
    buffer_load_dwordx4 v[164:167], v159, s[24:27], s55 offen offset:0 sc1
    buffer_load_dwordx4 v[168:171], v159, s[24:27], s55 offen offset:1024 sc1
    s_add_u32 s3, s42, 1
    s_add_u32 s42, s42, 4
    v_mov_b32 v10, 0
    s_waitcnt vmcnt(0)
    v_pk_add_f32 v[172:173], v[172:173], v[188:189]
    v_pk_add_f32 v[174:175], v[174:175], v[190:191]
    v_pk_add_f32 v[176:177], v[176:177], v[192:193]
    v_pk_add_f32 v[178:179], v[178:179], v[194:195]
    v_pk_add_f32 v[180:181], v[180:181], v[196:197]
    v_pk_add_f32 v[182:183], v[182:183], v[198:199]
    v_pk_add_f32 v[184:185], v[184:185], v[200:201]
    v_pk_add_f32 v[186:187], v[186:187], v[202:203]
    v_pk_add_f32 v[204:205], v[204:205], v[220:221]
    v_pk_add_f32 v[206:207], v[206:207], v[222:223]
    v_pk_add_f32 v[208:209], v[208:209], v[224:225]
    v_pk_add_f32 v[210:211], v[210:211], v[226:227]
    v_pk_add_f32 v[212:213], v[212:213], v[228:229]
    v_pk_add_f32 v[214:215], v[214:215], v[230:231]
    v_pk_add_f32 v[216:217], v[216:217], v[232:233]
    v_pk_add_f32 v[218:219], v[218:219], v[234:235]
    v_lshlrev_b32 v188, 16, v164
    v_and_b32 v189, s101, v164
    v_lshlrev_b32 v190, 16, v165
    v_and_b32 v191, s101, v165
    v_lshlrev_b32 v192, 16, v166
    v_and_b32 v193, s101, v166
    v_lshlrev_b32 v194, 16, v167
    v_and_b32 v195, s101, v167
    v_lshlrev_b32 v196, 16, v168
    v_and_b32 v197, s101, v168
    v_lshlrev_b32 v198, 16, v169
    v_and_b32 v199, s101, v169
    v_lshlrev_b32 v200, 16, v170
    v_and_b32 v201, s101, v170
    v_lshlrev_b32 v202, 16, v171
    v_and_b32 v203, s101, v171
    v_pk_add_f32 v[172:173], v[172:173], v[204:205]
    v_pk_add_f32 v[174:175], v[174:175], v[206:207]
    v_pk_add_f32 v[176:177], v[176:177], v[208:209]
    v_pk_add_f32 v[178:179], v[178:179], v[210:211]
    v_pk_add_f32 v[180:181], v[180:181], v[212:213]
    v_pk_add_f32 v[182:183], v[182:183], v[214:215]
    v_pk_add_f32 v[184:185], v[184:185], v[216:217]
    v_pk_add_f32 v[186:187], v[186:187], v[218:219]
    v_pk_add_f32 v[172:173], v[172:173], v[188:189]
    v_pk_add_f32 v[174:175], v[174:175], v[190:191]
    v_pk_add_f32 v[176:177], v[176:177], v[192:193]
    v_pk_add_f32 v[178:179], v[178:179], v[194:195]
    v_pk_add_f32 v[180:181], v[180:181], v[196:197]
    v_pk_add_f32 v[182:183], v[182:183], v[198:199]
    v_pk_add_f32 v[184:185], v[184:185], v[200:201]
    v_pk_add_f32 v[186:187], v[186:187], v[202:203]
    v_cvt_pk_bf16_f32 v204, v172, v173
    v_cvt_pk_bf16_f32 v205, v174, v175
    v_cvt_pk_bf16_f32 v206, v176, v177
    v_cvt_pk_bf16_f32 v207, v178, v179
    v_cvt_pk_bf16_f32 v208, v180, v181
    v_cvt_pk_bf16_f32 v209, v182, v183
    v_cvt_pk_bf16_f32 v210, v184, v185
    v_cvt_pk_bf16_f32 v211, v186, v187
    v_permlane32_swap_b32 v204, v206
    v_permlane32_swap_b32 v205, v207
    s_nop 0
    v_permlane16_swap_b32 v204, v206
    v_permlane16_swap_b32 v205, v207
    v_permlane32_swap_b32 v208, v210
    v_permlane32_swap_b32 v209, v211
    s_nop 0
    v_permlane16_swap_b32 v208, v210
    v_permlane16_swap_b32 v209, v211
    buffer_store_dwordx4 v[204:207], v158, s[28:31], s55 offen offset:0
    buffer_store_dwordx4 v[208:211], v158, s[28:31], s55 offen offset:64
    s_cmp_eq_u32 s45, 0
    s_cbranch_scc1 f2_blk0
    s_cmp_eq_u32 s45, 1
    s_cbranch_scc1 f2_blk1
    s_branch f2_fin
role_att:
    v_and_b32 v2, 15, v1
    v_lshrrev_b32 v3, 4, v1
    v_lshlrev_b32 v32, 2, v3
    v_sub_u32 v33, v2, v32
    v_mov_b32 v34, 0x3f80
    v_mov_b32 v35, 0x3f800000
    v_cmp_eq_u32 vcc, 0, v33
    s_nop 1
    v_cndmask_b32 v16, 0, v34, vcc
    v_cmp_eq_u32 vcc, 1, v33
    s_nop 1
    v_cndmask_b32 v16, v16, v35, vcc
    v_cmp_eq_u32 vcc, 2, v33
    s_nop 1
    v_cndmask_b32 v17, 0, v34, vcc
    v_cmp_eq_u32 vcc, 3, v33
    s_nop 1
    v_cndmask_b32 v17, v17, v35, vcc
    v_mov_b32 v34, 0xff000000
    v_mov_b32 v20, 0x3f803f80
    v_cmp_gt_i32 vcc, 0, v33
    s_nop 1
    v_cndmask_b32 v24, 0, v34, vcc
    v_cmp_lt_u32 vcc, 1, v3
    s_nop 1
    v_cndmask_b32 v28, 0, v34, vcc
    v_mov_b32 v21, 0x3f803f80
    v_cmp_gt_i32 vcc, 1, v33
    s_nop 1
    v_cndmask_b32 v25, 0, v34, vcc
    v_cmp_lt_u32 vcc, 1, v3
    s_nop 1
    v_cndmask_b32 v29, 0, v34, vcc
    v_mov_b32 v22, 0x3f803f80
    v_cmp_gt_i32 vcc, 2, v33
    s_nop 1
    v_cndmask_b32 v26, 0, v34, vcc
    v_cmp_lt_u32 vcc, 1, v3
    s_nop 1
    v_cndmask_b32 v30, 0, v34, vcc
    v_mov_b32 v23, 0x3f803f80
    v_cmp_gt_i32 vcc, 3, v33
    s_nop 1
    v_cndmask_b32 v27, 0, v34, vcc
    v_cmp_lt_u32 vcc, 1, v3
    s_nop 1
    v_cndmask_b32 v31, 0, v34, vcc
    v_lshlrev_b32 v36, 4, v1
    v_lshl_add_u32 v32, v3, 3, v2
    v_lshlrev_b32 v32, 4, v32
    v_mov_b32 v33, 0x80000000
    v_cmp_gt_u32 vcc, 8, v2
    s_nop 1
    v_cndmask_b32 v37, v33, v32, vcc
    s_mov_b32 s55, 0x3e0293ee
    s_add_u32 s8, s4, 0x400000
    s_addc_u32 s9, s5, 0
    s_mov_b32 s10, 0x3000000
    s_mov_b32 s11, 0x20000
    s_add_u32 s20, s4, 0x3400000
    s_addc_u32 s21, s5, 0
    s_mov_b32 s22, 0x800000
    s_mov_b32 s23, 0x20000
    s_add_u32 s12, s4, 0x3c00000
    s_addc_u32 s13, s5, 0
    s_mov_b32 s14, 0x1000000
    s_mov_b32 s15, 0x20000
    s_lshl_b32 s56, s37, 3
    s_lshl_b32 s46, s38, 2
    s_add_u32 s56, s56, s46
    s_add_u32 s56, s56, s36
    s_lshl_b32 s48, s38, 2
    s_lshl_b32 s47, s37, 7
    s_add_u32 s48, s48, s47
    s_add_u32 s48, s48, 65536
    v_mov_b32 v12, 0x80000000
    v_mov_b32 v13, s48
    v_cmp_eq_u32 vcc, 0, v1
    s_nop 1
    v_cndmask_b32 v12, v12, v13, vcc
    v_mov_b32 v39, 131136
    s_lshl_b32 s46, s36, 2
    v_add_u32 v38, s46, v39
    v_mov_b32 v32, 0
    ds_write_b32 v38, v32
    ds_write_b32 v39, v32 offset:16
    s_waitcnt lgkmcnt(0)
    s_barrier
    v_and_b32 v32, 15, v1
    v_lshlrev_b32 v32, 2, v32
    v_bfe_u32 v33, v1, 4, 1
    v_mov_b32 v34, 4096
    v_mov_b32 v35, 4160
    v_cmp_eq_u32 vcc, 1, v33
    s_nop 1
    v_cndmask_b32 v34, v34, v35, vcc
    v_add_u32 v7, v32, v34
    v_mov_b32 v34, 64
    v_cndmask_b32 v9, v34, 16, vcc
    s_mov_b32 s54, 0
    s_mov_b32 s43, 262144
    s_mov_b32 s41, 0
    s_mov_b32 s45, 0
    s_mov_b32 s39, 0
    s_mov_b32 s40, 0
att_loop:
    s_cmp_lg_u32 s40, 0
    s_cbranch_scc1 ah_238
    s_waitcnt vmcnt(0)
    s_max_i32 s45, s45, s39
    v_mov_b32 v32, s45
    s_mov_b64 exec, 1
    ds_write_b32 v38, v32
    s_mov_b64 exec, -1
    ds_read_b128 v[32:35], v39
    ds_read_b32 v140, v39 offset:16
    s_waitcnt lgkmcnt(0)
    v_min3_u32 v32, v32, v33, v34
    v_min_u32 v32, v32, v35
    s_nop 0
    v_readfirstlane_b32 s46, v32
    v_readfirstlane_b32 s41, v140
    s_nop 3
    s_cmp_le_u32 s46, s41
    s_cbranch_scc1 pub_241
    s_mov_b64 exec, 1
    ds_write_b32 v39, v32 offset:16
    s_mov_b64 exec, -1
    v_mov_b32 v11, 1
pub_242:
    s_lshl_b32 s47, s41, 9
    buffer_store_dword v11, v12, s[16:19], s47 offen sc1
    s_add_u32 s41, s41, 1
    s_cmp_lt_u32 s41, s46
    s_cbranch_scc1 pub_242
pub_241:
ab_239:
    s_lshr_b32 s50, s39, 2
    s_cmp_lt_u32 s50, s54
    s_cbranch_scc1 ar_240
    buffer_load_dword v8, v7, s[16:19], 0 offen sc1
    s_waitcnt vmcnt(0)
    v_cmp_ge_u32 vcc, v8, v9
    s_nop 3
    s_lshr_b32 s49, vcc_lo, 16
    s_and_b32 s49, s49, vcc_lo
    s_and_b32 s49, s49, 0xffff
    s_ff0_i32_b32 s54, s49
    s_lshr_b32 s50, s39, 2
    s_cmp_lt_u32 s50, s54
    s_cbranch_scc1 ar_240
    s_sleep 2
    s_sub_u32 s43, s43, 1
    s_cbranch_scc0 ab_239
    s_mov_b32 s44, 22
    s_branch ssp_err
ar_240:
    s_mov_b32 s10, 0x3000000
    s_mov_b32 s22, 0x800000
    s_add_u32 s51, s39, 0
    s_lshl_b32 s84, s51, 18
    s_lshl_b32 s47, s56, 12
    s_add_u32 s84, s84, s47
    s_add_u32 s85, s84, 0x20000
    s_add_u32 s86, s84, 0x1000000
    s_add_u32 s87, s86, 0x20000
    s_add_u32 s88, s86, 0x1000000
    s_add_u32 s89, s88, 0x20000
    s_lshl_b32 s98, s51, 5
    s_add_u32 s98, s98, s56
    s_lshl_b32 s98, s98, 11
    s_add_u32 s99, s98, 0x400000
    buffer_load_dwordx4 a[32:35], v36, s[8:11], s86 offen offset:0 sc1
    buffer_load_dwordx4 a[36:39], v36, s[8:11], s86 offen offset:1024 sc1
    buffer_load_dwordx4 a[40:43], v36, s[8:11], s86 offen offset:2048 sc1
    buffer_load_dwordx4 a[44:47], v36, s[8:11], s86 offen offset:3072 sc1
    buffer_load_dwordx4 a[48:51], v36, s[8:11], s87 offen offset:0 sc1
    buffer_load_dwordx4 a[52:55], v36, s[8:11], s87 offen offset:1024 sc1
    buffer_load_dwordx4 a[56:59], v36, s[8:11], s87 offen offset:2048 sc1
    buffer_load_dwordx4 a[60:63], v36, s[8:11], s87 offen offset:3072 sc1
    buffer_load_dwordx4 a[0:3], v36, s[8:11], s84 offen offset:0 sc1
    buffer_load_dwordx4 a[4:7], v36, s[8:11], s84 offen offset:1024 sc1
    buffer_load_dwordx4 a[8:11], v36, s[8:11], s84 offen offset:2048 sc1
    buffer_load_dwordx4 a[12:15], v36, s[8:11], s84 offen offset:3072 sc1
    buffer_load_dwordx4 a[16:19], v36, s[8:11], s85 offen offset:0 sc1
    buffer_load_dwordx4 a[20:23], v36, s[8:11], s85 offen offset:1024 sc1
    buffer_load_dwordx4 a[24:27], v36, s[8:11], s85 offen offset:2048 sc1
    buffer_load_dwordx4 a[28:31], v36, s[8:11], s85 offen offset:3072 sc1
    buffer_load_dwordx4 a[64:67], v36, s[8:11], s88 offen offset:0 sc1
    buffer_load_dwordx4 a[68:71], v36, s[8:11], s88 offen offset:1024 sc1
    buffer_load_dwordx4 a[72:75], v36, s[8:11], s88 offen offset:2048 sc1
    buffer_load_dwordx4 a[76:79], v36, s[8:11], s88 offen offset:3072 sc1
    buffer_load_dwordx4 a[80:83], v36, s[8:11], s89 offen offset:0 sc1
    buffer_load_dwordx4 a[84:87], v36, s[8:11], s89 offen offset:1024 sc1
    buffer_load_dwordx4 a[88:91], v36, s[8:11], s89 offen offset:2048 sc1
    buffer_load_dwordx4 a[92:95], v36, s[8:11], s89 offen offset:3072 sc1
    buffer_load_dwordx4 v[40:43], v37, s[20:23], s98 offen offset:0 sc1
    buffer_load_dwordx4 v[44:47], v37, s[20:23], s98 offen offset:512 sc1
    buffer_load_dwordx4 v[48:51], v37, s[20:23], s98 offen offset:1024 sc1
    buffer_load_dwordx4 v[52:55], v37, s[20:23], s98 offen offset:1536 sc1
    buffer_load_dwordx4 v[56:59], v37, s[20:23], s99 offen offset:0 sc1
    buffer_load_dwordx4 v[60:63], v37, s[20:23], s99 offen offset:512 sc1
    buffer_load_dwordx4 v[64:67], v37, s[20:23], s99 offen offset:1024 sc1
    buffer_load_dwordx4 v[68:71], v37, s[20:23], s99 offen offset:1536 sc1
    s_waitcnt vmcnt(0)
ah_238:
    s_waitcnt vmcnt(8)
    s_sub_u32 s51, s39, 1
    s_max_i32 s45, s45, s51
    v_mov_b32 v32, s45
    s_mov_b64 exec, 1
    ds_write_b32 v38, v32
    s_mov_b64 exec, -1
    ds_read_b128 v[32:35], v39
    ds_read_b32 v140, v39 offset:16
    s_lshl_b32 s100, s39, 5
    s_add_u32 s100, s100, s56
    s_lshl_b32 s100, s100, 11
    s_add_u32 s57, s100, 0x400000
    s_add_u32 s51, s39, 1
    s_lshl_b32 s84, s51, 18
    s_lshl_b32 s47, s56, 12
    s_add_u32 s84, s84, s47
    s_add_u32 s85, s84, 0x20000
    s_add_u32 s86, s84, 0x1000000
    s_add_u32 s87, s86, 0x20000
    s_add_u32 s88, s86, 0x1000000
    s_add_u32 s89, s88, 0x20000
    s_lshl_b32 s98, s51, 5
    s_add_u32 s98, s98, s56
    s_lshl_b32 s98, s98, 11
    s_add_u32 s99, s98, 0x400000
    s_lshr_b32 s50, s51, 2
    s_cmp_lt_u32 s50, s54
    s_cselect_b32 s40, 1, 0
    s_cmp_lt_u32 s51, 64
    s_cselect_b32 s40, s40, 0
    s_cmp_lg_u32 s40, 0
    s_cselect_b32 s10, 0x3000000, 0
    v_mfma_f32_16x16x32_bf16 v[72:75], a[32:35], a[0:3], v[24:27]
    v_mfma_f32_16x16x32_bf16 v[80:83], a[32:35], a[16:19], 0
    v_mfma_f32_16x16x32_bf16 v[84:87], a[48:51], a[16:19], v[24:27]
    v_mfma_f32_16x16x32_bf16 v[72:75], a[36:39], a[4:7], v[72:75]
    v_mfma_f32_16x16x32_bf16 v[80:83], a[36:39], a[20:23], v[80:83]
    v_mfma_f32_16x16x32_bf16 v[84:87], a[52:55], a[20:23], v[84:87]
    v_mfma_f32_16x16x32_bf16 v[72:75], a[40:43], a[8:11], v[72:75]
    v_mfma_f32_16x16x32_bf16 v[80:83], a[40:43], a[24:27], v[80:83]
    v_mfma_f32_16x16x32_bf16 v[84:87], a[56:59], a[24:27], v[84:87]
    v_mfma_f32_16x16x32_bf16 v[72:75], a[44:47], a[12:15], v[72:75]
    v_mfma_f32_16x16x32_bf16 v[80:83], a[44:47], a[28:31], v[80:83]
    v_mfma_f32_16x16x32_bf16 v[84:87], a[60:63], a[28:31], v[84:87]
    s_waitcnt lgkmcnt(0)
    v_min3_u32 v32, v32, v33, v34
    v_min_u32 v32, v32, v35
    s_nop 0
    v_readfirstlane_b32 s46, v32
    v_readfirstlane_b32 s41, v140
    s_nop 3
    s_cmp_le_u32 s46, s41
    s_cbranch_scc1 pub_243
    s_mov_b64 exec, 1
    ds_write_b32 v39, v32 offset:16
    s_mov_b64 exec, -1
    v_mov_b32 v11, 1
pub_244:
    s_lshl_b32 s47, s41, 9
    buffer_store_dword v11, v12, s[16:19], s47 offen sc1
    s_add_u32 s41, s41, 1
    s_cmp_lt_u32 s41, s46
    s_cbranch_scc1 pub_244
pub_243:
    v_mfma_f32_16x16x16_bf16 v[152:155], a[64:65], v[16:17], 0
    buffer_load_dwordx4 a[128:131], v36, s[8:11], s86 offen offset:0 sc1
    v_mfma_f32_16x16x16_bf16 v[156:159], a[80:81], v[16:17], 0
    v_mfma_f32_16x16x16_bf16 v[160:163], a[66:67], v[16:17], 0
    v_mfma_f32_16x16x16_bf16 v[164:167], a[82:83], v[16:17], 0
    buffer_load_dwordx4 a[132:135], v36, s[8:11], s86 offen offset:1024 sc1
    s_nop 2
    v_cvt_pk_bf16_f32 v92, v152, v153
    v_cvt_pk_bf16_f32 v93, v154, v155
    v_cvt_pk_bf16_f32 v94, v156, v157
    buffer_load_dwordx4 a[136:139], v36, s[8:11], s86 offen offset:2048 sc1
    v_cvt_pk_bf16_f32 v95, v158, v159
    v_mfma_f32_16x16x16_bf16 v[152:155], a[68:69], v[16:17], 0
    v_mfma_f32_16x16x16_bf16 v[156:159], a[84:85], v[16:17], 0
    buffer_load_dwordx4 a[140:143], v36, s[8:11], s86 offen offset:3072 sc1
    v_cvt_pk_bf16_f32 v96, v160, v161
    v_cvt_pk_bf16_f32 v97, v162, v163
    v_cvt_pk_bf16_f32 v98, v164, v165
    buffer_load_dwordx4 a[144:147], v36, s[8:11], s87 offen offset:0 sc1
    v_cvt_pk_bf16_f32 v99, v166, v167
    v_mfma_f32_16x16x16_bf16 v[160:163], a[70:71], v[16:17], 0
    v_mfma_f32_16x16x16_bf16 v[164:167], a[86:87], v[16:17], 0
    buffer_load_dwordx4 a[148:151], v36, s[8:11], s87 offen offset:1024 sc1
    v_cvt_pk_bf16_f32 v100, v152, v153
    v_cvt_pk_bf16_f32 v101, v154, v155
    v_cvt_pk_bf16_f32 v102, v156, v157
    buffer_load_dwordx4 a[152:155], v36, s[8:11], s87 offen offset:2048 sc1
    v_cvt_pk_bf16_f32 v103, v158, v159
    v_mfma_f32_16x16x16_bf16 v[152:155], a[72:73], v[16:17], 0
    v_mfma_f32_16x16x16_bf16 v[156:159], a[88:89], v[16:17], 0
    buffer_load_dwordx4 a[156:159], v36, s[8:11], s87 offen offset:3072 sc1
    v_cvt_pk_bf16_f32 v104, v160, v161
    v_cvt_pk_bf16_f32 v105, v162, v163
    v_cvt_pk_bf16_f32 v106, v164, v165
    buffer_load_dwordx4 a[160:163], v36, s[8:11], s88 offen offset:0 sc1
    v_cvt_pk_bf16_f32 v107, v166, v167
    v_mfma_f32_16x16x16_bf16 v[160:163], a[74:75], v[16:17], 0
    v_mfma_f32_16x16x16_bf16 v[164:167], a[90:91], v[16:17], 0
    buffer_load_dwordx4 a[164:167], v36, s[8:11], s88 offen offset:1024 sc1
    v_cvt_pk_bf16_f32 v108, v152, v153
    v_cvt_pk_bf16_f32 v109, v154, v155
    v_cvt_pk_bf16_f32 v110, v156, v157
    buffer_load_dwordx4 a[168:171], v36, s[8:11], s88 offen offset:2048 sc1
    v_cvt_pk_bf16_f32 v111, v158, v159
    v_mfma_f32_16x16x16_bf16 v[152:155], a[76:77], v[16:17], 0
    v_mfma_f32_16x16x16_bf16 v[156:159], a[92:93], v[16:17], 0
    buffer_load_dwordx4 a[172:175], v36, s[8:11], s88 offen offset:3072 sc1
    v_cvt_pk_bf16_f32 v112, v160, v161
    v_cvt_pk_bf16_f32 v113, v162, v163
    v_cvt_pk_bf16_f32 v114, v164, v165
    buffer_load_dwordx4 a[176:179], v36, s[8:11], s89 offen offset:0 sc1
    v_cvt_pk_bf16_f32 v115, v166, v167
    v_mfma_f32_16x16x16_bf16 v[160:163], a[78:79], v[16:17], 0
    v_mfma_f32_16x16x16_bf16 v[164:167], a[94:95], v[16:17], 0
    buffer_load_dwordx4 a[180:183], v36, s[8:11], s89 offen offset:1024 sc1
    v_cvt_pk_bf16_f32 v116, v152, v153
    v_cvt_pk_bf16_f32 v117, v154, v155
    v_cvt_pk_bf16_f32 v118, v156, v157
    buffer_load_dwordx4 a[184:187], v36, s[8:11], s89 offen offset:2048 sc1
    v_cvt_pk_bf16_f32 v119, v158, v159
    s_nop 0
    v_cvt_pk_bf16_f32 v120, v160, v161
    v_cvt_pk_bf16_f32 v121, v162, v163
    buffer_load_dwordx4 a[188:191], v36, s[8:11], s89 offen offset:3072 sc1
    v_cvt_pk_bf16_f32 v122, v164, v165
    v_cvt_pk_bf16_f32 v123, v166, v167
    v_max3_u32 v184, v40, v41, v42
    v_max3_u32 v185, v43, v44, v45
    v_max3_u32 v186, v46, v47, v48
    v_max3_u32 v187, v49, v50, v51
    v_max3_u32 v188, v52, v53, v54
    v_max3_u32 v189, v55, v56, v57
    v_max3_u32 v190, v58, v59, v60
    v_max3_u32 v191, v61, v62, v63
    v_max3_u32 v192, v64, v65, v66
    v_max3_u32 v193, v67, v68, v69
    v_max_u32 v194, v70, v71
    v_max3_u32 v184, v184, v185, v186
    v_max3_u32 v185, v187, v188, v189
    v_max3_u32 v186, v190, v191, v192
    v_max3_u32 v184, v184, v185, v186
    v_max3_u32 v184, v184, v193, v194
    v_cmp_eq_u32 vcc, -1, v184
    s_cbranch_vccz kvd_246
    s_waitcnt vmcnt(16)
    s_max_i32 s45, s45, s39
    v_mov_b32 v32, s45
    s_mov_b64 exec, 1
    ds_write_b32 v38, v32
    s_mov_b64 exec, -1
    ds_read_b128 v[32:35], v39
    ds_read_b32 v140, v39 offset:16
    s_waitcnt lgkmcnt(0)
    v_min3_u32 v32, v32, v33, v34
    v_min_u32 v32, v32, v35
    s_nop 0
    v_readfirstlane_b32 s46, v32
    v_readfirstlane_b32 s41, v140
    s_nop 3
    s_cmp_le_u32 s46, s41
    s_cbranch_scc1 pub_247
    s_mov_b64 exec, 1
    ds_write_b32 v39, v32 offset:16
    s_mov_b64 exec, -1
    v_mov_b32 v11, 1
pub_248:
    s_lshl_b32 s47, s41, 9
    buffer_store_dword v11, v12, s[16:19], s47 offen sc1
    s_add_u32 s41, s41, 1
    s_cmp_lt_u32 s41, s46
    s_cbranch_scc1 pub_248
pub_247:
    s_mov_b32 s22, 0x800000
kvm_245:
    buffer_load_dwordx4 v[40:43], v37, s[20:23], s100 offen offset:0 sc1
    buffer_load_dwordx4 v[44:47], v37, s[20:23], s100 offen offset:512 sc1
    buffer_load_dwordx4 v[48:51], v37, s[20:23], s100 offen offset:1024 sc1
    buffer_load_dwordx4 v[52:55], v37, s[20:23], s100 offen offset:1536 sc1
    buffer_load_dwordx4 v[56:59], v37, s[20:23], s57 offen offset:0 sc1
    buffer_load_dwordx4 v[60:63], v37, s[20:23], s57 offen offset:512 sc1
    buffer_load_dwordx4 v[64:67], v37, s[20:23], s57 offen offset:1024 sc1
    buffer_load_dwordx4 v[68:71], v37, s[20:23], s57 offen offset:1536 sc1
    s_waitcnt vmcnt(0)
    v_max3_u32 v184, v40, v41, v42
    v_max3_u32 v185, v43, v44, v45
    v_max3_u32 v186, v46, v47, v48
    v_max3_u32 v187, v49, v50, v51
    v_max3_u32 v188, v52, v53, v54
    v_max3_u32 v189, v55, v56, v57
    v_max3_u32 v190, v58, v59, v60
    v_max3_u32 v191, v61, v62, v63
    v_max3_u32 v192, v64, v65, v66
    v_max3_u32 v193, v67, v68, v69
    v_max_u32 v194, v70, v71
    v_max3_u32 v184, v184, v185, v186
    v_max3_u32 v185, v187, v188, v189
    v_max3_u32 v186, v190, v191, v192
    v_max3_u32 v184, v184, v185, v186
    v_max3_u32 v184, v184, v193, v194
    v_cmp_eq_u32 vcc, -1, v184
    s_cbranch_vccz kvd_246
    s_sleep 2
    s_sub_u32 s43, s43, 1
    s_cbranch_scc0 kvm_245
    s_mov_b32 s44, 23
    s_branch ssp_err
kvd_246:
    s_cmp_lg_u32 s40, 0
    s_cselect_b32 s22, 0x800000, 0
    v_mfma_f32_16x16x32_bf16 v[76:79], v[40:43], a[0:3], v[28:31]
    buffer_load_dwordx4 a[96:99], v36, s[8:11], s84 offen offset:0 sc1
    v_mfma_f32_16x16x32_bf16 v[88:91], v[40:43], a[16:19], v[28:31]
    v_mfma_f32_16x16x32_bf16 v[76:79], v[44:47], a[4:7], v[76:79]
    v_mfma_f32_16x16x32_bf16 v[88:91], v[44:47], a[20:23], v[88:91]
    v_mfma_f32_16x16x32_bf16 v[76:79], v[48:51], a[8:11], v[76:79]
    v_mfma_f32_16x16x32_bf16 v[88:91], v[48:51], a[24:27], v[88:91]
    v_mfma_f32_16x16x32_bf16 v[76:79], v[52:55], a[12:15], v[76:79]
    v_mfma_f32_16x16x32_bf16 v[88:91], v[52:55], a[28:31], v[88:91]
    v_mfma_f32_16x16x16_bf16 v[152:155], v[56:57], v[16:17], 0
    v_mfma_f32_16x16x16_bf16 v[156:159], v[58:59], v[16:17], 0
    buffer_load_dwordx4 a[100:103], v36, s[8:11], s84 offen offset:1024 sc1
    v_mfma_f32_16x16x16_bf16 v[160:163], v[60:61], v[16:17], 0
    s_nop 4
    v_cvt_pk_bf16_f32 v124, v152, v153
    v_cvt_pk_bf16_f32 v125, v154, v155
    v_mfma_f32_16x16x16_bf16 v[164:167], v[62:63], v[16:17], 0
    v_cvt_pk_bf16_f32 v126, v156, v157
    v_cvt_pk_bf16_f32 v127, v158, v159
    v_mfma_f32_16x16x16_bf16 v[152:155], v[64:65], v[16:17], 0
    v_cvt_pk_bf16_f32 v128, v160, v161
    v_cvt_pk_bf16_f32 v129, v162, v163
    buffer_load_dwordx4 a[104:107], v36, s[8:11], s84 offen offset:2048 sc1
    v_mfma_f32_16x16x16_bf16 v[156:159], v[66:67], v[16:17], 0
    s_nop 0
    v_cvt_pk_bf16_f32 v130, v164, v165
    v_cvt_pk_bf16_f32 v131, v166, v167
    v_mfma_f32_16x16x16_bf16 v[160:163], v[68:69], v[16:17], 0
    v_cvt_pk_bf16_f32 v132, v152, v153
    v_cvt_pk_bf16_f32 v133, v154, v155
    v_mfma_f32_16x16x16_bf16 v[164:167], v[70:71], v[16:17], 0
    s_nop 0
    v_cvt_pk_bf16_f32 v134, v156, v157
    v_cvt_pk_bf16_f32 v135, v158, v159
    buffer_load_dwordx4 a[108:111], v36, s[8:11], s84 offen offset:3072 sc1
    s_nop 0
    v_cvt_pk_bf16_f32 v136, v160, v161
    v_cvt_pk_bf16_f32 v137, v162, v163
    s_nop 0
    v_cvt_pk_bf16_f32 v138, v164, v165
    v_cvt_pk_bf16_f32 v139, v166, v167
    v_max3_f32 v32, v72, v73, v74
    v_max3_f32 v34, v80, v81, v82
    v_max3_f32 v34, v34, v83, v84
    v_max3_f32 v32, v32, v75, v76
    v_max3_f32 v34, v34, v85, v86
    buffer_load_dwordx4 a[112:115], v36, s[8:11], s85 offen offset:0 sc1
    v_max3_f32 v32, v32, v77, v78
    v_max3_f32 v34, v34, v87, v88
    v_max_f32 v32, v32, v79
    v_max3_f32 v34, v34, v89, v90
    v_max_f32 v34, v34, v91
    v_mov_b32 v33, v32
    v_mov_b32 v35, v34
    s_nop 0
    v_permlane32_swap_b32 v32, v33
    v_permlane32_swap_b32 v34, v35
    buffer_load_dwordx4 a[116:119], v36, s[8:11], s85 offen offset:1024 sc1
    v_max_f32 v32, v32, v33
    v_max_f32 v34, v34, v35
    v_mov_b32 v35, v34
    v_mov_b32 v33, v32
    s_nop 0
    v_permlane16_swap_b32 v34, v35
    v_permlane16_swap_b32 v32, v33
    v_max_f32 v34, v34, v35
    v_max_f32 v32, v32, v33
    v_mul_f32 v34, s55, v34
    buffer_load_dwordx4 a[120:123], v36, s[8:11], s85 offen offset:2048 sc1
    v_mul_f32 v32, s55, v32
    v_fma_f32 v80, v80, s55, -v34
    v_fma_f32 v81, v81, s55, -v34
    v_fma_f32 v72, v72, s55, -v32
    v_fma_f32 v82, v82, s55, -v34
    v_fma_f32 v73, v73, s55, -v32
    v_fma_f32 v83, v83, s55, -v34
    v_fma_f32 v74, v74, s55, -v32
    v_fma_f32 v84, v84, s55, -v34
    buffer_load_dwordx4 a[124:127], v36, s[8:11], s85 offen offset:3072 sc1
    v_fma_f32 v85, v85, s55, -v34
    v_fma_f32 v75, v75, s55, -v32
    v_fma_f32 v86, v86, s55, -v34
    v_fma_f32 v76, v76, s55, -v32
    v_fma_f32 v87, v87, s55, -v34
    v_fma_f32 v77, v77, s55, -v32
    v_fma_f32 v88, v88, s55, -v34
    v_fma_f32 v78, v78, s55, -v32
    buffer_load_dwordx4 v[216:219], v37, s[20:23], s98 offen offset:0 sc1
    v_fma_f32 v89, v89, s55, -v34
    v_fma_f32 v90, v90, s55, -v34
    v_fma_f32 v79, v79, s55, -v32
    v_fma_f32 v91, v91, s55, -v34
    v_exp_f32 v72, v72
    v_exp_f32 v80, v80
    v_exp_f32 v73, v73
    v_exp_f32 v81, v81
    v_exp_f32 v82, v82
    buffer_load_dwordx4 v[220:223], v37, s[20:23], s98 offen offset:512 sc1
    v_exp_f32 v74, v74
    v_exp_f32 v83, v83
    v_exp_f32 v75, v75
    v_exp_f32 v84, v84
    v_exp_f32 v76, v76
    v_exp_f32 v85, v85
    v_exp_f32 v77, v77
    v_exp_f32 v86, v86
    v_exp_f32 v87, v87
    buffer_load_dwordx4 v[224:227], v37, s[20:23], s98 offen offset:1024 sc1
    v_exp_f32 v78, v78
    v_exp_f32 v88, v88
    v_exp_f32 v79, v79
    v_exp_f32 v89, v89
    v_pk_add_f32 v[168:169], v[72:73], v[76:77]
    v_exp_f32 v90, v90
    v_exp_f32 v91, v91
    v_pk_add_f32 v[170:171], v[74:75], v[78:79]
    v_pk_add_f32 v[176:177], v[80:81], v[86:87]
    buffer_load_dwordx4 v[228:231], v37, s[20:23], s98 offen offset:1536 sc1
    v_pk_add_f32 v[168:169], v[168:169], v[170:171]
    v_pk_add_f32 v[178:179], v[82:83], v[88:89]
    v_add_f32 v32, v168, v169
    v_pk_add_f32 v[180:181], v[84:85], v[90:91]
    v_pk_add_f32 v[176:177], v[176:177], v[180:181]
    v_mov_b32 v33, v32
    v_pk_add_f32 v[176:177], v[176:177], v[178:179]
    s_nop 0
    v_permlane32_swap_b32 v32, v33
    v_add_f32 v34, v176, v177
    buffer_load_dwordx4 v[232:235], v37, s[20:23], s99 offen offset:0 sc1
    v_add_f32 v32, v32, v33
    v_mov_b32 v35, v34
    v_mov_b32 v33, v32
    s_nop 0
    v_permlane32_swap_b32 v34, v35
    v_add_f32 v34, v34, v35
    v_permlane16_swap_b32 v32, v33
    v_mov_b32 v35, v34
    v_add_f32 v32, v32, v33
    s_nop 0
    v_permlane16_swap_b32 v34, v35
    buffer_load_dwordx4 v[236:239], v37, s[20:23], s99 offen offset:512 sc1
    v_rcp_f32 v32, v32
    v_add_f32 v34, v34, v35
    v_rcp_f32 v34, v34
    v_pk_mul_f32 v[72:73], v[72:73], v[32:33] op_sel_hi:[1,0]
    v_pk_mul_f32 v[80:81], v[80:81], v[34:35] op_sel_hi:[1,0]
    v_pk_mul_f32 v[74:75], v[74:75], v[32:33] op_sel_hi:[1,0]
    v_pk_mul_f32 v[82:83], v[82:83], v[34:35] op_sel_hi:[1,0]
    v_pk_mul_f32 v[76:77], v[76:77], v[32:33] op_sel_hi:[1,0]
    v_pk_mul_f32 v[84:85], v[84:85], v[34:35] op_sel_hi:[1,0]
    buffer_load_dwordx4 v[240:243], v37, s[20:23], s99 offen offset:1024 sc1
    v_pk_mul_f32 v[78:79], v[78:79], v[32:33] op_sel_hi:[1,0]
    v_pk_mul_f32 v[86:87], v[86:87], v[34:35] op_sel_hi:[1,0]
    v_pk_mul_f32 v[88:89], v[88:89], v[34:35] op_sel_hi:[1,0]
    v_cvt_pk_bf16_f32 v140, v72, v73
    v_pk_mul_f32 v[90:91], v[90:91], v[34:35] op_sel_hi:[1,0]
    v_cvt_pk_bf16_f32 v141, v74, v75
    v_cvt_pk_bf16_f32 v146, v80, v81
    v_mov_b32 v142, 0
    v_cvt_pk_bf16_f32 v147, v82, v83
    buffer_load_dwordx4 v[244:247], v37, s[20:23], s99 offen offset:1536 sc1
    v_cvt_pk_bf16_f32 v148, v84, v85
    v_mov_b32 v143, 0
    v_cvt_pk_bf16_f32 v149, v86, v87
    v_cvt_pk_bf16_f32 v144, v76, v77
    v_cvt_pk_bf16_f32 v150, v88, v89
    v_cvt_pk_bf16_f32 v145, v78, v79
    v_cvt_pk_bf16_f32 v151, v90, v91
    s_lshl_b32 s46, s39, 18
    s_lshl_b32 s47, s56, 12
    s_add_u32 s46, s46, s47
    s_add_u32 s47, s46, 0x20000
    v_mfma_f32_16x16x32_bf16 v[152:155], v[92:95], v[140:143], 0
    v_mfma_f32_16x16x32_bf16 v[156:159], v[96:99], v[140:143], 0
    v_mfma_f32_16x16x32_bf16 v[160:163], v[100:103], v[140:143], 0
    v_mfma_f32_16x16x32_bf16 v[164:167], v[104:107], v[140:143], 0
    v_mfma_f32_16x16x32_bf16 v[168:171], v[108:111], v[140:143], 0
    v_mfma_f32_16x16x32_bf16 v[172:175], v[112:115], v[140:143], 0
    v_mfma_f32_16x16x32_bf16 v[176:179], v[116:119], v[140:143], 0
    v_mfma_f32_16x16x32_bf16 v[180:183], v[120:123], v[140:143], 0
    v_mfma_f32_16x16x16_bf16 v[152:155], v[124:125], v[144:145], v[152:155]
    v_mfma_f32_16x16x16_bf16 v[156:159], v[126:127], v[144:145], v[156:159]
    v_mfma_f32_16x16x16_bf16 v[160:163], v[128:129], v[144:145], v[160:163]
    v_mfma_f32_16x16x16_bf16 v[164:167], v[130:131], v[144:145], v[164:167]
    v_mfma_f32_16x16x16_bf16 v[168:171], v[132:133], v[144:145], v[168:171]
    v_mfma_f32_16x16x16_bf16 v[172:175], v[134:135], v[144:145], v[172:175]
    v_mfma_f32_16x16x16_bf16 v[176:179], v[136:137], v[144:145], v[176:179]
    v_mfma_f32_16x16x16_bf16 v[180:183], v[138:139], v[144:145], v[180:183]
    v_mfma_f32_16x16x32_bf16 v[184:187], v[92:95], v[146:149], 0
    v_mfma_f32_16x16x32_bf16 v[188:191], v[96:99], v[146:149], 0
    v_mfma_f32_16x16x32_bf16 v[192:195], v[100:103], v[146:149], 0
    v_mfma_f32_16x16x32_bf16 v[196:199], v[104:107], v[146:149], 0
    v_mfma_f32_16x16x32_bf16 v[200:203], v[108:111], v[146:149], 0
    v_mfma_f32_16x16x32_bf16 v[204:207], v[112:115], v[146:149], 0
    v_mfma_f32_16x16x32_bf16 v[208:211], v[116:119], v[146:149], 0
    v_mfma_f32_16x16x32_bf16 v[212:215], v[120:123], v[146:149], 0
    v_mfma_f32_16x16x16_bf16 v[184:187], v[124:125], v[150:151], v[184:187]
    v_mfma_f32_16x16x16_bf16 v[188:191], v[126:127], v[150:151], v[188:191]
    v_mfma_f32_16x16x16_bf16 v[192:195], v[128:129], v[150:151], v[192:195]
    v_mfma_f32_16x16x16_bf16 v[196:199], v[130:131], v[150:151], v[196:199]
    v_mfma_f32_16x16x16_bf16 v[200:203], v[132:133], v[150:151], v[200:203]
    v_mfma_f32_16x16x16_bf16 v[204:207], v[134:135], v[150:151], v[204:207]
    v_mfma_f32_16x16x16_bf16 v[208:211], v[136:137], v[150:151], v[208:211]
    v_mfma_f32_16x16x16_bf16 v[212:215], v[138:139], v[150:151], v[212:215]
    v_cvt_pk_bf16_f32 v92, v152, v153
    v_cvt_pk_bf16_f32 v93, v154, v155
    v_cvt_pk_bf16_f32 v94, v156, v157
    v_cvt_pk_bf16_f32 v95, v158, v159
    buffer_store_dwordx4 v[92:95], v36, s[12:15], s46 offen offset:0 sc1
    v_cvt_pk_bf16_f32 v96, v160, v161
    v_cvt_pk_bf16_f32 v97, v162, v163
    v_cvt_pk_bf16_f32 v98, v164, v165
    v_cvt_pk_bf16_f32 v99, v166, v167
    buffer_store_dwordx4 v[96:99], v36, s[12:15], s46 offen offset:1024 sc1
    v_cvt_pk_bf16_f32 v100, v168, v169
    v_cvt_pk_bf16_f32 v101, v170, v171
    v_cvt_pk_bf16_f32 v102, v172, v173
    v_cvt_pk_bf16_f32 v103, v174, v175
    buffer_store_dwordx4 v[100:103], v36, s[12:15], s46 offen offset:2048 sc1
    v_cvt_pk_bf16_f32 v104, v176, v177
    v_cvt_pk_bf16_f32 v105, v178, v179
    v_cvt_pk_bf16_f32 v106, v180, v181
    v_cvt_pk_bf16_f32 v107, v182, v183
    buffer_store_dwordx4 v[104:107], v36, s[12:15], s46 offen offset:3072 sc1
    v_cvt_pk_bf16_f32 v108, v184, v185
    v_cvt_pk_bf16_f32 v109, v186, v187
    v_cvt_pk_bf16_f32 v110, v188, v189
    v_cvt_pk_bf16_f32 v111, v190, v191
    buffer_store_dwordx4 v[108:111], v36, s[12:15], s47 offen offset:0 sc1
    v_cvt_pk_bf16_f32 v112, v192, v193
    v_cvt_pk_bf16_f32 v113, v194, v195
    v_cvt_pk_bf16_f32 v114, v196, v197
    v_cvt_pk_bf16_f32 v115, v198, v199
    buffer_store_dwordx4 v[112:115], v36, s[12:15], s47 offen offset:1024 sc1
    v_cvt_pk_bf16_f32 v116, v200, v201
    v_cvt_pk_bf16_f32 v117, v202, v203
    v_cvt_pk_bf16_f32 v118, v204, v205
    v_cvt_pk_bf16_f32 v119, v206, v207
    buffer_store_dwordx4 v[116:119], v36, s[12:15], s47 offen offset:2048 sc1
    v_cvt_pk_bf16_f32 v120, v208, v209
    v_cvt_pk_bf16_f32 v121, v210, v211
    v_cvt_pk_bf16_f32 v122, v212, v213
    v_cvt_pk_bf16_f32 v123, v214, v215
    buffer_store_dwordx4 v[120:123], v36, s[12:15], s47 offen offset:3072 sc1
    s_add_u32 s39, s39, 1
    s_cmp_lg_u32 s40, 0
    s_cbranch_scc1 ah_249
    s_waitcnt vmcnt(0)
    s_max_i32 s45, s45, s39
    v_mov_b32 v32, s45
    s_mov_b64 exec, 1
    ds_write_b32 v38, v32
    s_mov_b64 exec, -1
    ds_read_b128 v[32:35], v39
    ds_read_b32 v140, v39 offset:16
    s_waitcnt lgkmcnt(0)
    v_min3_u32 v32, v32, v33, v34
    v_min_u32 v32, v32, v35
    s_nop 0
    v_readfirstlane_b32 s46, v32
    v_readfirstlane_b32 s41, v140
    s_nop 3
    s_cmp_le_u32 s46, s41
    s_cbranch_scc1 pub_252
    s_mov_b64 exec, 1
    ds_write_b32 v39, v32 offset:16
    s_mov_b64 exec, -1
    v_mov_b32 v11, 1
pub_253:
    s_lshl_b32 s47, s41, 9
    buffer_store_dword v11, v12, s[16:19], s47 offen sc1
    s_add_u32 s41, s41, 1
    s_cmp_lt_u32 s41, s46
    s_cbranch_scc1 pub_253
pub_252:
ab_250:
    s_lshr_b32 s50, s39, 2
    s_cmp_lt_u32 s50, s54
    s_cbranch_scc1 ar_251
    buffer_load_dword v8, v7, s[16:19], 0 offen sc1
    s_waitcnt vmcnt(0)
    v_cmp_ge_u32 vcc, v8, v9
    s_nop 3
    s_lshr_b32 s49, vcc_lo, 16
    s_and_b32 s49, s49, vcc_lo
    s_and_b32 s49, s49, 0xffff
    s_ff0_i32_b32 s54, s49
    s_lshr_b32 s50, s39, 2
    s_cmp_lt_u32 s50, s54
    s_cbranch_scc1 ar_251
    s_sleep 2
    s_sub_u32 s43, s43, 1
    s_cbranch_scc0 ab_250
    s_mov_b32 s44, 22
    s_branch ssp_err
ar_251:
    s_mov_b32 s10, 0x3000000
    s_mov_b32 s22, 0x800000
    s_add_u32 s51, s39, 0
    s_lshl_b32 s84, s51, 18
    s_lshl_b32 s47, s56, 12
    s_add_u32 s84, s84, s47
    s_add_u32 s85, s84, 0x20000
    s_add_u32 s86, s84, 0x1000000
    s_add_u32 s87, s86, 0x20000
    s_add_u32 s88, s86, 0x1000000
    s_add_u32 s89, s88, 0x20000
    s_lshl_b32 s98, s51, 5
    s_add_u32 s98, s98, s56
    s_lshl_b32 s98, s98, 11
    s_add_u32 s99, s98, 0x400000
    buffer_load_dwordx4 a[128:131], v36, s[8:11], s86 offen offset:0 sc1
    buffer_load_dwordx4 a[132:135], v36, s[8:11], s86 offen offset:1024 sc1
    buffer_load_dwordx4 a[136:139], v36, s[8:11], s86 offen offset:2048 sc1
    buffer_load_dwordx4 a[140:143], v36, s[8:11], s86 offen offset:3072 sc1
    buffer_load_dwordx4 a[144:147], v36, s[8:11], s87 offen offset:0 sc1
    buffer_load_dwordx4 a[148:151], v36, s[8:11], s87 offen offset:1024 sc1
    buffer_load_dwordx4 a[152:155], v36, s[8:11], s87 offen offset:2048 sc1
    buffer_load_dwordx4 a[156:159], v36, s[8:11], s87 offen offset:3072 sc1
    buffer_load_dwordx4 a[96:99], v36, s[8:11], s84 offen offset:0 sc1
    buffer_load_dwordx4 a[100:103], v36, s[8:11], s84 offen offset:1024 sc1
    buffer_load_dwordx4 a[104:107], v36, s[8:11], s84 offen offset:2048 sc1
    buffer_load_dwordx4 a[108:111], v36, s[8:11], s84 offen offset:3072 sc1
    buffer_load_dwordx4 a[112:115], v36, s[8:11], s85 offen offset:0 sc1
    buffer_load_dwordx4 a[116:119], v36, s[8:11], s85 offen offset:1024 sc1
    buffer_load_dwordx4 a[120:123], v36, s[8:11], s85 offen offset:2048 sc1
    buffer_load_dwordx4 a[124:127], v36, s[8:11], s85 offen offset:3072 sc1
    buffer_load_dwordx4 a[160:163], v36, s[8:11], s88 offen offset:0 sc1
    buffer_load_dwordx4 a[164:167], v36, s[8:11], s88 offen offset:1024 sc1
    buffer_load_dwordx4 a[168:171], v36, s[8:11], s88 offen offset:2048 sc1
    buffer_load_dwordx4 a[172:175], v36, s[8:11], s88 offen offset:3072 sc1
    buffer_load_dwordx4 a[176:179], v36, s[8:11], s89 offen offset:0 sc1
    buffer_load_dwordx4 a[180:183], v36, s[8:11], s89 offen offset:1024 sc1
    buffer_load_dwordx4 a[184:187], v36, s[8:11], s89 offen offset:2048 sc1
    buffer_load_dwordx4 a[188:191], v36, s[8:11], s89 offen offset:3072 sc1
    buffer_load_dwordx4 v[216:219], v37, s[20:23], s98 offen offset:0 sc1
    buffer_load_dwordx4 v[220:223], v37, s[20:23], s98 offen offset:512 sc1
    buffer_load_dwordx4 v[224:227], v37, s[20:23], s98 offen offset:1024 sc1
    buffer_load_dwordx4 v[228:231], v37, s[20:23], s98 offen offset:1536 sc1
    buffer_load_dwordx4 v[232:235], v37, s[20:23], s99 offen offset:0 sc1
    buffer_load_dwordx4 v[236:239], v37, s[20:23], s99 offen offset:512 sc1
    buffer_load_dwordx4 v[240:243], v37, s[20:23], s99 offen offset:1024 sc1
    buffer_load_dwordx4 v[244:247], v37, s[20:23], s99 offen offset:1536 sc1
    s_waitcnt vmcnt(0)
ah_249:
    s_waitcnt vmcnt(8)
    s_sub_u32 s51, s39, 1
    s_max_i32 s45, s45, s51
    v_mov_b32 v32, s45
    s_mov_b64 exec, 1
    ds_write_b32 v38, v32
    s_mov_b64 exec, -1
    ds_read_b128 v[32:35], v39
    ds_read_b32 v140, v39 offset:16
    s_lshl_b32 s100, s39, 5
    s_add_u32 s100, s100, s56
    s_lshl_b32 s100, s100, 11
    s_add_u32 s57, s100, 0x400000
    s_add_u32 s51, s39, 1
    s_lshl_b32 s84, s51, 18
    s_lshl_b32 s47, s56, 12
    s_add_u32 s84, s84, s47
    s_add_u32 s85, s84, 0x20000
    s_add_u32 s86, s84, 0x1000000
    s_add_u32 s87, s86, 0x20000
    s_add_u32 s88, s86, 0x1000000
    s_add_u32 s89, s88, 0x20000
    s_lshl_b32 s98, s51, 5
    s_add_u32 s98, s98, s56
    s_lshl_b32 s98, s98, 11
    s_add_u32 s99, s98, 0x400000
    s_lshr_b32 s50, s51, 2
    s_cmp_lt_u32 s50, s54
    s_cselect_b32 s40, 1, 0
    s_cmp_lt_u32 s51, 64
    s_cselect_b32 s40, s40, 0
    s_cmp_lg_u32 s40, 0
    s_cselect_b32 s10, 0x3000000, 0
    v_mfma_f32_16x16x32_bf16 v[72:75], a[128:131], a[96:99], v[24:27]
    v_mfma_f32_16x16x32_bf16 v[80:83], a[128:131], a[112:115], 0
    v_mfma_f32_16x16x32_bf16 v[84:87], a[144:147], a[112:115], v[24:27]
    v_mfma_f32_16x16x32_bf16 v[72:75], a[132:135], a[100:103], v[72:75]
    v_mfma_f32_16x16x32_bf16 v[80:83], a[132:135], a[116:119], v[80:83]
    v_mfma_f32_16x16x32_bf16 v[84:87], a[148:151], a[116:119], v[84:87]
    v_mfma_f32_16x16x32_bf16 v[72:75], a[136:139], a[104:107], v[72:75]
    v_mfma_f32_16x16x32_bf16 v[80:83], a[136:139], a[120:123], v[80:83]
    v_mfma_f32_16x16x32_bf16 v[84:87], a[152:155], a[120:123], v[84:87]
    v_mfma_f32_16x16x32_bf16 v[72:75], a[140:143], a[108:111], v[72:75]
    v_mfma_f32_16x16x32_bf16 v[80:83], a[140:143], a[124:127], v[80:83]
    v_mfma_f32_16x16x32_bf16 v[84:87], a[156:159], a[124:127], v[84:87]
    s_waitcnt lgkmcnt(0)
    v_min3_u32 v32, v32, v33, v34
    v_min_u32 v32, v32, v35
    s_nop 0
    v_readfirstlane_b32 s46, v32
    v_readfirstlane_b32 s41, v140
    s_nop 3
    s_cmp_le_u32 s46, s41
    s_cbranch_scc1 pub_254
    s_mov_b64 exec, 1
    ds_write_b32 v39, v32 offset:16
    s_mov_b64 exec, -1
    v_mov_b32 v11, 1
pub_255:
    s_lshl_b32 s47, s41, 9
    buffer_store_dword v11, v12, s[16:19], s47 offen sc1
    s_add_u32 s41, s41, 1
    s_cmp_lt_u32 s41, s46
    s_cbranch_scc1 pub_255
pub_254:
    v_mfma_f32_16x16x16_bf16 v[152:155], a[160:161], v[16:17], 0
    buffer_load_dwordx4 a[32:35], v36, s[8:11], s86 offen offset:0 sc1
    v_mfma_f32_16x16x16_bf16 v[156:159], a[176:177], v[16:17], 0
    v_mfma_f32_16x16x16_bf16 v[160:163], a[162:163], v[16:17], 0
    v_mfma_f32_16x16x16_bf16 v[164:167], a[178:179], v[16:17], 0
    buffer_load_dwordx4 a[36:39], v36, s[8:11], s86 offen offset:1024 sc1
    s_nop 2
    v_cvt_pk_bf16_f32 v92, v152, v153
    v_cvt_pk_bf16_f32 v93, v154, v155
    v_cvt_pk_bf16_f32 v94, v156, v157
    buffer_load_dwordx4 a[40:43], v36, s[8:11], s86 offen offset:2048 sc1
    v_cvt_pk_bf16_f32 v95, v158, v159
    v_mfma_f32_16x16x16_bf16 v[152:155], a[164:165], v[16:17], 0
    v_mfma_f32_16x16x16_bf16 v[156:159], a[180:181], v[16:17], 0
    buffer_load_dwordx4 a[44:47], v36, s[8:11], s86 offen offset:3072 sc1
    v_cvt_pk_bf16_f32 v96, v160, v161
    v_cvt_pk_bf16_f32 v97, v162, v163
    v_cvt_pk_bf16_f32 v98, v164, v165
    buffer_load_dwordx4 a[48:51], v36, s[8:11], s87 offen offset:0 sc1
    v_cvt_pk_bf16_f32 v99, v166, v167
    v_mfma_f32_16x16x16_bf16 v[160:163], a[166:167], v[16:17], 0
    v_mfma_f32_16x16x16_bf16 v[164:167], a[182:183], v[16:17], 0
    buffer_load_dwordx4 a[52:55], v36, s[8:11], s87 offen offset:1024 sc1
    v_cvt_pk_bf16_f32 v100, v152, v153
    v_cvt_pk_bf16_f32 v101, v154, v155
    v_cvt_pk_bf16_f32 v102, v156, v157
    buffer_load_dwordx4 a[56:59], v36, s[8:11], s87 offen offset:2048 sc1
    v_cvt_pk_bf16_f32 v103, v158, v159
    v_mfma_f32_16x16x16_bf16 v[152:155], a[168:169], v[16:17], 0
    v_mfma_f32_16x16x16_bf16 v[156:159], a[184:185], v[16:17], 0
    buffer_load_dwordx4 a[60:63], v36, s[8:11], s87 offen offset:3072 sc1
    v_cvt_pk_bf16_f32 v104, v160, v161
    v_cvt_pk_bf16_f32 v105, v162, v163
    v_cvt_pk_bf16_f32 v106, v164, v165
    buffer_load_dwordx4 a[64:67], v36, s[8:11], s88 offen offset:0 sc1
    v_cvt_pk_bf16_f32 v107, v166, v167
    v_mfma_f32_16x16x16_bf16 v[160:163], a[170:171], v[16:17], 0
    v_mfma_f32_16x16x16_bf16 v[164:167], a[186:187], v[16:17], 0
    buffer_load_dwordx4 a[68:71], v36, s[8:11], s88 offen offset:1024 sc1
    v_cvt_pk_bf16_f32 v108, v152, v153
    v_cvt_pk_bf16_f32 v109, v154, v155
    v_cvt_pk_bf16_f32 v110, v156, v157
    buffer_load_dwordx4 a[72:75], v36, s[8:11], s88 offen offset:2048 sc1
    v_cvt_pk_bf16_f32 v111, v158, v159
    v_mfma_f32_16x16x16_bf16 v[152:155], a[172:173], v[16:17], 0
    v_mfma_f32_16x16x16_bf16 v[156:159], a[188:189], v[16:17], 0
    buffer_load_dwordx4 a[76:79], v36, s[8:11], s88 offen offset:3072 sc1
    v_cvt_pk_bf16_f32 v112, v160, v161
    v_cvt_pk_bf16_f32 v113, v162, v163
    v_cvt_pk_bf16_f32 v114, v164, v165
    buffer_load_dwordx4 a[80:83], v36, s[8:11], s89 offen offset:0 sc1
    v_cvt_pk_bf16_f32 v115, v166, v167
    v_mfma_f32_16x16x16_bf16 v[160:163], a[174:175], v[16:17], 0
    v_mfma_f32_16x16x16_bf16 v[164:167], a[190:191], v[16:17], 0
    buffer_load_dwordx4 a[84:87], v36, s[8:11], s89 offen offset:1024 sc1
    v_cvt_pk_bf16_f32 v116, v152, v153
    v_cvt_pk_bf16_f32 v117, v154, v155
    v_cvt_pk_bf16_f32 v118, v156, v157
    buffer_load_dwordx4 a[88:91], v36, s[8:11], s89 offen offset:2048 sc1
    v_cvt_pk_bf16_f32 v119, v158, v159
    s_nop 0
    v_cvt_pk_bf16_f32 v120, v160, v161
    v_cvt_pk_bf16_f32 v121, v162, v163
    buffer_load_dwordx4 a[92:95], v36, s[8:11], s89 offen offset:3072 sc1
    v_cvt_pk_bf16_f32 v122, v164, v165
    v_cvt_pk_bf16_f32 v123, v166, v167
    v_max3_u32 v184, v216, v217, v218
    v_max3_u32 v185, v219, v220, v221
    v_max3_u32 v186, v222, v223, v224
    v_max3_u32 v187, v225, v226, v227
    v_max3_u32 v188, v228, v229, v230
    v_max3_u32 v189, v231, v232, v233
    v_max3_u32 v190, v234, v235, v236
    v_max3_u32 v191, v237, v238, v239
    v_max3_u32 v192, v240, v241, v242
    v_max3_u32 v193, v243, v244, v245
    v_max_u32 v194, v246, v247
    v_max3_u32 v184, v184, v185, v186
    v_max3_u32 v185, v187, v188, v189
    v_max3_u32 v186, v190, v191, v192
    v_max3_u32 v184, v184, v185, v186
    v_max3_u32 v184, v184, v193, v194
    v_cmp_eq_u32 vcc, -1, v184
    s_cbranch_vccz kvd_257
    s_waitcnt vmcnt(16)
    s_max_i32 s45, s45, s39
    v_mov_b32 v32, s45
    s_mov_b64 exec, 1
    ds_write_b32 v38, v32
    s_mov_b64 exec, -1
    ds_read_b128 v[32:35], v39
    ds_read_b32 v140, v39 offset:16
    s_waitcnt lgkmcnt(0)
    v_min3_u32 v32, v32, v33, v34
    v_min_u32 v32, v32, v35
    s_nop 0
    v_readfirstlane_b32 s46, v32
    v_readfirstlane_b32 s41, v140
    s_nop 3
    s_cmp_le_u32 s46, s41
    s_cbranch_scc1 pub_258
    s_mov_b64 exec, 1
    ds_write_b32 v39, v32 offset:16
    s_mov_b64 exec, -1
    v_mov_b32 v11, 1
pub_259:
    s_lshl_b32 s47, s41, 9
    buffer_store_dword v11, v12, s[16:19], s47 offen sc1
    s_add_u32 s41, s41, 1
    s_cmp_lt_u32 s41, s46
    s_cbranch_scc1 pub_259
pub_258:
    s_mov_b32 s22, 0x800000
kvm_256:
    buffer_load_dwordx4 v[216:219], v37, s[20:23], s100 offen offset:0 sc1
    buffer_load_dwordx4 v[220:223], v37, s[20:23], s100 offen offset:512 sc1
    buffer_load_dwordx4 v[224:227], v37, s[20:23], s100 offen offset:1024 sc1
    buffer_load_dwordx4 v[228:231], v37, s[20:23], s100 offen offset:1536 sc1
    buffer_load_dwordx4 v[232:235], v37, s[20:23], s57 offen offset:0 sc1
    buffer_load_dwordx4 v[236:239], v37, s[20:23], s57 offen offset:512 sc1
    buffer_load_dwordx4 v[240:243], v37, s[20:23], s57 offen offset:1024 sc1
    buffer_load_dwordx4 v[244:247], v37, s[20:23], s57 offen offset:1536 sc1
    s_waitcnt vmcnt(0)
    v_max3_u32 v184, v216, v217, v218
    v_max3_u32 v185, v219, v220, v221
    v_max3_u32 v186, v222, v223, v224
    v_max3_u32 v187, v225, v226, v227
    v_max3_u32 v188, v228, v229, v230
    v_max3_u32 v189, v231, v232, v233
    v_max3_u32 v190, v234, v235, v236
    v_max3_u32 v191, v237, v238, v239
    v_max3_u32 v192, v240, v241, v242
    v_max3_u32 v193, v243, v244, v245
    v_max_u32 v194, v246, v247
    v_max3_u32 v184, v184, v185, v186
    v_max3_u32 v185, v187, v188, v189
    v_max3_u32 v186, v190, v191, v192
    v_max3_u32 v184, v184, v185, v186
    v_max3_u32 v184, v184, v193, v194
    v_cmp_eq_u32 vcc, -1, v184
    s_cbranch_vccz kvd_257
    s_sleep 2
    s_sub_u32 s43, s43, 1
    s_cbranch_scc0 kvm_256
    s_mov_b32 s44, 23
    s_branch ssp_err
kvd_257:
    s_cmp_lg_u32 s40, 0
    s_cselect_b32 s22, 0x800000, 0
    v_mfma_f32_16x16x32_bf16 v[76:79], v[216:219], a[96:99], v[28:31]
    buffer_load_dwordx4 a[0:3], v36, s[8:11], s84 offen offset:0 sc1
    v_mfma_f32_16x16x32_bf16 v[88:91], v[216:219], a[112:115], v[28:31]
    v_mfma_f32_16x16x32_bf16 v[76:79], v[220:223], a[100:103], v[76:79]
    v_mfma_f32_16x16x32_bf16 v[88:91], v[220:223], a[116:119], v[88:91]
    v_mfma_f32_16x16x32_bf16 v[76:79], v[224:227], a[104:107], v[76:79]
    v_mfma_f32_16x16x32_bf16 v[88:91], v[224:227], a[120:123], v[88:91]
    v_mfma_f32_16x16x32_bf16 v[76:79], v[228:231], a[108:111], v[76:79]
    v_mfma_f32_16x16x32_bf16 v[88:91], v[228:231], a[124:127], v[88:91]
    v_mfma_f32_16x16x16_bf16 v[152:155], v[232:233], v[16:17], 0
    v_mfma_f32_16x16x16_bf16 v[156:159], v[234:235], v[16:17], 0
    buffer_load_dwordx4 a[4:7], v36, s[8:11], s84 offen offset:1024 sc1
    v_mfma_f32_16x16x16_bf16 v[160:163], v[236:237], v[16:17], 0
    s_nop 4
    v_cvt_pk_bf16_f32 v124, v152, v153
    v_cvt_pk_bf16_f32 v125, v154, v155
    v_mfma_f32_16x16x16_bf16 v[164:167], v[238:239], v[16:17], 0
    v_cvt_pk_bf16_f32 v126, v156, v157
    v_cvt_pk_bf16_f32 v127, v158, v159
    v_mfma_f32_16x16x16_bf16 v[152:155], v[240:241], v[16:17], 0
    v_cvt_pk_bf16_f32 v128, v160, v161
    v_cvt_pk_bf16_f32 v129, v162, v163
    buffer_load_dwordx4 a[8:11], v36, s[8:11], s84 offen offset:2048 sc1
    v_mfma_f32_16x16x16_bf16 v[156:159], v[242:243], v[16:17], 0
    s_nop 0
    v_cvt_pk_bf16_f32 v130, v164, v165
    v_cvt_pk_bf16_f32 v131, v166, v167
    v_mfma_f32_16x16x16_bf16 v[160:163], v[244:245], v[16:17], 0
    v_cvt_pk_bf16_f32 v132, v152, v153
    v_cvt_pk_bf16_f32 v133, v154, v155
    v_mfma_f32_16x16x16_bf16 v[164:167], v[246:247], v[16:17], 0
    s_nop 0
    v_cvt_pk_bf16_f32 v134, v156, v157
    v_cvt_pk_bf16_f32 v135, v158, v159
    buffer_load_dwordx4 a[12:15], v36, s[8:11], s84 offen offset:3072 sc1
    s_nop 0
    v_cvt_pk_bf16_f32 v136, v160, v161
    v_cvt_pk_bf16_f32 v137, v162, v163
    s_nop 0
    v_cvt_pk_bf16_f32 v138, v164, v165
    v_cvt_pk_bf16_f32 v139, v166, v167
    v_max3_f32 v32, v72, v73, v74
    v_max3_f32 v34, v80, v81, v82
    v_max3_f32 v34, v34, v83, v84
    v_max3_f32 v32, v32, v75, v76
    v_max3_f32 v34, v34, v85, v86
    buffer_load_dwordx4 a[16:19], v36, s[8:11], s85 offen offset:0 sc1
    v_max3_f32 v32, v32, v77, v78
    v_max3_f32 v34, v34, v87, v88
    v_max_f32 v32, v32, v79
    v_max3_f32 v34, v34, v89, v90
    v_max_f32 v34, v34, v91
    v_mov_b32 v33, v32
    v_mov_b32 v35, v34
    s_nop 0
    v_permlane32_swap_b32 v32, v33
    v_permlane32_swap_b32 v34, v35
    buffer_load_dwordx4 a[20:23], v36, s[8:11], s85 offen offset:1024 sc1
    v_max_f32 v32, v32, v33
    v_max_f32 v34, v34, v35
    v_mov_b32 v35, v34
    v_mov_b32 v33, v32
    s_nop 0
    v_permlane16_swap_b32 v34, v35
    v_permlane16_swap_b32 v32, v33
    v_max_f32 v34, v34, v35
    v_max_f32 v32, v32, v33
    v_mul_f32 v34, s55, v34
    buffer_load_dwordx4 a[24:27], v36, s[8:11], s85 offen offset:2048 sc1
    v_mul_f32 v32, s55, v32
    v_fma_f32 v80, v80, s55, -v34
    v_fma_f32 v81, v81, s55, -v34
    v_fma_f32 v72, v72, s55, -v32
    v_fma_f32 v82, v82, s55, -v34
    v_fma_f32 v73, v73, s55, -v32
    v_fma_f32 v83, v83, s55, -v34
    v_fma_f32 v74, v74, s55, -v32
    v_fma_f32 v84, v84, s55, -v34
    buffer_load_dwordx4 a[28:31], v36, s[8:11], s85 offen offset:3072 sc1
    v_fma_f32 v85, v85, s55, -v34
    v_fma_f32 v75, v75, s55, -v32
    v_fma_f32 v86, v86, s55, -v34
    v_fma_f32 v76, v76, s55, -v32
    v_fma_f32 v87, v87, s55, -v34
    v_fma_f32 v77, v77, s55, -v32
    v_fma_f32 v88, v88, s55, -v34
    v_fma_f32 v78, v78, s55, -v32
    buffer_load_dwordx4 v[40:43], v37, s[20:23], s98 offen offset:0 sc1
    v_fma_f32 v89, v89, s55, -v34
    v_fma_f32 v90, v90, s55, -v34
    v_fma_f32 v79, v79, s55, -v32
    v_fma_f32 v91, v91, s55, -v34
    v_exp_f32 v72, v72
    v_exp_f32 v80, v80
    v_exp_f32 v73, v73
    v_exp_f32 v81, v81
    v_exp_f32 v82, v82
    buffer_load_dwordx4 v[44:47], v37, s[20:23], s98 offen offset:512 sc1
    v_exp_f32 v74, v74
    v_exp_f32 v83, v83
    v_exp_f32 v75, v75
    v_exp_f32 v84, v84
    v_exp_f32 v76, v76
    v_exp_f32 v85, v85
    v_exp_f32 v77, v77
    v_exp_f32 v86, v86
    v_exp_f32 v87, v87
    buffer_load_dwordx4 v[48:51], v37, s[20:23], s98 offen offset:1024 sc1
    v_exp_f32 v78, v78
    v_exp_f32 v88, v88
    v_exp_f32 v79, v79
    v_exp_f32 v89, v89
    v_pk_add_f32 v[168:169], v[72:73], v[76:77]
    v_exp_f32 v90, v90
    v_exp_f32 v91, v91
    v_pk_add_f32 v[170:171], v[74:75], v[78:79]
    v_pk_add_f32 v[176:177], v[80:81], v[86:87]
    buffer_load_dwordx4 v[52:55], v37, s[20:23], s98 offen offset:1536 sc1
    v_pk_add_f32 v[168:169], v[168:169], v[170:171]
    v_pk_add_f32 v[178:179], v[82:83], v[88:89]
    v_add_f32 v32, v168, v169
    v_pk_add_f32 v[180:181], v[84:85], v[90:91]
    v_pk_add_f32 v[176:177], v[176:177], v[180:181]
    v_mov_b32 v33, v32
    v_pk_add_f32 v[176:177], v[176:177], v[178:179]
    s_nop 0
    v_permlane32_swap_b32 v32, v33
    v_add_f32 v34, v176, v177
    buffer_load_dwordx4 v[56:59], v37, s[20:23], s99 offen offset:0 sc1
    v_add_f32 v32, v32, v33
    v_mov_b32 v35, v34
    v_mov_b32 v33, v32
    s_nop 0
    v_permlane32_swap_b32 v34, v35
    v_add_f32 v34, v34, v35
    v_permlane16_swap_b32 v32, v33
    v_mov_b32 v35, v34
    v_add_f32 v32, v32, v33
    s_nop 0
    v_permlane16_swap_b32 v34, v35
    buffer_load_dwordx4 v[60:63], v37, s[20:23], s99 offen offset:512 sc1
    v_rcp_f32 v32, v32
    v_add_f32 v34, v34, v35
    v_rcp_f32 v34, v34
    v_pk_mul_f32 v[72:73], v[72:73], v[32:33] op_sel_hi:[1,0]
    v_pk_mul_f32 v[80:81], v[80:81], v[34:35] op_sel_hi:[1,0]
    v_pk_mul_f32 v[74:75], v[74:75], v[32:33] op_sel_hi:[1,0]
    v_pk_mul_f32 v[82:83], v[82:83], v[34:35] op_sel_hi:[1,0]
    v_pk_mul_f32 v[76:77], v[76:77], v[32:33] op_sel_hi:[1,0]
    v_pk_mul_f32 v[84:85], v[84:85], v[34:35] op_sel_hi:[1,0]
    buffer_load_dwordx4 v[64:67], v37, s[20:23], s99 offen offset:1024 sc1
    v_pk_mul_f32 v[78:79], v[78:79], v[32:33] op_sel_hi:[1,0]
    v_pk_mul_f32 v[86:87], v[86:87], v[34:35] op_sel_hi:[1,0]
    v_pk_mul_f32 v[88:89], v[88:89], v[34:35] op_sel_hi:[1,0]
    v_cvt_pk_bf16_f32 v140, v72, v73
    v_pk_mul_f32 v[90:91], v[90:91], v[34:35] op_sel_hi:[1,0]
    v_cvt_pk_bf16_f32 v141, v74, v75
    v_cvt_pk_bf16_f32 v146, v80, v81
    v_mov_b32 v142, 0
    v_cvt_pk_bf16_f32 v147, v82, v83
    buffer_load_dwordx4 v[68:71], v37, s[20:23], s99 offen offset:1536 sc1
    v_cvt_pk_bf16_f32 v148, v84, v85
    v_mov_b32 v143, 0
    v_cvt_pk_bf16_f32 v149, v86, v87
    v_cvt_pk_bf16_f32 v144, v76, v77
    v_cvt_pk_bf16_f32 v150, v88, v89
    v_cvt_pk_bf16_f32 v145, v78, v79
    v_cvt_pk_bf16_f32 v151, v90, v91
    s_lshl_b32 s46, s39, 18
    s_lshl_b32 s47, s56, 12
    s_add_u32 s46, s46, s47
    s_add_u32 s47, s46, 0x20000
    v_mfma_f32_16x16x32_bf16 v[152:155], v[92:95], v[140:143], 0
    v_mfma_f32_16x16x32_bf16 v[156:159], v[96:99], v[140:143], 0
    v_mfma_f32_16x16x32_bf16 v[160:163], v[100:103], v[140:143], 0
    v_mfma_f32_16x16x32_bf16 v[164:167], v[104:107], v[140:143], 0
    v_mfma_f32_16x16x32_bf16 v[168:171], v[108:111], v[140:143], 0
    v_mfma_f32_16x16x32_bf16 v[172:175], v[112:115], v[140:143], 0
    v_mfma_f32_16x16x32_bf16 v[176:179], v[116:119], v[140:143], 0
    v_mfma_f32_16x16x32_bf16 v[180:183], v[120:123], v[140:143], 0
    v_mfma_f32_16x16x16_bf16 v[152:155], v[124:125], v[144:145], v[152:155]
    v_mfma_f32_16x16x16_bf16 v[156:159], v[126:127], v[144:145], v[156:159]
    v_mfma_f32_16x16x16_bf16 v[160:163], v[128:129], v[144:145], v[160:163]
    v_mfma_f32_16x16x16_bf16 v[164:167], v[130:131], v[144:145], v[164:167]
    v_mfma_f32_16x16x16_bf16 v[168:171], v[132:133], v[144:145], v[168:171]
    v_mfma_f32_16x16x16_bf16 v[172:175], v[134:135], v[144:145], v[172:175]
    v_mfma_f32_16x16x16_bf16 v[176:179], v[136:137], v[144:145], v[176:179]
    v_mfma_f32_16x16x16_bf16 v[180:183], v[138:139], v[144:145], v[180:183]
    v_mfma_f32_16x16x32_bf16 v[184:187], v[92:95], v[146:149], 0
    v_mfma_f32_16x16x32_bf16 v[188:191], v[96:99], v[146:149], 0
    v_mfma_f32_16x16x32_bf16 v[192:195], v[100:103], v[146:149], 0
    v_mfma_f32_16x16x32_bf16 v[196:199], v[104:107], v[146:149], 0
    v_mfma_f32_16x16x32_bf16 v[200:203], v[108:111], v[146:149], 0
    v_mfma_f32_16x16x32_bf16 v[204:207], v[112:115], v[146:149], 0
    v_mfma_f32_16x16x32_bf16 v[208:211], v[116:119], v[146:149], 0
    v_mfma_f32_16x16x32_bf16 v[212:215], v[120:123], v[146:149], 0
    v_mfma_f32_16x16x16_bf16 v[184:187], v[124:125], v[150:151], v[184:187]
    v_mfma_f32_16x16x16_bf16 v[188:191], v[126:127], v[150:151], v[188:191]
    v_mfma_f32_16x16x16_bf16 v[192:195], v[128:129], v[150:151], v[192:195]
    v_mfma_f32_16x16x16_bf16 v[196:199], v[130:131], v[150:151], v[196:199]
    v_mfma_f32_16x16x16_bf16 v[200:203], v[132:133], v[150:151], v[200:203]
    v_mfma_f32_16x16x16_bf16 v[204:207], v[134:135], v[150:151], v[204:207]
    v_mfma_f32_16x16x16_bf16 v[208:211], v[136:137], v[150:151], v[208:211]
    v_mfma_f32_16x16x16_bf16 v[212:215], v[138:139], v[150:151], v[212:215]
    v_cvt_pk_bf16_f32 v92, v152, v153
    v_cvt_pk_bf16_f32 v93, v154, v155
    v_cvt_pk_bf16_f32 v94, v156, v157
    v_cvt_pk_bf16_f32 v95, v158, v159
    buffer_store_dwordx4 v[92:95], v36, s[12:15], s46 offen offset:0 sc1
    v_cvt_pk_bf16_f32 v96, v160, v161
    v_cvt_pk_bf16_f32 v97, v162, v163
    v_cvt_pk_bf16_f32 v98, v164, v165
    v_cvt_pk_bf16_f32 v99, v166, v167
    buffer_store_dwordx4 v[96:99], v36, s[12:15], s46 offen offset:1024 sc1
    v_cvt_pk_bf16_f32 v100, v168, v169
    v_cvt_pk_bf16_f32 v101, v170, v171
    v_cvt_pk_bf16_f32 v102, v172, v173
    v_cvt_pk_bf16_f32 v103, v174, v175
    buffer_store_dwordx4 v[100:103], v36, s[12:15], s46 offen offset:2048 sc1
    v_cvt_pk_bf16_f32 v104, v176, v177
    v_cvt_pk_bf16_f32 v105, v178, v179
    v_cvt_pk_bf16_f32 v106, v180, v181
    v_cvt_pk_bf16_f32 v107, v182, v183
    buffer_store_dwordx4 v[104:107], v36, s[12:15], s46 offen offset:3072 sc1
    v_cvt_pk_bf16_f32 v108, v184, v185
    v_cvt_pk_bf16_f32 v109, v186, v187
    v_cvt_pk_bf16_f32 v110, v188, v189
    v_cvt_pk_bf16_f32 v111, v190, v191
    buffer_store_dwordx4 v[108:111], v36, s[12:15], s47 offen offset:0 sc1
    v_cvt_pk_bf16_f32 v112, v192, v193
    v_cvt_pk_bf16_f32 v113, v194, v195
    v_cvt_pk_bf16_f32 v114, v196, v197
    v_cvt_pk_bf16_f32 v115, v198, v199
    buffer_store_dwordx4 v[112:115], v36, s[12:15], s47 offen offset:1024 sc1
    v_cvt_pk_bf16_f32 v116, v200, v201
    v_cvt_pk_bf16_f32 v117, v202, v203
    v_cvt_pk_bf16_f32 v118, v204, v205
    v_cvt_pk_bf16_f32 v119, v206, v207
    buffer_store_dwordx4 v[116:119], v36, s[12:15], s47 offen offset:2048 sc1
    v_cvt_pk_bf16_f32 v120, v208, v209
    v_cvt_pk_bf16_f32 v121, v210, v211
    v_cvt_pk_bf16_f32 v122, v212, v213
    v_cvt_pk_bf16_f32 v123, v214, v215
    buffer_store_dwordx4 v[120:123], v36, s[12:15], s47 offen offset:3072 sc1
    s_add_u32 s39, s39, 1
    s_cmp_lt_u32 s39, 64
    s_cbranch_scc1 att_loop
    s_waitcnt vmcnt(0)
    s_max_i32 s45, s45, s39
    v_mov_b32 v32, s45
    s_mov_b64 exec, 1
    ds_write_b32 v38, v32
    s_mov_b64 exec, -1
    ds_read_b128 v[32:35], v39
    ds_read_b32 v140, v39 offset:16
    s_waitcnt lgkmcnt(0)
    v_min3_u32 v32, v32, v33, v34
    v_min_u32 v32, v32, v35
    s_nop 0
    v_readfirstlane_b32 s46, v32
    v_readfirstlane_b32 s41, v140
    s_nop 3
    s_cmp_le_u32 s46, s41
    s_cbranch_scc1 pub_260
    s_mov_b64 exec, 1
    ds_write_b32 v39, v32 offset:16
    s_mov_b64 exec, -1
    v_mov_b32 v11, 1
pub_261:
    s_lshl_b32 s47, s41, 9
    buffer_store_dword v11, v12, s[16:19], s47 offen sc1
    s_add_u32 s41, s41, 1
    s_cmp_lt_u32 s41, s46
    s_cbranch_scc1 pub_261
pub_260:
    s_branch ssp_end
ssp_err:
    v_mov_b32 v3, s44
    v_mov_b32 v2, 1536
    buffer_store_dword v3, v2, s[16:19], 0 offen
ssp_end:
    s_waitcnt vmcnt(0)
    s_endpgm
.section .rodata,"a"
.p2align 6
.amdhsa_kernel mega_kernel
  .amdhsa_next_free_vgpr 512
  .amdhsa_next_free_sgpr 102
  .amdhsa_accum_offset 256
  .amdhsa_group_segment_fixed_size 0
  .amdhsa_kernarg_size 112
  .amdhsa_user_sgpr_count 2
  .amdhsa_user_sgpr_kernarg_segment_ptr 1
  .amdhsa_system_sgpr_workgroup_id_x 1
.end_amdhsa_kernel
```
